```python
import torch

def _softmax(x, axis=-1):
    return torch.softmax(x, dim=axis)

def _gelu(x):
    return torch.nn.functional.gelu(x, approximate='tanh')

def _silu(x):
    return torch.nn.functional.silu(x)

def _sigmoid(x):
    return torch.sigmoid(x)

def _layernorm(x, axis=-1, eps=1e-05):
    m = x.mean(dim=axis, keepdim=True)
    v = x.var(dim=axis, keepdim=True, unbiased=False)
    return (x - m) / torch.sqrt(v + eps)

def _scatter_add(tgt, idx, src, axis=0):
    return tgt.clone().index_add_(axis, idx, src)

def _segment_sum(src, seg, n):
    out = torch.zeros((n,) + src.shape[1:], dtype=src.dtype)
    return out.index_add_(0, seg, src)

def _pad(x, pw):
    flat = tuple((v for pair in reversed(pw) for v in pair))
    return torch.nn.functional.pad(x, flat)
kernel_name = 'interleave_layers__memory_aug_recurrent_mem_tr__sliding_block__prompt'

def setup_inputs():

    _w = lambda a: (lambda t: t.to(torch.bfloat16) if t.is_floating_point() else t)(torch.as_tensor(a))

    def _A_setup():
        B, S, Dm = (1, 2048, 448)
        H, Dh = (16, 256)
        M, seg = (8, 32)
        seg = min(seg, S)
        S = S // seg * seg
        return {'x': _w((lambda *s: torch.randn(*s, dtype=torch.bfloat16) * 0.05)(B, S, Dm)), 'mem0': _w((lambda *s: torch.randn(*s, dtype=torch.bfloat16) * 0.4)(B, M, Dm)), 'Wq': _w((lambda *s: torch.randn(*s, dtype=torch.bfloat16) * 3.2)(Dm, H, Dh) * Dm ** (-0.5)), 'Wk': _w((lambda *s: torch.randn(*s, dtype=torch.bfloat16) * 3.2)(Dm, H, Dh) * Dm ** (-0.5)), 'Wv': _w((lambda *s: torch.randn(*s, dtype=torch.bfloat16) * 0.4)(Dm, H, Dh) * Dm ** (-0.5)), 'Wo': _w((lambda *s: torch.randn(*s, dtype=torch.bfloat16) * 0.4)(H, Dh, Dm) * (H * Dh) ** (-0.5)), 'seg_len': seg}
    _A_in = _A_setup()

    def _B_setup():
        B, S, D = (1, 2048, 448)
        return {'x': _w((lambda *s: torch.randn(*s, dtype=torch.bfloat16) * 0.05)(B, S, D)), 'wqkv': _w((lambda *s: torch.randn(*s, dtype=torch.bfloat16) * 0.05)(D, 3 * D)), 'wo': _w((lambda *s: torch.randn(*s, dtype=torch.bfloat16) * 0.05)(D, D))}
    _B_in = _B_setup()
    return {'A_x': _A_in['x'], 'A_mem0': _A_in['mem0'], 'A_Wq': _A_in['Wq'], 'A_Wk': _A_in['Wk'], 'A_Wv': _A_in['Wv'], 'A_Wo': _A_in['Wo'], 'A_seg_len': _A_in['seg_len'], 'B_x': _B_in['x'], 'B_wqkv': _B_in['wqkv'], 'B_wo': _B_in['wo']}

def reference(A_x, A_mem0, A_Wq, A_Wk, A_Wv, A_Wo, A_seg_len, B_x, B_wqkv, B_wo):

    def _A_ref(x, mem0, Wq, Wk, Wv, Wo, seg_len):
        B, S, Dm = x.shape
        H, Dh = (Wq.shape[1], Wq.shape[2])
        M = mem0.shape[1]
        scale = Dh ** (-0.5)
        n_seg = S // seg_len
        L = M + seg_len
        idx = torch.arange(L)
        mask = (idx[:, None] < M) | (idx[:, None] >= idx[None, :])
        mem = mem0
        outs = []
        for s in range(n_seg):
            xs = x[:, s * seg_len:(s + 1) * seg_len, :].clone()
            h = torch.concatenate([mem, xs], axis=1)
            q = torch.einsum('btd,dhe->bhte', h, Wq)
            k = torch.einsum('btd,dhe->bhte', h, Wk)
            v = torch.einsum('btd,dhe->bhte', h, Wv)
            scores = torch.einsum('bhqe,bhke->bhqk', q, k) * scale
            scores = torch.where(mask[None, None], scores, -1000000000.0)
            p = _softmax(scores, axis=-1)
            o = torch.einsum('bhqk,bhke->bhqe', p, v)
            o = torch.einsum('bhte,hed->btd', o, Wo)
            mem = o[:, :M, :].clone()
            outs.append(o[:, M:, :])
        return torch.concatenate(outs, axis=1)

    def _B_ref(x, wqkv, wo):
        B, S, D = x.shape
        H = 16
        Dh = D // H
        W = 256
        qkv = (lambda x, *d: x.permute(*d))((x @ wqkv).reshape(B, S, 3, H, Dh), 2, 0, 3, 1, 4)
        q, k, v = (qkv[0], qkv[1], qkv[2])
        scores = torch.einsum('bhqd,bhkd->bhqk', q, k) * Dh ** (-0.5)
        idx = torch.arange(S)
        mask = (idx[:, None] - idx[None, :] >= 0) & (idx[:, None] - idx[None, :] < W)
        scores = torch.where(mask[None, None], scores, -1000000000.0)
        p = _softmax(scores, axis=-1)
        o = torch.einsum('bhqk,bhkd->bhqd', p, v)
        return (lambda x, *d: x.permute(*d))(o, 0, 2, 1, 3).reshape(B, S, D) @ wo
    x = A_x
    x = x + _A_ref(_layernorm(x, axis=-1), A_mem0, A_Wq, A_Wk, A_Wv, A_Wo, A_seg_len)
    x = x + _B_ref(_layernorm(x, axis=-1), B_wqkv, B_wo)
    x = x + _A_ref(_layernorm(x, axis=-1), A_mem0, A_Wq, A_Wk, A_Wv, A_Wo, A_seg_len)
    x = x + _B_ref(_layernorm(x, axis=-1), B_wqkv, B_wo)
    return x
```

```asm
; @launch grid=(256,1,1) block=(256,1,1) lds=163840
.amdgcn_target "amdgcn-amd-amdhsa--gfx950"
.text
.globl interleave_layers__memory_aug_recurrent_mem_tr__sliding_block__prompt_kernel
.p2align 8
.type interleave_layers__memory_aug_recurrent_mem_tr__sliding_block__prompt_kernel,@function
interleave_layers__memory_aug_recurrent_mem_tr__sliding_block__prompt_kernel:
    s_cmp_ge_u32 s2, 256
    s_cbranch_scc1 L_end
    s_mov_b64 s[34:35], s[0:1]
    s_load_dwordx2 s[36:37], s[0:1], 88
    s_load_dwordx2 s[4:5], s[0:1], 96
    s_getreg_b32 s3, hwreg(HW_REG_XCC_ID)
    s_and_b32 s3, s3, 7
    v_lshrrev_b32 v1, 6, v0
    s_nop 0
    v_readfirstlane_b32 s15, v1
    s_waitcnt lgkmcnt(0)
    s_mov_b32 s6, 268435456
    s_mov_b32 s7, 0x00020000
    s_mov_b32 s92, s2
    s_mov_b32 s16, 0
    v_mov_b32 v200, 0
    s_cmp_lg_u32 s15, 0
    s_cbranch_scc1 L_tk
    s_lshl_b32 s16, s3, 2
    v_mov_b32 v201, s16
    v_mov_b32 v202, 1
    s_mov_b64 exec, 1
    global_atomic_add v200, v201, v202, s[36:37] sc0 sc1
    s_mov_b64 exec, -1
L_tk:
    s_and_b32 s18, s2, 7
    s_lshr_b32 s19, s2, 3
    s_cmp_eq_u32 s18, 0
    s_cbranch_scc1 P_misc
    s_sub_u32 s18, s18, 1
    s_lshl_b32 s18, s18, 5
    s_add_u32 s18, s18, s19
    s_mul_i32 s20, s18, 9363
    s_lshr_b32 s20, s20, 16
    s_mul_i32 s21, s20, 7
    s_sub_u32 s42, s18, s21
    s_and_b32 s41, s20, 15
    s_lshr_b32 s40, s20, 4
    s_xor_b32 s40, s40, 1
    s_lshl_b32 s58, s40, 4
    s_add_u32 s58, s58, s41
    v_and_b32 v2, 63, v0
    v_and_b32 v3, 15, v2
    v_lshrrev_b32 v4, 4, v2
    v_lshrrev_b32 v5, 5, v2
    v_and_b32 v6, 31, v2
    v_add_u32 v7, 0, v5
    v_lshlrev_b32 v7, 2, v7
    v_xor_b32 v7, v7, v6
    v_lshlrev_b32 v7, 4, v7
    v_lshl_add_u32 v20, v5, 13, v7
    v_add_u32 v7, 2, v5
    v_lshlrev_b32 v7, 2, v7
    v_xor_b32 v7, v7, v6
    v_lshlrev_b32 v7, 4, v7
    v_lshl_add_u32 v21, v5, 13, v7
    v_add_u32 v7, 4, v5
    v_lshlrev_b32 v7, 2, v7
    v_xor_b32 v7, v7, v6
    v_lshlrev_b32 v7, 4, v7
    v_lshl_add_u32 v22, v5, 13, v7
    v_add_u32 v7, 6, v5
    v_lshlrev_b32 v7, 2, v7
    v_xor_b32 v7, v7, v6
    v_lshlrev_b32 v7, 4, v7
    v_lshl_add_u32 v23, v5, 13, v7
    v_lshrrev_b32 v5, 2, v3
    v_and_b32 v6, 3, v3
    v_and_b32 v7, 1, v5
    v_lshl_add_u32 v7, v7, 2, v6
    v_lshl_add_u32 v5, v5, 3, v6
    v_lshlrev_b32 v5, 9, v5
    v_lshl_add_u32 v5, v4, 4, v5
    s_lshl_b32 s18, s15, 15
    s_add_u32 s54, s18, 32768
    v_add_u32 v5, s54, v5
    v_xor_b32 v6, 0, v7
    v_lshl_add_u32 v24, v6, 6, v5
    v_xor_b32 v6, 1, v7
    v_lshl_add_u32 v25, v6, 6, v5
    v_xor_b32 v6, 2, v7
    v_lshl_add_u32 v26, v6, 6, v5
    v_xor_b32 v6, 3, v7
    v_lshl_add_u32 v27, v6, 6, v5
    v_xor_b32 v6, 4, v7
    v_lshl_add_u32 v28, v6, 6, v5
    v_xor_b32 v6, 5, v7
    v_lshl_add_u32 v29, v6, 6, v5
    v_xor_b32 v6, 6, v7
    v_lshl_add_u32 v30, v6, 6, v5
    v_xor_b32 v6, 7, v7
    v_lshl_add_u32 v31, v6, 6, v5
    v_lshlrev_b32 v9, 4, v2
    s_cmp_eq_u32 s40, 1
    s_cbranch_scc1 P_isB_1
    s_load_dwordx2 s[44:45], s[34:35], 16
    s_waitcnt lgkmcnt(0)
    s_mov_b32 s46, 3670016
    s_mov_b32 s47, 0x00020000
    s_load_dwordx2 s[48:49], s[34:35], 24
    s_waitcnt lgkmcnt(0)
    s_mov_b32 s50, 3670016
    s_mov_b32 s51, 0x00020000
    s_lshl_b32 s18, s42, 2
    s_add_u32 s18, s18, s15
    s_mul_i32 s19, s18, 9363
    s_lshr_b32 s19, s19, 16
    s_mul_i32 s20, s19, 7
    s_sub_u32 s20, s18, s20
    s_mul_i32 s21, s19, 112
    s_lshr_b32 s22, s20, 1
    s_lshl_b32 s22, s22, 5
    s_and_b32 s23, s20, 1
    s_lshl_b32 s23, s23, 2
    s_add_u32 s22, s22, s23
    s_add_u32 s22, s22, s21
    s_add_u32 s21, s21, 96
    v_lshrrev_b32 v5, 2, v3
    v_lshlrev_b32 v5, 3, v5
    v_and_b32 v6, 3, v3
    v_add_u32 v5, v5, v6
    v_add_u32 v5, s22, v5
    v_add_u32 v6, s21, v3
    s_cmp_eq_u32 s20, 6
    s_cselect_b64 vcc, -1, 0
    v_cndmask_b32 v5, v5, v6, vcc
    v_lshlrev_b32 v5, 13, v5
    v_lshl_add_u32 v12, v4, 4, v5
    s_lshl_b32 s18, s41, 9
    s_lshl_b32 s19, s15, 13
    s_mov_b32 m0, s19
    s_nop 0
    buffer_load_dwordx4 v12, s[48:51], s18 offen lds
    s_add_u32 s18, s18, 64
    s_add_u32 s19, s19, 1024
    s_mov_b32 m0, s19
    s_nop 0
    buffer_load_dwordx4 v12, s[48:51], s18 offen lds
    s_add_u32 s18, s18, 64
    s_add_u32 s19, s19, 1024
    s_mov_b32 m0, s19
    s_nop 0
    buffer_load_dwordx4 v12, s[48:51], s18 offen lds
    s_add_u32 s18, s18, 64
    s_add_u32 s19, s19, 1024
    s_mov_b32 m0, s19
    s_nop 0
    buffer_load_dwordx4 v12, s[48:51], s18 offen lds
    s_add_u32 s18, s18, 64
    s_add_u32 s19, s19, 1024
    s_mov_b32 m0, s19
    s_nop 0
    buffer_load_dwordx4 v12, s[48:51], s18 offen lds
    s_add_u32 s18, s18, 64
    s_add_u32 s19, s19, 1024
    s_mov_b32 m0, s19
    s_nop 0
    buffer_load_dwordx4 v12, s[48:51], s18 offen lds
    s_add_u32 s18, s18, 64
    s_add_u32 s19, s19, 1024
    s_mov_b32 m0, s19
    s_nop 0
    buffer_load_dwordx4 v12, s[48:51], s18 offen lds
    s_add_u32 s18, s18, 64
    s_add_u32 s19, s19, 1024
    s_mov_b32 m0, s19
    s_nop 0
    buffer_load_dwordx4 v12, s[48:51], s18 offen lds
    v_lshrrev_b32 v5, 5, v2
    v_lshlrev_b32 v5, 13, v5
    v_and_b32 v6, 31, v2
    v_lshl_add_u32 v5, v6, 4, v5
    s_lshl_b32 s18, s42, 6
    s_lshl_b32 s19, s15, 4
    s_add_u32 s18, s18, s19
    s_lshl_b32 s18, s18, 13
    s_lshl_b32 s19, s41, 9
    s_add_u32 s18, s18, s19
    buffer_load_dwordx4 v[16:19], v5, s[44:47], s18 offen
    s_add_u32 s18, s18, 16384
    buffer_load_dwordx4 v[16:19], v5, s[44:47], s18 offen
    s_add_u32 s18, s18, 16384
    buffer_load_dwordx4 v[16:19], v5, s[44:47], s18 offen
    s_add_u32 s18, s18, 16384
    buffer_load_dwordx4 v[16:19], v5, s[44:47], s18 offen
    s_add_u32 s18, s18, 16384
    buffer_load_dwordx4 v[16:19], v5, s[44:47], s18 offen
    s_add_u32 s18, s18, 16384
    buffer_load_dwordx4 v[16:19], v5, s[44:47], s18 offen
    s_add_u32 s18, s18, 16384
    buffer_load_dwordx4 v[16:19], v5, s[44:47], s18 offen
    s_add_u32 s18, s18, 16384
    buffer_load_dwordx4 v[16:19], v5, s[44:47], s18 offen
    s_mov_b32 s53, s15
    s_mul_i32 s18, s53, 262144
    s_lshl_b32 s19, s41, 9
    s_add_u32 s18, s18, s19
    s_add_u32 s19, s54, 0
    s_mov_b32 m0, s19
    s_nop 0
    buffer_load_dwordx4 v20, s[44:47], s18 offen lds
    s_add_u32 s18, s18, 16384
    s_add_u32 s19, s19, 1024
    s_mov_b32 m0, s19
    s_nop 0
    buffer_load_dwordx4 v21, s[44:47], s18 offen lds
    s_add_u32 s18, s18, 16384
    s_add_u32 s19, s19, 1024
    s_mov_b32 m0, s19
    s_nop 0
    buffer_load_dwordx4 v20, s[44:47], s18 offen lds
    s_add_u32 s18, s18, 16384
    s_add_u32 s19, s19, 1024
    s_mov_b32 m0, s19
    s_nop 0
    buffer_load_dwordx4 v21, s[44:47], s18 offen lds
    s_add_u32 s18, s18, 16384
    s_add_u32 s19, s19, 1024
    s_mov_b32 m0, s19
    s_nop 0
    buffer_load_dwordx4 v22, s[44:47], s18 offen lds
    s_add_u32 s18, s18, 16384
    s_add_u32 s19, s19, 1024
    s_mov_b32 m0, s19
    s_nop 0
    buffer_load_dwordx4 v23, s[44:47], s18 offen lds
    s_add_u32 s18, s18, 16384
    s_add_u32 s19, s19, 1024
    s_mov_b32 m0, s19
    s_nop 0
    buffer_load_dwordx4 v22, s[44:47], s18 offen lds
    s_add_u32 s18, s18, 16384
    s_add_u32 s19, s19, 1024
    s_mov_b32 m0, s19
    s_nop 0
    buffer_load_dwordx4 v23, s[44:47], s18 offen lds
    s_add_u32 s18, s18, 16384
    s_add_u32 s19, s19, 1024
    s_mov_b32 m0, s19
    s_nop 0
    buffer_load_dwordx4 v20, s[44:47], s18 offen lds
    s_add_u32 s18, s18, 16384
    s_add_u32 s19, s19, 1024
    s_mov_b32 m0, s19
    s_nop 0
    buffer_load_dwordx4 v21, s[44:47], s18 offen lds
    s_add_u32 s18, s18, 16384
    s_add_u32 s19, s19, 1024
    s_mov_b32 m0, s19
    s_nop 0
    buffer_load_dwordx4 v20, s[44:47], s18 offen lds
    s_add_u32 s18, s18, 16384
    s_add_u32 s19, s19, 1024
    s_mov_b32 m0, s19
    s_nop 0
    buffer_load_dwordx4 v21, s[44:47], s18 offen lds
    s_add_u32 s18, s18, 16384
    s_add_u32 s19, s19, 1024
    s_mov_b32 m0, s19
    s_nop 0
    buffer_load_dwordx4 v22, s[44:47], s18 offen lds
    s_add_u32 s18, s18, 16384
    s_add_u32 s19, s19, 1024
    s_mov_b32 m0, s19
    s_nop 0
    buffer_load_dwordx4 v23, s[44:47], s18 offen lds
    s_add_u32 s18, s18, 16384
    s_add_u32 s19, s19, 1024
    s_mov_b32 m0, s19
    s_nop 0
    buffer_load_dwordx4 v22, s[44:47], s18 offen lds
    s_add_u32 s18, s18, 16384
    s_add_u32 s19, s19, 1024
    s_mov_b32 m0, s19
    s_nop 0
    buffer_load_dwordx4 v23, s[44:47], s18 offen lds
    s_waitcnt vmcnt(24)
    s_barrier
    v_lshlrev_b32 v5, 4, v2
    ds_read_b128 v[64:67], v5 offset:0
    ds_read_b128 v[68:71], v5 offset:1024
    ds_read_b128 v[72:75], v5 offset:2048
    ds_read_b128 v[76:79], v5 offset:3072
    ds_read_b128 v[80:83], v5 offset:4096
    ds_read_b128 v[84:87], v5 offset:5120
    ds_read_b128 v[88:91], v5 offset:6144
    ds_read_b128 v[92:95], v5 offset:7168
    s_waitcnt lgkmcnt(0)
    ds_read_b128 v[96:99], v5 offset:8192
    ds_read_b128 v[100:103], v5 offset:9216
    ds_read_b128 v[104:107], v5 offset:10240
    ds_read_b128 v[108:111], v5 offset:11264
    ds_read_b128 v[112:115], v5 offset:12288
    ds_read_b128 v[116:119], v5 offset:13312
    ds_read_b128 v[120:123], v5 offset:14336
    ds_read_b128 v[124:127], v5 offset:15360
    s_waitcnt lgkmcnt(0)
    ds_read_b128 v[128:131], v5 offset:16384
    ds_read_b128 v[132:135], v5 offset:17408
    ds_read_b128 v[136:139], v5 offset:18432
    ds_read_b128 v[140:143], v5 offset:19456
    ds_read_b128 v[144:147], v5 offset:20480
    ds_read_b128 v[148:151], v5 offset:21504
    ds_read_b128 v[152:155], v5 offset:22528
    ds_read_b128 v[156:159], v5 offset:23552
    s_waitcnt lgkmcnt(0)
    ds_read_b128 v[160:163], v5 offset:24576
    ds_read_b128 v[164:167], v5 offset:25600
    ds_read_b128 v[168:171], v5 offset:26624
    ds_read_b128 v[172:175], v5 offset:27648
    ds_read_b128 v[176:179], v5 offset:28672
    ds_read_b128 v[180:183], v5 offset:29696
    ds_read_b128 v[184:187], v5 offset:30720
    ds_read_b128 v[188:191], v5 offset:31744
    s_waitcnt lgkmcnt(0)
    s_branch P_j_2
P_isB_1:
    s_load_dwordx2 s[44:45], s[34:35], 32
    s_waitcnt lgkmcnt(0)
    s_mov_b32 s46, 3670016
    s_mov_b32 s47, 0x00020000
    s_load_dwordx2 s[48:49], s[34:35], 40
    s_waitcnt lgkmcnt(0)
    s_mov_b32 s50, 3670016
    s_mov_b32 s51, 0x00020000
    v_lshrrev_b32 v5, 3, v2
    v_mul_u32_u24 v5, 896, v5
    v_and_b32 v6, 7, v2
    v_lshl_add_u32 v5, v6, 4, v5
    s_mul_i32 s18, s41, 229376
    s_lshl_b32 s19, s42, 7
    s_add_u32 s18, s18, s19
    s_mul_i32 s19, s15, 57344
    s_add_u32 s18, s18, s19
    s_lshl_b32 s19, s15, 13
    s_mov_b32 m0, s19
    s_nop 0
    buffer_load_dwordx4 v5, s[48:51], s18 offen lds
    s_add_u32 s18, s18, 7168
    s_add_u32 s19, s19, 1024
    s_mov_b32 m0, s19
    s_nop 0
    buffer_load_dwordx4 v5, s[48:51], s18 offen lds
    s_add_u32 s18, s18, 7168
    s_add_u32 s19, s19, 1024
    s_mov_b32 m0, s19
    s_nop 0
    buffer_load_dwordx4 v5, s[48:51], s18 offen lds
    s_add_u32 s18, s18, 7168
    s_add_u32 s19, s19, 1024
    s_mov_b32 m0, s19
    s_nop 0
    buffer_load_dwordx4 v5, s[48:51], s18 offen lds
    s_add_u32 s18, s18, 7168
    s_add_u32 s19, s19, 1024
    s_mov_b32 m0, s19
    s_nop 0
    buffer_load_dwordx4 v5, s[48:51], s18 offen lds
    s_add_u32 s18, s18, 7168
    s_add_u32 s19, s19, 1024
    s_mov_b32 m0, s19
    s_nop 0
    buffer_load_dwordx4 v5, s[48:51], s18 offen lds
    s_add_u32 s18, s18, 7168
    s_add_u32 s19, s19, 1024
    s_mov_b32 m0, s19
    s_nop 0
    buffer_load_dwordx4 v5, s[48:51], s18 offen lds
    s_add_u32 s18, s18, 7168
    s_add_u32 s19, s19, 1024
    s_mov_b32 m0, s19
    s_nop 0
    buffer_load_dwordx4 v5, s[48:51], s18 offen lds
    v_lshrrev_b32 v5, 5, v2
    v_lshlrev_b32 v5, 13, v5
    v_and_b32 v6, 31, v2
    v_lshl_add_u32 v5, v6, 4, v5
    s_lshl_b32 s18, s42, 6
    s_lshl_b32 s19, s15, 4
    s_add_u32 s18, s18, s19
    s_lshl_b32 s18, s18, 13
    s_lshl_b32 s19, s41, 9
    s_add_u32 s18, s18, s19
    buffer_load_dwordx4 v[16:19], v5, s[44:47], s18 offen
    s_add_u32 s18, s18, 16384
    buffer_load_dwordx4 v[16:19], v5, s[44:47], s18 offen
    s_add_u32 s18, s18, 16384
    buffer_load_dwordx4 v[16:19], v5, s[44:47], s18 offen
    s_add_u32 s18, s18, 16384
    buffer_load_dwordx4 v[16:19], v5, s[44:47], s18 offen
    s_add_u32 s18, s18, 16384
    buffer_load_dwordx4 v[16:19], v5, s[44:47], s18 offen
    s_add_u32 s18, s18, 16384
    buffer_load_dwordx4 v[16:19], v5, s[44:47], s18 offen
    s_add_u32 s18, s18, 16384
    buffer_load_dwordx4 v[16:19], v5, s[44:47], s18 offen
    s_add_u32 s18, s18, 16384
    buffer_load_dwordx4 v[16:19], v5, s[44:47], s18 offen
    s_mov_b32 s53, s15
    s_mul_i32 s18, s53, 262144
    s_lshl_b32 s19, s41, 9
    s_add_u32 s18, s18, s19
    s_add_u32 s19, s54, 0
    s_mov_b32 m0, s19
    s_nop 0
    buffer_load_dwordx4 v20, s[44:47], s18 offen lds
    s_add_u32 s18, s18, 16384
    s_add_u32 s19, s19, 1024
    s_mov_b32 m0, s19
    s_nop 0
    buffer_load_dwordx4 v21, s[44:47], s18 offen lds
    s_add_u32 s18, s18, 16384
    s_add_u32 s19, s19, 1024
    s_mov_b32 m0, s19
    s_nop 0
    buffer_load_dwordx4 v20, s[44:47], s18 offen lds
    s_add_u32 s18, s18, 16384
    s_add_u32 s19, s19, 1024
    s_mov_b32 m0, s19
    s_nop 0
    buffer_load_dwordx4 v21, s[44:47], s18 offen lds
    s_add_u32 s18, s18, 16384
    s_add_u32 s19, s19, 1024
    s_mov_b32 m0, s19
    s_nop 0
    buffer_load_dwordx4 v22, s[44:47], s18 offen lds
    s_add_u32 s18, s18, 16384
    s_add_u32 s19, s19, 1024
    s_mov_b32 m0, s19
    s_nop 0
    buffer_load_dwordx4 v23, s[44:47], s18 offen lds
    s_add_u32 s18, s18, 16384
    s_add_u32 s19, s19, 1024
    s_mov_b32 m0, s19
    s_nop 0
    buffer_load_dwordx4 v22, s[44:47], s18 offen lds
    s_add_u32 s18, s18, 16384
    s_add_u32 s19, s19, 1024
    s_mov_b32 m0, s19
    s_nop 0
    buffer_load_dwordx4 v23, s[44:47], s18 offen lds
    s_add_u32 s18, s18, 16384
    s_add_u32 s19, s19, 1024
    s_mov_b32 m0, s19
    s_nop 0
    buffer_load_dwordx4 v20, s[44:47], s18 offen lds
    s_add_u32 s18, s18, 16384
    s_add_u32 s19, s19, 1024
    s_mov_b32 m0, s19
    s_nop 0
    buffer_load_dwordx4 v21, s[44:47], s18 offen lds
    s_add_u32 s18, s18, 16384
    s_add_u32 s19, s19, 1024
    s_mov_b32 m0, s19
    s_nop 0
    buffer_load_dwordx4 v20, s[44:47], s18 offen lds
    s_add_u32 s18, s18, 16384
    s_add_u32 s19, s19, 1024
    s_mov_b32 m0, s19
    s_nop 0
    buffer_load_dwordx4 v21, s[44:47], s18 offen lds
    s_add_u32 s18, s18, 16384
    s_add_u32 s19, s19, 1024
    s_mov_b32 m0, s19
    s_nop 0
    buffer_load_dwordx4 v22, s[44:47], s18 offen lds
    s_add_u32 s18, s18, 16384
    s_add_u32 s19, s19, 1024
    s_mov_b32 m0, s19
    s_nop 0
    buffer_load_dwordx4 v23, s[44:47], s18 offen lds
    s_add_u32 s18, s18, 16384
    s_add_u32 s19, s19, 1024
    s_mov_b32 m0, s19
    s_nop 0
    buffer_load_dwordx4 v22, s[44:47], s18 offen lds
    s_add_u32 s18, s18, 16384
    s_add_u32 s19, s19, 1024
    s_mov_b32 m0, s19
    s_nop 0
    buffer_load_dwordx4 v23, s[44:47], s18 offen lds
    s_waitcnt vmcnt(24)
    s_barrier
    v_lshrrev_b32 v5, 2, v3
    v_lshl_add_u32 v5, v4, 3, v5
    v_lshlrev_b32 v5, 7, v5
    v_and_b32 v6, 3, v3
    v_lshl_add_u32 v5, v6, 3, v5
    ds_read_b64_tr_b16 v[64:65], v5 offset:0
    ds_read_b64_tr_b16 v[66:67], v5 offset:512
    ds_read_b64_tr_b16 v[68:69], v5 offset:4096
    ds_read_b64_tr_b16 v[70:71], v5 offset:4608
    ds_read_b64_tr_b16 v[72:73], v5 offset:8192
    ds_read_b64_tr_b16 v[74:75], v5 offset:8704
    ds_read_b64_tr_b16 v[76:77], v5 offset:12288
    ds_read_b64_tr_b16 v[78:79], v5 offset:12800
    ds_read_b64_tr_b16 v[80:81], v5 offset:16384
    ds_read_b64_tr_b16 v[82:83], v5 offset:16896
    ds_read_b64_tr_b16 v[84:85], v5 offset:20480
    ds_read_b64_tr_b16 v[86:87], v5 offset:20992
    ds_read_b64_tr_b16 v[88:89], v5 offset:24576
    ds_read_b64_tr_b16 v[90:91], v5 offset:25088
    ds_read_b64_tr_b16 v[92:93], v5 offset:28672
    ds_read_b64_tr_b16 v[94:95], v5 offset:29184
    s_waitcnt lgkmcnt(0)
    ds_read_b64_tr_b16 v[96:97], v5 offset:32
    ds_read_b64_tr_b16 v[98:99], v5 offset:544
    ds_read_b64_tr_b16 v[100:101], v5 offset:4128
    ds_read_b64_tr_b16 v[102:103], v5 offset:4640
    ds_read_b64_tr_b16 v[104:105], v5 offset:8224
    ds_read_b64_tr_b16 v[106:107], v5 offset:8736
    ds_read_b64_tr_b16 v[108:109], v5 offset:12320
    ds_read_b64_tr_b16 v[110:111], v5 offset:12832
    ds_read_b64_tr_b16 v[112:113], v5 offset:16416
    ds_read_b64_tr_b16 v[114:115], v5 offset:16928
    ds_read_b64_tr_b16 v[116:117], v5 offset:20512
    ds_read_b64_tr_b16 v[118:119], v5 offset:21024
    ds_read_b64_tr_b16 v[120:121], v5 offset:24608
    ds_read_b64_tr_b16 v[122:123], v5 offset:25120
    ds_read_b64_tr_b16 v[124:125], v5 offset:28704
    ds_read_b64_tr_b16 v[126:127], v5 offset:29216
    s_waitcnt lgkmcnt(0)
    ds_read_b64_tr_b16 v[128:129], v5 offset:64
    ds_read_b64_tr_b16 v[130:131], v5 offset:576
    ds_read_b64_tr_b16 v[132:133], v5 offset:4160
    ds_read_b64_tr_b16 v[134:135], v5 offset:4672
    ds_read_b64_tr_b16 v[136:137], v5 offset:8256
    ds_read_b64_tr_b16 v[138:139], v5 offset:8768
    ds_read_b64_tr_b16 v[140:141], v5 offset:12352
    ds_read_b64_tr_b16 v[142:143], v5 offset:12864
    ds_read_b64_tr_b16 v[144:145], v5 offset:16448
    ds_read_b64_tr_b16 v[146:147], v5 offset:16960
    ds_read_b64_tr_b16 v[148:149], v5 offset:20544
    ds_read_b64_tr_b16 v[150:151], v5 offset:21056
    ds_read_b64_tr_b16 v[152:153], v5 offset:24640
    ds_read_b64_tr_b16 v[154:155], v5 offset:25152
    ds_read_b64_tr_b16 v[156:157], v5 offset:28736
    ds_read_b64_tr_b16 v[158:159], v5 offset:29248
    s_waitcnt lgkmcnt(0)
    ds_read_b64_tr_b16 v[160:161], v5 offset:96
    ds_read_b64_tr_b16 v[162:163], v5 offset:608
    ds_read_b64_tr_b16 v[164:165], v5 offset:4192
    ds_read_b64_tr_b16 v[166:167], v5 offset:4704
    ds_read_b64_tr_b16 v[168:169], v5 offset:8288
    ds_read_b64_tr_b16 v[170:171], v5 offset:8800
    ds_read_b64_tr_b16 v[172:173], v5 offset:12384
    ds_read_b64_tr_b16 v[174:175], v5 offset:12896
    ds_read_b64_tr_b16 v[176:177], v5 offset:16480
    ds_read_b64_tr_b16 v[178:179], v5 offset:16992
    ds_read_b64_tr_b16 v[180:181], v5 offset:20576
    ds_read_b64_tr_b16 v[182:183], v5 offset:21088
    ds_read_b64_tr_b16 v[184:185], v5 offset:24672
    ds_read_b64_tr_b16 v[186:187], v5 offset:25184
    ds_read_b64_tr_b16 v[188:189], v5 offset:28768
    ds_read_b64_tr_b16 v[190:191], v5 offset:29280
    s_waitcnt lgkmcnt(0)
P_j_2:
    s_cmp_eq_u32 s40, 0
    s_mov_b32 s52, 6422528
    s_cselect_b32 s52, 0, s52
    s_mul_i32 s18, s41, 401408
    s_add_u32 s52, s52, s18
    s_mul_i32 s18, s42, 57344
    s_add_u32 s52, s52, s18
    s_lshl_b32 s18, s42, 6
    s_add_u32 s18, s18, 0
    v_add_u32 v12, s18, v3
    s_mov_b32 s18, 2341
    v_mul_u32_u24 v13, s18, v12
    v_lshrrev_b32 v13, 16, v13
    v_mul_u32_u24 v14, 28, v13
    v_sub_u32 v14, v12, v14
    s_mul_i32 s18, s41, 28
    v_add_u32 v14, s18, v14
    s_mov_b32 s18, 401408
    v_mul_lo_u32 v192, v13, s18
    v_lshrrev_b32 v15, 4, v14
    v_mul_u32_u24 v15, 14336, v15
    v_add_u32 v192, v192, v15
    v_and_b32 v15, 15, v14
    v_lshl_add_u32 v15, v4, 4, v15
    v_lshl_add_u32 v192, v15, 4, v192
    s_lshl_b32 s18, s42, 6
    s_add_u32 s18, s18, 16
    v_add_u32 v12, s18, v3
    s_mov_b32 s18, 2341
    v_mul_u32_u24 v13, s18, v12
    v_lshrrev_b32 v13, 16, v13
    v_mul_u32_u24 v14, 28, v13
    v_sub_u32 v14, v12, v14
    s_mul_i32 s18, s41, 28
    v_add_u32 v14, s18, v14
    s_mov_b32 s18, 401408
    v_mul_lo_u32 v193, v13, s18
    v_lshrrev_b32 v15, 4, v14
    v_mul_u32_u24 v15, 14336, v15
    v_add_u32 v193, v193, v15
    v_and_b32 v15, 15, v14
    v_lshl_add_u32 v15, v4, 4, v15
    v_lshl_add_u32 v193, v15, 4, v193
    s_lshl_b32 s18, s42, 6
    s_add_u32 s18, s18, 32
    v_add_u32 v12, s18, v3
    s_mov_b32 s18, 2341
    v_mul_u32_u24 v13, s18, v12
    v_lshrrev_b32 v13, 16, v13
    v_mul_u32_u24 v14, 28, v13
    v_sub_u32 v14, v12, v14
    s_mul_i32 s18, s41, 28
    v_add_u32 v14, s18, v14
    s_mov_b32 s18, 401408
    v_mul_lo_u32 v194, v13, s18
    v_lshrrev_b32 v15, 4, v14
    v_mul_u32_u24 v15, 14336, v15
    v_add_u32 v194, v194, v15
    v_and_b32 v15, 15, v14
    v_lshl_add_u32 v15, v4, 4, v15
    v_lshl_add_u32 v194, v15, 4, v194
    s_lshl_b32 s18, s42, 6
    s_add_u32 s18, s18, 48
    v_add_u32 v12, s18, v3
    s_mov_b32 s18, 2341
    v_mul_u32_u24 v13, s18, v12
    v_lshrrev_b32 v13, 16, v13
    v_mul_u32_u24 v14, 28, v13
    v_sub_u32 v14, v12, v14
    s_mul_i32 s18, s41, 28
    v_add_u32 v14, s18, v14
    s_mov_b32 s18, 401408
    v_mul_lo_u32 v195, v13, s18
    v_lshrrev_b32 v15, 4, v14
    v_mul_u32_u24 v15, 14336, v15
    v_add_u32 v195, v195, v15
    v_and_b32 v15, 15, v14
    v_lshl_add_u32 v15, v4, 4, v15
    v_lshl_add_u32 v195, v15, 4, v195
    s_add_u32 s24, s53, 4
    s_min_u32 s24, s24, 13
    s_mul_i32 s18, s24, 262144
    s_lshl_b32 s19, s41, 9
    s_add_u32 s18, s18, s19
    s_add_u32 s19, s54, 16384
    s_mov_b32 m0, s19
    s_nop 0
    buffer_load_dwordx4 v20, s[44:47], s18 offen lds
    s_add_u32 s18, s18, 16384
    s_add_u32 s19, s19, 1024
    s_mov_b32 m0, s19
    s_nop 0
    buffer_load_dwordx4 v21, s[44:47], s18 offen lds
    s_add_u32 s18, s18, 16384
    s_add_u32 s19, s19, 1024
    s_mov_b32 m0, s19
    s_nop 0
    buffer_load_dwordx4 v20, s[44:47], s18 offen lds
    s_add_u32 s18, s18, 16384
    s_add_u32 s19, s19, 1024
    s_mov_b32 m0, s19
    s_nop 0
    buffer_load_dwordx4 v21, s[44:47], s18 offen lds
    s_add_u32 s18, s18, 16384
    s_add_u32 s19, s19, 1024
    s_mov_b32 m0, s19
    s_nop 0
    buffer_load_dwordx4 v22, s[44:47], s18 offen lds
    s_add_u32 s18, s18, 16384
    s_add_u32 s19, s19, 1024
    s_mov_b32 m0, s19
    s_nop 0
    buffer_load_dwordx4 v23, s[44:47], s18 offen lds
    s_add_u32 s18, s18, 16384
    s_add_u32 s19, s19, 1024
    s_mov_b32 m0, s19
    s_nop 0
    buffer_load_dwordx4 v22, s[44:47], s18 offen lds
    s_add_u32 s18, s18, 16384
    s_add_u32 s19, s19, 1024
    s_mov_b32 m0, s19
    s_nop 0
    buffer_load_dwordx4 v23, s[44:47], s18 offen lds
    s_add_u32 s18, s18, 16384
    s_add_u32 s19, s19, 1024
    s_mov_b32 m0, s19
    s_nop 0
    buffer_load_dwordx4 v20, s[44:47], s18 offen lds
    s_add_u32 s18, s18, 16384
    s_add_u32 s19, s19, 1024
    s_mov_b32 m0, s19
    s_nop 0
    buffer_load_dwordx4 v21, s[44:47], s18 offen lds
    s_add_u32 s18, s18, 16384
    s_add_u32 s19, s19, 1024
    s_mov_b32 m0, s19
    s_nop 0
    buffer_load_dwordx4 v20, s[44:47], s18 offen lds
    s_add_u32 s18, s18, 16384
    s_add_u32 s19, s19, 1024
    s_mov_b32 m0, s19
    s_nop 0
    buffer_load_dwordx4 v21, s[44:47], s18 offen lds
    s_add_u32 s18, s18, 16384
    s_add_u32 s19, s19, 1024
    s_mov_b32 m0, s19
    s_nop 0
    buffer_load_dwordx4 v22, s[44:47], s18 offen lds
    s_add_u32 s18, s18, 16384
    s_add_u32 s19, s19, 1024
    s_mov_b32 m0, s19
    s_nop 0
    buffer_load_dwordx4 v23, s[44:47], s18 offen lds
    s_add_u32 s18, s18, 16384
    s_add_u32 s19, s19, 1024
    s_mov_b32 m0, s19
    s_nop 0
    buffer_load_dwordx4 v22, s[44:47], s18 offen lds
    s_add_u32 s18, s18, 16384
    s_add_u32 s19, s19, 1024
    s_mov_b32 m0, s19
    s_nop 0
    buffer_load_dwordx4 v23, s[44:47], s18 offen lds
    s_waitcnt vmcnt(16)
    s_mov_b32 s16, 2
    ds_read_b128 a[0:3], v24 offset:0
    ds_read_b128 a[4:7], v25 offset:0
    ds_read_b128 a[8:11], v26 offset:0
    ds_read_b128 a[12:15], v27 offset:0
    ds_read_b128 a[16:19], v28 offset:0
    ds_read_b128 a[20:23], v29 offset:0
    ds_read_b128 a[24:27], v30 offset:0
    ds_read_b128 a[28:31], v31 offset:0
    ds_read_b128 a[32:35], v24 offset:2048
    ds_read_b128 a[36:39], v25 offset:2048
    ds_read_b128 a[40:43], v26 offset:2048
    ds_read_b128 a[44:47], v27 offset:2048
    ds_read_b128 a[48:51], v28 offset:2048
    ds_read_b128 a[52:55], v29 offset:2048
    ds_read_b128 a[56:59], v30 offset:2048
    ds_read_b128 a[60:63], v31 offset:2048
    s_waitcnt lgkmcnt(0)
    v_mfma_f32_16x16x32_bf16 v[32:35], a[0:3], v[64:67], 0
    v_mfma_f32_16x16x32_bf16 v[36:39], a[32:35], v[64:67], 0
    v_mfma_f32_16x16x32_bf16 v[40:43], a[0:3], v[96:99], 0
    v_mfma_f32_16x16x32_bf16 v[44:47], a[32:35], v[96:99], 0
    v_mfma_f32_16x16x32_bf16 v[48:51], a[0:3], v[128:131], 0
    v_mfma_f32_16x16x32_bf16 v[52:55], a[32:35], v[128:131], 0
    v_mfma_f32_16x16x32_bf16 v[56:59], a[0:3], v[160:163], 0
    v_mfma_f32_16x16x32_bf16 v[60:63], a[32:35], v[160:163], 0
    v_mfma_f32_16x16x32_bf16 v[32:35], a[4:7], v[68:71], v[32:35]
    v_mfma_f32_16x16x32_bf16 v[36:39], a[36:39], v[68:71], v[36:39]
    v_mfma_f32_16x16x32_bf16 v[40:43], a[4:7], v[100:103], v[40:43]
    v_mfma_f32_16x16x32_bf16 v[44:47], a[36:39], v[100:103], v[44:47]
    v_mfma_f32_16x16x32_bf16 v[48:51], a[4:7], v[132:135], v[48:51]
    v_mfma_f32_16x16x32_bf16 v[52:55], a[36:39], v[132:135], v[52:55]
    v_mfma_f32_16x16x32_bf16 v[56:59], a[4:7], v[164:167], v[56:59]
    v_mfma_f32_16x16x32_bf16 v[60:63], a[36:39], v[164:167], v[60:63]
    v_mfma_f32_16x16x32_bf16 v[32:35], a[8:11], v[72:75], v[32:35]
    v_mfma_f32_16x16x32_bf16 v[36:39], a[40:43], v[72:75], v[36:39]
    v_mfma_f32_16x16x32_bf16 v[40:43], a[8:11], v[104:107], v[40:43]
    v_mfma_f32_16x16x32_bf16 v[44:47], a[40:43], v[104:107], v[44:47]
    v_mfma_f32_16x16x32_bf16 v[48:51], a[8:11], v[136:139], v[48:51]
    v_mfma_f32_16x16x32_bf16 v[52:55], a[40:43], v[136:139], v[52:55]
    v_mfma_f32_16x16x32_bf16 v[56:59], a[8:11], v[168:171], v[56:59]
    v_mfma_f32_16x16x32_bf16 v[60:63], a[40:43], v[168:171], v[60:63]
    v_mfma_f32_16x16x32_bf16 v[32:35], a[12:15], v[76:79], v[32:35]
    v_mfma_f32_16x16x32_bf16 v[36:39], a[44:47], v[76:79], v[36:39]
    v_mfma_f32_16x16x32_bf16 v[40:43], a[12:15], v[108:111], v[40:43]
    v_mfma_f32_16x16x32_bf16 v[44:47], a[44:47], v[108:111], v[44:47]
    v_mfma_f32_16x16x32_bf16 v[48:51], a[12:15], v[140:143], v[48:51]
    v_mfma_f32_16x16x32_bf16 v[52:55], a[44:47], v[140:143], v[52:55]
    v_mfma_f32_16x16x32_bf16 v[56:59], a[12:15], v[172:175], v[56:59]
    v_mfma_f32_16x16x32_bf16 v[60:63], a[44:47], v[172:175], v[60:63]
    v_mfma_f32_16x16x32_bf16 v[32:35], a[16:19], v[80:83], v[32:35]
    v_mfma_f32_16x16x32_bf16 v[36:39], a[48:51], v[80:83], v[36:39]
    v_mfma_f32_16x16x32_bf16 v[40:43], a[16:19], v[112:115], v[40:43]
    v_mfma_f32_16x16x32_bf16 v[44:47], a[48:51], v[112:115], v[44:47]
    v_mfma_f32_16x16x32_bf16 v[48:51], a[16:19], v[144:147], v[48:51]
    v_mfma_f32_16x16x32_bf16 v[52:55], a[48:51], v[144:147], v[52:55]
    v_mfma_f32_16x16x32_bf16 v[56:59], a[16:19], v[176:179], v[56:59]
    v_mfma_f32_16x16x32_bf16 v[60:63], a[48:51], v[176:179], v[60:63]
    v_mfma_f32_16x16x32_bf16 v[32:35], a[20:23], v[84:87], v[32:35]
    v_mfma_f32_16x16x32_bf16 v[36:39], a[52:55], v[84:87], v[36:39]
    v_mfma_f32_16x16x32_bf16 v[40:43], a[20:23], v[116:119], v[40:43]
    v_mfma_f32_16x16x32_bf16 v[44:47], a[52:55], v[116:119], v[44:47]
    v_mfma_f32_16x16x32_bf16 v[48:51], a[20:23], v[148:151], v[48:51]
    v_mfma_f32_16x16x32_bf16 v[52:55], a[52:55], v[148:151], v[52:55]
    v_mfma_f32_16x16x32_bf16 v[56:59], a[20:23], v[180:183], v[56:59]
    v_mfma_f32_16x16x32_bf16 v[60:63], a[52:55], v[180:183], v[60:63]
    v_mfma_f32_16x16x32_bf16 v[32:35], a[24:27], v[88:91], v[32:35]
    v_mfma_f32_16x16x32_bf16 v[36:39], a[56:59], v[88:91], v[36:39]
    v_mfma_f32_16x16x32_bf16 v[40:43], a[24:27], v[120:123], v[40:43]
    v_mfma_f32_16x16x32_bf16 v[44:47], a[56:59], v[120:123], v[44:47]
    v_mfma_f32_16x16x32_bf16 v[48:51], a[24:27], v[152:155], v[48:51]
    v_mfma_f32_16x16x32_bf16 v[52:55], a[56:59], v[152:155], v[52:55]
    v_mfma_f32_16x16x32_bf16 v[56:59], a[24:27], v[184:187], v[56:59]
    v_mfma_f32_16x16x32_bf16 v[60:63], a[56:59], v[184:187], v[60:63]
    v_mfma_f32_16x16x32_bf16 v[32:35], a[28:31], v[92:95], v[32:35]
    v_mfma_f32_16x16x32_bf16 v[36:39], a[60:63], v[92:95], v[36:39]
    v_mfma_f32_16x16x32_bf16 v[40:43], a[28:31], v[124:127], v[40:43]
    v_mfma_f32_16x16x32_bf16 v[44:47], a[60:63], v[124:127], v[44:47]
    v_mfma_f32_16x16x32_bf16 v[48:51], a[28:31], v[156:159], v[48:51]
    v_mfma_f32_16x16x32_bf16 v[52:55], a[60:63], v[156:159], v[52:55]
    v_mfma_f32_16x16x32_bf16 v[56:59], a[28:31], v[188:191], v[56:59]
    v_mfma_f32_16x16x32_bf16 v[60:63], a[60:63], v[188:191], v[60:63]
    s_lshl_b32 s18, s53, 10
    s_add_u32 s18, s18, s52
    v_cvt_pk_bf16_f32 v32, v32, v33
    v_cvt_pk_bf16_f32 v33, v34, v35
    v_cvt_pk_bf16_f32 v34, v36, v37
    v_cvt_pk_bf16_f32 v35, v38, v39
    buffer_store_dwordx4 v[32:35], v9, s[4:7], s18 offen sc1
    s_add_u32 s18, s18, 14336
    v_cvt_pk_bf16_f32 v40, v40, v41
    v_cvt_pk_bf16_f32 v41, v42, v43
    v_cvt_pk_bf16_f32 v42, v44, v45
    v_cvt_pk_bf16_f32 v43, v46, v47
    buffer_store_dwordx4 v[40:43], v9, s[4:7], s18 offen sc1
    s_add_u32 s18, s18, 14336
    v_cvt_pk_bf16_f32 v48, v48, v49
    v_cvt_pk_bf16_f32 v49, v50, v51
    v_cvt_pk_bf16_f32 v50, v52, v53
    v_cvt_pk_bf16_f32 v51, v54, v55
    buffer_store_dwordx4 v[48:51], v9, s[4:7], s18 offen sc1
    s_add_u32 s18, s18, 14336
    v_cvt_pk_bf16_f32 v56, v56, v57
    v_cvt_pk_bf16_f32 v57, v58, v59
    v_cvt_pk_bf16_f32 v58, v60, v61
    v_cvt_pk_bf16_f32 v59, v62, v63
    buffer_store_dwordx4 v[56:59], v9, s[4:7], s18 offen sc1
    s_cmp_eq_u32 s40, 0
    s_cbranch_scc1 P_nov_3
    s_lshl_b32 s18, s53, 10
    s_add_u32 s18, s18, 12845056
    buffer_store_dwordx4 v[32:35], v192, s[4:7], s18 offen sc1
    buffer_store_dwordx4 v[40:43], v193, s[4:7], s18 offen sc1
    buffer_store_dwordx4 v[48:51], v194, s[4:7], s18 offen sc1
    buffer_store_dwordx4 v[56:59], v195, s[4:7], s18 offen sc1
    s_nop 1
P_nov_3:
    s_add_u32 s53, s53, 4
    s_add_u32 s24, s53, 4
    s_min_u32 s24, s24, 13
    s_mul_i32 s18, s24, 262144
    s_lshl_b32 s19, s41, 9
    s_add_u32 s18, s18, s19
    s_add_u32 s19, s54, 0
    s_mov_b32 m0, s19
    s_nop 0
    buffer_load_dwordx4 v20, s[44:47], s18 offen lds
    s_add_u32 s18, s18, 16384
    s_add_u32 s19, s19, 1024
    s_mov_b32 m0, s19
    s_nop 0
    buffer_load_dwordx4 v21, s[44:47], s18 offen lds
    s_add_u32 s18, s18, 16384
    s_add_u32 s19, s19, 1024
    s_mov_b32 m0, s19
    s_nop 0
    buffer_load_dwordx4 v20, s[44:47], s18 offen lds
    s_add_u32 s18, s18, 16384
    s_add_u32 s19, s19, 1024
    s_mov_b32 m0, s19
    s_nop 0
    buffer_load_dwordx4 v21, s[44:47], s18 offen lds
    s_add_u32 s18, s18, 16384
    s_add_u32 s19, s19, 1024
    s_mov_b32 m0, s19
    s_nop 0
    buffer_load_dwordx4 v22, s[44:47], s18 offen lds
    s_add_u32 s18, s18, 16384
    s_add_u32 s19, s19, 1024
    s_mov_b32 m0, s19
    s_nop 0
    buffer_load_dwordx4 v23, s[44:47], s18 offen lds
    s_add_u32 s18, s18, 16384
    s_add_u32 s19, s19, 1024
    s_mov_b32 m0, s19
    s_nop 0
    buffer_load_dwordx4 v22, s[44:47], s18 offen lds
    s_add_u32 s18, s18, 16384
    s_add_u32 s19, s19, 1024
    s_mov_b32 m0, s19
    s_nop 0
    buffer_load_dwordx4 v23, s[44:47], s18 offen lds
    s_add_u32 s18, s18, 16384
    s_add_u32 s19, s19, 1024
    s_mov_b32 m0, s19
    s_nop 0
    buffer_load_dwordx4 v20, s[44:47], s18 offen lds
    s_add_u32 s18, s18, 16384
    s_add_u32 s19, s19, 1024
    s_mov_b32 m0, s19
    s_nop 0
    buffer_load_dwordx4 v21, s[44:47], s18 offen lds
    s_add_u32 s18, s18, 16384
    s_add_u32 s19, s19, 1024
    s_mov_b32 m0, s19
    s_nop 0
    buffer_load_dwordx4 v20, s[44:47], s18 offen lds
    s_add_u32 s18, s18, 16384
    s_add_u32 s19, s19, 1024
    s_mov_b32 m0, s19
    s_nop 0
    buffer_load_dwordx4 v21, s[44:47], s18 offen lds
    s_add_u32 s18, s18, 16384
    s_add_u32 s19, s19, 1024
    s_mov_b32 m0, s19
    s_nop 0
    buffer_load_dwordx4 v22, s[44:47], s18 offen lds
    s_add_u32 s18, s18, 16384
    s_add_u32 s19, s19, 1024
    s_mov_b32 m0, s19
    s_nop 0
    buffer_load_dwordx4 v23, s[44:47], s18 offen lds
    s_add_u32 s18, s18, 16384
    s_add_u32 s19, s19, 1024
    s_mov_b32 m0, s19
    s_nop 0
    buffer_load_dwordx4 v22, s[44:47], s18 offen lds
    s_add_u32 s18, s18, 16384
    s_add_u32 s19, s19, 1024
    s_mov_b32 m0, s19
    s_nop 0
    buffer_load_dwordx4 v23, s[44:47], s18 offen lds
    s_cmp_eq_u32 s40, 0
    s_cbranch_scc1 P_wa_4
    s_waitcnt vmcnt(24)
    s_branch P_wb_5
P_wa_4:
    s_waitcnt vmcnt(20)
P_wb_5:
    s_mov_b32 s16, 3
    ds_read_b128 a[0:3], v24 offset:16384
    ds_read_b128 a[4:7], v25 offset:16384
    ds_read_b128 a[8:11], v26 offset:16384
    ds_read_b128 a[12:15], v27 offset:16384
    ds_read_b128 a[16:19], v28 offset:16384
    ds_read_b128 a[20:23], v29 offset:16384
    ds_read_b128 a[24:27], v30 offset:16384
    ds_read_b128 a[28:31], v31 offset:16384
    ds_read_b128 a[32:35], v24 offset:18432
    ds_read_b128 a[36:39], v25 offset:18432
    ds_read_b128 a[40:43], v26 offset:18432
    ds_read_b128 a[44:47], v27 offset:18432
    ds_read_b128 a[48:51], v28 offset:18432
    ds_read_b128 a[52:55], v29 offset:18432
    ds_read_b128 a[56:59], v30 offset:18432
    ds_read_b128 a[60:63], v31 offset:18432
    s_waitcnt lgkmcnt(0)
    v_mfma_f32_16x16x32_bf16 v[32:35], a[0:3], v[64:67], 0
    v_mfma_f32_16x16x32_bf16 v[36:39], a[32:35], v[64:67], 0
    v_mfma_f32_16x16x32_bf16 v[40:43], a[0:3], v[96:99], 0
    v_mfma_f32_16x16x32_bf16 v[44:47], a[32:35], v[96:99], 0
    v_mfma_f32_16x16x32_bf16 v[48:51], a[0:3], v[128:131], 0
    v_mfma_f32_16x16x32_bf16 v[52:55], a[32:35], v[128:131], 0
    v_mfma_f32_16x16x32_bf16 v[56:59], a[0:3], v[160:163], 0
    v_mfma_f32_16x16x32_bf16 v[60:63], a[32:35], v[160:163], 0
    v_mfma_f32_16x16x32_bf16 v[32:35], a[4:7], v[68:71], v[32:35]
    v_mfma_f32_16x16x32_bf16 v[36:39], a[36:39], v[68:71], v[36:39]
    v_mfma_f32_16x16x32_bf16 v[40:43], a[4:7], v[100:103], v[40:43]
    v_mfma_f32_16x16x32_bf16 v[44:47], a[36:39], v[100:103], v[44:47]
    v_mfma_f32_16x16x32_bf16 v[48:51], a[4:7], v[132:135], v[48:51]
    v_mfma_f32_16x16x32_bf16 v[52:55], a[36:39], v[132:135], v[52:55]
    v_mfma_f32_16x16x32_bf16 v[56:59], a[4:7], v[164:167], v[56:59]
    v_mfma_f32_16x16x32_bf16 v[60:63], a[36:39], v[164:167], v[60:63]
    v_mfma_f32_16x16x32_bf16 v[32:35], a[8:11], v[72:75], v[32:35]
    v_mfma_f32_16x16x32_bf16 v[36:39], a[40:43], v[72:75], v[36:39]
    v_mfma_f32_16x16x32_bf16 v[40:43], a[8:11], v[104:107], v[40:43]
    v_mfma_f32_16x16x32_bf16 v[44:47], a[40:43], v[104:107], v[44:47]
    v_mfma_f32_16x16x32_bf16 v[48:51], a[8:11], v[136:139], v[48:51]
    v_mfma_f32_16x16x32_bf16 v[52:55], a[40:43], v[136:139], v[52:55]
    v_mfma_f32_16x16x32_bf16 v[56:59], a[8:11], v[168:171], v[56:59]
    v_mfma_f32_16x16x32_bf16 v[60:63], a[40:43], v[168:171], v[60:63]
    v_mfma_f32_16x16x32_bf16 v[32:35], a[12:15], v[76:79], v[32:35]
    v_mfma_f32_16x16x32_bf16 v[36:39], a[44:47], v[76:79], v[36:39]
    v_mfma_f32_16x16x32_bf16 v[40:43], a[12:15], v[108:111], v[40:43]
    v_mfma_f32_16x16x32_bf16 v[44:47], a[44:47], v[108:111], v[44:47]
    v_mfma_f32_16x16x32_bf16 v[48:51], a[12:15], v[140:143], v[48:51]
    v_mfma_f32_16x16x32_bf16 v[52:55], a[44:47], v[140:143], v[52:55]
    v_mfma_f32_16x16x32_bf16 v[56:59], a[12:15], v[172:175], v[56:59]
    v_mfma_f32_16x16x32_bf16 v[60:63], a[44:47], v[172:175], v[60:63]
    v_mfma_f32_16x16x32_bf16 v[32:35], a[16:19], v[80:83], v[32:35]
    v_mfma_f32_16x16x32_bf16 v[36:39], a[48:51], v[80:83], v[36:39]
    v_mfma_f32_16x16x32_bf16 v[40:43], a[16:19], v[112:115], v[40:43]
    v_mfma_f32_16x16x32_bf16 v[44:47], a[48:51], v[112:115], v[44:47]
    v_mfma_f32_16x16x32_bf16 v[48:51], a[16:19], v[144:147], v[48:51]
    v_mfma_f32_16x16x32_bf16 v[52:55], a[48:51], v[144:147], v[52:55]
    v_mfma_f32_16x16x32_bf16 v[56:59], a[16:19], v[176:179], v[56:59]
    v_mfma_f32_16x16x32_bf16 v[60:63], a[48:51], v[176:179], v[60:63]
    v_mfma_f32_16x16x32_bf16 v[32:35], a[20:23], v[84:87], v[32:35]
    v_mfma_f32_16x16x32_bf16 v[36:39], a[52:55], v[84:87], v[36:39]
    v_mfma_f32_16x16x32_bf16 v[40:43], a[20:23], v[116:119], v[40:43]
    v_mfma_f32_16x16x32_bf16 v[44:47], a[52:55], v[116:119], v[44:47]
    v_mfma_f32_16x16x32_bf16 v[48:51], a[20:23], v[148:151], v[48:51]
    v_mfma_f32_16x16x32_bf16 v[52:55], a[52:55], v[148:151], v[52:55]
    v_mfma_f32_16x16x32_bf16 v[56:59], a[20:23], v[180:183], v[56:59]
    v_mfma_f32_16x16x32_bf16 v[60:63], a[52:55], v[180:183], v[60:63]
    v_mfma_f32_16x16x32_bf16 v[32:35], a[24:27], v[88:91], v[32:35]
    v_mfma_f32_16x16x32_bf16 v[36:39], a[56:59], v[88:91], v[36:39]
    v_mfma_f32_16x16x32_bf16 v[40:43], a[24:27], v[120:123], v[40:43]
    v_mfma_f32_16x16x32_bf16 v[44:47], a[56:59], v[120:123], v[44:47]
    v_mfma_f32_16x16x32_bf16 v[48:51], a[24:27], v[152:155], v[48:51]
    v_mfma_f32_16x16x32_bf16 v[52:55], a[56:59], v[152:155], v[52:55]
    v_mfma_f32_16x16x32_bf16 v[56:59], a[24:27], v[184:187], v[56:59]
    v_mfma_f32_16x16x32_bf16 v[60:63], a[56:59], v[184:187], v[60:63]
    v_mfma_f32_16x16x32_bf16 v[32:35], a[28:31], v[92:95], v[32:35]
    v_mfma_f32_16x16x32_bf16 v[36:39], a[60:63], v[92:95], v[36:39]
    v_mfma_f32_16x16x32_bf16 v[40:43], a[28:31], v[124:127], v[40:43]
    v_mfma_f32_16x16x32_bf16 v[44:47], a[60:63], v[124:127], v[44:47]
    v_mfma_f32_16x16x32_bf16 v[48:51], a[28:31], v[156:159], v[48:51]
    v_mfma_f32_16x16x32_bf16 v[52:55], a[60:63], v[156:159], v[52:55]
    v_mfma_f32_16x16x32_bf16 v[56:59], a[28:31], v[188:191], v[56:59]
    v_mfma_f32_16x16x32_bf16 v[60:63], a[60:63], v[188:191], v[60:63]
    s_waitcnt vmcnt(16)
    s_barrier
    s_cmp_lg_u32 s15, 0
    s_nop 3
    s_cbranch_scc1 P_sg_6
    s_mov_b32 s32, 400000
    v_mov_b32 v201, 40
    s_nop 1
P_z_7:
    global_load_dword v202, v201, s[36:37] sc1
    s_waitcnt vmcnt(0)
    v_readfirstlane_b32 s18, v202
    s_cmp_ge_u32 s18, 1
    s_nop 2
    s_cbranch_scc1 P_zo_8
    s_sleep 1
    s_sub_u32 s32, s32, 1
    s_cmp_lg_u32 s32, 0
    s_cbranch_scc1 P_z_7
    s_branch L_fail
P_zo_8:
    s_lshl_b32 s18, s58, 7
    s_lshl_b32 s19, s42, 2
    s_add_u32 s18, s18, s19
    s_add_u32 s18, s18, 126894080
    v_mov_b32 v202, 1
    s_mov_b64 exec, 1
    buffer_store_dword v202, off, s[4:7], s18 sc1
    s_mov_b64 exec, -1
P_sg_6:
    s_lshl_b32 s18, s53, 10
    s_add_u32 s18, s18, s52
    v_cvt_pk_bf16_f32 v32, v32, v33
    v_cvt_pk_bf16_f32 v33, v34, v35
    v_cvt_pk_bf16_f32 v34, v36, v37
    v_cvt_pk_bf16_f32 v35, v38, v39
    buffer_store_dwordx4 v[32:35], v9, s[4:7], s18 offen sc1
    s_add_u32 s18, s18, 14336
    v_cvt_pk_bf16_f32 v40, v40, v41
    v_cvt_pk_bf16_f32 v41, v42, v43
    v_cvt_pk_bf16_f32 v42, v44, v45
    v_cvt_pk_bf16_f32 v43, v46, v47
    buffer_store_dwordx4 v[40:43], v9, s[4:7], s18 offen sc1
    s_add_u32 s18, s18, 14336
    v_cvt_pk_bf16_f32 v48, v48, v49
    v_cvt_pk_bf16_f32 v49, v50, v51
    v_cvt_pk_bf16_f32 v50, v52, v53
    v_cvt_pk_bf16_f32 v51, v54, v55
    buffer_store_dwordx4 v[48:51], v9, s[4:7], s18 offen sc1
    s_add_u32 s18, s18, 14336
    v_cvt_pk_bf16_f32 v56, v56, v57
    v_cvt_pk_bf16_f32 v57, v58, v59
    v_cvt_pk_bf16_f32 v58, v60, v61
    v_cvt_pk_bf16_f32 v59, v62, v63
    buffer_store_dwordx4 v[56:59], v9, s[4:7], s18 offen sc1
    s_cmp_eq_u32 s40, 0
    s_cbranch_scc1 P_nov_9
    s_lshl_b32 s18, s53, 10
    s_add_u32 s18, s18, 12845056
    buffer_store_dwordx4 v[32:35], v192, s[4:7], s18 offen sc1
    buffer_store_dwordx4 v[40:43], v193, s[4:7], s18 offen sc1
    buffer_store_dwordx4 v[48:51], v194, s[4:7], s18 offen sc1
    buffer_store_dwordx4 v[56:59], v195, s[4:7], s18 offen sc1
    s_nop 1
P_nov_9:
    s_add_u32 s53, s53, 4
    s_add_u32 s24, s53, 4
    s_min_u32 s24, s24, 13
    s_mul_i32 s18, s24, 262144
    s_lshl_b32 s19, s41, 9
    s_add_u32 s18, s18, s19
    s_add_u32 s19, s54, 16384
    s_mov_b32 m0, s19
    s_nop 0
    buffer_load_dwordx4 v20, s[44:47], s18 offen lds
    s_add_u32 s18, s18, 16384
    s_add_u32 s19, s19, 1024
    s_mov_b32 m0, s19
    s_nop 0
    buffer_load_dwordx4 v21, s[44:47], s18 offen lds
    s_add_u32 s18, s18, 16384
    s_add_u32 s19, s19, 1024
    s_mov_b32 m0, s19
    s_nop 0
    buffer_load_dwordx4 v20, s[44:47], s18 offen lds
    s_add_u32 s18, s18, 16384
    s_add_u32 s19, s19, 1024
    s_mov_b32 m0, s19
    s_nop 0
    buffer_load_dwordx4 v21, s[44:47], s18 offen lds
    s_add_u32 s18, s18, 16384
    s_add_u32 s19, s19, 1024
    s_mov_b32 m0, s19
    s_nop 0
    buffer_load_dwordx4 v22, s[44:47], s18 offen lds
    s_add_u32 s18, s18, 16384
    s_add_u32 s19, s19, 1024
    s_mov_b32 m0, s19
    s_nop 0
    buffer_load_dwordx4 v23, s[44:47], s18 offen lds
    s_add_u32 s18, s18, 16384
    s_add_u32 s19, s19, 1024
    s_mov_b32 m0, s19
    s_nop 0
    buffer_load_dwordx4 v22, s[44:47], s18 offen lds
    s_add_u32 s18, s18, 16384
    s_add_u32 s19, s19, 1024
    s_mov_b32 m0, s19
    s_nop 0
    buffer_load_dwordx4 v23, s[44:47], s18 offen lds
    s_add_u32 s18, s18, 16384
    s_add_u32 s19, s19, 1024
    s_mov_b32 m0, s19
    s_nop 0
    buffer_load_dwordx4 v20, s[44:47], s18 offen lds
    s_add_u32 s18, s18, 16384
    s_add_u32 s19, s19, 1024
    s_mov_b32 m0, s19
    s_nop 0
    buffer_load_dwordx4 v21, s[44:47], s18 offen lds
    s_add_u32 s18, s18, 16384
    s_add_u32 s19, s19, 1024
    s_mov_b32 m0, s19
    s_nop 0
    buffer_load_dwordx4 v20, s[44:47], s18 offen lds
    s_add_u32 s18, s18, 16384
    s_add_u32 s19, s19, 1024
    s_mov_b32 m0, s19
    s_nop 0
    buffer_load_dwordx4 v21, s[44:47], s18 offen lds
    s_add_u32 s18, s18, 16384
    s_add_u32 s19, s19, 1024
    s_mov_b32 m0, s19
    s_nop 0
    buffer_load_dwordx4 v22, s[44:47], s18 offen lds
    s_add_u32 s18, s18, 16384
    s_add_u32 s19, s19, 1024
    s_mov_b32 m0, s19
    s_nop 0
    buffer_load_dwordx4 v23, s[44:47], s18 offen lds
    s_add_u32 s18, s18, 16384
    s_add_u32 s19, s19, 1024
    s_mov_b32 m0, s19
    s_nop 0
    buffer_load_dwordx4 v22, s[44:47], s18 offen lds
    s_add_u32 s18, s18, 16384
    s_add_u32 s19, s19, 1024
    s_mov_b32 m0, s19
    s_nop 0
    buffer_load_dwordx4 v23, s[44:47], s18 offen lds
    s_cmp_eq_u32 s40, 0
    s_cbranch_scc1 P_wa_10
    s_waitcnt vmcnt(24)
    s_branch P_wb_11
P_wa_10:
    s_waitcnt vmcnt(20)
P_wb_11:
    s_mov_b32 s16, 4
    ds_read_b128 a[0:3], v24 offset:0
    ds_read_b128 a[4:7], v25 offset:0
    ds_read_b128 a[8:11], v26 offset:0
    ds_read_b128 a[12:15], v27 offset:0
    ds_read_b128 a[16:19], v28 offset:0
    ds_read_b128 a[20:23], v29 offset:0
    ds_read_b128 a[24:27], v30 offset:0
    ds_read_b128 a[28:31], v31 offset:0
    ds_read_b128 a[32:35], v24 offset:2048
    ds_read_b128 a[36:39], v25 offset:2048
    ds_read_b128 a[40:43], v26 offset:2048
    ds_read_b128 a[44:47], v27 offset:2048
    ds_read_b128 a[48:51], v28 offset:2048
    ds_read_b128 a[52:55], v29 offset:2048
    ds_read_b128 a[56:59], v30 offset:2048
    ds_read_b128 a[60:63], v31 offset:2048
    s_waitcnt lgkmcnt(0)
    v_mfma_f32_16x16x32_bf16 v[32:35], a[0:3], v[64:67], 0
    v_mfma_f32_16x16x32_bf16 v[36:39], a[32:35], v[64:67], 0
    v_mfma_f32_16x16x32_bf16 v[40:43], a[0:3], v[96:99], 0
    v_mfma_f32_16x16x32_bf16 v[44:47], a[32:35], v[96:99], 0
    v_mfma_f32_16x16x32_bf16 v[48:51], a[0:3], v[128:131], 0
    v_mfma_f32_16x16x32_bf16 v[52:55], a[32:35], v[128:131], 0
    v_mfma_f32_16x16x32_bf16 v[56:59], a[0:3], v[160:163], 0
    v_mfma_f32_16x16x32_bf16 v[60:63], a[32:35], v[160:163], 0
    v_mfma_f32_16x16x32_bf16 v[32:35], a[4:7], v[68:71], v[32:35]
    v_mfma_f32_16x16x32_bf16 v[36:39], a[36:39], v[68:71], v[36:39]
    v_mfma_f32_16x16x32_bf16 v[40:43], a[4:7], v[100:103], v[40:43]
    v_mfma_f32_16x16x32_bf16 v[44:47], a[36:39], v[100:103], v[44:47]
    v_mfma_f32_16x16x32_bf16 v[48:51], a[4:7], v[132:135], v[48:51]
    v_mfma_f32_16x16x32_bf16 v[52:55], a[36:39], v[132:135], v[52:55]
    v_mfma_f32_16x16x32_bf16 v[56:59], a[4:7], v[164:167], v[56:59]
    v_mfma_f32_16x16x32_bf16 v[60:63], a[36:39], v[164:167], v[60:63]
    v_mfma_f32_16x16x32_bf16 v[32:35], a[8:11], v[72:75], v[32:35]
    v_mfma_f32_16x16x32_bf16 v[36:39], a[40:43], v[72:75], v[36:39]
    v_mfma_f32_16x16x32_bf16 v[40:43], a[8:11], v[104:107], v[40:43]
    v_mfma_f32_16x16x32_bf16 v[44:47], a[40:43], v[104:107], v[44:47]
    v_mfma_f32_16x16x32_bf16 v[48:51], a[8:11], v[136:139], v[48:51]
    v_mfma_f32_16x16x32_bf16 v[52:55], a[40:43], v[136:139], v[52:55]
    v_mfma_f32_16x16x32_bf16 v[56:59], a[8:11], v[168:171], v[56:59]
    v_mfma_f32_16x16x32_bf16 v[60:63], a[40:43], v[168:171], v[60:63]
    v_mfma_f32_16x16x32_bf16 v[32:35], a[12:15], v[76:79], v[32:35]
    v_mfma_f32_16x16x32_bf16 v[36:39], a[44:47], v[76:79], v[36:39]
    v_mfma_f32_16x16x32_bf16 v[40:43], a[12:15], v[108:111], v[40:43]
    v_mfma_f32_16x16x32_bf16 v[44:47], a[44:47], v[108:111], v[44:47]
    v_mfma_f32_16x16x32_bf16 v[48:51], a[12:15], v[140:143], v[48:51]
    v_mfma_f32_16x16x32_bf16 v[52:55], a[44:47], v[140:143], v[52:55]
    v_mfma_f32_16x16x32_bf16 v[56:59], a[12:15], v[172:175], v[56:59]
    v_mfma_f32_16x16x32_bf16 v[60:63], a[44:47], v[172:175], v[60:63]
    v_mfma_f32_16x16x32_bf16 v[32:35], a[16:19], v[80:83], v[32:35]
    v_mfma_f32_16x16x32_bf16 v[36:39], a[48:51], v[80:83], v[36:39]
    v_mfma_f32_16x16x32_bf16 v[40:43], a[16:19], v[112:115], v[40:43]
    v_mfma_f32_16x16x32_bf16 v[44:47], a[48:51], v[112:115], v[44:47]
    v_mfma_f32_16x16x32_bf16 v[48:51], a[16:19], v[144:147], v[48:51]
    v_mfma_f32_16x16x32_bf16 v[52:55], a[48:51], v[144:147], v[52:55]
    v_mfma_f32_16x16x32_bf16 v[56:59], a[16:19], v[176:179], v[56:59]
    v_mfma_f32_16x16x32_bf16 v[60:63], a[48:51], v[176:179], v[60:63]
    v_mfma_f32_16x16x32_bf16 v[32:35], a[20:23], v[84:87], v[32:35]
    v_mfma_f32_16x16x32_bf16 v[36:39], a[52:55], v[84:87], v[36:39]
    v_mfma_f32_16x16x32_bf16 v[40:43], a[20:23], v[116:119], v[40:43]
    v_mfma_f32_16x16x32_bf16 v[44:47], a[52:55], v[116:119], v[44:47]
    v_mfma_f32_16x16x32_bf16 v[48:51], a[20:23], v[148:151], v[48:51]
    v_mfma_f32_16x16x32_bf16 v[52:55], a[52:55], v[148:151], v[52:55]
    v_mfma_f32_16x16x32_bf16 v[56:59], a[20:23], v[180:183], v[56:59]
    v_mfma_f32_16x16x32_bf16 v[60:63], a[52:55], v[180:183], v[60:63]
    v_mfma_f32_16x16x32_bf16 v[32:35], a[24:27], v[88:91], v[32:35]
    v_mfma_f32_16x16x32_bf16 v[36:39], a[56:59], v[88:91], v[36:39]
    v_mfma_f32_16x16x32_bf16 v[40:43], a[24:27], v[120:123], v[40:43]
    v_mfma_f32_16x16x32_bf16 v[44:47], a[56:59], v[120:123], v[44:47]
    v_mfma_f32_16x16x32_bf16 v[48:51], a[24:27], v[152:155], v[48:51]
    v_mfma_f32_16x16x32_bf16 v[52:55], a[56:59], v[152:155], v[52:55]
    v_mfma_f32_16x16x32_bf16 v[56:59], a[24:27], v[184:187], v[56:59]
    v_mfma_f32_16x16x32_bf16 v[60:63], a[56:59], v[184:187], v[60:63]
    v_mfma_f32_16x16x32_bf16 v[32:35], a[28:31], v[92:95], v[32:35]
    v_mfma_f32_16x16x32_bf16 v[36:39], a[60:63], v[92:95], v[36:39]
    v_mfma_f32_16x16x32_bf16 v[40:43], a[28:31], v[124:127], v[40:43]
    v_mfma_f32_16x16x32_bf16 v[44:47], a[60:63], v[124:127], v[44:47]
    v_mfma_f32_16x16x32_bf16 v[48:51], a[28:31], v[156:159], v[48:51]
    v_mfma_f32_16x16x32_bf16 v[52:55], a[60:63], v[156:159], v[52:55]
    v_mfma_f32_16x16x32_bf16 v[56:59], a[28:31], v[188:191], v[56:59]
    v_mfma_f32_16x16x32_bf16 v[60:63], a[60:63], v[188:191], v[60:63]
    s_waitcnt vmcnt(16)
    s_barrier
    s_cmp_lg_u32 s15, 0
    s_nop 3
    s_cbranch_scc1 P_sg_12
    s_lshl_b32 s18, s58, 7
    s_lshl_b32 s19, s42, 2
    s_add_u32 s18, s18, s19
    s_add_u32 s18, s18, 126894112
    v_mov_b32 v202, 1
    s_mov_b64 exec, 1
    buffer_store_dword v202, off, s[4:7], s18 sc1
    s_mov_b64 exec, -1
P_sg_12:
    s_lshl_b32 s18, s53, 10
    s_add_u32 s18, s18, s52
    v_cvt_pk_bf16_f32 v32, v32, v33
    v_cvt_pk_bf16_f32 v33, v34, v35
    v_cvt_pk_bf16_f32 v34, v36, v37
    v_cvt_pk_bf16_f32 v35, v38, v39
    buffer_store_dwordx4 v[32:35], v9, s[4:7], s18 offen sc1
    s_add_u32 s18, s18, 14336
    v_cvt_pk_bf16_f32 v40, v40, v41
    v_cvt_pk_bf16_f32 v41, v42, v43
    v_cvt_pk_bf16_f32 v42, v44, v45
    v_cvt_pk_bf16_f32 v43, v46, v47
    buffer_store_dwordx4 v[40:43], v9, s[4:7], s18 offen sc1
    s_add_u32 s18, s18, 14336
    v_cvt_pk_bf16_f32 v48, v48, v49
    v_cvt_pk_bf16_f32 v49, v50, v51
    v_cvt_pk_bf16_f32 v50, v52, v53
    v_cvt_pk_bf16_f32 v51, v54, v55
    buffer_store_dwordx4 v[48:51], v9, s[4:7], s18 offen sc1
    s_add_u32 s18, s18, 14336
    v_cvt_pk_bf16_f32 v56, v56, v57
    v_cvt_pk_bf16_f32 v57, v58, v59
    v_cvt_pk_bf16_f32 v58, v60, v61
    v_cvt_pk_bf16_f32 v59, v62, v63
    buffer_store_dwordx4 v[56:59], v9, s[4:7], s18 offen sc1
    s_cmp_eq_u32 s40, 0
    s_cbranch_scc1 P_nov_13
    s_lshl_b32 s18, s53, 10
    s_add_u32 s18, s18, 12845056
    buffer_store_dwordx4 v[32:35], v192, s[4:7], s18 offen sc1
    buffer_store_dwordx4 v[40:43], v193, s[4:7], s18 offen sc1
    buffer_store_dwordx4 v[48:51], v194, s[4:7], s18 offen sc1
    buffer_store_dwordx4 v[56:59], v195, s[4:7], s18 offen sc1
    s_nop 1
P_nov_13:
    s_add_u32 s53, s53, 4
    s_cmp_ge_u32 s15, 2
    s_cbranch_scc1 P_g3
    s_cmp_eq_u32 s40, 0
    s_cbranch_scc1 P_wa_14
    s_waitcnt vmcnt(8)
    s_branch P_wb_15
P_wa_14:
    s_waitcnt vmcnt(4)
P_wb_15:
    s_mov_b32 s16, 5
    ds_read_b128 a[0:3], v24 offset:16384
    ds_read_b128 a[4:7], v25 offset:16384
    ds_read_b128 a[8:11], v26 offset:16384
    ds_read_b128 a[12:15], v27 offset:16384
    ds_read_b128 a[16:19], v28 offset:16384
    ds_read_b128 a[20:23], v29 offset:16384
    ds_read_b128 a[24:27], v30 offset:16384
    ds_read_b128 a[28:31], v31 offset:16384
    ds_read_b128 a[32:35], v24 offset:18432
    ds_read_b128 a[36:39], v25 offset:18432
    ds_read_b128 a[40:43], v26 offset:18432
    ds_read_b128 a[44:47], v27 offset:18432
    ds_read_b128 a[48:51], v28 offset:18432
    ds_read_b128 a[52:55], v29 offset:18432
    ds_read_b128 a[56:59], v30 offset:18432
    ds_read_b128 a[60:63], v31 offset:18432
    s_waitcnt lgkmcnt(0)
    v_mfma_f32_16x16x32_bf16 v[32:35], a[0:3], v[64:67], 0
    v_mfma_f32_16x16x32_bf16 v[36:39], a[32:35], v[64:67], 0
    v_mfma_f32_16x16x32_bf16 v[40:43], a[0:3], v[96:99], 0
    v_mfma_f32_16x16x32_bf16 v[44:47], a[32:35], v[96:99], 0
    v_mfma_f32_16x16x32_bf16 v[48:51], a[0:3], v[128:131], 0
    v_mfma_f32_16x16x32_bf16 v[52:55], a[32:35], v[128:131], 0
    v_mfma_f32_16x16x32_bf16 v[56:59], a[0:3], v[160:163], 0
    v_mfma_f32_16x16x32_bf16 v[60:63], a[32:35], v[160:163], 0
    v_mfma_f32_16x16x32_bf16 v[32:35], a[4:7], v[68:71], v[32:35]
    v_mfma_f32_16x16x32_bf16 v[36:39], a[36:39], v[68:71], v[36:39]
    v_mfma_f32_16x16x32_bf16 v[40:43], a[4:7], v[100:103], v[40:43]
    v_mfma_f32_16x16x32_bf16 v[44:47], a[36:39], v[100:103], v[44:47]
    v_mfma_f32_16x16x32_bf16 v[48:51], a[4:7], v[132:135], v[48:51]
    v_mfma_f32_16x16x32_bf16 v[52:55], a[36:39], v[132:135], v[52:55]
    v_mfma_f32_16x16x32_bf16 v[56:59], a[4:7], v[164:167], v[56:59]
    v_mfma_f32_16x16x32_bf16 v[60:63], a[36:39], v[164:167], v[60:63]
    v_mfma_f32_16x16x32_bf16 v[32:35], a[8:11], v[72:75], v[32:35]
    v_mfma_f32_16x16x32_bf16 v[36:39], a[40:43], v[72:75], v[36:39]
    v_mfma_f32_16x16x32_bf16 v[40:43], a[8:11], v[104:107], v[40:43]
    v_mfma_f32_16x16x32_bf16 v[44:47], a[40:43], v[104:107], v[44:47]
    v_mfma_f32_16x16x32_bf16 v[48:51], a[8:11], v[136:139], v[48:51]
    v_mfma_f32_16x16x32_bf16 v[52:55], a[40:43], v[136:139], v[52:55]
    v_mfma_f32_16x16x32_bf16 v[56:59], a[8:11], v[168:171], v[56:59]
    v_mfma_f32_16x16x32_bf16 v[60:63], a[40:43], v[168:171], v[60:63]
    v_mfma_f32_16x16x32_bf16 v[32:35], a[12:15], v[76:79], v[32:35]
    v_mfma_f32_16x16x32_bf16 v[36:39], a[44:47], v[76:79], v[36:39]
    v_mfma_f32_16x16x32_bf16 v[40:43], a[12:15], v[108:111], v[40:43]
    v_mfma_f32_16x16x32_bf16 v[44:47], a[44:47], v[108:111], v[44:47]
    v_mfma_f32_16x16x32_bf16 v[48:51], a[12:15], v[140:143], v[48:51]
    v_mfma_f32_16x16x32_bf16 v[52:55], a[44:47], v[140:143], v[52:55]
    v_mfma_f32_16x16x32_bf16 v[56:59], a[12:15], v[172:175], v[56:59]
    v_mfma_f32_16x16x32_bf16 v[60:63], a[44:47], v[172:175], v[60:63]
    v_mfma_f32_16x16x32_bf16 v[32:35], a[16:19], v[80:83], v[32:35]
    v_mfma_f32_16x16x32_bf16 v[36:39], a[48:51], v[80:83], v[36:39]
    v_mfma_f32_16x16x32_bf16 v[40:43], a[16:19], v[112:115], v[40:43]
    v_mfma_f32_16x16x32_bf16 v[44:47], a[48:51], v[112:115], v[44:47]
    v_mfma_f32_16x16x32_bf16 v[48:51], a[16:19], v[144:147], v[48:51]
    v_mfma_f32_16x16x32_bf16 v[52:55], a[48:51], v[144:147], v[52:55]
    v_mfma_f32_16x16x32_bf16 v[56:59], a[16:19], v[176:179], v[56:59]
    v_mfma_f32_16x16x32_bf16 v[60:63], a[48:51], v[176:179], v[60:63]
    v_mfma_f32_16x16x32_bf16 v[32:35], a[20:23], v[84:87], v[32:35]
    v_mfma_f32_16x16x32_bf16 v[36:39], a[52:55], v[84:87], v[36:39]
    v_mfma_f32_16x16x32_bf16 v[40:43], a[20:23], v[116:119], v[40:43]
    v_mfma_f32_16x16x32_bf16 v[44:47], a[52:55], v[116:119], v[44:47]
    v_mfma_f32_16x16x32_bf16 v[48:51], a[20:23], v[148:151], v[48:51]
    v_mfma_f32_16x16x32_bf16 v[52:55], a[52:55], v[148:151], v[52:55]
    v_mfma_f32_16x16x32_bf16 v[56:59], a[20:23], v[180:183], v[56:59]
    v_mfma_f32_16x16x32_bf16 v[60:63], a[52:55], v[180:183], v[60:63]
    v_mfma_f32_16x16x32_bf16 v[32:35], a[24:27], v[88:91], v[32:35]
    v_mfma_f32_16x16x32_bf16 v[36:39], a[56:59], v[88:91], v[36:39]
    v_mfma_f32_16x16x32_bf16 v[40:43], a[24:27], v[120:123], v[40:43]
    v_mfma_f32_16x16x32_bf16 v[44:47], a[56:59], v[120:123], v[44:47]
    v_mfma_f32_16x16x32_bf16 v[48:51], a[24:27], v[152:155], v[48:51]
    v_mfma_f32_16x16x32_bf16 v[52:55], a[56:59], v[152:155], v[52:55]
    v_mfma_f32_16x16x32_bf16 v[56:59], a[24:27], v[184:187], v[56:59]
    v_mfma_f32_16x16x32_bf16 v[60:63], a[56:59], v[184:187], v[60:63]
    v_mfma_f32_16x16x32_bf16 v[32:35], a[28:31], v[92:95], v[32:35]
    v_mfma_f32_16x16x32_bf16 v[36:39], a[60:63], v[92:95], v[36:39]
    v_mfma_f32_16x16x32_bf16 v[40:43], a[28:31], v[124:127], v[40:43]
    v_mfma_f32_16x16x32_bf16 v[44:47], a[60:63], v[124:127], v[44:47]
    v_mfma_f32_16x16x32_bf16 v[48:51], a[28:31], v[156:159], v[48:51]
    v_mfma_f32_16x16x32_bf16 v[52:55], a[60:63], v[156:159], v[52:55]
    v_mfma_f32_16x16x32_bf16 v[56:59], a[28:31], v[188:191], v[56:59]
    v_mfma_f32_16x16x32_bf16 v[60:63], a[60:63], v[188:191], v[60:63]
    s_waitcnt vmcnt(0)
    s_barrier
    s_cmp_lg_u32 s15, 0
    s_nop 3
    s_cbranch_scc1 P_sg_16
    s_lshl_b32 s18, s58, 7
    s_lshl_b32 s19, s42, 2
    s_add_u32 s18, s18, s19
    s_add_u32 s18, s18, 126894144
    v_mov_b32 v202, 1
    s_mov_b64 exec, 1
    buffer_store_dword v202, off, s[4:7], s18 sc1
    s_mov_b64 exec, -1
P_sg_16:
    s_lshl_b32 s18, s53, 10
    s_add_u32 s18, s18, s52
    v_cvt_pk_bf16_f32 v32, v32, v33
    v_cvt_pk_bf16_f32 v33, v34, v35
    v_cvt_pk_bf16_f32 v34, v36, v37
    v_cvt_pk_bf16_f32 v35, v38, v39
    buffer_store_dwordx4 v[32:35], v9, s[4:7], s18 offen sc1
    s_add_u32 s18, s18, 14336
    v_cvt_pk_bf16_f32 v40, v40, v41
    v_cvt_pk_bf16_f32 v41, v42, v43
    v_cvt_pk_bf16_f32 v42, v44, v45
    v_cvt_pk_bf16_f32 v43, v46, v47
    buffer_store_dwordx4 v[40:43], v9, s[4:7], s18 offen sc1
    s_add_u32 s18, s18, 14336
    v_cvt_pk_bf16_f32 v48, v48, v49
    v_cvt_pk_bf16_f32 v49, v50, v51
    v_cvt_pk_bf16_f32 v50, v52, v53
    v_cvt_pk_bf16_f32 v51, v54, v55
    buffer_store_dwordx4 v[48:51], v9, s[4:7], s18 offen sc1
    s_add_u32 s18, s18, 14336
    v_cvt_pk_bf16_f32 v56, v56, v57
    v_cvt_pk_bf16_f32 v57, v58, v59
    v_cvt_pk_bf16_f32 v58, v60, v61
    v_cvt_pk_bf16_f32 v59, v62, v63
    buffer_store_dwordx4 v[56:59], v9, s[4:7], s18 offen sc1
    s_cmp_eq_u32 s40, 0
    s_cbranch_scc1 P_nov_17
    s_lshl_b32 s18, s53, 10
    s_add_u32 s18, s18, 12845056
    buffer_store_dwordx4 v[32:35], v192, s[4:7], s18 offen sc1
    buffer_store_dwordx4 v[40:43], v193, s[4:7], s18 offen sc1
    buffer_store_dwordx4 v[48:51], v194, s[4:7], s18 offen sc1
    buffer_store_dwordx4 v[56:59], v195, s[4:7], s18 offen sc1
    s_nop 1
P_nov_17:
    s_add_u32 s53, s53, 4
    s_waitcnt vmcnt(0)
    s_barrier
    s_cmp_lg_u32 s15, 0
    s_cbranch_scc1 P_sg_18
    s_lshl_b32 s18, s58, 7
    s_lshl_b32 s19, s42, 2
    s_add_u32 s18, s18, s19
    s_add_u32 s18, s18, 126894176
    v_mov_b32 v202, 1
    s_mov_b64 exec, 1
    buffer_store_dword v202, off, s[4:7], s18 sc1
    s_mov_b64 exec, -1
P_sg_18:
    s_branch P_gdone
P_g3:
    s_waitcnt vmcnt(0)
    s_barrier
    s_barrier
P_gdone:
    s_mov_b32 s16, 6
    s_branch P_done
P_misc:
    s_mov_b32 s40, s19
    s_cmp_lg_u32 s40, 0
    s_cbranch_scc1 P_nz_19
    v_lshlrev_b32 v6, 4, v0
    v_mov_b32 v12, 0
    v_mov_b32 v13, 0
    v_mov_b32 v14, 0
    v_mov_b32 v15, 0
    s_mov_b32 s46, 126894080
    buffer_store_dwordx4 v[12:15], v6, s[4:7], s46 offen sc1
    s_load_dwordx2 s[8:9], s[34:35], 8
    s_waitcnt lgkmcnt(0)
    s_mov_b32 s10, 7168
    s_mov_b32 s11, 0x00020000
    v_add_u32 v4, 0, v0
    v_and_b32 v5, 7, v4
    v_mul_u32_u24 v5, 896, v5
    v_lshrrev_b32 v6, 3, v4
    v_lshl_add_u32 v5, v6, 4, v5
    buffer_load_dwordx4 v[140:143], v5, s[8:11], 0 offen
    v_add_u32 v4, 256, v0
    v_and_b32 v5, 7, v4
    v_mul_u32_u24 v5, 896, v5
    v_lshrrev_b32 v6, 3, v4
    v_lshl_add_u32 v5, v6, 4, v5
    buffer_load_dwordx4 v[144:147], v5, s[8:11], 0 offen
    s_waitcnt vmcnt(2)
    s_barrier
    s_cmp_lg_u32 s15, 0
    s_cbranch_scc1 P_nz2_20
    v_mov_b32 v201, 40
    v_mov_b32 v202, 1
    s_mov_b64 exec, 1
    global_atomic_add v201, v202, s[36:37] sc1
    s_mov_b64 exec, -1
P_nz2_20:
P_nz_19:
    s_load_dwordx2 s[8:9], s[34:35], 0
    s_waitcnt lgkmcnt(0)
    s_mov_b32 s10, 1835008
    s_mov_b32 s11, 0x00020000
    v_lshrrev_b32 v4, 3, v0
    v_and_b32 v5, 7, v0
    v_mul_u32_u24 v2, 896, v4
    v_lshl_add_u32 v2, v5, 4, v2
    v_mul_u32_u24 v3, 928, v4
    v_lshl_add_u32 v3, v5, 4, v3
    s_mul_i32 s42, s40, 28672
    buffer_load_dwordx4 v[16:19], v2, s[8:11], s42 offen offset:0
    buffer_load_dwordx4 v[20:23], v2, s[8:11], s42 offen offset:128
    buffer_load_dwordx4 v[24:27], v2, s[8:11], s42 offen offset:256
    buffer_load_dwordx4 v[28:31], v2, s[8:11], s42 offen offset:384
    buffer_load_dwordx4 v[32:35], v2, s[8:11], s42 offen offset:512
    buffer_load_dwordx4 v[36:39], v2, s[8:11], s42 offen offset:640
    buffer_load_dwordx4 v[40:43], v2, s[8:11], s42 offen offset:768
    s_waitcnt vmcnt(0)
    v_lshlrev_b32 v48, 16, v16
    v_and_b32 v49, 0xffff0000, v16
    v_lshlrev_b32 v50, 16, v17
    v_and_b32 v51, 0xffff0000, v17
    v_lshlrev_b32 v52, 16, v18
    v_and_b32 v53, 0xffff0000, v18
    v_lshlrev_b32 v54, 16, v19
    v_and_b32 v55, 0xffff0000, v19
    v_lshlrev_b32 v56, 16, v20
    v_and_b32 v57, 0xffff0000, v20
    v_lshlrev_b32 v58, 16, v21
    v_and_b32 v59, 0xffff0000, v21
    v_lshlrev_b32 v60, 16, v22
    v_and_b32 v61, 0xffff0000, v22
    v_lshlrev_b32 v62, 16, v23
    v_and_b32 v63, 0xffff0000, v23
    v_lshlrev_b32 v64, 16, v24
    v_and_b32 v65, 0xffff0000, v24
    v_lshlrev_b32 v66, 16, v25
    v_and_b32 v67, 0xffff0000, v25
    v_lshlrev_b32 v68, 16, v26
    v_and_b32 v69, 0xffff0000, v26
    v_lshlrev_b32 v70, 16, v27
    v_and_b32 v71, 0xffff0000, v27
    v_lshlrev_b32 v72, 16, v28
    v_and_b32 v73, 0xffff0000, v28
    v_lshlrev_b32 v74, 16, v29
    v_and_b32 v75, 0xffff0000, v29
    v_lshlrev_b32 v76, 16, v30
    v_and_b32 v77, 0xffff0000, v30
    v_lshlrev_b32 v78, 16, v31
    v_and_b32 v79, 0xffff0000, v31
    v_lshlrev_b32 v80, 16, v32
    v_and_b32 v81, 0xffff0000, v32
    v_lshlrev_b32 v82, 16, v33
    v_and_b32 v83, 0xffff0000, v33
    v_lshlrev_b32 v84, 16, v34
    v_and_b32 v85, 0xffff0000, v34
    v_lshlrev_b32 v86, 16, v35
    v_and_b32 v87, 0xffff0000, v35
    v_lshlrev_b32 v88, 16, v36
    v_and_b32 v89, 0xffff0000, v36
    v_lshlrev_b32 v90, 16, v37
    v_and_b32 v91, 0xffff0000, v37
    v_lshlrev_b32 v92, 16, v38
    v_and_b32 v93, 0xffff0000, v38
    v_lshlrev_b32 v94, 16, v39
    v_and_b32 v95, 0xffff0000, v39
    v_lshlrev_b32 v96, 16, v40
    v_and_b32 v97, 0xffff0000, v40
    v_lshlrev_b32 v98, 16, v41
    v_and_b32 v99, 0xffff0000, v41
    v_lshlrev_b32 v100, 16, v42
    v_and_b32 v101, 0xffff0000, v42
    v_lshlrev_b32 v102, 16, v43
    v_and_b32 v103, 0xffff0000, v43
    v_pk_add_f32 v[6:7], v[48:49], v[50:51]
    v_pk_add_f32 v[8:9], v[52:53], v[54:55]
    v_pk_add_f32 v[6:7], v[6:7], v[56:57]
    v_pk_add_f32 v[8:9], v[8:9], v[58:59]
    v_pk_add_f32 v[6:7], v[6:7], v[60:61]
    v_pk_add_f32 v[8:9], v[8:9], v[62:63]
    v_pk_add_f32 v[6:7], v[6:7], v[64:65]
    v_pk_add_f32 v[8:9], v[8:9], v[66:67]
    v_pk_add_f32 v[6:7], v[6:7], v[68:69]
    v_pk_add_f32 v[8:9], v[8:9], v[70:71]
    v_pk_add_f32 v[6:7], v[6:7], v[72:73]
    v_pk_add_f32 v[8:9], v[8:9], v[74:75]
    v_pk_add_f32 v[6:7], v[6:7], v[76:77]
    v_pk_add_f32 v[8:9], v[8:9], v[78:79]
    v_pk_add_f32 v[6:7], v[6:7], v[80:81]
    v_pk_add_f32 v[8:9], v[8:9], v[82:83]
    v_pk_add_f32 v[6:7], v[6:7], v[84:85]
    v_pk_add_f32 v[8:9], v[8:9], v[86:87]
    v_pk_add_f32 v[6:7], v[6:7], v[88:89]
    v_pk_add_f32 v[8:9], v[8:9], v[90:91]
    v_pk_add_f32 v[6:7], v[6:7], v[92:93]
    v_pk_add_f32 v[8:9], v[8:9], v[94:95]
    v_pk_add_f32 v[6:7], v[6:7], v[96:97]
    v_pk_add_f32 v[8:9], v[8:9], v[98:99]
    v_pk_add_f32 v[6:7], v[6:7], v[100:101]
    v_pk_add_f32 v[8:9], v[8:9], v[102:103]
    v_pk_add_f32 v[6:7], v[6:7], v[8:9]
    v_add_f32 v4, v6, v7
    s_nop 1
    v_add_f32_dpp v4, v4, v4 quad_perm:[1,0,3,2] row_mask:0xf bank_mask:0xf
    s_nop 1
    v_add_f32_dpp v4, v4, v4 quad_perm:[2,3,0,1] row_mask:0xf bank_mask:0xf
    s_nop 1
    v_add_f32_dpp v4, v4, v4 row_half_mirror row_mask:0xf bank_mask:0xf
    v_mul_f32 v8, 0xbb124925, v4
    v_mov_b32 v9, v8
    v_pk_add_f32 v[48:49], v[48:49], v[8:9]
    v_pk_add_f32 v[50:51], v[50:51], v[8:9]
    v_pk_add_f32 v[52:53], v[52:53], v[8:9]
    v_pk_add_f32 v[54:55], v[54:55], v[8:9]
    v_pk_add_f32 v[56:57], v[56:57], v[8:9]
    v_pk_add_f32 v[58:59], v[58:59], v[8:9]
    v_pk_add_f32 v[60:61], v[60:61], v[8:9]
    v_pk_add_f32 v[62:63], v[62:63], v[8:9]
    v_pk_add_f32 v[64:65], v[64:65], v[8:9]
    v_pk_add_f32 v[66:67], v[66:67], v[8:9]
    v_pk_add_f32 v[68:69], v[68:69], v[8:9]
    v_pk_add_f32 v[70:71], v[70:71], v[8:9]
    v_pk_add_f32 v[72:73], v[72:73], v[8:9]
    v_pk_add_f32 v[74:75], v[74:75], v[8:9]
    v_pk_add_f32 v[76:77], v[76:77], v[8:9]
    v_pk_add_f32 v[78:79], v[78:79], v[8:9]
    v_pk_add_f32 v[80:81], v[80:81], v[8:9]
    v_pk_add_f32 v[82:83], v[82:83], v[8:9]
    v_pk_add_f32 v[84:85], v[84:85], v[8:9]
    v_pk_add_f32 v[86:87], v[86:87], v[8:9]
    v_pk_add_f32 v[88:89], v[88:89], v[8:9]
    v_pk_add_f32 v[90:91], v[90:91], v[8:9]
    v_pk_add_f32 v[92:93], v[92:93], v[8:9]
    v_pk_add_f32 v[94:95], v[94:95], v[8:9]
    v_pk_add_f32 v[96:97], v[96:97], v[8:9]
    v_pk_add_f32 v[98:99], v[98:99], v[8:9]
    v_pk_add_f32 v[100:101], v[100:101], v[8:9]
    v_pk_add_f32 v[102:103], v[102:103], v[8:9]
    v_pk_mul_f32 v[6:7], v[48:49], v[48:49]
    v_pk_mul_f32 v[8:9], v[50:51], v[50:51]
    v_pk_fma_f32 v[6:7], v[52:53], v[52:53], v[6:7]
    v_pk_fma_f32 v[8:9], v[54:55], v[54:55], v[8:9]
    v_pk_fma_f32 v[6:7], v[56:57], v[56:57], v[6:7]
    v_pk_fma_f32 v[8:9], v[58:59], v[58:59], v[8:9]
    v_pk_fma_f32 v[6:7], v[60:61], v[60:61], v[6:7]
    v_pk_fma_f32 v[8:9], v[62:63], v[62:63], v[8:9]
    v_pk_fma_f32 v[6:7], v[64:65], v[64:65], v[6:7]
    v_pk_fma_f32 v[8:9], v[66:67], v[66:67], v[8:9]
    v_pk_fma_f32 v[6:7], v[68:69], v[68:69], v[6:7]
    v_pk_fma_f32 v[8:9], v[70:71], v[70:71], v[8:9]
    v_pk_fma_f32 v[6:7], v[72:73], v[72:73], v[6:7]
    v_pk_fma_f32 v[8:9], v[74:75], v[74:75], v[8:9]
    v_pk_fma_f32 v[6:7], v[76:77], v[76:77], v[6:7]
    v_pk_fma_f32 v[8:9], v[78:79], v[78:79], v[8:9]
    v_pk_fma_f32 v[6:7], v[80:81], v[80:81], v[6:7]
    v_pk_fma_f32 v[8:9], v[82:83], v[82:83], v[8:9]
    v_pk_fma_f32 v[6:7], v[84:85], v[84:85], v[6:7]
    v_pk_fma_f32 v[8:9], v[86:87], v[86:87], v[8:9]
    v_pk_fma_f32 v[6:7], v[88:89], v[88:89], v[6:7]
    v_pk_fma_f32 v[8:9], v[90:91], v[90:91], v[8:9]
    v_pk_fma_f32 v[6:7], v[92:93], v[92:93], v[6:7]
    v_pk_fma_f32 v[8:9], v[94:95], v[94:95], v[8:9]
    v_pk_fma_f32 v[6:7], v[96:97], v[96:97], v[6:7]
    v_pk_fma_f32 v[8:9], v[98:99], v[98:99], v[8:9]
    v_pk_fma_f32 v[6:7], v[100:101], v[100:101], v[6:7]
    v_pk_fma_f32 v[8:9], v[102:103], v[102:103], v[8:9]
    v_pk_add_f32 v[6:7], v[6:7], v[8:9]
    v_add_f32 v4, v6, v7
    s_nop 1
    v_add_f32_dpp v4, v4, v4 quad_perm:[1,0,3,2] row_mask:0xf bank_mask:0xf
    s_nop 1
    v_add_f32_dpp v4, v4, v4 quad_perm:[2,3,0,1] row_mask:0xf bank_mask:0xf
    s_nop 1
    v_add_f32_dpp v4, v4, v4 row_half_mirror row_mask:0xf bank_mask:0xf
    v_mov_b32 v6, 0x3727c5ac
    v_fmac_f32 v6, 0x3b124925, v4
    v_rsq_f32 v6, v6
    s_nop 0
    v_mov_b32 v7, v6
    v_pk_mul_f32 v[48:49], v[48:49], v[6:7]
    v_cvt_pk_bf16_f32 v16, v48, v49
    v_pk_mul_f32 v[50:51], v[50:51], v[6:7]
    v_cvt_pk_bf16_f32 v17, v50, v51
    v_pk_mul_f32 v[52:53], v[52:53], v[6:7]
    v_cvt_pk_bf16_f32 v18, v52, v53
    v_pk_mul_f32 v[54:55], v[54:55], v[6:7]
    v_cvt_pk_bf16_f32 v19, v54, v55
    v_pk_mul_f32 v[56:57], v[56:57], v[6:7]
    v_cvt_pk_bf16_f32 v20, v56, v57
    v_pk_mul_f32 v[58:59], v[58:59], v[6:7]
    v_cvt_pk_bf16_f32 v21, v58, v59
    v_pk_mul_f32 v[60:61], v[60:61], v[6:7]
    v_cvt_pk_bf16_f32 v22, v60, v61
    v_pk_mul_f32 v[62:63], v[62:63], v[6:7]
    v_cvt_pk_bf16_f32 v23, v62, v63
    v_pk_mul_f32 v[64:65], v[64:65], v[6:7]
    v_cvt_pk_bf16_f32 v24, v64, v65
    v_pk_mul_f32 v[66:67], v[66:67], v[6:7]
    v_cvt_pk_bf16_f32 v25, v66, v67
    v_pk_mul_f32 v[68:69], v[68:69], v[6:7]
    v_cvt_pk_bf16_f32 v26, v68, v69
    v_pk_mul_f32 v[70:71], v[70:71], v[6:7]
    v_cvt_pk_bf16_f32 v27, v70, v71
    v_pk_mul_f32 v[72:73], v[72:73], v[6:7]
    v_cvt_pk_bf16_f32 v28, v72, v73
    v_pk_mul_f32 v[74:75], v[74:75], v[6:7]
    v_cvt_pk_bf16_f32 v29, v74, v75
    v_pk_mul_f32 v[76:77], v[76:77], v[6:7]
    v_cvt_pk_bf16_f32 v30, v76, v77
    v_pk_mul_f32 v[78:79], v[78:79], v[6:7]
    v_cvt_pk_bf16_f32 v31, v78, v79
    v_pk_mul_f32 v[80:81], v[80:81], v[6:7]
    v_cvt_pk_bf16_f32 v32, v80, v81
    v_pk_mul_f32 v[82:83], v[82:83], v[6:7]
    v_cvt_pk_bf16_f32 v33, v82, v83
    v_pk_mul_f32 v[84:85], v[84:85], v[6:7]
    v_cvt_pk_bf16_f32 v34, v84, v85
    v_pk_mul_f32 v[86:87], v[86:87], v[6:7]
    v_cvt_pk_bf16_f32 v35, v86, v87
    v_pk_mul_f32 v[88:89], v[88:89], v[6:7]
    v_cvt_pk_bf16_f32 v36, v88, v89
    v_pk_mul_f32 v[90:91], v[90:91], v[6:7]
    v_cvt_pk_bf16_f32 v37, v90, v91
    v_pk_mul_f32 v[92:93], v[92:93], v[6:7]
    v_cvt_pk_bf16_f32 v38, v92, v93
    v_pk_mul_f32 v[94:95], v[94:95], v[6:7]
    v_cvt_pk_bf16_f32 v39, v94, v95
    v_pk_mul_f32 v[96:97], v[96:97], v[6:7]
    v_cvt_pk_bf16_f32 v40, v96, v97
    v_pk_mul_f32 v[98:99], v[98:99], v[6:7]
    v_cvt_pk_bf16_f32 v41, v98, v99
    v_pk_mul_f32 v[100:101], v[100:101], v[6:7]
    v_cvt_pk_bf16_f32 v42, v100, v101
    v_pk_mul_f32 v[102:103], v[102:103], v[6:7]
    v_cvt_pk_bf16_f32 v43, v102, v103
    s_mul_i32 s42, s40, 29696
    s_add_u32 s42, s42, 19267584
    buffer_store_dwordx4 v[16:19], v3, s[4:7], s42 offen offset:0 sc1
    buffer_store_dwordx4 v[20:23], v3, s[4:7], s42 offen offset:128 sc1
    buffer_store_dwordx4 v[24:27], v3, s[4:7], s42 offen offset:256 sc1
    buffer_store_dwordx4 v[28:31], v3, s[4:7], s42 offen offset:384 sc1
    buffer_store_dwordx4 v[32:35], v3, s[4:7], s42 offen offset:512 sc1
    buffer_store_dwordx4 v[36:39], v3, s[4:7], s42 offen offset:640 sc1
    buffer_store_dwordx4 v[40:43], v3, s[4:7], s42 offen offset:768 sc1
    s_cmp_lg_u32 s40, 0
    s_cbranch_scc1 P_done
    v_add_u32 v4, 0, v0
    v_lshlrev_b32 v6, 4, v4
    v_cmp_gt_u32 vcc, 448, v4
    s_and_saveexec_b64 s[42:43], vcc
    s_mov_b32 s46, 32391168
    buffer_store_dwordx4 v[140:143], v6, s[4:7], s46 offen sc1
    s_mov_b32 s46, 32849920
    buffer_store_dwordx4 v[140:143], v6, s[4:7], s46 offen sc1
    s_mov_b32 s46, 33308672
    buffer_store_dwordx4 v[140:143], v6, s[4:7], s46 offen sc1
    s_mov_b32 s46, 33767424
    buffer_store_dwordx4 v[140:143], v6, s[4:7], s46 offen sc1
    s_mov_b64 exec, s[42:43]
    v_add_u32 v4, 256, v0
    v_lshlrev_b32 v6, 4, v4
    v_cmp_gt_u32 vcc, 448, v4
    s_and_saveexec_b64 s[42:43], vcc
    s_mov_b32 s46, 32391168
    buffer_store_dwordx4 v[144:147], v6, s[4:7], s46 offen sc1
    s_mov_b32 s46, 32849920
    buffer_store_dwordx4 v[144:147], v6, s[4:7], s46 offen sc1
    s_mov_b32 s46, 33308672
    buffer_store_dwordx4 v[144:147], v6, s[4:7], s46 offen sc1
    s_mov_b32 s46, 33767424
    buffer_store_dwordx4 v[144:147], v6, s[4:7], s46 offen sc1
    s_mov_b64 exec, s[42:43]
    s_nop 0
P_done:
    s_mov_b32 s16, 1
    s_barrier
    v_mov_b32 v5, 0
    s_cmp_lg_u32 s15, 0
    s_cbranch_scc1 L_tk2
    s_mov_b64 exec, 1
    ds_write_b32 v5, v200
    s_waitcnt lgkmcnt(0)
    s_mov_b64 exec, -1
L_tk2:
    s_barrier
    ds_read_b32 v4, v5
    s_waitcnt lgkmcnt(0)
    v_readfirstlane_b32 s17, v4
    s_barrier
    s_mov_b32 s32, 400000
    v_and_b32 v5, 7, v0
    v_lshlrev_b32 v5, 2, v5
    v_mov_b32 v8, 40
    s_nop 1
L_cnt:
    global_load_dword v4, v5, s[36:37] sc1
    global_load_dword v7, v8, s[36:37] sc1
    s_waitcnt vmcnt(0)
    v_mov_b32 v6, v4
    s_nop 1
    v_add_u32_dpp v6, v6, v6 quad_perm:[1,0,3,2] row_mask:0xf bank_mask:0xf
    s_nop 1
    v_add_u32_dpp v6, v6, v6 quad_perm:[2,3,0,1] row_mask:0xf bank_mask:0xf
    s_nop 1
    v_add_u32_dpp v6, v6, v6 row_half_mirror row_mask:0xf bank_mask:0xf
    s_nop 0
    v_readfirstlane_b32 s19, v6
    v_readfirstlane_b32 s20, v7
    s_cmp_eq_u32 s20, 0
    s_cselect_b32 s19, 0, s19
    s_cmp_ge_u32 s19, 256
    s_nop 0
    s_cbranch_scc1 L_cntok
    s_sleep 1
    s_sub_u32 s32, s32, 1
    s_cmp_lg_u32 s32, 0
    s_cbranch_scc1 L_cnt
    s_branch L_fail
L_cntok:
    v_cmp_ne_u32 vcc, 32, v4
    s_lshl_b32 s18, s3, 5
    s_add_u32 s18, s18, s17
    s_mov_b32 s14, 0
    s_nop 0
    s_cbranch_vccz L_modeok
    s_mov_b32 s18, s2
    s_mov_b32 s14, 1
L_modeok:
    s_mov_b32 s92, s18
    s_mov_b32 s93, 0xffff
    s_sub_u32 s19, s18, 32
    s_cmp_lt_u32 s19, 32
    s_cselect_b32 s93, s19, s93
    s_sub_u32 s19, s18, 160
    s_cmp_ge_u32 s18, 192
    s_cselect_b32 s93, s19, s93
    s_sub_u32 s19, s18, 64
    s_lshr_b32 s20, s19, 2
    s_lshl_b32 s20, s20, 1
    s_and_b32 s21, s18, 1
    s_add_u32 s20, s20, s21
    s_add_u32 s20, s20, 96
    s_cmp_lt_u32 s19, 128
    s_cselect_b32 s21, 1, 0
    s_bitcmp1_b32 s18, 1
    s_cselect_b32 s21, s21, 0
    s_cmp_eq_u32 s21, 1
    s_cselect_b32 s93, s20, s93
    s_mov_b32 s16, 1
    s_lshr_b32 s13, s18, 5
    s_cmp_ge_u32 s18, 64
    s_cbranch_scc1 L_bulk
    s_and_b32 s12, s18, 15
    s_bitcmp1_b32 s18, 4
    s_cbranch_scc1 L_VC
    s_mov_b32 s60, s12
    s_mul_i32 s18, s12, 401408
    s_mul_i32 s19, s15, 100352
    s_add_u32 s18, s18, s19
    s_add_u32 s20, s18, 0
    v_and_b32 v1, 63, v0
    v_lshlrev_b32 v1, 4, v1
    s_mov_b32 s40, s93
    s_cmp_ge_u32 s40, 160
    s_cbranch_scc1 M_end_21
    v_lshlrev_b32 v6, 4, v0
    v_mov_b32 v8, -1
    v_mov_b32 v12, 0
    v_mov_b32 v9, -1
    v_mov_b32 v13, 0
    v_mov_b32 v10, -1
    v_mov_b32 v14, 0
    v_mov_b32 v11, -1
    v_mov_b32 v15, 0
    s_lshl_b32 s42, s40, 12
    s_add_u32 s42, s42, 126763008
    s_mov_b32 s46, 126894080
    s_mov_b32 s44, s4
    s_mov_b32 s45, s5
    s_mov_b32 s47, 0x00020000
    buffer_store_dwordx4 v[12:15], v6, s[44:47], s42 offen sc1
    s_lshl_b32 s42, s40, 12
    s_add_u32 s42, s42, 32398336
    s_mov_b32 s46, 32849920
    s_mov_b32 s44, s4
    s_mov_b32 s45, s5
    s_mov_b32 s47, 0x00020000
    buffer_store_dwordx4 v[8:11], v6, s[44:47], s42 offen sc1
    s_lshl_b32 s42, s40, 12
    s_add_u32 s42, s42, 33315840
    s_mov_b32 s46, 33767424
    s_mov_b32 s44, s4
    s_mov_b32 s45, s5
    s_mov_b32 s47, 0x00020000
    buffer_store_dwordx4 v[8:11], v6, s[44:47], s42 offen sc1
    s_lshl_b32 s42, s40, 12
    s_add_u32 s42, s42, 34226176
    s_mov_b32 s46, 34881536
    s_mov_b32 s44, s4
    s_mov_b32 s45, s5
    s_mov_b32 s47, 0x00020000
    buffer_store_dwordx4 v[8:11], v6, s[44:47], s42 offen sc1
    s_lshl_b32 s42, s40, 12
    s_add_u32 s42, s42, 32857088
    s_mov_b32 s46, 33308672
    s_mov_b32 s44, s4
    s_mov_b32 s45, s5
    s_mov_b32 s47, 0x00020000
    buffer_store_dwordx4 v[8:11], v6, s[44:47], s42 offen sc1
    s_lshl_b32 s42, s40, 12
    s_add_u32 s42, s42, 33774592
    s_mov_b32 s46, 34226176
    s_mov_b32 s44, s4
    s_mov_b32 s45, s5
    s_mov_b32 s47, 0x00020000
    buffer_store_dwordx4 v[8:11], v6, s[44:47], s42 offen sc1
    s_lshl_b32 s42, s40, 12
    s_add_u32 s42, s42, 34881536
    s_mov_b32 s46, 35536896
    s_mov_b32 s44, s4
    s_mov_b32 s45, s5
    s_mov_b32 s47, 0x00020000
    buffer_store_dwordx4 v[8:11], v6, s[44:47], s42 offen sc1
    s_cmp_ge_u32 s40, 32
    s_cbranch_scc1 M_end_21
    s_load_dwordx2 s[8:9], s[34:35], 0
    s_waitcnt lgkmcnt(0)
    s_mov_b32 s10, 1835008
    s_mov_b32 s11, 0x00020000
    v_lshrrev_b32 v4, 3, v0
    v_and_b32 v5, 7, v0
    v_mul_u32_u24 v2, 896, v4
    v_lshl_add_u32 v2, v5, 4, v2
    v_mul_u32_u24 v3, 928, v4
    v_lshl_add_u32 v3, v5, 4, v3
    s_add_u32 s41, s40, 32
    s_mul_i32 s42, s41, 28672
    buffer_load_dwordx4 v[16:19], v2, s[8:11], s42 offen offset:0
    buffer_load_dwordx4 v[20:23], v2, s[8:11], s42 offen offset:128
    buffer_load_dwordx4 v[24:27], v2, s[8:11], s42 offen offset:256
    buffer_load_dwordx4 v[28:31], v2, s[8:11], s42 offen offset:384
    buffer_load_dwordx4 v[32:35], v2, s[8:11], s42 offen offset:512
    buffer_load_dwordx4 v[36:39], v2, s[8:11], s42 offen offset:640
    buffer_load_dwordx4 v[40:43], v2, s[8:11], s42 offen offset:768
    s_waitcnt vmcnt(0)
    v_lshlrev_b32 v48, 16, v16
    v_and_b32 v49, 0xffff0000, v16
    v_lshlrev_b32 v50, 16, v17
    v_and_b32 v51, 0xffff0000, v17
    v_lshlrev_b32 v52, 16, v18
    v_and_b32 v53, 0xffff0000, v18
    v_lshlrev_b32 v54, 16, v19
    v_and_b32 v55, 0xffff0000, v19
    v_lshlrev_b32 v56, 16, v20
    v_and_b32 v57, 0xffff0000, v20
    v_lshlrev_b32 v58, 16, v21
    v_and_b32 v59, 0xffff0000, v21
    v_lshlrev_b32 v60, 16, v22
    v_and_b32 v61, 0xffff0000, v22
    v_lshlrev_b32 v62, 16, v23
    v_and_b32 v63, 0xffff0000, v23
    v_lshlrev_b32 v64, 16, v24
    v_and_b32 v65, 0xffff0000, v24
    v_lshlrev_b32 v66, 16, v25
    v_and_b32 v67, 0xffff0000, v25
    v_lshlrev_b32 v68, 16, v26
    v_and_b32 v69, 0xffff0000, v26
    v_lshlrev_b32 v70, 16, v27
    v_and_b32 v71, 0xffff0000, v27
    v_lshlrev_b32 v72, 16, v28
    v_and_b32 v73, 0xffff0000, v28
    v_lshlrev_b32 v74, 16, v29
    v_and_b32 v75, 0xffff0000, v29
    v_lshlrev_b32 v76, 16, v30
    v_and_b32 v77, 0xffff0000, v30
    v_lshlrev_b32 v78, 16, v31
    v_and_b32 v79, 0xffff0000, v31
    v_lshlrev_b32 v80, 16, v32
    v_and_b32 v81, 0xffff0000, v32
    v_lshlrev_b32 v82, 16, v33
    v_and_b32 v83, 0xffff0000, v33
    v_lshlrev_b32 v84, 16, v34
    v_and_b32 v85, 0xffff0000, v34
    v_lshlrev_b32 v86, 16, v35
    v_and_b32 v87, 0xffff0000, v35
    v_lshlrev_b32 v88, 16, v36
    v_and_b32 v89, 0xffff0000, v36
    v_lshlrev_b32 v90, 16, v37
    v_and_b32 v91, 0xffff0000, v37
    v_lshlrev_b32 v92, 16, v38
    v_and_b32 v93, 0xffff0000, v38
    v_lshlrev_b32 v94, 16, v39
    v_and_b32 v95, 0xffff0000, v39
    v_lshlrev_b32 v96, 16, v40
    v_and_b32 v97, 0xffff0000, v40
    v_lshlrev_b32 v98, 16, v41
    v_and_b32 v99, 0xffff0000, v41
    v_lshlrev_b32 v100, 16, v42
    v_and_b32 v101, 0xffff0000, v42
    v_lshlrev_b32 v102, 16, v43
    v_and_b32 v103, 0xffff0000, v43
    v_pk_add_f32 v[6:7], v[48:49], v[50:51]
    v_pk_add_f32 v[8:9], v[52:53], v[54:55]
    v_pk_add_f32 v[6:7], v[6:7], v[56:57]
    v_pk_add_f32 v[8:9], v[8:9], v[58:59]
    v_pk_add_f32 v[6:7], v[6:7], v[60:61]
    v_pk_add_f32 v[8:9], v[8:9], v[62:63]
    v_pk_add_f32 v[6:7], v[6:7], v[64:65]
    v_pk_add_f32 v[8:9], v[8:9], v[66:67]
    v_pk_add_f32 v[6:7], v[6:7], v[68:69]
    v_pk_add_f32 v[8:9], v[8:9], v[70:71]
    v_pk_add_f32 v[6:7], v[6:7], v[72:73]
    v_pk_add_f32 v[8:9], v[8:9], v[74:75]
    v_pk_add_f32 v[6:7], v[6:7], v[76:77]
    v_pk_add_f32 v[8:9], v[8:9], v[78:79]
    v_pk_add_f32 v[6:7], v[6:7], v[80:81]
    v_pk_add_f32 v[8:9], v[8:9], v[82:83]
    v_pk_add_f32 v[6:7], v[6:7], v[84:85]
    v_pk_add_f32 v[8:9], v[8:9], v[86:87]
    v_pk_add_f32 v[6:7], v[6:7], v[88:89]
    v_pk_add_f32 v[8:9], v[8:9], v[90:91]
    v_pk_add_f32 v[6:7], v[6:7], v[92:93]
    v_pk_add_f32 v[8:9], v[8:9], v[94:95]
    v_pk_add_f32 v[6:7], v[6:7], v[96:97]
    v_pk_add_f32 v[8:9], v[8:9], v[98:99]
    v_pk_add_f32 v[6:7], v[6:7], v[100:101]
    v_pk_add_f32 v[8:9], v[8:9], v[102:103]
    v_pk_add_f32 v[6:7], v[6:7], v[8:9]
    v_add_f32 v4, v6, v7
    s_nop 1
    v_add_f32_dpp v4, v4, v4 quad_perm:[1,0,3,2] row_mask:0xf bank_mask:0xf
    s_nop 1
    v_add_f32_dpp v4, v4, v4 quad_perm:[2,3,0,1] row_mask:0xf bank_mask:0xf
    s_nop 1
    v_add_f32_dpp v4, v4, v4 row_half_mirror row_mask:0xf bank_mask:0xf
    v_mul_f32 v8, 0xbb124925, v4
    v_mov_b32 v9, v8
    v_pk_add_f32 v[48:49], v[48:49], v[8:9]
    v_pk_add_f32 v[50:51], v[50:51], v[8:9]
    v_pk_add_f32 v[52:53], v[52:53], v[8:9]
    v_pk_add_f32 v[54:55], v[54:55], v[8:9]
    v_pk_add_f32 v[56:57], v[56:57], v[8:9]
    v_pk_add_f32 v[58:59], v[58:59], v[8:9]
    v_pk_add_f32 v[60:61], v[60:61], v[8:9]
    v_pk_add_f32 v[62:63], v[62:63], v[8:9]
    v_pk_add_f32 v[64:65], v[64:65], v[8:9]
    v_pk_add_f32 v[66:67], v[66:67], v[8:9]
    v_pk_add_f32 v[68:69], v[68:69], v[8:9]
    v_pk_add_f32 v[70:71], v[70:71], v[8:9]
    v_pk_add_f32 v[72:73], v[72:73], v[8:9]
    v_pk_add_f32 v[74:75], v[74:75], v[8:9]
    v_pk_add_f32 v[76:77], v[76:77], v[8:9]
    v_pk_add_f32 v[78:79], v[78:79], v[8:9]
    v_pk_add_f32 v[80:81], v[80:81], v[8:9]
    v_pk_add_f32 v[82:83], v[82:83], v[8:9]
    v_pk_add_f32 v[84:85], v[84:85], v[8:9]
    v_pk_add_f32 v[86:87], v[86:87], v[8:9]
    v_pk_add_f32 v[88:89], v[88:89], v[8:9]
    v_pk_add_f32 v[90:91], v[90:91], v[8:9]
    v_pk_add_f32 v[92:93], v[92:93], v[8:9]
    v_pk_add_f32 v[94:95], v[94:95], v[8:9]
    v_pk_add_f32 v[96:97], v[96:97], v[8:9]
    v_pk_add_f32 v[98:99], v[98:99], v[8:9]
    v_pk_add_f32 v[100:101], v[100:101], v[8:9]
    v_pk_add_f32 v[102:103], v[102:103], v[8:9]
    v_pk_mul_f32 v[6:7], v[48:49], v[48:49]
    v_pk_mul_f32 v[8:9], v[50:51], v[50:51]
    v_pk_fma_f32 v[6:7], v[52:53], v[52:53], v[6:7]
    v_pk_fma_f32 v[8:9], v[54:55], v[54:55], v[8:9]
    v_pk_fma_f32 v[6:7], v[56:57], v[56:57], v[6:7]
    v_pk_fma_f32 v[8:9], v[58:59], v[58:59], v[8:9]
    v_pk_fma_f32 v[6:7], v[60:61], v[60:61], v[6:7]
    v_pk_fma_f32 v[8:9], v[62:63], v[62:63], v[8:9]
    v_pk_fma_f32 v[6:7], v[64:65], v[64:65], v[6:7]
    v_pk_fma_f32 v[8:9], v[66:67], v[66:67], v[8:9]
    v_pk_fma_f32 v[6:7], v[68:69], v[68:69], v[6:7]
    v_pk_fma_f32 v[8:9], v[70:71], v[70:71], v[8:9]
    v_pk_fma_f32 v[6:7], v[72:73], v[72:73], v[6:7]
    v_pk_fma_f32 v[8:9], v[74:75], v[74:75], v[8:9]
    v_pk_fma_f32 v[6:7], v[76:77], v[76:77], v[6:7]
    v_pk_fma_f32 v[8:9], v[78:79], v[78:79], v[8:9]
    v_pk_fma_f32 v[6:7], v[80:81], v[80:81], v[6:7]
    v_pk_fma_f32 v[8:9], v[82:83], v[82:83], v[8:9]
    v_pk_fma_f32 v[6:7], v[84:85], v[84:85], v[6:7]
    v_pk_fma_f32 v[8:9], v[86:87], v[86:87], v[8:9]
    v_pk_fma_f32 v[6:7], v[88:89], v[88:89], v[6:7]
    v_pk_fma_f32 v[8:9], v[90:91], v[90:91], v[8:9]
    v_pk_fma_f32 v[6:7], v[92:93], v[92:93], v[6:7]
    v_pk_fma_f32 v[8:9], v[94:95], v[94:95], v[8:9]
    v_pk_fma_f32 v[6:7], v[96:97], v[96:97], v[6:7]
    v_pk_fma_f32 v[8:9], v[98:99], v[98:99], v[8:9]
    v_pk_fma_f32 v[6:7], v[100:101], v[100:101], v[6:7]
    v_pk_fma_f32 v[8:9], v[102:103], v[102:103], v[8:9]
    v_pk_add_f32 v[6:7], v[6:7], v[8:9]
    v_add_f32 v4, v6, v7
    s_nop 1
    v_add_f32_dpp v4, v4, v4 quad_perm:[1,0,3,2] row_mask:0xf bank_mask:0xf
    s_nop 1
    v_add_f32_dpp v4, v4, v4 quad_perm:[2,3,0,1] row_mask:0xf bank_mask:0xf
    s_nop 1
    v_add_f32_dpp v4, v4, v4 row_half_mirror row_mask:0xf bank_mask:0xf
    v_mov_b32 v6, 0x3727c5ac
    v_fmac_f32 v6, 0x3b124925, v4
    v_rsq_f32 v6, v6
    s_nop 0
    v_mov_b32 v7, v6
    v_pk_mul_f32 v[48:49], v[48:49], v[6:7]
    v_cvt_pk_bf16_f32 v16, v48, v49
    v_pk_mul_f32 v[50:51], v[50:51], v[6:7]
    v_cvt_pk_bf16_f32 v17, v50, v51
    v_pk_mul_f32 v[52:53], v[52:53], v[6:7]
    v_cvt_pk_bf16_f32 v18, v52, v53
    v_pk_mul_f32 v[54:55], v[54:55], v[6:7]
    v_cvt_pk_bf16_f32 v19, v54, v55
    v_pk_mul_f32 v[56:57], v[56:57], v[6:7]
    v_cvt_pk_bf16_f32 v20, v56, v57
    v_pk_mul_f32 v[58:59], v[58:59], v[6:7]
    v_cvt_pk_bf16_f32 v21, v58, v59
    v_pk_mul_f32 v[60:61], v[60:61], v[6:7]
    v_cvt_pk_bf16_f32 v22, v60, v61
    v_pk_mul_f32 v[62:63], v[62:63], v[6:7]
    v_cvt_pk_bf16_f32 v23, v62, v63
    v_pk_mul_f32 v[64:65], v[64:65], v[6:7]
    v_cvt_pk_bf16_f32 v24, v64, v65
    v_pk_mul_f32 v[66:67], v[66:67], v[6:7]
    v_cvt_pk_bf16_f32 v25, v66, v67
    v_pk_mul_f32 v[68:69], v[68:69], v[6:7]
    v_cvt_pk_bf16_f32 v26, v68, v69
    v_pk_mul_f32 v[70:71], v[70:71], v[6:7]
    v_cvt_pk_bf16_f32 v27, v70, v71
    v_pk_mul_f32 v[72:73], v[72:73], v[6:7]
    v_cvt_pk_bf16_f32 v28, v72, v73
    v_pk_mul_f32 v[74:75], v[74:75], v[6:7]
    v_cvt_pk_bf16_f32 v29, v74, v75
    v_pk_mul_f32 v[76:77], v[76:77], v[6:7]
    v_cvt_pk_bf16_f32 v30, v76, v77
    v_pk_mul_f32 v[78:79], v[78:79], v[6:7]
    v_cvt_pk_bf16_f32 v31, v78, v79
    v_pk_mul_f32 v[80:81], v[80:81], v[6:7]
    v_cvt_pk_bf16_f32 v32, v80, v81
    v_pk_mul_f32 v[82:83], v[82:83], v[6:7]
    v_cvt_pk_bf16_f32 v33, v82, v83
    v_pk_mul_f32 v[84:85], v[84:85], v[6:7]
    v_cvt_pk_bf16_f32 v34, v84, v85
    v_pk_mul_f32 v[86:87], v[86:87], v[6:7]
    v_cvt_pk_bf16_f32 v35, v86, v87
    v_pk_mul_f32 v[88:89], v[88:89], v[6:7]
    v_cvt_pk_bf16_f32 v36, v88, v89
    v_pk_mul_f32 v[90:91], v[90:91], v[6:7]
    v_cvt_pk_bf16_f32 v37, v90, v91
    v_pk_mul_f32 v[92:93], v[92:93], v[6:7]
    v_cvt_pk_bf16_f32 v38, v92, v93
    v_pk_mul_f32 v[94:95], v[94:95], v[6:7]
    v_cvt_pk_bf16_f32 v39, v94, v95
    v_pk_mul_f32 v[96:97], v[96:97], v[6:7]
    v_cvt_pk_bf16_f32 v40, v96, v97
    v_pk_mul_f32 v[98:99], v[98:99], v[6:7]
    v_cvt_pk_bf16_f32 v41, v98, v99
    v_pk_mul_f32 v[100:101], v[100:101], v[6:7]
    v_cvt_pk_bf16_f32 v42, v100, v101
    v_pk_mul_f32 v[102:103], v[102:103], v[6:7]
    v_cvt_pk_bf16_f32 v43, v102, v103
    s_mul_i32 s42, s41, 29696
    s_add_u32 s42, s42, 19267584
    buffer_store_dwordx4 v[16:19], v3, s[4:7], s42 offen offset:0 sc1
    buffer_store_dwordx4 v[20:23], v3, s[4:7], s42 offen offset:128 sc1
    buffer_store_dwordx4 v[24:27], v3, s[4:7], s42 offen offset:256 sc1
    buffer_store_dwordx4 v[28:31], v3, s[4:7], s42 offen offset:384 sc1
    buffer_store_dwordx4 v[32:35], v3, s[4:7], s42 offen offset:512 sc1
    buffer_store_dwordx4 v[36:39], v3, s[4:7], s42 offen offset:640 sc1
    buffer_store_dwordx4 v[40:43], v3, s[4:7], s42 offen offset:768 sc1
    s_nop 1
M_end_21:
    v_and_b32 v1, 63, v0
    v_lshlrev_b32 v1, 4, v1
    s_waitcnt vmcnt(0)
    s_barrier
    s_cmp_lg_u32 s15, 0
    s_cbranch_scc1 L_ic_23
    v_mov_b32 v46, 32
    v_mov_b32 v47, 1
    s_mov_b64 exec, 1
    global_atomic_add v46, v47, s[36:37] sc1
    s_mov_b64 exec, -1
L_ic_23:
    s_mov_b32 s32, 400000
    v_mbcnt_lo_u32_b32 v45, -1, 0
    v_lshrrev_b32 v44, 3, v45
    v_add_u32 v44, s60, v44
    v_lshlrev_b32 v44, 7, v44
    v_and_b32 v45, 7, v45
    v_lshl_add_u32 v45, v45, 2, v44
    s_mov_b32 s61, 1
    s_mov_b32 s26, 126894176
    s_mov_b32 exec_lo, 0x7f
    s_mov_b32 exec_hi, 0
L_iw_27:
    buffer_load_dword v44, v45, s[4:7], s26 offen sc1
    s_waitcnt vmcnt(0)
    v_cmp_eq_u32 vcc, 0, v44
    s_nop 3
    s_cbranch_vccz L_iwok_24
    s_mov_b32 s61, 0
    s_mov_b32 s26, 126894080
    s_mov_b32 exec_lo, 0x7f
    s_mov_b32 exec_hi, 0
L_iw_28:
    buffer_load_dword v44, v45, s[4:7], s26 offen sc1
    s_waitcnt vmcnt(0)
    v_cmp_eq_u32 vcc, 0, v44
    s_nop 3
    s_cbranch_vccz L_iwok_24
    s_sleep 1
    s_sub_u32 s32, s32, 1
    s_cmp_lg_u32 s32, 0
    s_cbranch_scc1 L_iw_28
    s_branch L_fail
L_iwok_24:
    s_mov_b64 exec, -1
L_iwsk_25:
    s_add_u32 s21, s20, 0
    buffer_load_dwordx4 v[120:123], v1, s[4:7], s21 offen offset:0 sc1
    buffer_load_dwordx4 v[124:127], v1, s[4:7], s21 offen offset:1024 sc1
    buffer_load_dwordx4 v[128:131], v1, s[4:7], s21 offen offset:2048 sc1
    buffer_load_dwordx4 v[132:135], v1, s[4:7], s21 offen offset:3072 sc1
    s_add_u32 s21, s20, 14336
    buffer_load_dwordx4 v[176:179], v1, s[4:7], s21 offen offset:0 sc1
    buffer_load_dwordx4 v[180:183], v1, s[4:7], s21 offen offset:1024 sc1
    buffer_load_dwordx4 v[184:187], v1, s[4:7], s21 offen offset:2048 sc1
    buffer_load_dwordx4 v[188:191], v1, s[4:7], s21 offen offset:3072 sc1
    s_add_u32 s21, s20, 28672
    buffer_load_dwordx4 v[232:235], v1, s[4:7], s21 offen offset:0 sc1
    buffer_load_dwordx4 v[236:239], v1, s[4:7], s21 offen offset:1024 sc1
    buffer_load_dwordx4 v[240:243], v1, s[4:7], s21 offen offset:2048 sc1
    buffer_load_dwordx4 v[244:247], v1, s[4:7], s21 offen offset:3072 sc1
    s_add_u32 s21, s20, 43008
    buffer_load_dwordx4 a[32:35], v1, s[4:7], s21 offen offset:0 sc1
    buffer_load_dwordx4 a[36:39], v1, s[4:7], s21 offen offset:1024 sc1
    buffer_load_dwordx4 a[40:43], v1, s[4:7], s21 offen offset:2048 sc1
    buffer_load_dwordx4 a[44:47], v1, s[4:7], s21 offen offset:3072 sc1
    s_add_u32 s21, s20, 57344
    buffer_load_dwordx4 a[88:91], v1, s[4:7], s21 offen offset:0 sc1
    buffer_load_dwordx4 a[92:95], v1, s[4:7], s21 offen offset:1024 sc1
    buffer_load_dwordx4 a[96:99], v1, s[4:7], s21 offen offset:2048 sc1
    buffer_load_dwordx4 a[100:103], v1, s[4:7], s21 offen offset:3072 sc1
    s_add_u32 s21, s20, 71680
    buffer_load_dwordx4 a[144:147], v1, s[4:7], s21 offen offset:0 sc1
    buffer_load_dwordx4 a[148:151], v1, s[4:7], s21 offen offset:1024 sc1
    buffer_load_dwordx4 a[152:155], v1, s[4:7], s21 offen offset:2048 sc1
    buffer_load_dwordx4 a[156:159], v1, s[4:7], s21 offen offset:3072 sc1
    s_add_u32 s21, s20, 86016
    buffer_load_dwordx4 a[200:203], v1, s[4:7], s21 offen offset:0 sc1
    buffer_load_dwordx4 a[204:207], v1, s[4:7], s21 offen offset:1024 sc1
    buffer_load_dwordx4 a[208:211], v1, s[4:7], s21 offen offset:2048 sc1
    buffer_load_dwordx4 a[212:215], v1, s[4:7], s21 offen offset:3072 sc1
    s_cmp_eq_u32 s61, 1
    s_cbranch_scc1 L_iwsk_30
    s_mov_b32 s32, 400000
    s_mov_b32 s26, 126894112
    s_mov_b32 exec_lo, 0x7f
    s_mov_b32 exec_hi, 0
L_iw_31:
    buffer_load_dword v44, v45, s[4:7], s26 offen sc1
    s_waitcnt vmcnt(0)
    v_cmp_eq_u32 vcc, 0, v44
    s_nop 3
    s_cbranch_vccz L_iwok_29
    s_sleep 1
    s_sub_u32 s32, s32, 1
    s_cmp_lg_u32 s32, 0
    s_cbranch_scc1 L_iw_31
    s_branch L_fail
L_iwok_29:
    s_mov_b64 exec, -1
L_iwsk_30:
    s_add_u32 s21, s20, 4096
    buffer_load_dwordx4 v[136:139], v1, s[4:7], s21 offen offset:0 sc1
    buffer_load_dwordx4 v[140:143], v1, s[4:7], s21 offen offset:1024 sc1
    buffer_load_dwordx4 v[144:147], v1, s[4:7], s21 offen offset:2048 sc1
    buffer_load_dwordx4 v[148:151], v1, s[4:7], s21 offen offset:3072 sc1
    s_add_u32 s21, s20, 18432
    buffer_load_dwordx4 v[192:195], v1, s[4:7], s21 offen offset:0 sc1
    buffer_load_dwordx4 v[196:199], v1, s[4:7], s21 offen offset:1024 sc1
    buffer_load_dwordx4 v[200:203], v1, s[4:7], s21 offen offset:2048 sc1
    buffer_load_dwordx4 v[204:207], v1, s[4:7], s21 offen offset:3072 sc1
    s_add_u32 s21, s20, 32768
    buffer_load_dwordx4 v[248:251], v1, s[4:7], s21 offen offset:0 sc1
    buffer_load_dwordx4 v[252:255], v1, s[4:7], s21 offen offset:1024 sc1
    buffer_load_dwordx4 a[0:3], v1, s[4:7], s21 offen offset:2048 sc1
    buffer_load_dwordx4 a[4:7], v1, s[4:7], s21 offen offset:3072 sc1
    s_add_u32 s21, s20, 47104
    buffer_load_dwordx4 a[48:51], v1, s[4:7], s21 offen offset:0 sc1
    buffer_load_dwordx4 a[52:55], v1, s[4:7], s21 offen offset:1024 sc1
    buffer_load_dwordx4 a[56:59], v1, s[4:7], s21 offen offset:2048 sc1
    buffer_load_dwordx4 a[60:63], v1, s[4:7], s21 offen offset:3072 sc1
    s_add_u32 s21, s20, 61440
    buffer_load_dwordx4 a[104:107], v1, s[4:7], s21 offen offset:0 sc1
    buffer_load_dwordx4 a[108:111], v1, s[4:7], s21 offen offset:1024 sc1
    buffer_load_dwordx4 a[112:115], v1, s[4:7], s21 offen offset:2048 sc1
    buffer_load_dwordx4 a[116:119], v1, s[4:7], s21 offen offset:3072 sc1
    s_add_u32 s21, s20, 75776
    buffer_load_dwordx4 a[160:163], v1, s[4:7], s21 offen offset:0 sc1
    buffer_load_dwordx4 a[164:167], v1, s[4:7], s21 offen offset:1024 sc1
    buffer_load_dwordx4 a[168:171], v1, s[4:7], s21 offen offset:2048 sc1
    buffer_load_dwordx4 a[172:175], v1, s[4:7], s21 offen offset:3072 sc1
    s_add_u32 s21, s20, 90112
    buffer_load_dwordx4 a[216:219], v1, s[4:7], s21 offen offset:0 sc1
    buffer_load_dwordx4 a[220:223], v1, s[4:7], s21 offen offset:1024 sc1
    buffer_load_dwordx4 a[224:227], v1, s[4:7], s21 offen offset:2048 sc1
    buffer_load_dwordx4 a[228:231], v1, s[4:7], s21 offen offset:3072 sc1
    s_cmp_eq_u32 s61, 1
    s_cbranch_scc1 L_iwsk_33
    s_mov_b32 s32, 400000
    s_mov_b32 s26, 126894144
    s_mov_b32 exec_lo, 0x7f
    s_mov_b32 exec_hi, 0
L_iw_34:
    buffer_load_dword v44, v45, s[4:7], s26 offen sc1
    s_waitcnt vmcnt(0)
    v_cmp_eq_u32 vcc, 0, v44
    s_nop 3
    s_cbranch_vccz L_iwok_32
    s_sleep 1
    s_sub_u32 s32, s32, 1
    s_cmp_lg_u32 s32, 0
    s_cbranch_scc1 L_iw_34
    s_branch L_fail
L_iwok_32:
    s_mov_b64 exec, -1
L_iwsk_33:
    s_waitcnt vmcnt(28)
    s_add_u32 s21, s20, 8192
    buffer_load_dwordx4 v[152:155], v1, s[4:7], s21 offen offset:0 sc1
    buffer_load_dwordx4 v[156:159], v1, s[4:7], s21 offen offset:1024 sc1
    buffer_load_dwordx4 v[160:163], v1, s[4:7], s21 offen offset:2048 sc1
    buffer_load_dwordx4 v[164:167], v1, s[4:7], s21 offen offset:3072 sc1
    s_add_u32 s21, s20, 22528
    buffer_load_dwordx4 v[208:211], v1, s[4:7], s21 offen offset:0 sc1
    buffer_load_dwordx4 v[212:215], v1, s[4:7], s21 offen offset:1024 sc1
    buffer_load_dwordx4 v[216:219], v1, s[4:7], s21 offen offset:2048 sc1
    buffer_load_dwordx4 v[220:223], v1, s[4:7], s21 offen offset:3072 sc1
    s_add_u32 s21, s20, 36864
    buffer_load_dwordx4 a[8:11], v1, s[4:7], s21 offen offset:0 sc1
    buffer_load_dwordx4 a[12:15], v1, s[4:7], s21 offen offset:1024 sc1
    buffer_load_dwordx4 a[16:19], v1, s[4:7], s21 offen offset:2048 sc1
    buffer_load_dwordx4 a[20:23], v1, s[4:7], s21 offen offset:3072 sc1
    s_add_u32 s21, s20, 51200
    buffer_load_dwordx4 a[64:67], v1, s[4:7], s21 offen offset:0 sc1
    buffer_load_dwordx4 a[68:71], v1, s[4:7], s21 offen offset:1024 sc1
    buffer_load_dwordx4 a[72:75], v1, s[4:7], s21 offen offset:2048 sc1
    buffer_load_dwordx4 a[76:79], v1, s[4:7], s21 offen offset:3072 sc1
    s_add_u32 s21, s20, 65536
    buffer_load_dwordx4 a[120:123], v1, s[4:7], s21 offen offset:0 sc1
    buffer_load_dwordx4 a[124:127], v1, s[4:7], s21 offen offset:1024 sc1
    buffer_load_dwordx4 a[128:131], v1, s[4:7], s21 offen offset:2048 sc1
    buffer_load_dwordx4 a[132:135], v1, s[4:7], s21 offen offset:3072 sc1
    s_add_u32 s21, s20, 79872
    buffer_load_dwordx4 a[176:179], v1, s[4:7], s21 offen offset:0 sc1
    buffer_load_dwordx4 a[180:183], v1, s[4:7], s21 offen offset:1024 sc1
    buffer_load_dwordx4 a[184:187], v1, s[4:7], s21 offen offset:2048 sc1
    buffer_load_dwordx4 a[188:191], v1, s[4:7], s21 offen offset:3072 sc1
    s_add_u32 s21, s20, 94208
    buffer_load_dwordx4 a[232:235], v1, s[4:7], s21 offen offset:0 sc1
    buffer_load_dwordx4 a[236:239], v1, s[4:7], s21 offen offset:1024 sc1
    buffer_load_dwordx4 a[240:243], v1, s[4:7], s21 offen offset:2048 sc1
    buffer_load_dwordx4 a[244:247], v1, s[4:7], s21 offen offset:3072 sc1
    s_cmp_eq_u32 s61, 1
    s_cbranch_scc1 L_iwsk_36
    s_mov_b32 s32, 400000
    s_mov_b32 s26, 126894176
    s_mov_b32 exec_lo, 0x7f
    s_mov_b32 exec_hi, 0
L_iw_37:
    buffer_load_dword v44, v45, s[4:7], s26 offen sc1
    s_waitcnt vmcnt(0)
    v_cmp_eq_u32 vcc, 0, v44
    s_nop 3
    s_cbranch_vccz L_iwok_35
    s_sleep 1
    s_sub_u32 s32, s32, 1
    s_cmp_lg_u32 s32, 0
    s_cbranch_scc1 L_iw_37
    s_branch L_fail
L_iwok_35:
    s_mov_b64 exec, -1
L_iwsk_36:
    s_waitcnt vmcnt(28)
    v_mov_b32 v47, 32
    global_load_dword v46, v47, s[36:37] sc1
    s_add_u32 s21, s20, 12288
    buffer_load_dwordx4 v[168:171], v1, s[4:7], s21 offen offset:0 sc1
    buffer_load_dwordx4 v[172:175], v1, s[4:7], s21 offen offset:1024 sc1
    s_add_u32 s21, s20, 26624
    buffer_load_dwordx4 v[224:227], v1, s[4:7], s21 offen offset:0 sc1
    buffer_load_dwordx4 v[228:231], v1, s[4:7], s21 offen offset:1024 sc1
    s_add_u32 s21, s20, 40960
    buffer_load_dwordx4 a[24:27], v1, s[4:7], s21 offen offset:0 sc1
    buffer_load_dwordx4 a[28:31], v1, s[4:7], s21 offen offset:1024 sc1
    s_add_u32 s21, s20, 55296
    buffer_load_dwordx4 a[80:83], v1, s[4:7], s21 offen offset:0 sc1
    buffer_load_dwordx4 a[84:87], v1, s[4:7], s21 offen offset:1024 sc1
    s_add_u32 s21, s20, 69632
    buffer_load_dwordx4 a[136:139], v1, s[4:7], s21 offen offset:0 sc1
    buffer_load_dwordx4 a[140:143], v1, s[4:7], s21 offen offset:1024 sc1
    s_add_u32 s21, s20, 83968
    buffer_load_dwordx4 a[192:195], v1, s[4:7], s21 offen offset:0 sc1
    buffer_load_dwordx4 a[196:199], v1, s[4:7], s21 offen offset:1024 sc1
    s_add_u32 s21, s20, 98304
    buffer_load_dwordx4 a[248:251], v1, s[4:7], s21 offen offset:0 sc1
    buffer_load_dwordx4 a[252:255], v1, s[4:7], s21 offen offset:1024 sc1
    s_waitcnt vmcnt(0)
    s_mov_b32 s16, 2
    v_readfirstlane_b32 s59, v46
    s_cmp_ge_u32 s59, 256
    s_nop 2
    s_cbranch_scc1 L_iok_38
    s_mov_b32 s32, 400000
    v_mbcnt_lo_u32_b32 v45, -1, 0
    v_add_u32 v45, 8, v45
    v_lshlrev_b32 v45, 2, v45
    s_mov_b64 exec, 1
    s_nop 0
L_dw_39:
    global_load_dword v44, v45, s[36:37] sc1
    s_waitcnt vmcnt(0)
    v_cmp_gt_u32 vcc, 256, v44
    s_nop 3
    s_cbranch_vccz L_dwok_40
    s_sleep 1
    s_sub_u32 s32, s32, 1
    s_cmp_lg_u32 s32, 0
    s_cbranch_scc1 L_dw_39
    s_branch L_fail
L_dwok_40:
    s_mov_b64 exec, -1
L_iok_38:
    v_and_b32 v18, 63, v0
    s_lshl_b32 s18, s15, 10
    v_lshlrev_b32 v2, 4, v18
    v_add_u32 v2, s18, v2
    v_lshrrev_b32 v19, 4, v18
    v_lshlrev_b32 v3, 8, v19
    v_and_b32 v19, 7, v18
    v_lshl_add_u32 v3, v19, 4, v3
    v_bfe_u32 v20, v18, 3, 1
    v_lshl_add_u32 v3, v20, 3, v3
    v_add_u32 v3, s18, v3
    v_add_u32 v3, 103936, v3
    v_add_u32 v4, 3072, v3
    s_cmp_eq_u32 s15, 0
    s_cselect_b32 s53, 6144, 0
    v_add_u32 v5, s53, v3
    v_mul_u32_u24 v6, 928, v19
    v_lshrrev_b32 v20, 3, v18
    v_lshl_add_u32 v6, v20, 4, v6
    s_lshl_b32 s18, s15, 7
    v_add_u32 v6, s18, v6
    v_add_u32 v6, 89088, v6
    s_cmp_eq_u32 s15, 0
    s_cselect_b32 s54, 768, 0
    v_and_b32 v18, 63, v0
    v_lshlrev_b32 v17, 4, v18
    v_add_u32 v8, 103936, v17
    v_and_b32 v19, 15, v18
    v_lshrrev_b32 v20, 4, v18
    s_mul_i32 s18, s15, 224
    v_mul_u32_u24 v11, 928, v19
    v_add_u32 v11, s18, v11
    v_lshl_add_u32 v12, v20, 3, v11
    v_add_u32 v12, 192, v12
    v_lshl_add_u32 v11, v20, 4, v11
    v_add_u32 v9, 89088, v11
    v_add_u32 v10, 89088, v12
    s_mul_i32 s18, s15, 4480
    s_add_u32 s18, s18, 111104
    v_mul_u32_u24 v13, 40, v19
    v_lshl_add_u32 v13, v20, 3, v13
    v_add_u32 v13, s18, v13
    v_lshrrev_b32 v21, 2, v19
    v_lshl_add_u32 v21, v20, 2, v21
    v_mul_u32_u24 v14, 40, v21
    v_and_b32 v21, 3, v19
    v_lshl_add_u32 v14, v21, 3, v14
    v_add_u32 v14, s18, v14
    s_mul_i32 s18, s15, 3264
    s_add_u32 s18, s18, 129024
    v_mul_u32_u24 v15, 272, v20
    v_lshl_add_u32 v15, v19, 4, v15
    v_add_u32 v15, s18, v15
    v_lshrrev_b32 v21, 2, v18
    v_mul_u32_u24 v62, 272, v21
    v_bfe_u32 v22, v18, 1, 1
    v_lshlrev_b32 v22, 3, v22
    v_and_b32 v23, 1, v18
    s_lshl_b32 s18, s15, 1
    v_add_u32 v23, s18, v23
    v_add_u32 v22, v22, v23
    v_lshl_add_u32 v62, v22, 4, v62
    v_add_u32 v62, 129024, v62
    v_mov_b32 v24, 144128
    s_mov_b32 s20, 0xffff00ff
    s_mov_b32 s21, 0x0000ffff
    v_cndmask_b32 v62, v24, v62, s[20:21]
    v_mov_b32 v26, 0xff800000
    v_mov_b32 v27, 0xff800000
    v_mov_b32 v28, 0xff800000
    v_mov_b32 v29, 0xff800000
    ds_write_b128 v24, v[26:29] offset:0
    ds_write_b128 v24, v[26:29] offset:3264
    ds_write_b128 v24, v[26:29] offset:6528
    ds_write_b128 v24, v[26:29] offset:9792
    v_lshrrev_b32 v22, 1, v21
    v_subrev_u32 v22, 1, v22
    v_max_i32 v22, 0, v22
    v_lshlrev_b32 v16, 7, v22
    v_lshl_add_u32 v16, v23, 4, v16
    v_and_b32 v22, 1, v21
    v_lshl_add_u32 v16, v22, 3, v16
    s_mul_i32 s18, s12, 640
    v_add_u32 v16, s18, v16
    s_mov_b32 s48, 0xffff00ff
    s_mov_b32 s49, 0x0000ffff
    s_mov_b32 s50, 0x33330033
    s_mov_b32 s51, 0x00003333
    s_mov_b32 s52, 0x3db8aa3b
    v_mov_b32 v60, 0x4444
    v_mov_b32 v21, 0xeeee
    v_cmp_gt_u32 vcc, 8, v19
    s_nop 1
    v_cndmask_b32 v60, v21, v60, vcc
    v_lshlrev_b32 v21, 2, v20
    v_sub_u32 v21, v19, v21
    v_mov_b32 v34, 0
    v_mov_b32 v22, 0x3f80
    v_cmp_eq_u32 vcc, 0, v21
    s_nop 1
    v_cndmask_b32 v34, v34, v22, vcc
    v_mov_b32 v22, 0x3f800000
    v_cmp_eq_u32 vcc, 1, v21
    s_nop 1
    v_cndmask_b32 v34, v34, v22, vcc
    v_mov_b32 v35, 0
    v_mov_b32 v22, 0x3f80
    v_cmp_eq_u32 vcc, 2, v21
    s_nop 1
    v_cndmask_b32 v35, v35, v22, vcc
    v_mov_b32 v22, 0x3f800000
    v_cmp_eq_u32 vcc, 3, v21
    s_nop 1
    v_cndmask_b32 v35, v35, v22, vcc
    v_mov_b32 v61, 0
    v_mov_b32 v22, 0
    v_mov_b32 v23, 0
    v_mov_b32 v24, 0
    v_mov_b32 v25, 0
    v_lshlrev_b32 v21, 4, v0
    v_add_u32 v21, 96512, v21
    ds_write_b128 v21, v[22:25]
    v_cmp_gt_u32 vcc, 208, v0
    s_and_saveexec_b64 s[18:19], vcc
    ds_write_b128 v21, v[22:25] offset:4096
    s_mov_b64 exec, s[18:19]
    s_cmp_eq_u32 s13, 0
    s_mov_b32 s40, 0x1f54000
    s_cselect_b32 s40, 0x1ee4000, s40
    s_cmp_eq_u32 s13, 0
    s_mov_b32 s41, 0x2144000
    s_cselect_b32 s41, 0x20a4000, s41
    s_cmp_eq_u32 s13, 0
    s_mov_b32 s42, 0x1431000
    s_cselect_b32 s42, 0x1260000, s42
    s_cmp_eq_u32 s13, 0
    s_mov_b32 s56, 0x2034000
    s_cselect_b32 s56, 0x1fc4000, s56
    s_cmp_eq_u32 s13, 0
    s_mov_b32 s46, 0x78fe000
    s_cselect_b32 s46, 0x78ee000, s46
    s_mov_b32 s16, 0
    s_mov_b32 s47, 0
    s_mov_b32 s55, 0
    s_cmp_lg_u32 s15, 3
    s_cbranch_scc1 L_xinit_41
    s_cmp_eq_u32 s13, 0
    s_cbranch_scc1 L_noflag_42
    s_mov_b32 s32, 400000
    v_mbcnt_lo_u32_b32 v19, -1, 0
    v_lshlrev_b32 v19, 2, v19
    s_mov_b32 exec_lo, 0x3
    s_mov_b32 exec_hi, 0
L_wf_43:
    buffer_load_dword v18, v19, s[4:7], s46 offen sc1
    s_waitcnt vmcnt(0)
    v_cmp_eq_u32 vcc, 0, v18
    s_nop 3
    s_cbranch_vccz L_wfok_44
    s_sleep 1
    s_sub_u32 s32, s32, 1
    s_cmp_lg_u32 s32, 0
    s_cbranch_scc1 L_wf_43
    s_branch L_fail
L_wfok_44:
    s_mov_b64 exec, -1
L_noflag_42:
    s_add_u32 s18, s46, 128
    v_mbcnt_lo_u32_b32 v18, -1, 0
    v_lshlrev_b32 v18, 2, v18
    s_mov_b32 exec_lo, -1
    s_mov_b32 exec_hi, 0
    buffer_load_dword v63, v18, s[4:7], s18 offen sc1
    s_mov_b64 exec, -1
    s_mov_b32 s44, s42
    s_mov_b32 s45, s47
    s_mov_b32 m0, s45
    s_nop 0
    buffer_load_dwordx4 v17, s[4:7], s44 offen offset:0 sc1 lds
    buffer_load_dwordx4 v17, s[4:7], s44 offen offset:1024 sc1 lds
    buffer_load_dwordx4 v17, s[4:7], s44 offen offset:2048 sc1 lds
    buffer_load_dwordx4 v17, s[4:7], s44 offen offset:3072 sc1 lds
    s_add_u32 s45, s45, 4096
    s_add_u32 s44, s44, 4096
    s_mov_b32 m0, s45
    s_nop 0
    buffer_load_dwordx4 v17, s[4:7], s44 offen offset:0 sc1 lds
    buffer_load_dwordx4 v17, s[4:7], s44 offen offset:1024 sc1 lds
    buffer_load_dwordx4 v17, s[4:7], s44 offen offset:2048 sc1 lds
    buffer_load_dwordx4 v17, s[4:7], s44 offen offset:3072 sc1 lds
    s_add_u32 s45, s45, 4096
    s_add_u32 s44, s44, 4096
    s_mov_b32 m0, s45
    s_nop 0
    buffer_load_dwordx4 v17, s[4:7], s44 offen offset:0 sc1 lds
    buffer_load_dwordx4 v17, s[4:7], s44 offen offset:1024 sc1 lds
    buffer_load_dwordx4 v17, s[4:7], s44 offen offset:2048 sc1 lds
    buffer_load_dwordx4 v17, s[4:7], s44 offen offset:3072 sc1 lds
    s_add_u32 s45, s45, 4096
    s_add_u32 s44, s44, 4096
    s_mov_b32 m0, s45
    s_nop 0
    buffer_load_dwordx4 v17, s[4:7], s44 offen offset:0 sc1 lds
    buffer_load_dwordx4 v17, s[4:7], s44 offen offset:1024 sc1 lds
    buffer_load_dwordx4 v17, s[4:7], s44 offen offset:2048 sc1 lds
    buffer_load_dwordx4 v17, s[4:7], s44 offen offset:3072 sc1 lds
    s_add_u32 s45, s45, 4096
    s_add_u32 s44, s44, 4096
    s_mov_b32 m0, s45
    s_nop 0
    buffer_load_dwordx4 v17, s[4:7], s44 offen offset:0 sc1 lds
    buffer_load_dwordx4 v17, s[4:7], s44 offen offset:1024 sc1 lds
    buffer_load_dwordx4 v17, s[4:7], s44 offen offset:2048 sc1 lds
    buffer_load_dwordx4 v17, s[4:7], s44 offen offset:3072 sc1 lds
    s_add_u32 s45, s45, 4096
    s_add_u32 s44, s44, 4096
    s_mov_b32 m0, s45
    s_nop 0
    buffer_load_dwordx4 v17, s[4:7], s44 offen offset:0 sc1 lds
    buffer_load_dwordx4 v17, s[4:7], s44 offen offset:1024 sc1 lds
    buffer_load_dwordx4 v17, s[4:7], s44 offen offset:2048 sc1 lds
    buffer_load_dwordx4 v17, s[4:7], s44 offen offset:3072 sc1 lds
    s_add_u32 s45, s45, 4096
    s_add_u32 s44, s44, 4096
    s_mov_b32 m0, s45
    s_nop 0
    buffer_load_dwordx4 v17, s[4:7], s44 offen offset:0 sc1 lds
    buffer_load_dwordx4 v17, s[4:7], s44 offen offset:1024 sc1 lds
    buffer_load_dwordx4 v17, s[4:7], s44 offen offset:2048 sc1 lds
    buffer_load_dwordx4 v17, s[4:7], s44 offen offset:3072 sc1 lds
    s_add_u32 s45, s45, 4096
    s_add_u32 s44, s44, 4096
    s_mov_b32 m0, s45
    s_nop 0
    buffer_load_dwordx4 v17, s[4:7], s44 offen offset:0 sc1 lds
    s_add_u32 s46, s46, 128
    s_add_u32 s42, s42, 29696
    s_add_u32 s47, s47, 29696
    s_cmp_eq_u32 s47, 89088
    s_cselect_b32 s47, 0, s47
    s_cmp_eq_u32 s13, 0
    s_cbranch_scc1 L_noflag_46
    s_mov_b32 s32, 400000
    v_mbcnt_lo_u32_b32 v19, -1, 0
    v_lshlrev_b32 v19, 2, v19
    s_mov_b32 exec_lo, 0x3
    s_mov_b32 exec_hi, 0
L_wf_47:
    buffer_load_dword v18, v19, s[4:7], s46 offen sc1
    s_waitcnt vmcnt(0)
    v_cmp_eq_u32 vcc, 0, v18
    s_nop 3
    s_cbranch_vccz L_wfok_48
    s_sleep 1
    s_sub_u32 s32, s32, 1
    s_cmp_lg_u32 s32, 0
    s_cbranch_scc1 L_wf_47
    s_branch L_fail
L_wfok_48:
    s_mov_b64 exec, -1
L_noflag_46:
    s_add_u32 s18, s46, 128
    v_mbcnt_lo_u32_b32 v18, -1, 0
    v_lshlrev_b32 v18, 2, v18
    s_mov_b32 exec_lo, -1
    s_mov_b32 exec_hi, 0
    buffer_load_dword v63, v18, s[4:7], s18 offen sc1
    s_mov_b64 exec, -1
    s_mov_b32 s44, s42
    s_mov_b32 s45, s47
    s_mov_b32 m0, s45
    s_nop 0
    buffer_load_dwordx4 v17, s[4:7], s44 offen offset:0 sc1 lds
    buffer_load_dwordx4 v17, s[4:7], s44 offen offset:1024 sc1 lds
    buffer_load_dwordx4 v17, s[4:7], s44 offen offset:2048 sc1 lds
    buffer_load_dwordx4 v17, s[4:7], s44 offen offset:3072 sc1 lds
    s_add_u32 s45, s45, 4096
    s_add_u32 s44, s44, 4096
    s_mov_b32 m0, s45
    s_nop 0
    buffer_load_dwordx4 v17, s[4:7], s44 offen offset:0 sc1 lds
    buffer_load_dwordx4 v17, s[4:7], s44 offen offset:1024 sc1 lds
    buffer_load_dwordx4 v17, s[4:7], s44 offen offset:2048 sc1 lds
    buffer_load_dwordx4 v17, s[4:7], s44 offen offset:3072 sc1 lds
    s_add_u32 s45, s45, 4096
    s_add_u32 s44, s44, 4096
    s_mov_b32 m0, s45
    s_nop 0
    buffer_load_dwordx4 v17, s[4:7], s44 offen offset:0 sc1 lds
    buffer_load_dwordx4 v17, s[4:7], s44 offen offset:1024 sc1 lds
    buffer_load_dwordx4 v17, s[4:7], s44 offen offset:2048 sc1 lds
    buffer_load_dwordx4 v17, s[4:7], s44 offen offset:3072 sc1 lds
    s_add_u32 s45, s45, 4096
    s_add_u32 s44, s44, 4096
    s_mov_b32 m0, s45
    s_nop 0
    buffer_load_dwordx4 v17, s[4:7], s44 offen offset:0 sc1 lds
    buffer_load_dwordx4 v17, s[4:7], s44 offen offset:1024 sc1 lds
    buffer_load_dwordx4 v17, s[4:7], s44 offen offset:2048 sc1 lds
    buffer_load_dwordx4 v17, s[4:7], s44 offen offset:3072 sc1 lds
    s_add_u32 s45, s45, 4096
    s_add_u32 s44, s44, 4096
    s_mov_b32 m0, s45
    s_nop 0
    buffer_load_dwordx4 v17, s[4:7], s44 offen offset:0 sc1 lds
    buffer_load_dwordx4 v17, s[4:7], s44 offen offset:1024 sc1 lds
    buffer_load_dwordx4 v17, s[4:7], s44 offen offset:2048 sc1 lds
    buffer_load_dwordx4 v17, s[4:7], s44 offen offset:3072 sc1 lds
    s_add_u32 s45, s45, 4096
    s_add_u32 s44, s44, 4096
    s_mov_b32 m0, s45
    s_nop 0
    buffer_load_dwordx4 v17, s[4:7], s44 offen offset:0 sc1 lds
    buffer_load_dwordx4 v17, s[4:7], s44 offen offset:1024 sc1 lds
    buffer_load_dwordx4 v17, s[4:7], s44 offen offset:2048 sc1 lds
    buffer_load_dwordx4 v17, s[4:7], s44 offen offset:3072 sc1 lds
    s_add_u32 s45, s45, 4096
    s_add_u32 s44, s44, 4096
    s_mov_b32 m0, s45
    s_nop 0
    buffer_load_dwordx4 v17, s[4:7], s44 offen offset:0 sc1 lds
    buffer_load_dwordx4 v17, s[4:7], s44 offen offset:1024 sc1 lds
    buffer_load_dwordx4 v17, s[4:7], s44 offen offset:2048 sc1 lds
    buffer_load_dwordx4 v17, s[4:7], s44 offen offset:3072 sc1 lds
    s_add_u32 s45, s45, 4096
    s_add_u32 s44, s44, 4096
    s_mov_b32 m0, s45
    s_nop 0
    buffer_load_dwordx4 v17, s[4:7], s44 offen offset:0 sc1 lds
    s_add_u32 s46, s46, 128
    s_add_u32 s42, s42, 29696
    s_add_u32 s47, s47, 29696
    s_cmp_eq_u32 s47, 89088
    s_cselect_b32 s47, 0, s47
L_xinit_41:
L_SC_loop:
    v_mov_b32 v64, 0
    v_mov_b32 v65, 0
    v_mov_b32 v66, 0
    v_mov_b32 v67, 0
    v_mov_b32 v68, 0
    v_mov_b32 v69, 0
    v_mov_b32 v70, 0
    v_mov_b32 v71, 0
    v_mov_b32 v72, 0
    v_mov_b32 v73, 0
    v_mov_b32 v74, 0
    v_mov_b32 v75, 0
    v_mov_b32 v76, 0
    v_mov_b32 v77, 0
    v_mov_b32 v78, 0
    v_mov_b32 v79, 0
    v_mov_b32 v80, 0
    v_mov_b32 v81, 0
    v_mov_b32 v82, 0
    v_mov_b32 v83, 0
    v_mov_b32 v84, 0
    v_mov_b32 v85, 0
    v_mov_b32 v86, 0
    v_mov_b32 v87, 0
    v_mov_b32 v88, 0
    v_mov_b32 v89, 0
    v_mov_b32 v90, 0
    v_mov_b32 v91, 0
    s_cmp_eq_u32 s15, 3
    s_cbranch_scc1 L_scio_50
    s_mov_b32 s32, 400000
    s_add_u32 s25, s40, s53
    v_mov_b32 v44, 0
    v_mov_b32 v45, 0
    v_mov_b32 v46, 0
    v_mov_b32 v47, 0
    s_nop 1
L_mpoll_52:
    buffer_load_dwordx4 v[36:39], v2, s[4:7], s40 offen sc1
    buffer_load_dwordx4 v[40:43], v2, s[4:7], s40 offen offset:3072 sc1
    s_cmp_lg_u32 s15, 0
    s_cbranch_scc1 L_t3_56
    buffer_load_dwordx4 v[44:47], v2, s[4:7], s25 offen sc1
L_t3_56:
    s_waitcnt vmcnt(0)
    v_max3_u32 v18, v36, v37, v38
    v_max3_u32 v19, v39, v40, v41
    v_max3_u32 v18, v18, v42, v43
    v_max3_u32 v19, v19, v44, v45
    v_max3_u32 v18, v18, v46, v47
    v_max_u32 v18, v18, v19
    v_cmp_eq_u32 vcc, -1, v18
    s_nop 3
    s_cbranch_vccz L_mgot_53
    s_sub_u32 s32, s32, 1
    s_cmp_lg_u32 s32, 0
    s_cbranch_scc1 L_mpoll_52
    s_branch L_fail
L_mgot_53:
    ds_write2_b32 v3, v36, v38 offset0:0 offset1:1
    ds_write2_b32 v3, v37, v39 offset0:32 offset1:33
    ds_write2_b32 v4, v40, v42 offset0:0 offset1:1
    ds_write2_b32 v4, v41, v43 offset0:32 offset1:33
    ds_write_b128 v6, v[36:39]
    ds_write_b128 v6, v[40:43] offset:384
    s_cmp_lg_u32 s15, 0
    s_cbranch_scc1 L_s3_57
    ds_write2_b32 v5, v44, v46 offset0:0 offset1:1
    ds_write2_b32 v5, v45, v47 offset0:32 offset1:33
    v_add_u32 v18, s54, v6
    ds_write_b128 v18, v[44:47]
    s_nop 0
L_s3_57:
    s_waitcnt lgkmcnt(0)
    s_branch L_scb1_51
L_scio_50:
    s_cmp_eq_u32 s16, 0
    s_cbranch_scc1 L_sc_w0
    s_cmp_ge_u32 s16, 62
    s_cbranch_scc1 L_sc_wall
L_sc_w0:
    s_waitcnt vmcnt(29)
    s_branch L_scb1_51
L_sc_wall:
    s_waitcnt vmcnt(0)
L_scb1_51:
    s_barrier
    ds_read_b128 v[92:95], v8 offset:0
    ds_read_b128 v[96:99], v8 offset:1024
    ds_read_b128 v[100:103], v8 offset:2048
    ds_read_b128 v[104:107], v8 offset:3072
    ds_read_b128 v[108:111], v8 offset:4096
    ds_read_b128 v[112:115], v8 offset:5120
    ds_read_b128 v[116:119], v8 offset:6144
    s_waitcnt lgkmcnt(6)
    v_smfmac_f32_16x16x64_bf16 v[64:67], v[92:95], v[120:127], v60
    s_waitcnt lgkmcnt(5)
    v_smfmac_f32_16x16x64_bf16 v[64:67], v[96:99], v[128:135], v60
    s_waitcnt lgkmcnt(4)
    v_smfmac_f32_16x16x64_bf16 v[64:67], v[100:103], v[136:143], v60
    s_waitcnt lgkmcnt(3)
    v_smfmac_f32_16x16x64_bf16 v[64:67], v[104:107], v[144:151], v60
    s_waitcnt lgkmcnt(2)
    v_smfmac_f32_16x16x64_bf16 v[64:67], v[108:111], v[152:159], v60
    s_waitcnt lgkmcnt(1)
    v_smfmac_f32_16x16x64_bf16 v[64:67], v[112:115], v[160:167], v60
    s_waitcnt lgkmcnt(0)
    v_smfmac_f32_16x16x64_bf16 v[64:67], v[116:119], v[168:175], v60
    v_smfmac_f32_16x16x64_bf16 v[68:71], v[92:95], v[176:183], v60
    s_cmp_eq_u32 s15, 3
    s_cbranch_scc1 L_scv_58
    s_waitcnt vmcnt(0)
L_scv_58:
    v_smfmac_f32_16x16x64_bf16 v[68:71], v[96:99], v[184:191], v60
    ds_read_b128 v[48:51], v9 offset:0
    ds_read_b128 v[52:55], v11 offset:0
    ds_read_b128 v[56:59], v11 offset:14848
    s_nop 0
    v_smfmac_f32_16x16x64_bf16 v[68:71], v[100:103], v[192:199], v60
    s_nop 0
    v_smfmac_f32_16x16x64_bf16 v[68:71], v[104:107], v[200:207], v60
    s_nop 0
    v_smfmac_f32_16x16x64_bf16 v[68:71], v[108:111], v[208:215], v60
    v_cvt_pk_bf16_f32 v64, v64, v65
    v_cvt_pk_bf16_f32 v65, v66, v67
    v_smfmac_f32_16x16x64_bf16 v[68:71], v[112:115], v[216:223], v60
    ds_write_b64 v13, v[64:65] offset:0
    v_smfmac_f32_16x16x64_bf16 v[68:71], v[116:119], v[224:231], v60
    ds_read_b64_tr_b16 v[64:65], v14 offset:0
    v_smfmac_f32_16x16x64_bf16 v[72:75], v[92:95], v[232:239], v60
    v_smfmac_f32_16x16x64_bf16 v[72:75], v[96:99], v[240:247], v60
    s_nop 0
    v_smfmac_f32_16x16x64_bf16 v[72:75], v[100:103], v[248:255], v60
    s_nop 0
    v_smfmac_f32_16x16x64_bf16 v[72:75], v[104:107], a[0:7], v60
    s_nop 0
    v_smfmac_f32_16x16x64_bf16 v[72:75], v[108:111], a[8:15], v60
    v_cvt_pk_bf16_f32 v68, v68, v69
    v_cvt_pk_bf16_f32 v69, v70, v71
    v_smfmac_f32_16x16x64_bf16 v[72:75], v[112:115], a[16:23], v60
    ds_write_b64 v13, v[68:69] offset:640
    v_smfmac_f32_16x16x64_bf16 v[72:75], v[116:119], a[24:31], v60
    ds_read_b64_tr_b16 v[66:67], v14 offset:640
    v_smfmac_f32_16x16x64_bf16 v[76:79], v[92:95], a[32:39], v60
    v_smfmac_f32_16x16x64_bf16 v[76:79], v[96:99], a[40:47], v60
    s_nop 0
    v_smfmac_f32_16x16x64_bf16 v[76:79], v[100:103], a[48:55], v60
    s_nop 0
    v_smfmac_f32_16x16x64_bf16 v[76:79], v[104:107], a[56:63], v60
    s_nop 0
    s_waitcnt lgkmcnt(0)
    v_mfma_f32_16x16x32_bf16 v[36:39], v[48:51], v[64:67], 0
    v_mfma_f32_16x16x32_bf16 v[40:43], v[52:55], v[64:67], 0
    v_mfma_f32_16x16x32_bf16 v[44:47], v[56:59], v[64:67], 0
    v_smfmac_f32_16x16x64_bf16 v[76:79], v[108:111], a[64:71], v60
    v_cvt_pk_bf16_f32 v72, v72, v73
    v_cvt_pk_bf16_f32 v73, v74, v75
    v_smfmac_f32_16x16x64_bf16 v[76:79], v[112:115], a[72:79], v60
    ds_write_b64 v13, v[72:73] offset:1280
    v_smfmac_f32_16x16x64_bf16 v[76:79], v[116:119], a[80:87], v60
    ds_read_b64_tr_b16 v[72:73], v14 offset:1280
    ds_read_b128 v[48:51], v9 offset:64
    ds_read_b128 v[52:55], v11 offset:64
    ds_read_b128 v[56:59], v11 offset:14912
    v_smfmac_f32_16x16x64_bf16 v[80:83], v[92:95], a[88:95], v60
    v_smfmac_f32_16x16x64_bf16 v[80:83], v[96:99], a[96:103], v60
    s_nop 0
    v_smfmac_f32_16x16x64_bf16 v[80:83], v[100:103], a[104:111], v60
    s_nop 0
    v_smfmac_f32_16x16x64_bf16 v[80:83], v[104:107], a[112:119], v60
    s_nop 0
    v_smfmac_f32_16x16x64_bf16 v[80:83], v[108:111], a[120:127], v60
    v_cvt_pk_bf16_f32 v76, v76, v77
    v_cvt_pk_bf16_f32 v77, v78, v79
    v_smfmac_f32_16x16x64_bf16 v[80:83], v[112:115], a[128:135], v60
    ds_write_b64 v13, v[76:77] offset:1920
    v_smfmac_f32_16x16x64_bf16 v[80:83], v[116:119], a[136:143], v60
    ds_read_b64_tr_b16 v[74:75], v14 offset:1920
    v_smfmac_f32_16x16x64_bf16 v[84:87], v[92:95], a[144:151], v60
    v_smfmac_f32_16x16x64_bf16 v[84:87], v[96:99], a[152:159], v60
    s_nop 0
    v_smfmac_f32_16x16x64_bf16 v[84:87], v[100:103], a[160:167], v60
    s_nop 0
    v_smfmac_f32_16x16x64_bf16 v[84:87], v[104:107], a[168:175], v60
    s_nop 0
    s_waitcnt lgkmcnt(0)
    v_mfma_f32_16x16x32_bf16 v[36:39], v[48:51], v[72:75], v[36:39]
    v_mfma_f32_16x16x32_bf16 v[40:43], v[52:55], v[72:75], v[40:43]
    v_mfma_f32_16x16x32_bf16 v[44:47], v[56:59], v[72:75], v[44:47]
    v_smfmac_f32_16x16x64_bf16 v[84:87], v[108:111], a[176:183], v60
    v_cvt_pk_bf16_f32 v80, v80, v81
    v_cvt_pk_bf16_f32 v81, v82, v83
    v_smfmac_f32_16x16x64_bf16 v[84:87], v[112:115], a[184:191], v60
    ds_write_b64 v13, v[80:81] offset:2560
    v_smfmac_f32_16x16x64_bf16 v[84:87], v[116:119], a[192:199], v60
    ds_read_b64_tr_b16 v[80:81], v14 offset:2560
    ds_read_b128 v[48:51], v9 offset:128
    ds_read_b128 v[52:55], v11 offset:128
    ds_read_b128 v[56:59], v11 offset:14976
    v_smfmac_f32_16x16x64_bf16 v[88:91], v[92:95], a[200:207], v60
    v_smfmac_f32_16x16x64_bf16 v[88:91], v[96:99], a[208:215], v60
    s_nop 0
    v_smfmac_f32_16x16x64_bf16 v[88:91], v[100:103], a[216:223], v60
    s_nop 0
    v_smfmac_f32_16x16x64_bf16 v[88:91], v[104:107], a[224:231], v60
    s_nop 0
    v_smfmac_f32_16x16x64_bf16 v[88:91], v[108:111], a[232:239], v60
    v_cvt_pk_bf16_f32 v84, v84, v85
    v_cvt_pk_bf16_f32 v85, v86, v87
    v_smfmac_f32_16x16x64_bf16 v[88:91], v[112:115], a[240:247], v60
    s_nop 0
    v_mfma_f32_16x16x16_bf16 v[22:25], v[84:85], v[34:35], 0
    v_smfmac_f32_16x16x64_bf16 v[88:91], v[116:119], a[248:255], v60
    s_nop 6
    v_cvt_pk_bf16_f32 v82, v22, v23
    v_cvt_pk_bf16_f32 v83, v24, v25
    s_waitcnt lgkmcnt(0)
    s_nop 0
    v_mfma_f32_16x16x32_bf16 v[36:39], v[48:51], v[80:83], v[36:39]
    v_mfma_f32_16x16x32_bf16 v[40:43], v[52:55], v[80:83], v[40:43]
    v_mfma_f32_16x16x32_bf16 v[44:47], v[56:59], v[80:83], v[44:47]
    ds_read_b64 v[48:49], v10
    ds_read_b64 v[52:53], v12
    ds_read_b64 v[56:57], v12 offset:14848
    v_cvt_pk_bf16_f32 v88, v88, v89
    v_cvt_pk_bf16_f32 v89, v90, v91
    s_nop 1
    v_mfma_f32_16x16x16_bf16 v[18:21], v[88:89], v[34:35], 0
    s_nop 7
    v_cvt_pk_bf16_f32 v88, v18, v19
    v_cvt_pk_bf16_f32 v89, v20, v21
    s_waitcnt lgkmcnt(0)
    s_nop 0
    v_mfma_f32_16x16x16_bf16 v[36:39], v[48:49], v[88:89], v[36:39]
    v_mfma_f32_16x16x16_bf16 v[40:43], v[52:53], v[88:89], v[40:43]
    v_mfma_f32_16x16x16_bf16 v[44:47], v[56:57], v[88:89], v[44:47]
    s_nop 5
    ds_write_b128 v15, v[36:39] offset:0
    ds_write_b128 v15, v[40:43] offset:1088
    ds_write_b128 v15, v[44:47] offset:2176
    s_waitcnt lgkmcnt(0)
    s_barrier
    ds_read_b128 v[64:67], v62 offset:0
    ds_read_b128 v[68:71], v62 offset:3264
    ds_read_b128 v[72:75], v62 offset:6528
    ds_read_b128 v[76:79], v62 offset:9792
    s_waitcnt lgkmcnt(2)
    v_add_f32 v64, v64, v68
    v_add_f32 v65, v65, v69
    v_add_f32 v66, v66, v70
    v_add_f32 v67, v67, v71
    s_waitcnt lgkmcnt(0)
    v_add_f32 v72, v72, v76
    v_add_f32 v73, v73, v77
    v_add_f32 v74, v74, v78
    v_add_f32 v75, v75, v79
    v_add_f32 v64, v64, v72
    v_add_f32 v65, v65, v73
    v_add_f32 v66, v66, v74
    v_add_f32 v67, v67, v75
    v_add_f32_dpp v64, v64, v64 quad_perm:[2,3,0,1] row_mask:0xf bank_mask:0xf
    v_add_f32_dpp v65, v65, v65 quad_perm:[2,3,0,1] row_mask:0xf bank_mask:0xf
    v_add_f32_dpp v66, v66, v66 quad_perm:[2,3,0,1] row_mask:0xf bank_mask:0xf
    v_add_f32_dpp v67, v67, v67 quad_perm:[2,3,0,1] row_mask:0xf bank_mask:0xf
    v_max3_f32 v18, v64, v65, v66
    v_max_f32 v18, v18, v67
    s_nop 1
    v_max_f32_dpp v18, v18, v18 row_ror:4 row_mask:0xf bank_mask:0xf
    s_nop 1
    v_max_f32_dpp v18, v18, v18 row_ror:8 row_mask:0xf bank_mask:0xf
    v_mov_b32 v19, v18
    s_nop 1
    v_permlane16_swap_b32 v19, v18
    v_max_f32 v18, v18, v19
    v_mov_b32 v19, v18
    s_nop 1
    v_permlane32_swap_b32 v19, v18
    v_max_f32 v18, v18, v19
    v_mul_f32 v18, s52, v18
    v_fma_f32 v64, v64, s52, -v18
    v_fma_f32 v65, v65, s52, -v18
    v_fma_f32 v66, v66, s52, -v18
    v_fma_f32 v67, v67, s52, -v18
    v_exp_f32 v64, v64
    v_exp_f32 v65, v65
    v_exp_f32 v66, v66
    v_exp_f32 v67, v67
    v_add_f32 v18, v64, v65
    v_add_f32 v19, v66, v67
    v_add_f32 v18, v18, v19
    s_nop 1
    v_add_f32_dpp v18, v18, v18 row_ror:4 row_mask:0xf bank_mask:0xf
    s_nop 1
    v_add_f32_dpp v18, v18, v18 row_ror:8 row_mask:0xf bank_mask:0xf
    v_mov_b32 v19, v18
    s_nop 1
    v_permlane16_swap_b32 v19, v18
    v_add_f32 v18, v18, v19
    v_mov_b32 v19, v18
    s_nop 1
    v_permlane32_swap_b32 v19, v18
    v_add_f32 v18, v18, v19
    v_rcp_f32 v18, v18
    s_nop 0
    v_mul_f32 v64, v64, v18
    v_mul_f32 v65, v65, v18
    v_mul_f32 v66, v66, v18
    v_mul_f32 v67, v67, v18
    v_cvt_pk_bf16_f32 v64, v64, v65
    v_cvt_pk_bf16_f32 v65, v66, v67
    s_mov_b64 exec, s[50:51]
    s_cmp_lg_u32 s14, 0
    s_cbranch_scc1 L_slow_59
    buffer_store_dwordx2 v[64:65], v16, s[4:7], s41 offen
    s_branch L_st_60
L_slow_59:
    buffer_store_dwordx2 v[64:65], v16, s[4:7], s41 offen sc1
L_st_60:
    s_mov_b64 exec, -1
    s_add_u32 s16, s16, 1
    s_cmp_ge_u32 s16, 63
    s_cbranch_scc1 L_role_done
    s_add_u32 s40, s40, 7168
    s_add_u32 s56, s56, 7168
    s_add_u32 s41, s41, 10240
    s_add_u32 s55, s55, 29696
    s_cmp_eq_u32 s55, 89088
    s_mov_b32 s18, 29696
    s_cselect_b32 s18, 0xffff1800, s18
    s_cselect_b32 s55, 0, s55
    v_add_u32 v11, s18, v11
    v_add_u32 v12, s18, v12
    s_cmp_lg_u32 s15, 3
    s_cbranch_scc1 L_noxn_61
    s_add_u32 s18, s16, 1
    s_cmp_ge_u32 s18, 63
    s_cbranch_scc1 L_noxn_61
    s_cmp_eq_u32 s13, 0
    s_cbranch_scc1 L_noflag_62
    s_mov_b32 exec_lo, 0x3
    s_mov_b32 exec_hi, 0
    v_cmp_eq_u32 vcc, 0, v63
    s_mov_b64 exec, -1
    s_nop 2
    s_cbranch_vccz L_noflag_62
    s_mov_b32 s32, 400000
    v_mbcnt_lo_u32_b32 v19, -1, 0
    v_lshlrev_b32 v19, 2, v19
    s_mov_b32 exec_lo, 0x3
    s_mov_b32 exec_hi, 0
L_wf_63:
    buffer_load_dword v18, v19, s[4:7], s46 offen sc1
    s_waitcnt vmcnt(0)
    v_cmp_eq_u32 vcc, 0, v18
    s_nop 3
    s_cbranch_vccz L_wfok_64
    s_sleep 1
    s_sub_u32 s32, s32, 1
    s_cmp_lg_u32 s32, 0
    s_cbranch_scc1 L_wf_63
    s_branch L_fail
L_wfok_64:
    s_mov_b64 exec, -1
L_noflag_62:
    s_add_u32 s18, s46, 128
    v_mbcnt_lo_u32_b32 v18, -1, 0
    v_lshlrev_b32 v18, 2, v18
    s_mov_b32 exec_lo, -1
    s_mov_b32 exec_hi, 0
    buffer_load_dword v63, v18, s[4:7], s18 offen sc1
    s_mov_b64 exec, -1
    s_mov_b32 s44, s42
    s_mov_b32 s45, s47
    s_mov_b32 m0, s45
    s_nop 0
    buffer_load_dwordx4 v17, s[4:7], s44 offen offset:0 sc1 lds
    buffer_load_dwordx4 v17, s[4:7], s44 offen offset:1024 sc1 lds
    buffer_load_dwordx4 v17, s[4:7], s44 offen offset:2048 sc1 lds
    buffer_load_dwordx4 v17, s[4:7], s44 offen offset:3072 sc1 lds
    s_add_u32 s45, s45, 4096
    s_add_u32 s44, s44, 4096
    s_mov_b32 m0, s45
    s_nop 0
    buffer_load_dwordx4 v17, s[4:7], s44 offen offset:0 sc1 lds
    buffer_load_dwordx4 v17, s[4:7], s44 offen offset:1024 sc1 lds
    buffer_load_dwordx4 v17, s[4:7], s44 offen offset:2048 sc1 lds
    buffer_load_dwordx4 v17, s[4:7], s44 offen offset:3072 sc1 lds
    s_add_u32 s45, s45, 4096
    s_add_u32 s44, s44, 4096
    s_mov_b32 m0, s45
    s_nop 0
    buffer_load_dwordx4 v17, s[4:7], s44 offen offset:0 sc1 lds
    buffer_load_dwordx4 v17, s[4:7], s44 offen offset:1024 sc1 lds
    buffer_load_dwordx4 v17, s[4:7], s44 offen offset:2048 sc1 lds
    buffer_load_dwordx4 v17, s[4:7], s44 offen offset:3072 sc1 lds
    s_add_u32 s45, s45, 4096
    s_add_u32 s44, s44, 4096
    s_mov_b32 m0, s45
    s_nop 0
    buffer_load_dwordx4 v17, s[4:7], s44 offen offset:0 sc1 lds
    buffer_load_dwordx4 v17, s[4:7], s44 offen offset:1024 sc1 lds
    buffer_load_dwordx4 v17, s[4:7], s44 offen offset:2048 sc1 lds
    buffer_load_dwordx4 v17, s[4:7], s44 offen offset:3072 sc1 lds
    s_add_u32 s45, s45, 4096
    s_add_u32 s44, s44, 4096
    s_mov_b32 m0, s45
    s_nop 0
    buffer_load_dwordx4 v17, s[4:7], s44 offen offset:0 sc1 lds
    buffer_load_dwordx4 v17, s[4:7], s44 offen offset:1024 sc1 lds
    buffer_load_dwordx4 v17, s[4:7], s44 offen offset:2048 sc1 lds
    buffer_load_dwordx4 v17, s[4:7], s44 offen offset:3072 sc1 lds
    s_add_u32 s45, s45, 4096
    s_add_u32 s44, s44, 4096
    s_mov_b32 m0, s45
    s_nop 0
    buffer_load_dwordx4 v17, s[4:7], s44 offen offset:0 sc1 lds
    buffer_load_dwordx4 v17, s[4:7], s44 offen offset:1024 sc1 lds
    buffer_load_dwordx4 v17, s[4:7], s44 offen offset:2048 sc1 lds
    buffer_load_dwordx4 v17, s[4:7], s44 offen offset:3072 sc1 lds
    s_add_u32 s45, s45, 4096
    s_add_u32 s44, s44, 4096
    s_mov_b32 m0, s45
    s_nop 0
    buffer_load_dwordx4 v17, s[4:7], s44 offen offset:0 sc1 lds
    buffer_load_dwordx4 v17, s[4:7], s44 offen offset:1024 sc1 lds
    buffer_load_dwordx4 v17, s[4:7], s44 offen offset:2048 sc1 lds
    buffer_load_dwordx4 v17, s[4:7], s44 offen offset:3072 sc1 lds
    s_add_u32 s45, s45, 4096
    s_add_u32 s44, s44, 4096
    s_mov_b32 m0, s45
    s_nop 0
    buffer_load_dwordx4 v17, s[4:7], s44 offen offset:0 sc1 lds
    s_add_u32 s46, s46, 128
    s_add_u32 s42, s42, 29696
    s_add_u32 s47, s47, 29696
    s_cmp_eq_u32 s47, 89088
    s_cselect_b32 s47, 0, s47
L_noxn_61:
    s_branch L_SC_loop
L_VC:
    s_lshl_b32 s60, s15, 2
    s_add_u32 s60, s60, 16
    s_mul_i32 s18, s12, 401408
    s_mul_i32 s19, s15, 100352
    s_add_u32 s18, s18, s19
    s_add_u32 s20, s18, 12845056
    v_and_b32 v1, 63, v0
    v_lshlrev_b32 v1, 4, v1
    s_mov_b32 s40, s93
    s_cmp_ge_u32 s40, 160
    s_cbranch_scc1 M_end_66
    v_lshlrev_b32 v6, 4, v0
    v_mov_b32 v8, -1
    v_mov_b32 v12, 0
    v_mov_b32 v9, -1
    v_mov_b32 v13, 0
    v_mov_b32 v10, -1
    v_mov_b32 v14, 0
    v_mov_b32 v11, -1
    v_mov_b32 v15, 0
    s_lshl_b32 s42, s40, 12
    s_add_u32 s42, s42, 126763008
    s_mov_b32 s46, 126894080
    s_mov_b32 s44, s4
    s_mov_b32 s45, s5
    s_mov_b32 s47, 0x00020000
    buffer_store_dwordx4 v[12:15], v6, s[44:47], s42 offen sc1
    s_lshl_b32 s42, s40, 12
    s_add_u32 s42, s42, 32398336
    s_mov_b32 s46, 32849920
    s_mov_b32 s44, s4
    s_mov_b32 s45, s5
    s_mov_b32 s47, 0x00020000
    buffer_store_dwordx4 v[8:11], v6, s[44:47], s42 offen sc1
    s_lshl_b32 s42, s40, 12
    s_add_u32 s42, s42, 33315840
    s_mov_b32 s46, 33767424
    s_mov_b32 s44, s4
    s_mov_b32 s45, s5
    s_mov_b32 s47, 0x00020000
    buffer_store_dwordx4 v[8:11], v6, s[44:47], s42 offen sc1
    s_lshl_b32 s42, s40, 12
    s_add_u32 s42, s42, 34226176
    s_mov_b32 s46, 34881536
    s_mov_b32 s44, s4
    s_mov_b32 s45, s5
    s_mov_b32 s47, 0x00020000
    buffer_store_dwordx4 v[8:11], v6, s[44:47], s42 offen sc1
    s_lshl_b32 s42, s40, 12
    s_add_u32 s42, s42, 32857088
    s_mov_b32 s46, 33308672
    s_mov_b32 s44, s4
    s_mov_b32 s45, s5
    s_mov_b32 s47, 0x00020000
    buffer_store_dwordx4 v[8:11], v6, s[44:47], s42 offen sc1
    s_lshl_b32 s42, s40, 12
    s_add_u32 s42, s42, 33774592
    s_mov_b32 s46, 34226176
    s_mov_b32 s44, s4
    s_mov_b32 s45, s5
    s_mov_b32 s47, 0x00020000
    buffer_store_dwordx4 v[8:11], v6, s[44:47], s42 offen sc1
    s_lshl_b32 s42, s40, 12
    s_add_u32 s42, s42, 34881536
    s_mov_b32 s46, 35536896
    s_mov_b32 s44, s4
    s_mov_b32 s45, s5
    s_mov_b32 s47, 0x00020000
    buffer_store_dwordx4 v[8:11], v6, s[44:47], s42 offen sc1
    s_cmp_ge_u32 s40, 32
    s_cbranch_scc1 M_end_66
    s_load_dwordx2 s[8:9], s[34:35], 0
    s_waitcnt lgkmcnt(0)
    s_mov_b32 s10, 1835008
    s_mov_b32 s11, 0x00020000
    v_lshrrev_b32 v4, 3, v0
    v_and_b32 v5, 7, v0
    v_mul_u32_u24 v2, 896, v4
    v_lshl_add_u32 v2, v5, 4, v2
    v_mul_u32_u24 v3, 928, v4
    v_lshl_add_u32 v3, v5, 4, v3
    s_add_u32 s41, s40, 32
    s_mul_i32 s42, s41, 28672
    buffer_load_dwordx4 v[16:19], v2, s[8:11], s42 offen offset:0
    buffer_load_dwordx4 v[20:23], v2, s[8:11], s42 offen offset:128
    buffer_load_dwordx4 v[24:27], v2, s[8:11], s42 offen offset:256
    buffer_load_dwordx4 v[28:31], v2, s[8:11], s42 offen offset:384
    buffer_load_dwordx4 v[32:35], v2, s[8:11], s42 offen offset:512
    buffer_load_dwordx4 v[36:39], v2, s[8:11], s42 offen offset:640
    buffer_load_dwordx4 v[40:43], v2, s[8:11], s42 offen offset:768
    s_waitcnt vmcnt(0)
    v_lshlrev_b32 v48, 16, v16
    v_and_b32 v49, 0xffff0000, v16
    v_lshlrev_b32 v50, 16, v17
    v_and_b32 v51, 0xffff0000, v17
    v_lshlrev_b32 v52, 16, v18
    v_and_b32 v53, 0xffff0000, v18
    v_lshlrev_b32 v54, 16, v19
    v_and_b32 v55, 0xffff0000, v19
    v_lshlrev_b32 v56, 16, v20
    v_and_b32 v57, 0xffff0000, v20
    v_lshlrev_b32 v58, 16, v21
    v_and_b32 v59, 0xffff0000, v21
    v_lshlrev_b32 v60, 16, v22
    v_and_b32 v61, 0xffff0000, v22
    v_lshlrev_b32 v62, 16, v23
    v_and_b32 v63, 0xffff0000, v23
    v_lshlrev_b32 v64, 16, v24
    v_and_b32 v65, 0xffff0000, v24
    v_lshlrev_b32 v66, 16, v25
    v_and_b32 v67, 0xffff0000, v25
    v_lshlrev_b32 v68, 16, v26
    v_and_b32 v69, 0xffff0000, v26
    v_lshlrev_b32 v70, 16, v27
    v_and_b32 v71, 0xffff0000, v27
    v_lshlrev_b32 v72, 16, v28
    v_and_b32 v73, 0xffff0000, v28
    v_lshlrev_b32 v74, 16, v29
    v_and_b32 v75, 0xffff0000, v29
    v_lshlrev_b32 v76, 16, v30
    v_and_b32 v77, 0xffff0000, v30
    v_lshlrev_b32 v78, 16, v31
    v_and_b32 v79, 0xffff0000, v31
    v_lshlrev_b32 v80, 16, v32
    v_and_b32 v81, 0xffff0000, v32
    v_lshlrev_b32 v82, 16, v33
    v_and_b32 v83, 0xffff0000, v33
    v_lshlrev_b32 v84, 16, v34
    v_and_b32 v85, 0xffff0000, v34
    v_lshlrev_b32 v86, 16, v35
    v_and_b32 v87, 0xffff0000, v35
    v_lshlrev_b32 v88, 16, v36
    v_and_b32 v89, 0xffff0000, v36
    v_lshlrev_b32 v90, 16, v37
    v_and_b32 v91, 0xffff0000, v37
    v_lshlrev_b32 v92, 16, v38
    v_and_b32 v93, 0xffff0000, v38
    v_lshlrev_b32 v94, 16, v39
    v_and_b32 v95, 0xffff0000, v39
    v_lshlrev_b32 v96, 16, v40
    v_and_b32 v97, 0xffff0000, v40
    v_lshlrev_b32 v98, 16, v41
    v_and_b32 v99, 0xffff0000, v41
    v_lshlrev_b32 v100, 16, v42
    v_and_b32 v101, 0xffff0000, v42
    v_lshlrev_b32 v102, 16, v43
    v_and_b32 v103, 0xffff0000, v43
    v_pk_add_f32 v[6:7], v[48:49], v[50:51]
    v_pk_add_f32 v[8:9], v[52:53], v[54:55]
    v_pk_add_f32 v[6:7], v[6:7], v[56:57]
    v_pk_add_f32 v[8:9], v[8:9], v[58:59]
    v_pk_add_f32 v[6:7], v[6:7], v[60:61]
    v_pk_add_f32 v[8:9], v[8:9], v[62:63]
    v_pk_add_f32 v[6:7], v[6:7], v[64:65]
    v_pk_add_f32 v[8:9], v[8:9], v[66:67]
    v_pk_add_f32 v[6:7], v[6:7], v[68:69]
    v_pk_add_f32 v[8:9], v[8:9], v[70:71]
    v_pk_add_f32 v[6:7], v[6:7], v[72:73]
    v_pk_add_f32 v[8:9], v[8:9], v[74:75]
    v_pk_add_f32 v[6:7], v[6:7], v[76:77]
    v_pk_add_f32 v[8:9], v[8:9], v[78:79]
    v_pk_add_f32 v[6:7], v[6:7], v[80:81]
    v_pk_add_f32 v[8:9], v[8:9], v[82:83]
    v_pk_add_f32 v[6:7], v[6:7], v[84:85]
    v_pk_add_f32 v[8:9], v[8:9], v[86:87]
    v_pk_add_f32 v[6:7], v[6:7], v[88:89]
    v_pk_add_f32 v[8:9], v[8:9], v[90:91]
    v_pk_add_f32 v[6:7], v[6:7], v[92:93]
    v_pk_add_f32 v[8:9], v[8:9], v[94:95]
    v_pk_add_f32 v[6:7], v[6:7], v[96:97]
    v_pk_add_f32 v[8:9], v[8:9], v[98:99]
    v_pk_add_f32 v[6:7], v[6:7], v[100:101]
    v_pk_add_f32 v[8:9], v[8:9], v[102:103]
    v_pk_add_f32 v[6:7], v[6:7], v[8:9]
    v_add_f32 v4, v6, v7
    s_nop 1
    v_add_f32_dpp v4, v4, v4 quad_perm:[1,0,3,2] row_mask:0xf bank_mask:0xf
    s_nop 1
    v_add_f32_dpp v4, v4, v4 quad_perm:[2,3,0,1] row_mask:0xf bank_mask:0xf
    s_nop 1
    v_add_f32_dpp v4, v4, v4 row_half_mirror row_mask:0xf bank_mask:0xf
    v_mul_f32 v8, 0xbb124925, v4
    v_mov_b32 v9, v8
    v_pk_add_f32 v[48:49], v[48:49], v[8:9]
    v_pk_add_f32 v[50:51], v[50:51], v[8:9]
    v_pk_add_f32 v[52:53], v[52:53], v[8:9]
    v_pk_add_f32 v[54:55], v[54:55], v[8:9]
    v_pk_add_f32 v[56:57], v[56:57], v[8:9]
    v_pk_add_f32 v[58:59], v[58:59], v[8:9]
    v_pk_add_f32 v[60:61], v[60:61], v[8:9]
    v_pk_add_f32 v[62:63], v[62:63], v[8:9]
    v_pk_add_f32 v[64:65], v[64:65], v[8:9]
    v_pk_add_f32 v[66:67], v[66:67], v[8:9]
    v_pk_add_f32 v[68:69], v[68:69], v[8:9]
    v_pk_add_f32 v[70:71], v[70:71], v[8:9]
    v_pk_add_f32 v[72:73], v[72:73], v[8:9]
    v_pk_add_f32 v[74:75], v[74:75], v[8:9]
    v_pk_add_f32 v[76:77], v[76:77], v[8:9]
    v_pk_add_f32 v[78:79], v[78:79], v[8:9]
    v_pk_add_f32 v[80:81], v[80:81], v[8:9]
    v_pk_add_f32 v[82:83], v[82:83], v[8:9]
    v_pk_add_f32 v[84:85], v[84:85], v[8:9]
    v_pk_add_f32 v[86:87], v[86:87], v[8:9]
    v_pk_add_f32 v[88:89], v[88:89], v[8:9]
    v_pk_add_f32 v[90:91], v[90:91], v[8:9]
    v_pk_add_f32 v[92:93], v[92:93], v[8:9]
    v_pk_add_f32 v[94:95], v[94:95], v[8:9]
    v_pk_add_f32 v[96:97], v[96:97], v[8:9]
    v_pk_add_f32 v[98:99], v[98:99], v[8:9]
    v_pk_add_f32 v[100:101], v[100:101], v[8:9]
    v_pk_add_f32 v[102:103], v[102:103], v[8:9]
    v_pk_mul_f32 v[6:7], v[48:49], v[48:49]
    v_pk_mul_f32 v[8:9], v[50:51], v[50:51]
    v_pk_fma_f32 v[6:7], v[52:53], v[52:53], v[6:7]
    v_pk_fma_f32 v[8:9], v[54:55], v[54:55], v[8:9]
    v_pk_fma_f32 v[6:7], v[56:57], v[56:57], v[6:7]
    v_pk_fma_f32 v[8:9], v[58:59], v[58:59], v[8:9]
    v_pk_fma_f32 v[6:7], v[60:61], v[60:61], v[6:7]
    v_pk_fma_f32 v[8:9], v[62:63], v[62:63], v[8:9]
    v_pk_fma_f32 v[6:7], v[64:65], v[64:65], v[6:7]
    v_pk_fma_f32 v[8:9], v[66:67], v[66:67], v[8:9]
    v_pk_fma_f32 v[6:7], v[68:69], v[68:69], v[6:7]
    v_pk_fma_f32 v[8:9], v[70:71], v[70:71], v[8:9]
    v_pk_fma_f32 v[6:7], v[72:73], v[72:73], v[6:7]
    v_pk_fma_f32 v[8:9], v[74:75], v[74:75], v[8:9]
    v_pk_fma_f32 v[6:7], v[76:77], v[76:77], v[6:7]
    v_pk_fma_f32 v[8:9], v[78:79], v[78:79], v[8:9]
    v_pk_fma_f32 v[6:7], v[80:81], v[80:81], v[6:7]
    v_pk_fma_f32 v[8:9], v[82:83], v[82:83], v[8:9]
    v_pk_fma_f32 v[6:7], v[84:85], v[84:85], v[6:7]
    v_pk_fma_f32 v[8:9], v[86:87], v[86:87], v[8:9]
    v_pk_fma_f32 v[6:7], v[88:89], v[88:89], v[6:7]
    v_pk_fma_f32 v[8:9], v[90:91], v[90:91], v[8:9]
    v_pk_fma_f32 v[6:7], v[92:93], v[92:93], v[6:7]
    v_pk_fma_f32 v[8:9], v[94:95], v[94:95], v[8:9]
    v_pk_fma_f32 v[6:7], v[96:97], v[96:97], v[6:7]
    v_pk_fma_f32 v[8:9], v[98:99], v[98:99], v[8:9]
    v_pk_fma_f32 v[6:7], v[100:101], v[100:101], v[6:7]
    v_pk_fma_f32 v[8:9], v[102:103], v[102:103], v[8:9]
    v_pk_add_f32 v[6:7], v[6:7], v[8:9]
    v_add_f32 v4, v6, v7
    s_nop 1
    v_add_f32_dpp v4, v4, v4 quad_perm:[1,0,3,2] row_mask:0xf bank_mask:0xf
    s_nop 1
    v_add_f32_dpp v4, v4, v4 quad_perm:[2,3,0,1] row_mask:0xf bank_mask:0xf
    s_nop 1
    v_add_f32_dpp v4, v4, v4 row_half_mirror row_mask:0xf bank_mask:0xf
    v_mov_b32 v6, 0x3727c5ac
    v_fmac_f32 v6, 0x3b124925, v4
    v_rsq_f32 v6, v6
    s_nop 0
    v_mov_b32 v7, v6
    v_pk_mul_f32 v[48:49], v[48:49], v[6:7]
    v_cvt_pk_bf16_f32 v16, v48, v49
    v_pk_mul_f32 v[50:51], v[50:51], v[6:7]
    v_cvt_pk_bf16_f32 v17, v50, v51
    v_pk_mul_f32 v[52:53], v[52:53], v[6:7]
    v_cvt_pk_bf16_f32 v18, v52, v53
    v_pk_mul_f32 v[54:55], v[54:55], v[6:7]
    v_cvt_pk_bf16_f32 v19, v54, v55
    v_pk_mul_f32 v[56:57], v[56:57], v[6:7]
    v_cvt_pk_bf16_f32 v20, v56, v57
    v_pk_mul_f32 v[58:59], v[58:59], v[6:7]
    v_cvt_pk_bf16_f32 v21, v58, v59
    v_pk_mul_f32 v[60:61], v[60:61], v[6:7]
    v_cvt_pk_bf16_f32 v22, v60, v61
    v_pk_mul_f32 v[62:63], v[62:63], v[6:7]
    v_cvt_pk_bf16_f32 v23, v62, v63
    v_pk_mul_f32 v[64:65], v[64:65], v[6:7]
    v_cvt_pk_bf16_f32 v24, v64, v65
    v_pk_mul_f32 v[66:67], v[66:67], v[6:7]
    v_cvt_pk_bf16_f32 v25, v66, v67
    v_pk_mul_f32 v[68:69], v[68:69], v[6:7]
    v_cvt_pk_bf16_f32 v26, v68, v69
    v_pk_mul_f32 v[70:71], v[70:71], v[6:7]
    v_cvt_pk_bf16_f32 v27, v70, v71
    v_pk_mul_f32 v[72:73], v[72:73], v[6:7]
    v_cvt_pk_bf16_f32 v28, v72, v73
    v_pk_mul_f32 v[74:75], v[74:75], v[6:7]
    v_cvt_pk_bf16_f32 v29, v74, v75
    v_pk_mul_f32 v[76:77], v[76:77], v[6:7]
    v_cvt_pk_bf16_f32 v30, v76, v77
    v_pk_mul_f32 v[78:79], v[78:79], v[6:7]
    v_cvt_pk_bf16_f32 v31, v78, v79
    v_pk_mul_f32 v[80:81], v[80:81], v[6:7]
    v_cvt_pk_bf16_f32 v32, v80, v81
    v_pk_mul_f32 v[82:83], v[82:83], v[6:7]
    v_cvt_pk_bf16_f32 v33, v82, v83
    v_pk_mul_f32 v[84:85], v[84:85], v[6:7]
    v_cvt_pk_bf16_f32 v34, v84, v85
    v_pk_mul_f32 v[86:87], v[86:87], v[6:7]
    v_cvt_pk_bf16_f32 v35, v86, v87
    v_pk_mul_f32 v[88:89], v[88:89], v[6:7]
    v_cvt_pk_bf16_f32 v36, v88, v89
    v_pk_mul_f32 v[90:91], v[90:91], v[6:7]
    v_cvt_pk_bf16_f32 v37, v90, v91
    v_pk_mul_f32 v[92:93], v[92:93], v[6:7]
    v_cvt_pk_bf16_f32 v38, v92, v93
    v_pk_mul_f32 v[94:95], v[94:95], v[6:7]
    v_cvt_pk_bf16_f32 v39, v94, v95
    v_pk_mul_f32 v[96:97], v[96:97], v[6:7]
    v_cvt_pk_bf16_f32 v40, v96, v97
    v_pk_mul_f32 v[98:99], v[98:99], v[6:7]
    v_cvt_pk_bf16_f32 v41, v98, v99
    v_pk_mul_f32 v[100:101], v[100:101], v[6:7]
    v_cvt_pk_bf16_f32 v42, v100, v101
    v_pk_mul_f32 v[102:103], v[102:103], v[6:7]
    v_cvt_pk_bf16_f32 v43, v102, v103
    s_mul_i32 s42, s41, 29696
    s_add_u32 s42, s42, 19267584
    buffer_store_dwordx4 v[16:19], v3, s[4:7], s42 offen offset:0 sc1
    buffer_store_dwordx4 v[20:23], v3, s[4:7], s42 offen offset:128 sc1
    buffer_store_dwordx4 v[24:27], v3, s[4:7], s42 offen offset:256 sc1
    buffer_store_dwordx4 v[28:31], v3, s[4:7], s42 offen offset:384 sc1
    buffer_store_dwordx4 v[32:35], v3, s[4:7], s42 offen offset:512 sc1
    buffer_store_dwordx4 v[36:39], v3, s[4:7], s42 offen offset:640 sc1
    buffer_store_dwordx4 v[40:43], v3, s[4:7], s42 offen offset:768 sc1
    s_nop 1
M_end_66:
    v_and_b32 v1, 63, v0
    v_lshlrev_b32 v1, 4, v1
    s_waitcnt vmcnt(0)
    s_barrier
    s_cmp_lg_u32 s15, 0
    s_cbranch_scc1 L_ic_68
    v_mov_b32 v46, 32
    v_mov_b32 v47, 1
    s_mov_b64 exec, 1
    global_atomic_add v46, v47, s[36:37] sc1
    s_mov_b64 exec, -1
L_ic_68:
    s_mov_b32 s32, 400000
    v_mbcnt_lo_u32_b32 v45, -1, 0
    v_lshrrev_b32 v44, 3, v45
    v_add_u32 v44, s60, v44
    v_lshlrev_b32 v44, 7, v44
    v_and_b32 v45, 7, v45
    v_lshl_add_u32 v45, v45, 2, v44
    s_mov_b32 s61, 1
    s_mov_b32 s26, 126894176
    s_mov_b32 exec_lo, 0x7f7f7f7f
    s_mov_b32 exec_hi, 0
L_iw_72:
    buffer_load_dword v44, v45, s[4:7], s26 offen sc1
    s_waitcnt vmcnt(0)
    v_cmp_eq_u32 vcc, 0, v44
    s_nop 3
    s_cbranch_vccz L_iwok_69
    s_mov_b32 s61, 0
    s_mov_b32 s26, 126894080
    s_mov_b32 exec_lo, 0x7f7f7f7f
    s_mov_b32 exec_hi, 0
L_iw_73:
    buffer_load_dword v44, v45, s[4:7], s26 offen sc1
    s_waitcnt vmcnt(0)
    v_cmp_eq_u32 vcc, 0, v44
    s_nop 3
    s_cbranch_vccz L_iwok_69
    s_sleep 1
    s_sub_u32 s32, s32, 1
    s_cmp_lg_u32 s32, 0
    s_cbranch_scc1 L_iw_73
    s_branch L_fail
L_iwok_69:
    s_mov_b64 exec, -1
L_iwsk_70:
    s_add_u32 s21, s20, 0
    buffer_load_dwordx4 v[120:123], v1, s[4:7], s21 offen offset:0 sc1
    buffer_load_dwordx4 v[124:127], v1, s[4:7], s21 offen offset:1024 sc1
    buffer_load_dwordx4 v[128:131], v1, s[4:7], s21 offen offset:2048 sc1
    buffer_load_dwordx4 v[132:135], v1, s[4:7], s21 offen offset:3072 sc1
    s_add_u32 s21, s20, 14336
    buffer_load_dwordx4 v[176:179], v1, s[4:7], s21 offen offset:0 sc1
    buffer_load_dwordx4 v[180:183], v1, s[4:7], s21 offen offset:1024 sc1
    buffer_load_dwordx4 v[184:187], v1, s[4:7], s21 offen offset:2048 sc1
    buffer_load_dwordx4 v[188:191], v1, s[4:7], s21 offen offset:3072 sc1
    s_add_u32 s21, s20, 28672
    buffer_load_dwordx4 v[232:235], v1, s[4:7], s21 offen offset:0 sc1
    buffer_load_dwordx4 v[236:239], v1, s[4:7], s21 offen offset:1024 sc1
    buffer_load_dwordx4 v[240:243], v1, s[4:7], s21 offen offset:2048 sc1
    buffer_load_dwordx4 v[244:247], v1, s[4:7], s21 offen offset:3072 sc1
    s_add_u32 s21, s20, 43008
    buffer_load_dwordx4 a[32:35], v1, s[4:7], s21 offen offset:0 sc1
    buffer_load_dwordx4 a[36:39], v1, s[4:7], s21 offen offset:1024 sc1
    buffer_load_dwordx4 a[40:43], v1, s[4:7], s21 offen offset:2048 sc1
    buffer_load_dwordx4 a[44:47], v1, s[4:7], s21 offen offset:3072 sc1
    s_add_u32 s21, s20, 57344
    buffer_load_dwordx4 a[88:91], v1, s[4:7], s21 offen offset:0 sc1
    buffer_load_dwordx4 a[92:95], v1, s[4:7], s21 offen offset:1024 sc1
    buffer_load_dwordx4 a[96:99], v1, s[4:7], s21 offen offset:2048 sc1
    buffer_load_dwordx4 a[100:103], v1, s[4:7], s21 offen offset:3072 sc1
    s_add_u32 s21, s20, 71680
    buffer_load_dwordx4 a[144:147], v1, s[4:7], s21 offen offset:0 sc1
    buffer_load_dwordx4 a[148:151], v1, s[4:7], s21 offen offset:1024 sc1
    buffer_load_dwordx4 a[152:155], v1, s[4:7], s21 offen offset:2048 sc1
    buffer_load_dwordx4 a[156:159], v1, s[4:7], s21 offen offset:3072 sc1
    s_add_u32 s21, s20, 86016
    buffer_load_dwordx4 a[200:203], v1, s[4:7], s21 offen offset:0 sc1
    buffer_load_dwordx4 a[204:207], v1, s[4:7], s21 offen offset:1024 sc1
    buffer_load_dwordx4 a[208:211], v1, s[4:7], s21 offen offset:2048 sc1
    buffer_load_dwordx4 a[212:215], v1, s[4:7], s21 offen offset:3072 sc1
    s_cmp_eq_u32 s61, 1
    s_cbranch_scc1 L_iwsk_75
    s_mov_b32 s32, 400000
    s_mov_b32 s26, 126894112
    s_mov_b32 exec_lo, 0x7f7f7f7f
    s_mov_b32 exec_hi, 0
L_iw_76:
    buffer_load_dword v44, v45, s[4:7], s26 offen sc1
    s_waitcnt vmcnt(0)
    v_cmp_eq_u32 vcc, 0, v44
    s_nop 3
    s_cbranch_vccz L_iwok_74
    s_sleep 1
    s_sub_u32 s32, s32, 1
    s_cmp_lg_u32 s32, 0
    s_cbranch_scc1 L_iw_76
    s_branch L_fail
L_iwok_74:
    s_mov_b64 exec, -1
L_iwsk_75:
    s_add_u32 s21, s20, 4096
    buffer_load_dwordx4 v[136:139], v1, s[4:7], s21 offen offset:0 sc1
    buffer_load_dwordx4 v[140:143], v1, s[4:7], s21 offen offset:1024 sc1
    buffer_load_dwordx4 v[144:147], v1, s[4:7], s21 offen offset:2048 sc1
    buffer_load_dwordx4 v[148:151], v1, s[4:7], s21 offen offset:3072 sc1
    s_add_u32 s21, s20, 18432
    buffer_load_dwordx4 v[192:195], v1, s[4:7], s21 offen offset:0 sc1
    buffer_load_dwordx4 v[196:199], v1, s[4:7], s21 offen offset:1024 sc1
    buffer_load_dwordx4 v[200:203], v1, s[4:7], s21 offen offset:2048 sc1
    buffer_load_dwordx4 v[204:207], v1, s[4:7], s21 offen offset:3072 sc1
    s_add_u32 s21, s20, 32768
    buffer_load_dwordx4 v[248:251], v1, s[4:7], s21 offen offset:0 sc1
    buffer_load_dwordx4 v[252:255], v1, s[4:7], s21 offen offset:1024 sc1
    buffer_load_dwordx4 a[0:3], v1, s[4:7], s21 offen offset:2048 sc1
    buffer_load_dwordx4 a[4:7], v1, s[4:7], s21 offen offset:3072 sc1
    s_add_u32 s21, s20, 47104
    buffer_load_dwordx4 a[48:51], v1, s[4:7], s21 offen offset:0 sc1
    buffer_load_dwordx4 a[52:55], v1, s[4:7], s21 offen offset:1024 sc1
    buffer_load_dwordx4 a[56:59], v1, s[4:7], s21 offen offset:2048 sc1
    buffer_load_dwordx4 a[60:63], v1, s[4:7], s21 offen offset:3072 sc1
    s_add_u32 s21, s20, 61440
    buffer_load_dwordx4 a[104:107], v1, s[4:7], s21 offen offset:0 sc1
    buffer_load_dwordx4 a[108:111], v1, s[4:7], s21 offen offset:1024 sc1
    buffer_load_dwordx4 a[112:115], v1, s[4:7], s21 offen offset:2048 sc1
    buffer_load_dwordx4 a[116:119], v1, s[4:7], s21 offen offset:3072 sc1
    s_add_u32 s21, s20, 75776
    buffer_load_dwordx4 a[160:163], v1, s[4:7], s21 offen offset:0 sc1
    buffer_load_dwordx4 a[164:167], v1, s[4:7], s21 offen offset:1024 sc1
    buffer_load_dwordx4 a[168:171], v1, s[4:7], s21 offen offset:2048 sc1
    buffer_load_dwordx4 a[172:175], v1, s[4:7], s21 offen offset:3072 sc1
    s_add_u32 s21, s20, 90112
    buffer_load_dwordx4 a[216:219], v1, s[4:7], s21 offen offset:0 sc1
    buffer_load_dwordx4 a[220:223], v1, s[4:7], s21 offen offset:1024 sc1
    buffer_load_dwordx4 a[224:227], v1, s[4:7], s21 offen offset:2048 sc1
    buffer_load_dwordx4 a[228:231], v1, s[4:7], s21 offen offset:3072 sc1
    s_cmp_eq_u32 s61, 1
    s_cbranch_scc1 L_iwsk_78
    s_mov_b32 s32, 400000
    s_mov_b32 s26, 126894144
    s_mov_b32 exec_lo, 0x7f7f7f7f
    s_mov_b32 exec_hi, 0
L_iw_79:
    buffer_load_dword v44, v45, s[4:7], s26 offen sc1
    s_waitcnt vmcnt(0)
    v_cmp_eq_u32 vcc, 0, v44
    s_nop 3
    s_cbranch_vccz L_iwok_77
    s_sleep 1
    s_sub_u32 s32, s32, 1
    s_cmp_lg_u32 s32, 0
    s_cbranch_scc1 L_iw_79
    s_branch L_fail
L_iwok_77:
    s_mov_b64 exec, -1
L_iwsk_78:
    s_waitcnt vmcnt(28)
    s_add_u32 s21, s20, 8192
    buffer_load_dwordx4 v[152:155], v1, s[4:7], s21 offen offset:0 sc1
    buffer_load_dwordx4 v[156:159], v1, s[4:7], s21 offen offset:1024 sc1
    buffer_load_dwordx4 v[160:163], v1, s[4:7], s21 offen offset:2048 sc1
    buffer_load_dwordx4 v[164:167], v1, s[4:7], s21 offen offset:3072 sc1
    s_add_u32 s21, s20, 22528
    buffer_load_dwordx4 v[208:211], v1, s[4:7], s21 offen offset:0 sc1
    buffer_load_dwordx4 v[212:215], v1, s[4:7], s21 offen offset:1024 sc1
    buffer_load_dwordx4 v[216:219], v1, s[4:7], s21 offen offset:2048 sc1
    buffer_load_dwordx4 v[220:223], v1, s[4:7], s21 offen offset:3072 sc1
    s_add_u32 s21, s20, 36864
    buffer_load_dwordx4 a[8:11], v1, s[4:7], s21 offen offset:0 sc1
    buffer_load_dwordx4 a[12:15], v1, s[4:7], s21 offen offset:1024 sc1
    buffer_load_dwordx4 a[16:19], v1, s[4:7], s21 offen offset:2048 sc1
    buffer_load_dwordx4 a[20:23], v1, s[4:7], s21 offen offset:3072 sc1
    s_add_u32 s21, s20, 51200
    buffer_load_dwordx4 a[64:67], v1, s[4:7], s21 offen offset:0 sc1
    buffer_load_dwordx4 a[68:71], v1, s[4:7], s21 offen offset:1024 sc1
    buffer_load_dwordx4 a[72:75], v1, s[4:7], s21 offen offset:2048 sc1
    buffer_load_dwordx4 a[76:79], v1, s[4:7], s21 offen offset:3072 sc1
    s_add_u32 s21, s20, 65536
    buffer_load_dwordx4 a[120:123], v1, s[4:7], s21 offen offset:0 sc1
    buffer_load_dwordx4 a[124:127], v1, s[4:7], s21 offen offset:1024 sc1
    buffer_load_dwordx4 a[128:131], v1, s[4:7], s21 offen offset:2048 sc1
    buffer_load_dwordx4 a[132:135], v1, s[4:7], s21 offen offset:3072 sc1
    s_add_u32 s21, s20, 79872
    buffer_load_dwordx4 a[176:179], v1, s[4:7], s21 offen offset:0 sc1
    buffer_load_dwordx4 a[180:183], v1, s[4:7], s21 offen offset:1024 sc1
    buffer_load_dwordx4 a[184:187], v1, s[4:7], s21 offen offset:2048 sc1
    buffer_load_dwordx4 a[188:191], v1, s[4:7], s21 offen offset:3072 sc1
    s_add_u32 s21, s20, 94208
    buffer_load_dwordx4 a[232:235], v1, s[4:7], s21 offen offset:0 sc1
    buffer_load_dwordx4 a[236:239], v1, s[4:7], s21 offen offset:1024 sc1
    buffer_load_dwordx4 a[240:243], v1, s[4:7], s21 offen offset:2048 sc1
    buffer_load_dwordx4 a[244:247], v1, s[4:7], s21 offen offset:3072 sc1
    s_cmp_eq_u32 s61, 1
    s_cbranch_scc1 L_iwsk_81
    s_mov_b32 s32, 400000
    s_mov_b32 s26, 126894176
    s_mov_b32 exec_lo, 0x7f7f7f7f
    s_mov_b32 exec_hi, 0
L_iw_82:
    buffer_load_dword v44, v45, s[4:7], s26 offen sc1
    s_waitcnt vmcnt(0)
    v_cmp_eq_u32 vcc, 0, v44
    s_nop 3
    s_cbranch_vccz L_iwok_80
    s_sleep 1
    s_sub_u32 s32, s32, 1
    s_cmp_lg_u32 s32, 0
    s_cbranch_scc1 L_iw_82
    s_branch L_fail
L_iwok_80:
    s_mov_b64 exec, -1
L_iwsk_81:
    s_waitcnt vmcnt(28)
    v_mov_b32 v47, 32
    global_load_dword v46, v47, s[36:37] sc1
    s_add_u32 s21, s20, 12288
    buffer_load_dwordx4 v[168:171], v1, s[4:7], s21 offen offset:0 sc1
    buffer_load_dwordx4 v[172:175], v1, s[4:7], s21 offen offset:1024 sc1
    s_add_u32 s21, s20, 26624
    buffer_load_dwordx4 v[224:227], v1, s[4:7], s21 offen offset:0 sc1
    buffer_load_dwordx4 v[228:231], v1, s[4:7], s21 offen offset:1024 sc1
    s_add_u32 s21, s20, 40960
    buffer_load_dwordx4 a[24:27], v1, s[4:7], s21 offen offset:0 sc1
    buffer_load_dwordx4 a[28:31], v1, s[4:7], s21 offen offset:1024 sc1
    s_add_u32 s21, s20, 55296
    buffer_load_dwordx4 a[80:83], v1, s[4:7], s21 offen offset:0 sc1
    buffer_load_dwordx4 a[84:87], v1, s[4:7], s21 offen offset:1024 sc1
    s_add_u32 s21, s20, 69632
    buffer_load_dwordx4 a[136:139], v1, s[4:7], s21 offen offset:0 sc1
    buffer_load_dwordx4 a[140:143], v1, s[4:7], s21 offen offset:1024 sc1
    s_add_u32 s21, s20, 83968
    buffer_load_dwordx4 a[192:195], v1, s[4:7], s21 offen offset:0 sc1
    buffer_load_dwordx4 a[196:199], v1, s[4:7], s21 offen offset:1024 sc1
    s_add_u32 s21, s20, 98304
    buffer_load_dwordx4 a[248:251], v1, s[4:7], s21 offen offset:0 sc1
    buffer_load_dwordx4 a[252:255], v1, s[4:7], s21 offen offset:1024 sc1
    s_waitcnt vmcnt(0)
    s_mov_b32 s16, 2
    v_readfirstlane_b32 s59, v46
    s_cmp_ge_u32 s59, 256
    s_nop 2
    s_cbranch_scc1 L_iok_83
    s_mov_b32 s32, 400000
    v_mbcnt_lo_u32_b32 v45, -1, 0
    v_add_u32 v45, 8, v45
    v_lshlrev_b32 v45, 2, v45
    s_mov_b64 exec, 1
    s_nop 0
L_dw_84:
    global_load_dword v44, v45, s[36:37] sc1
    s_waitcnt vmcnt(0)
    v_cmp_gt_u32 vcc, 256, v44
    s_nop 3
    s_cbranch_vccz L_dwok_85
    s_sleep 1
    s_sub_u32 s32, s32, 1
    s_cmp_lg_u32 s32, 0
    s_cbranch_scc1 L_dw_84
    s_branch L_fail
L_dwok_85:
    s_mov_b64 exec, -1
L_iok_83:
    v_and_b32 v25, 63, v0
    v_and_b32 v26, 15, v25
    v_lshrrev_b32 v27, 4, v25
    s_mul_i32 s21, s12, 28
    v_mov_b32 v2, 0
    v_mov_b32 v3, 0
    v_mov_b32 v4, 0
    v_mov_b32 v5, 0
    v_mov_b32 v6, 0
    v_mov_b32 v7, 0
    v_mov_b32 v8, 0
    s_cmp_eq_u32 s15, 3
    s_cbranch_scc1 L_vs3_86
    v_and_b32 v32, 63, v0
    s_lshl_b32 s18, s15, 10
    v_lshlrev_b32 v2, 4, v32
    v_add_u32 v2, s18, v2
    v_lshrrev_b32 v33, 4, v32
    v_lshlrev_b32 v3, 8, v33
    v_and_b32 v33, 7, v32
    v_lshl_add_u32 v3, v33, 4, v3
    v_bfe_u32 v34, v32, 3, 1
    v_lshl_add_u32 v3, v34, 3, v3
    v_add_u32 v3, s18, v3
    v_add_u32 v3, 71680, v3
    v_add_u32 v4, 3072, v3
    s_cmp_eq_u32 s15, 0
    s_cselect_b32 s57, 6144, 0
    v_add_u32 v5, s57, v3
    s_nop 0
    s_branch L_vs3j_87
L_vs3_86:
    v_add_u32 v32, 0, v25
    s_mov_b32 s19, 2341
    v_mul_u32_u24 v33, s19, v32
    v_lshrrev_b32 v33, 16, v33
    v_mul_u32_u24 v34, 28, v33
    v_sub_u32 v34, v32, v34
    v_add_u32 v34, s21, v34
    v_mul_u32_u24 v2, 7168, v33
    v_lshl_add_u32 v2, v34, 4, v2
    v_add_u32 v32, 64, v25
    s_mov_b32 s19, 2341
    v_mul_u32_u24 v33, s19, v32
    v_lshrrev_b32 v33, 16, v33
    v_mul_u32_u24 v34, 28, v33
    v_sub_u32 v34, v32, v34
    v_add_u32 v34, s21, v34
    v_mul_u32_u24 v3, 7168, v33
    v_lshl_add_u32 v3, v34, 4, v3
    v_add_u32 v32, 128, v25
    s_mov_b32 s19, 2341
    v_mul_u32_u24 v33, s19, v32
    v_lshrrev_b32 v33, 16, v33
    v_mul_u32_u24 v34, 28, v33
    v_sub_u32 v34, v32, v34
    v_add_u32 v34, s21, v34
    v_mul_u32_u24 v4, 7168, v33
    v_lshl_add_u32 v4, v34, 4, v4
    v_add_u32 v32, 192, v25
    s_mov_b32 s19, 2341
    v_mul_u32_u24 v33, s19, v32
    v_lshrrev_b32 v33, 16, v33
    v_mul_u32_u24 v34, 28, v33
    v_sub_u32 v34, v32, v34
    v_add_u32 v34, s21, v34
    v_mul_u32_u24 v5, 7168, v33
    v_lshl_add_u32 v5, v34, 4, v5
    v_add_u32 v32, 256, v25
    s_mov_b32 s19, 2341
    v_mul_u32_u24 v33, s19, v32
    v_lshrrev_b32 v33, 16, v33
    v_mul_u32_u24 v34, 28, v33
    v_sub_u32 v34, v32, v34
    v_add_u32 v34, s21, v34
    v_mul_u32_u24 v6, 7168, v33
    v_lshl_add_u32 v6, v34, 4, v6
    v_add_u32 v32, 320, v25
    s_mov_b32 s19, 2341
    v_mul_u32_u24 v33, s19, v32
    v_lshrrev_b32 v33, 16, v33
    v_mul_u32_u24 v34, 28, v33
    v_sub_u32 v34, v32, v34
    v_add_u32 v34, s21, v34
    v_mul_u32_u24 v7, 7168, v33
    v_lshl_add_u32 v7, v34, 4, v7
    v_add_u32 v32, 384, v25
    s_mov_b32 s19, 2341
    v_mul_u32_u24 v33, s19, v32
    v_lshrrev_b32 v33, 16, v33
    v_mul_u32_u24 v34, 28, v33
    v_sub_u32 v34, v32, v34
    v_add_u32 v34, s21, v34
    v_mul_u32_u24 v8, 7168, v33
    v_lshl_add_u32 v8, v34, 4, v8
    s_nop 1
L_vs3j_87:
    v_lshlrev_b32 v9, 4, v25
    v_add_u32 v19, 78848, v9
    v_add_u32 v9, 71680, v9
    s_lshl_b32 s18, s15, 11
    v_add_u32 v19, s18, v19
    v_lshrrev_b32 v32, 5, v25
    v_and_b32 v33, 1, v27
    s_mul_i32 s18, s15, 112
    s_add_u32 s18, s18, 0
    v_add_u32 v34, s18, v26
    v_lshl_add_u32 v34, v32, 4, v34
    s_mov_b32 s19, 2341
    v_mul_u32_u24 v35, s19, v34
    v_lshrrev_b32 v35, 16, v35
    v_mul_u32_u24 v36, 28, v35
    v_sub_u32 v36, v34, v36
    v_mul_u32_u24 v10, 2240, v35
    v_lshl_add_u32 v10, v36, 4, v10
    v_lshl_add_u32 v10, v33, 3, v10
    s_mul_i32 s18, s15, 112
    s_add_u32 s18, s18, 32
    v_add_u32 v34, s18, v26
    v_lshl_add_u32 v34, v32, 4, v34
    s_mov_b32 s19, 2341
    v_mul_u32_u24 v35, s19, v34
    v_lshrrev_b32 v35, 16, v35
    v_mul_u32_u24 v36, 28, v35
    v_sub_u32 v36, v34, v36
    v_mul_u32_u24 v11, 2240, v35
    v_lshl_add_u32 v11, v36, 4, v11
    v_lshl_add_u32 v11, v33, 3, v11
    s_mul_i32 s18, s15, 112
    s_add_u32 s18, s18, 64
    v_add_u32 v34, s18, v26
    v_lshl_add_u32 v34, v32, 4, v34
    s_mov_b32 s19, 2341
    v_mul_u32_u24 v35, s19, v34
    v_lshrrev_b32 v35, 16, v35
    v_mul_u32_u24 v36, 28, v35
    v_sub_u32 v36, v34, v36
    v_mul_u32_u24 v12, 2240, v35
    v_lshl_add_u32 v12, v36, 4, v12
    v_lshl_add_u32 v12, v33, 3, v12
    s_mul_i32 s18, s15, 112
    s_add_u32 s18, s18, 96
    v_add_u32 v34, s18, v26
    s_mov_b32 s19, 2341
    v_mul_u32_u24 v35, s19, v34
    v_lshrrev_b32 v35, 16, v35
    v_mul_u32_u24 v36, 28, v35
    v_sub_u32 v36, v34, v36
    v_mul_u32_u24 v13, 2240, v35
    v_lshl_add_u32 v13, v36, 4, v13
    v_lshl_add_u32 v13, v33, 3, v13
    v_cmp_le_u32 vcc, 28, v25
    v_mov_b32 v32, 0
    v_mov_b32 v33, 1
    v_cndmask_b32 v32, v32, v33, vcc
    v_mul_u32_u24 v34, 28, v32
    v_sub_u32 v34, v25, v34
    v_mul_u32_u24 v14, 2240, v32
    v_lshl_add_u32 v14, v34, 4, v14
    s_mov_b32 s19, 35840
    v_mul_lo_u32 v15, v32, s19
    v_add_u32 v34, s21, v34
    v_lshl_add_u32 v15, v34, 4, v15
    s_mul_i32 s18, s15, 20
    v_add_u32 v32, s18, v27
    v_mul_u32_u24 v16, 448, v32
    v_lshl_add_u32 v16, v26, 4, v16
    v_and_b32 v33, 7, v26
    v_lshlrev_b32 v18, 7, v32
    v_lshl_add_u32 v18, v33, 4, v18
    v_lshrrev_b32 v34, 3, v26
    v_lshl_add_u32 v17, v34, 9, v18
    v_add_u32 v18, 2048, v18
    s_lshl_b32 s18, s15, 4
    s_add_u32 s18, s18, s21
    v_lshlrev_b32 v34, 2, v27
    v_add_u32 v34, s18, v34
    v_lshrrev_b32 v35, 3, v34
    v_lshlrev_b32 v20, 7, v35
    v_lshl_add_u32 v20, v33, 4, v20
    v_bfe_u32 v35, v34, 2, 1
    v_lshl_add_u32 v20, v35, 3, v20
    s_mul_i32 s18, s12, 5
    v_add_u32 v23, s18, v25
    v_lshlrev_b32 v23, 7, v23
    v_mov_b32 v24, 0x4444
    v_mov_b32 v32, 0xeeee
    v_cmp_gt_u32 vcc, 8, v26
    s_nop 1
    v_cndmask_b32 v24, v32, v24, vcc
    s_mov_b64 s[50:51], vcc
    v_cmp_gt_u32 vcc, 48, v25
    s_and_b64 s[52:53], s[50:51], vcc
    v_mov_b32 v21, 0
    v_mov_b32 v22, 0
    s_cmp_eq_u32 s13, 0
    s_mov_b32 s40, 0x1f54000
    s_cselect_b32 s40, 0x1ee4000, s40
    s_cmp_eq_u32 s13, 0
    s_mov_b32 s41, 0x2144000
    s_cselect_b32 s41, 0x20a4000, s41
    s_cmp_eq_u32 s13, 0
    s_mov_b32 s42, 0x44e4000
    s_cselect_b32 s42, 0x21e4000, s42
    s_cmp_eq_u32 s13, 0
    s_mov_b32 s46, 0x2034000
    s_cselect_b32 s46, 0x1fc4000, s46
    s_cmp_eq_u32 s13, 0
    s_mov_b32 s43, 0x78f4000
    s_cselect_b32 s43, 0x78e4000, s43
    s_cmp_eq_u32 s13, 0
    s_mov_b32 s44, 0x7902000
    s_cselect_b32 s44, 0x78f2000, s44
    s_mov_b32 s55, 0
    s_mov_b32 s56, 35840
    s_mov_b32 s16, 0
    s_add_u32 s43, s43, 128
L_VC_loop:
    v_mov_b32 v64, 0
    v_mov_b32 v65, 0
    v_mov_b32 v66, 0
    v_mov_b32 v67, 0
    v_mov_b32 v68, 0
    v_mov_b32 v69, 0
    v_mov_b32 v70, 0
    v_mov_b32 v71, 0
    v_mov_b32 v72, 0
    v_mov_b32 v73, 0
    v_mov_b32 v74, 0
    v_mov_b32 v75, 0
    v_mov_b32 v76, 0
    v_mov_b32 v77, 0
    v_mov_b32 v78, 0
    v_mov_b32 v79, 0
    v_mov_b32 v80, 0
    v_mov_b32 v81, 0
    v_mov_b32 v82, 0
    v_mov_b32 v83, 0
    v_mov_b32 v84, 0
    v_mov_b32 v85, 0
    v_mov_b32 v86, 0
    v_mov_b32 v87, 0
    v_mov_b32 v88, 0
    v_mov_b32 v89, 0
    v_mov_b32 v90, 0
    v_mov_b32 v91, 0
    s_cmp_eq_u32 s15, 3
    s_cbranch_scc1 L_vcio_88
    s_mov_b32 s32, 400000
    s_add_u32 s25, s40, s57
    v_mov_b32 v40, 0
    v_mov_b32 v41, 0
    v_mov_b32 v42, 0
    v_mov_b32 v43, 0
    s_nop 1
L_mpoll_90:
    buffer_load_dwordx4 v[32:35], v2, s[4:7], s40 offen sc1
    buffer_load_dwordx4 v[36:39], v2, s[4:7], s40 offen offset:3072 sc1
    s_cmp_lg_u32 s15, 0
    s_cbranch_scc1 L_t3_94
    buffer_load_dwordx4 v[40:43], v2, s[4:7], s25 offen sc1
L_t3_94:
    s_waitcnt vmcnt(0)
    v_max3_u32 v25, v32, v33, v34
    v_max3_u32 v26, v35, v36, v37
    v_max3_u32 v25, v25, v38, v39
    v_max3_u32 v26, v26, v40, v41
    v_max3_u32 v25, v25, v42, v43
    v_max_u32 v25, v25, v26
    v_cmp_eq_u32 vcc, -1, v25
    s_nop 3
    s_cbranch_vccz L_mgot_91
    s_sleep 1
    s_sub_u32 s32, s32, 1
    s_cmp_lg_u32 s32, 0
    s_cbranch_scc1 L_mpoll_90
    s_branch L_fail
L_mgot_91:
    ds_write2_b32 v3, v32, v34 offset0:0 offset1:1
    ds_write2_b32 v3, v33, v35 offset0:32 offset1:33
    ds_write2_b32 v4, v36, v38 offset0:0 offset1:1
    ds_write2_b32 v4, v37, v39 offset0:32 offset1:33
    s_cmp_lg_u32 s15, 0
    s_cbranch_scc1 L_s3_95
    ds_write2_b32 v5, v40, v42 offset0:0 offset1:1
    ds_write2_b32 v5, v41, v43 offset0:32 offset1:33
    s_cmp_eq_u32 s16, 0
    s_cbranch_scc1 L_nomp_96
    s_cmp_lg_u32 s12, 0
    s_cbranch_scc1 L_nomp_96
    s_add_u32 s18, s46, s57
    buffer_store_dwordx4 v[32:35], v2, s[4:7], s46 offen sc1
    buffer_store_dwordx4 v[36:39], v2, s[4:7], s46 offen offset:3072 sc1
    buffer_store_dwordx4 v[40:43], v2, s[4:7], s18 offen sc1
    s_nop 1
L_nomp_96:
    s_branch L_s3j_97
L_s3_95:
    s_cmp_eq_u32 s16, 0
    s_cbranch_scc1 L_nomp_98
    s_cmp_lg_u32 s12, 0
    s_cbranch_scc1 L_nomp_98
    s_add_u32 s18, s46, s57
    buffer_store_dwordx4 v[32:35], v2, s[4:7], s46 offen sc1
    buffer_store_dwordx4 v[36:39], v2, s[4:7], s46 offen offset:3072 sc1
    s_nop 1
L_nomp_98:
L_s3j_97:
    s_waitcnt lgkmcnt(0)
    s_branch L_vcb1_89
L_vcio_88:
    s_cmp_eq_u32 s16, 0
    s_cbranch_scc1 L_nosig_99
    s_waitcnt vmcnt(35)
    s_sub_u32 s19, s44, 128
    v_mov_b32 v25, 1
    s_lshl_b32 s18, s12, 2
    v_mov_b32 v26, s18
    s_mov_b64 exec, 1
    buffer_store_dword v25, v26, s[4:7], s19 offen sc1
    s_mov_b64 exec, -1
L_nosig_99:
L_vcb1_89:
    s_barrier
    ds_read_b128 v[92:95], v9 offset:0
    ds_read_b128 v[96:99], v9 offset:1024
    ds_read_b128 v[100:103], v9 offset:2048
    ds_read_b128 v[104:107], v9 offset:3072
    ds_read_b128 v[108:111], v9 offset:4096
    ds_read_b128 v[112:115], v9 offset:5120
    ds_read_b128 v[116:119], v9 offset:6144
    s_cmp_lg_u32 s15, 2
    s_cbranch_scc1 L_nw_100
    s_add_u32 s18, s41, 10240
    s_mov_b64 exec, 31
    buffer_load_dword v30, v23, s[4:7], s18 offen sc1
    s_add_u32 s18, s40, 7168
    s_mul_i32 s19, s12, 128
    s_sub_u32 s18, s18, s19
    s_mov_b64 exec, 15
    buffer_load_dword v31, v23, s[4:7], s18 offen sc1
    s_mov_b64 exec, -1
L_nw_100:
    s_waitcnt lgkmcnt(0)
    v_smfmac_f32_16x16x64_bf16 v[64:67], v[92:95], v[120:127], v24
    v_smfmac_f32_16x16x64_bf16 v[64:67], v[96:99], v[128:135], v24
    v_smfmac_f32_16x16x64_bf16 v[64:67], v[100:103], v[136:143], v24
    v_smfmac_f32_16x16x64_bf16 v[64:67], v[104:107], v[144:151], v24
    v_smfmac_f32_16x16x64_bf16 v[64:67], v[108:111], v[152:159], v24
    v_smfmac_f32_16x16x64_bf16 v[64:67], v[112:115], v[160:167], v24
    v_smfmac_f32_16x16x64_bf16 v[64:67], v[116:119], v[168:175], v24
    v_smfmac_f32_16x16x64_bf16 v[68:71], v[92:95], v[176:183], v24
    v_smfmac_f32_16x16x64_bf16 v[68:71], v[96:99], v[184:191], v24
    v_smfmac_f32_16x16x64_bf16 v[68:71], v[100:103], v[192:199], v24
    v_smfmac_f32_16x16x64_bf16 v[68:71], v[104:107], v[200:207], v24
    v_smfmac_f32_16x16x64_bf16 v[68:71], v[108:111], v[208:215], v24
    v_smfmac_f32_16x16x64_bf16 v[68:71], v[112:115], v[216:223], v24
    v_smfmac_f32_16x16x64_bf16 v[68:71], v[116:119], v[224:231], v24
    v_smfmac_f32_16x16x64_bf16 v[72:75], v[92:95], v[232:239], v24
    v_smfmac_f32_16x16x64_bf16 v[72:75], v[96:99], v[240:247], v24
    v_smfmac_f32_16x16x64_bf16 v[72:75], v[100:103], v[248:255], v24
    v_smfmac_f32_16x16x64_bf16 v[72:75], v[104:107], a[0:7], v24
    v_smfmac_f32_16x16x64_bf16 v[72:75], v[108:111], a[8:15], v24
    v_smfmac_f32_16x16x64_bf16 v[72:75], v[112:115], a[16:23], v24
    v_smfmac_f32_16x16x64_bf16 v[72:75], v[116:119], a[24:31], v24
    s_nop 0
    v_permlane32_swap_b32 v64, v68
    v_permlane32_swap_b32 v65, v69
    v_smfmac_f32_16x16x64_bf16 v[76:79], v[92:95], a[32:39], v24
    v_permlane32_swap_b32 v66, v70
    v_permlane32_swap_b32 v67, v71
    v_smfmac_f32_16x16x64_bf16 v[76:79], v[96:99], a[40:47], v24
    v_add_f32 v64, v64, v68
    v_add_f32 v65, v65, v69
    v_smfmac_f32_16x16x64_bf16 v[76:79], v[100:103], a[48:55], v24
    v_add_f32 v66, v66, v70
    v_add_f32 v67, v67, v71
    v_smfmac_f32_16x16x64_bf16 v[76:79], v[104:107], a[56:63], v24
    v_cvt_pk_bf16_f32 v64, v64, v65
    v_cvt_pk_bf16_f32 v65, v66, v67
    v_smfmac_f32_16x16x64_bf16 v[76:79], v[108:111], a[64:71], v24
    v_add_u32 v29, s55, v10
    ds_write_b64 v29, v[64:65]
    v_smfmac_f32_16x16x64_bf16 v[76:79], v[112:115], a[72:79], v24
    v_smfmac_f32_16x16x64_bf16 v[76:79], v[116:119], a[80:87], v24
    v_smfmac_f32_16x16x64_bf16 v[80:83], v[92:95], a[88:95], v24
    v_smfmac_f32_16x16x64_bf16 v[80:83], v[96:99], a[96:103], v24
    v_smfmac_f32_16x16x64_bf16 v[80:83], v[100:103], a[104:111], v24
    v_smfmac_f32_16x16x64_bf16 v[80:83], v[104:107], a[112:119], v24
    v_smfmac_f32_16x16x64_bf16 v[80:83], v[108:111], a[120:127], v24
    v_smfmac_f32_16x16x64_bf16 v[80:83], v[112:115], a[128:135], v24
    v_smfmac_f32_16x16x64_bf16 v[80:83], v[116:119], a[136:143], v24
    s_nop 0
    v_permlane32_swap_b32 v72, v76
    v_permlane32_swap_b32 v73, v77
    v_smfmac_f32_16x16x64_bf16 v[84:87], v[92:95], a[144:151], v24
    v_permlane32_swap_b32 v74, v78
    v_permlane32_swap_b32 v75, v79
    v_smfmac_f32_16x16x64_bf16 v[84:87], v[96:99], a[152:159], v24
    v_add_f32 v72, v72, v76
    v_add_f32 v73, v73, v77
    v_smfmac_f32_16x16x64_bf16 v[84:87], v[100:103], a[160:167], v24
    v_add_f32 v74, v74, v78
    v_add_f32 v75, v75, v79
    v_smfmac_f32_16x16x64_bf16 v[84:87], v[104:107], a[168:175], v24
    v_cvt_pk_bf16_f32 v72, v72, v73
    v_cvt_pk_bf16_f32 v73, v74, v75
    v_smfmac_f32_16x16x64_bf16 v[84:87], v[108:111], a[176:183], v24
    v_add_u32 v29, s55, v11
    ds_write_b64 v29, v[72:73]
    v_smfmac_f32_16x16x64_bf16 v[84:87], v[112:115], a[184:191], v24
    v_smfmac_f32_16x16x64_bf16 v[84:87], v[116:119], a[192:199], v24
    v_smfmac_f32_16x16x64_bf16 v[88:91], v[92:95], a[200:207], v24
    v_smfmac_f32_16x16x64_bf16 v[88:91], v[96:99], a[208:215], v24
    v_smfmac_f32_16x16x64_bf16 v[88:91], v[100:103], a[216:223], v24
    v_smfmac_f32_16x16x64_bf16 v[88:91], v[104:107], a[224:231], v24
    v_smfmac_f32_16x16x64_bf16 v[88:91], v[108:111], a[232:239], v24
    v_smfmac_f32_16x16x64_bf16 v[88:91], v[112:115], a[240:247], v24
    v_smfmac_f32_16x16x64_bf16 v[88:91], v[116:119], a[248:255], v24
    s_nop 0
    v_permlane32_swap_b32 v80, v84
    v_permlane32_swap_b32 v81, v85
    v_permlane32_swap_b32 v82, v86
    v_permlane32_swap_b32 v83, v87
    v_add_f32 v80, v80, v84
    v_add_f32 v81, v81, v85
    v_add_f32 v82, v82, v86
    v_add_f32 v83, v83, v87
    v_cvt_pk_bf16_f32 v80, v80, v81
    v_cvt_pk_bf16_f32 v81, v82, v83
    v_add_u32 v29, s55, v12
    ds_write_b64 v29, v[80:81]
    v_mov_b32 v25, v88
    v_mov_b32 v26, v89
    v_mov_b32 v27, v90
    v_mov_b32 v28, v91
    v_permlane32_swap_b32 v25, v88
    v_permlane32_swap_b32 v26, v89
    v_permlane32_swap_b32 v27, v90
    v_permlane32_swap_b32 v28, v91
    v_add_f32 v88, v88, v25
    v_add_f32 v89, v89, v26
    v_add_f32 v90, v90, v27
    v_add_f32 v91, v91, v28
    v_cvt_pk_bf16_f32 v88, v88, v89
    v_cvt_pk_bf16_f32 v89, v90, v91
    v_add_u32 v29, s55, v13
    ds_write_b64 v29, v[88:89]
    s_cmp_lg_u32 s15, 3
    s_cbranch_scc1 L_zw_101
    s_cmp_lg_u32 s16, 0
    s_cbranch_scc1 L_z0_102
    s_sub_u32 s19, s43, 128
    s_mov_b32 s32, 400000
    v_mbcnt_lo_u32_b32 v31, -1, 0
    v_lshlrev_b32 v31, 2, v31
    s_mov_b32 exec_lo, 0xffffffff
    s_mov_b32 exec_hi, 0
L_wf_103:
    buffer_load_dword v30, v31, s[4:7], s19 offen sc1
    s_waitcnt vmcnt(0)
    v_cmp_eq_u32 vcc, 0, v30
    s_nop 3
    s_cbranch_vccz L_wfok_104
    s_sleep 1
    s_sub_u32 s32, s32, 1
    s_cmp_lg_u32 s32, 0
    s_cbranch_scc1 L_wf_103
    s_branch L_fail
L_wfok_104:
    s_mov_b64 exec, -1
    s_mov_b32 s47, s42
    s_mov_b32 s54, s55
    s_mov_b32 m0, s54
    s_mov_b32 exec_lo, 0xf0000000
    s_mov_b32 exec_hi, 0xffffffff
    buffer_load_dwordx4 v2, s[4:7], s47 offen sc1 lds
    s_add_u32 s54, s54, 1024
    s_mov_b32 m0, s54
    s_mov_b32 exec_lo, 0xffffffff
    s_mov_b32 exec_hi, 0xffffffff
    buffer_load_dwordx4 v3, s[4:7], s47 offen sc1 lds
    s_add_u32 s54, s54, 1024
    s_mov_b32 m0, s54
    s_mov_b32 exec_lo, 0xfff
    s_mov_b32 exec_hi, 0xffffff00
    buffer_load_dwordx4 v4, s[4:7], s47 offen sc1 lds
    s_add_u32 s54, s54, 1024
    s_mov_b32 m0, s54
    s_mov_b32 exec_lo, 0xffffffff
    s_mov_b32 exec_hi, 0xffffffff
    buffer_load_dwordx4 v5, s[4:7], s47 offen sc1 lds
    s_add_u32 s54, s54, 1024
    s_mov_b32 m0, s54
    s_mov_b32 exec_lo, 0xffffff
    s_mov_b32 exec_hi, 0xfff00000
    buffer_load_dwordx4 v6, s[4:7], s47 offen sc1 lds
    s_add_u32 s54, s54, 1024
    s_mov_b32 m0, s54
    s_mov_b32 exec_lo, 0xffffffff
    s_mov_b32 exec_hi, 0xffffffff
    buffer_load_dwordx4 v7, s[4:7], s47 offen sc1 lds
    s_add_u32 s54, s54, 1024
    s_mov_b32 m0, s54
    s_mov_b32 exec_lo, 0xffffffff
    s_mov_b32 exec_hi, 0xf
    buffer_load_dwordx4 v8, s[4:7], s47 offen sc1 lds
    s_add_u32 s54, s54, 1024
    s_add_u32 s47, s47, 114688
    s_mov_b32 m0, s54
    s_mov_b32 exec_lo, 0xffffffff
    s_mov_b32 exec_hi, 0xffffffff
    buffer_load_dwordx4 v2, s[4:7], s47 offen sc1 lds
    s_add_u32 s54, s54, 1024
    s_mov_b32 m0, s54
    s_mov_b32 exec_lo, 0xffffffff
    s_mov_b32 exec_hi, 0xffff
    buffer_load_dwordx4 v3, s[4:7], s47 offen sc1 lds
    s_add_u32 s54, s54, 1024
    s_mov_b32 m0, s54
    s_mov_b32 exec_lo, 0xfffff000
    s_mov_b32 exec_hi, 0xffffffff
    buffer_load_dwordx4 v4, s[4:7], s47 offen sc1 lds
    s_add_u32 s54, s54, 1024
    s_mov_b32 m0, s54
    s_mov_b32 exec_lo, 0xffffffff
    s_mov_b32 exec_hi, 0xfffffff
    buffer_load_dwordx4 v5, s[4:7], s47 offen sc1 lds
    s_add_u32 s54, s54, 1024
    s_mov_b32 m0, s54
    s_mov_b32 exec_lo, 0xff000000
    s_mov_b32 exec_hi, 0xffffffff
    buffer_load_dwordx4 v6, s[4:7], s47 offen sc1 lds
    s_add_u32 s54, s54, 1024
    s_mov_b32 m0, s54
    s_mov_b32 exec_lo, 0xffffffff
    s_mov_b32 exec_hi, 0xffffffff
    buffer_load_dwordx4 v7, s[4:7], s47 offen sc1 lds
    s_add_u32 s54, s54, 1024
    s_mov_b32 m0, s54
    s_mov_b32 exec_lo, 0xff
    s_mov_b32 exec_hi, 0xfffffff0
    buffer_load_dwordx4 v8, s[4:7], s47 offen sc1 lds
    s_add_u32 s54, s54, 1024
    s_add_u32 s47, s47, 114688
    s_mov_b32 m0, s54
    s_mov_b32 exec_lo, 0xffffffff
    s_mov_b32 exec_hi, 0xffffffff
    buffer_load_dwordx4 v2, s[4:7], s47 offen sc1 lds
    s_add_u32 s54, s54, 1024
    s_mov_b32 m0, s54
    s_mov_b32 exec_lo, 0xfffff
    s_mov_b32 exec_hi, 0xffff0000
    buffer_load_dwordx4 v3, s[4:7], s47 offen sc1 lds
    s_add_u32 s54, s54, 1024
    s_mov_b32 m0, s54
    s_mov_b32 exec_lo, 0xffffffff
    s_mov_b32 exec_hi, 0xffffffff
    buffer_load_dwordx4 v4, s[4:7], s47 offen sc1 lds
    s_add_u32 s54, s54, 1024
    s_mov_b32 m0, s54
    s_mov_b32 exec_lo, 0xffffffff
    s_mov_b32 exec_hi, 0xf0000000
    buffer_load_dwordx4 v5, s[4:7], s47 offen sc1 lds
    s_add_u32 s54, s54, 1024
    s_mov_b32 m0, s54
    s_mov_b32 exec_lo, 0xffffffff
    s_mov_b32 exec_hi, 0xffffffff
    buffer_load_dwordx4 v6, s[4:7], s47 offen sc1 lds
    s_add_u32 s54, s54, 1024
    s_mov_b32 m0, s54
    s_mov_b32 exec_lo, 0xffffffff
    s_mov_b32 exec_hi, 0xfff
    buffer_load_dwordx4 v7, s[4:7], s47 offen sc1 lds
    s_add_u32 s54, s54, 1024
    s_mov_b32 m0, s54
    s_mov_b32 exec_lo, 0xffffff00
    s_mov_b32 exec_hi, 0xffffffff
    buffer_load_dwordx4 v8, s[4:7], s47 offen sc1 lds
    s_add_u32 s54, s54, 1024
    s_add_u32 s47, s47, 114688
    s_mov_b32 m0, s54
    s_mov_b32 exec_lo, 0xffffffff
    s_mov_b32 exec_hi, 0xffffff
    buffer_load_dwordx4 v2, s[4:7], s47 offen sc1 lds
    s_add_u32 s54, s54, 1024
    s_mov_b32 m0, s54
    s_mov_b32 exec_lo, 0xfff00000
    s_mov_b32 exec_hi, 0xffffffff
    buffer_load_dwordx4 v3, s[4:7], s47 offen sc1 lds
    s_add_u32 s54, s54, 1024
    s_mov_b32 m0, s54
    s_mov_b32 exec_lo, 0xffffffff
    s_mov_b32 exec_hi, 0xffffffff
    buffer_load_dwordx4 v4, s[4:7], s47 offen sc1 lds
    s_add_u32 s54, s54, 1024
    s_mov_b32 m0, s54
    s_mov_b32 exec_lo, 0xf
    s_mov_b32 exec_hi, 0xffffffff
    buffer_load_dwordx4 v5, s[4:7], s47 offen sc1 lds
    s_add_u32 s54, s54, 1024
    s_mov_b32 m0, s54
    s_mov_b32 exec_lo, 0xffffffff
    s_mov_b32 exec_hi, 0xffffffff
    buffer_load_dwordx4 v6, s[4:7], s47 offen sc1 lds
    s_add_u32 s54, s54, 1024
    s_mov_b32 m0, s54
    s_mov_b32 exec_lo, 0xffff
    s_mov_b32 exec_hi, 0xfffff000
    buffer_load_dwordx4 v7, s[4:7], s47 offen sc1 lds
    s_add_u32 s54, s54, 1024
    s_mov_b32 m0, s54
    s_mov_b32 exec_lo, 0xffffffff
    s_mov_b32 exec_hi, 0xffffffff
    buffer_load_dwordx4 v8, s[4:7], s47 offen sc1 lds
    s_add_u32 s54, s54, 1024
    s_add_u32 s47, s47, 114688
    s_mov_b32 m0, s54
    s_mov_b32 exec_lo, 0xfffffff
    s_mov_b32 exec_hi, 0xff000000
    buffer_load_dwordx4 v2, s[4:7], s47 offen sc1 lds
    s_add_u32 s54, s54, 1024
    s_mov_b32 m0, s54
    s_mov_b32 exec_lo, 0xffffffff
    s_mov_b32 exec_hi, 0xffffffff
    buffer_load_dwordx4 v3, s[4:7], s47 offen sc1 lds
    s_add_u32 s54, s54, 1024
    s_mov_b32 m0, s54
    s_mov_b32 exec_lo, 0xffffffff
    s_mov_b32 exec_hi, 0xff
    buffer_load_dwordx4 v4, s[4:7], s47 offen sc1 lds
    s_add_u32 s54, s54, 1024
    s_mov_b32 m0, s54
    s_mov_b32 exec_lo, 0xfffffff0
    s_mov_b32 exec_hi, 0xffffffff
    buffer_load_dwordx4 v5, s[4:7], s47 offen sc1 lds
    s_add_u32 s54, s54, 1024
    s_mov_b32 m0, s54
    s_mov_b32 exec_lo, 0xffffffff
    s_mov_b32 exec_hi, 0xfffff
    buffer_load_dwordx4 v6, s[4:7], s47 offen sc1 lds
    s_add_u32 s54, s54, 1024
    s_mov_b32 m0, s54
    s_mov_b32 exec_lo, 0xffff0000
    s_mov_b32 exec_hi, 0xffffffff
    buffer_load_dwordx4 v7, s[4:7], s47 offen sc1 lds
    s_add_u32 s54, s54, 1024
    s_mov_b32 m0, s54
    s_mov_b32 exec_lo, 0xffffffff
    s_mov_b32 exec_hi, 0xffffffff
    buffer_load_dwordx4 v8, s[4:7], s47 offen sc1 lds
    s_add_u32 s54, s54, 1024
    s_mov_b64 exec, -1
L_z0_102:
    s_waitcnt vmcnt(0)
L_zw_101:
    s_waitcnt lgkmcnt(0)
    s_barrier
    s_cmp_lt_u32 s16, 63
    s_cbranch_scc1 L_comb_106
    s_cmp_lg_u32 s15, 3
    s_cbranch_scc1 L_role_done
    v_add_u32 v29, s55, v14
    s_mov_b32 exec_hi, 0x00ffffff
    ds_read_b128 v[64:67], v29 offset:0
    ds_read_b128 v[68:71], v29 offset:4480
    ds_read_b128 v[72:75], v29 offset:8960
    ds_read_b128 v[76:79], v29 offset:13440
    ds_read_b128 v[80:83], v29 offset:17920
    ds_read_b128 v[84:87], v29 offset:22400
    ds_read_b128 v[88:91], v29 offset:26880
    ds_read_b128 v[92:95], v29 offset:31360
    s_mov_b32 s47, s42
    s_waitcnt lgkmcnt(7)
    buffer_store_dwordx4 v[64:67], v15, s[4:7], s47 offen sc1
    s_add_u32 s47, s47, 71680
    s_waitcnt lgkmcnt(6)
    buffer_store_dwordx4 v[68:71], v15, s[4:7], s47 offen sc1
    s_add_u32 s47, s47, 71680
    s_waitcnt lgkmcnt(5)
    buffer_store_dwordx4 v[72:75], v15, s[4:7], s47 offen sc1
    s_add_u32 s47, s47, 71680
    s_waitcnt lgkmcnt(4)
    buffer_store_dwordx4 v[76:79], v15, s[4:7], s47 offen sc1
    s_add_u32 s47, s47, 71680
    s_waitcnt lgkmcnt(3)
    buffer_store_dwordx4 v[80:83], v15, s[4:7], s47 offen sc1
    s_add_u32 s47, s47, 71680
    s_waitcnt lgkmcnt(2)
    buffer_store_dwordx4 v[84:87], v15, s[4:7], s47 offen sc1
    s_add_u32 s47, s47, 71680
    s_waitcnt lgkmcnt(1)
    buffer_store_dwordx4 v[88:91], v15, s[4:7], s47 offen sc1
    s_add_u32 s47, s47, 71680
    s_waitcnt lgkmcnt(0)
    buffer_store_dwordx4 v[92:95], v15, s[4:7], s47 offen sc1
    s_mov_b32 exec_hi, -1
    s_branch L_VC_last
L_comb_106:
    v_add_u32 v29, s55, v16
    ds_read_b128 v[64:67], v29 offset:0
    ds_read_b128 v[68:71], v29 offset:256
    ds_read_b128 v[72:75], v29 offset:1792
    ds_read_b128 v[76:79], v29 offset:2048
    ds_read_b128 v[80:83], v29 offset:3584
    ds_read_b128 v[84:87], v29 offset:3840
    ds_read_b128 v[88:91], v29 offset:5376
    ds_read_b128 v[92:95], v29 offset:5632
    ds_read_b128 v[96:99], v29 offset:7168
    ds_read_b128 v[100:103], v29 offset:7424
    s_mov_b32 s32, 400000
L_ppoll_107:
    buffer_load_dwordx4 v[32:35], v17, s[4:7], s41 offen sc1
    buffer_load_dwordx4 v[36:39], v17, s[4:7], s41 offen offset:1024 sc1
    buffer_load_dwordx4 v[40:43], v18, s[4:7], s41 offen sc1
    s_waitcnt vmcnt(0)
    v_max3_u32 v25, v32, v33, v34
    v_max3_u32 v26, v35, v36, v37
    v_max3_u32 v25, v25, v38, v39
    v_max3_u32 v26, v26, v40, v41
    v_max3_u32 v25, v25, v42, v43
    v_max_u32 v25, v25, v26
    v_cmp_eq_u32 vcc, -1, v25
    s_nop 3
    s_cbranch_vccz L_pgA_108
    s_sub_u32 s32, s32, 1
    s_cmp_lg_u32 s32, 0
    s_cbranch_scc1 L_ppoll_107
    s_branch L_fail
L_pgA_108:
    s_waitcnt lgkmcnt(0)
    v_mfma_f32_16x16x32_bf16 v[48:51], v[64:67], v[32:35], 0
    v_mfma_f32_16x16x32_bf16 v[52:55], v[68:71], v[32:35], 0
    v_mfma_f32_16x16x32_bf16 v[56:59], v[72:75], v[32:35], 0
    v_mfma_f32_16x16x32_bf16 v[60:63], v[76:79], v[32:35], 0
    v_mfma_f32_16x16x32_bf16 v[48:51], v[80:83], v[36:39], v[48:51]
    v_mfma_f32_16x16x32_bf16 v[52:55], v[84:87], v[36:39], v[52:55]
    v_mfma_f32_16x16x32_bf16 v[56:59], v[88:91], v[36:39], v[56:59]
    v_mfma_f32_16x16x32_bf16 v[60:63], v[92:95], v[36:39], v[60:63]
    v_mfma_f32_16x16x32_bf16 v[48:51], v[96:99], v[40:43], v[48:51]
    v_mfma_f32_16x16x32_bf16 v[52:55], v[100:103], v[40:43], v[52:55]
    s_nop 6
    s_branch L_pgJ_110
L_pgB_109:
    s_waitcnt lgkmcnt(0)
    v_mfma_f32_16x16x32_bf16 v[48:51], v[64:67], v[104:107], 0
    v_mfma_f32_16x16x32_bf16 v[52:55], v[68:71], v[104:107], 0
    v_mfma_f32_16x16x32_bf16 v[56:59], v[72:75], v[104:107], 0
    v_mfma_f32_16x16x32_bf16 v[60:63], v[76:79], v[104:107], 0
    v_mfma_f32_16x16x32_bf16 v[48:51], v[80:83], v[108:111], v[48:51]
    v_mfma_f32_16x16x32_bf16 v[52:55], v[84:87], v[108:111], v[52:55]
    v_mfma_f32_16x16x32_bf16 v[56:59], v[88:91], v[108:111], v[56:59]
    v_mfma_f32_16x16x32_bf16 v[60:63], v[92:95], v[108:111], v[60:63]
    v_mfma_f32_16x16x32_bf16 v[48:51], v[96:99], v[112:115], v[48:51]
    v_mfma_f32_16x16x32_bf16 v[52:55], v[100:103], v[112:115], v[52:55]
    s_nop 7
L_pgJ_110:
    v_add_f32_dpp v48, v56, v48 row_ror:8 row_mask:0xf bank_mask:0xf
    v_add_f32_dpp v49, v57, v49 row_ror:8 row_mask:0xf bank_mask:0xf
    v_add_f32_dpp v50, v58, v50 row_ror:8 row_mask:0xf bank_mask:0xf
    v_add_f32_dpp v51, v59, v51 row_ror:8 row_mask:0xf bank_mask:0xf
    v_add_f32_dpp v52, v60, v52 row_ror:8 row_mask:0xf bank_mask:0xf
    v_add_f32_dpp v53, v61, v53 row_ror:8 row_mask:0xf bank_mask:0xf
    v_add_f32_dpp v54, v62, v54 row_ror:8 row_mask:0xf bank_mask:0xf
    v_add_f32_dpp v55, v63, v55 row_ror:8 row_mask:0xf bank_mask:0xf
    ds_write_b128 v19, v[48:51]
    ds_write_b128 v19, v[52:55] offset:1024
    s_waitcnt lgkmcnt(0)
    s_barrier
    s_cmp_ge_u32 s15, 2
    s_cbranch_scc1 L_nofin_111
    s_lshl_b32 s18, s15, 10
    v_subrev_u32 v29, s18, v19
    ds_read_b128 v[64:67], v29 offset:0
    ds_read_b128 v[68:71], v29 offset:2048
    ds_read_b128 v[72:75], v29 offset:4096
    ds_read_b128 v[76:79], v29 offset:6144
    s_cmp_eq_u32 s15, 0
    s_cselect_b64 exec, s[50:51], s[52:53]
    s_add_u32 s18, s40, 7168
    s_waitcnt lgkmcnt(2)
    v_add_f32 v64, v64, v68
    v_add_f32 v65, v65, v69
    v_add_f32 v66, v66, v70
    v_add_f32 v67, v67, v71
    s_waitcnt lgkmcnt(0)
    v_add_f32 v72, v72, v76
    v_add_f32 v73, v73, v77
    v_add_f32 v74, v74, v78
    v_add_f32 v75, v75, v79
    v_add_f32 v64, v64, v72
    v_add_f32 v65, v65, v73
    v_add_f32 v66, v66, v74
    v_add_f32 v67, v67, v75
    v_cvt_pk_bf16_f32 v64, v64, v65
    v_cvt_pk_bf16_f32 v65, v66, v67
    s_cmp_lg_u32 s14, 0
    s_cbranch_scc1 L_slow_112
    buffer_store_dwordx2 v[64:65], v20, s[4:7], s18 offen
    s_branch L_st_113
L_slow_112:
    buffer_store_dwordx2 v[64:65], v20, s[4:7], s18 offen sc1
L_st_113:
    s_mov_b64 exec, -1
L_nofin_111:
    s_barrier
    s_cmp_lg_u32 s15, 3
    s_cbranch_scc1 L_nio_114
    v_add_u32 v29, s55, v14
    s_mov_b32 exec_hi, 0x00ffffff
    ds_read_b128 v[64:67], v29 offset:0
    ds_read_b128 v[68:71], v29 offset:4480
    ds_read_b128 v[72:75], v29 offset:8960
    ds_read_b128 v[76:79], v29 offset:13440
    ds_read_b128 v[80:83], v29 offset:17920
    ds_read_b128 v[84:87], v29 offset:22400
    ds_read_b128 v[88:91], v29 offset:26880
    ds_read_b128 v[92:95], v29 offset:31360
    s_mov_b32 s47, s42
    s_waitcnt lgkmcnt(7)
    buffer_store_dwordx4 v[64:67], v15, s[4:7], s47 offen sc1
    s_add_u32 s47, s47, 71680
    s_waitcnt lgkmcnt(6)
    buffer_store_dwordx4 v[68:71], v15, s[4:7], s47 offen sc1
    s_add_u32 s47, s47, 71680
    s_waitcnt lgkmcnt(5)
    buffer_store_dwordx4 v[72:75], v15, s[4:7], s47 offen sc1
    s_add_u32 s47, s47, 71680
    s_waitcnt lgkmcnt(4)
    buffer_store_dwordx4 v[76:79], v15, s[4:7], s47 offen sc1
    s_add_u32 s47, s47, 71680
    s_waitcnt lgkmcnt(3)
    buffer_store_dwordx4 v[80:83], v15, s[4:7], s47 offen sc1
    s_add_u32 s47, s47, 71680
    s_waitcnt lgkmcnt(2)
    buffer_store_dwordx4 v[84:87], v15, s[4:7], s47 offen sc1
    s_add_u32 s47, s47, 71680
    s_waitcnt lgkmcnt(1)
    buffer_store_dwordx4 v[88:91], v15, s[4:7], s47 offen sc1
    s_add_u32 s47, s47, 71680
    s_waitcnt lgkmcnt(0)
    buffer_store_dwordx4 v[92:95], v15, s[4:7], s47 offen sc1
    s_mov_b32 exec_hi, -1
    s_mov_b32 s22, s42
    s_cmp_ge_u32 s16, 62
    s_cbranch_scc1 L_zl_115
    s_mov_b32 exec_lo, 0xffffffff
    s_mov_b32 exec_hi, 0
    v_cmp_eq_u32 vcc, 0, v22
    s_mov_b64 exec, -1
    s_nop 2
    s_cbranch_vccz L_zok_116
    s_mov_b32 s32, 400000
    v_mbcnt_lo_u32_b32 v26, -1, 0
    v_lshlrev_b32 v26, 2, v26
    s_mov_b32 exec_lo, 0xffffffff
    s_mov_b32 exec_hi, 0
L_wf_117:
    buffer_load_dword v25, v26, s[4:7], s43 offen sc1
    s_waitcnt vmcnt(0)
    v_cmp_eq_u32 vcc, 0, v25
    s_nop 3
    s_cbranch_vccz L_wfok_118
    s_sleep 1
    s_sub_u32 s32, s32, 1
    s_cmp_lg_u32 s32, 0
    s_cbranch_scc1 L_wf_117
    s_branch L_fail
L_wfok_118:
    s_mov_b64 exec, -1
L_zok_116:
    s_add_u32 s22, s42, 573440
L_zl_115:
    s_add_u32 s18, s43, 128
    v_mbcnt_lo_u32_b32 v25, -1, 0
    v_lshlrev_b32 v25, 2, v25
    s_mov_b32 exec_lo, -1
    s_mov_b32 exec_hi, 0
    buffer_load_dword v22, v25, s[4:7], s18 offen sc1
    s_mov_b64 exec, -1
    s_add_u32 s23, s55, s56
    s_mov_b32 s47, s22
    s_mov_b32 s54, s23
    s_mov_b32 m0, s54
    s_mov_b32 exec_lo, 0xf0000000
    s_mov_b32 exec_hi, 0xffffffff
    buffer_load_dwordx4 v2, s[4:7], s47 offen sc1 lds
    s_add_u32 s54, s54, 1024
    s_mov_b32 m0, s54
    s_mov_b32 exec_lo, 0xffffffff
    s_mov_b32 exec_hi, 0xffffffff
    buffer_load_dwordx4 v3, s[4:7], s47 offen sc1 lds
    s_add_u32 s54, s54, 1024
    s_mov_b32 m0, s54
    s_mov_b32 exec_lo, 0xfff
    s_mov_b32 exec_hi, 0xffffff00
    buffer_load_dwordx4 v4, s[4:7], s47 offen sc1 lds
    s_add_u32 s54, s54, 1024
    s_mov_b32 m0, s54
    s_mov_b32 exec_lo, 0xffffffff
    s_mov_b32 exec_hi, 0xffffffff
    buffer_load_dwordx4 v5, s[4:7], s47 offen sc1 lds
    s_add_u32 s54, s54, 1024
    s_mov_b32 m0, s54
    s_mov_b32 exec_lo, 0xffffff
    s_mov_b32 exec_hi, 0xfff00000
    buffer_load_dwordx4 v6, s[4:7], s47 offen sc1 lds
    s_add_u32 s54, s54, 1024
    s_mov_b32 m0, s54
    s_mov_b32 exec_lo, 0xffffffff
    s_mov_b32 exec_hi, 0xffffffff
    buffer_load_dwordx4 v7, s[4:7], s47 offen sc1 lds
    s_add_u32 s54, s54, 1024
    s_mov_b32 m0, s54
    s_mov_b32 exec_lo, 0xffffffff
    s_mov_b32 exec_hi, 0xf
    buffer_load_dwordx4 v8, s[4:7], s47 offen sc1 lds
    s_add_u32 s54, s54, 1024
    s_add_u32 s47, s47, 114688
    s_mov_b32 m0, s54
    s_mov_b32 exec_lo, 0xffffffff
    s_mov_b32 exec_hi, 0xffffffff
    buffer_load_dwordx4 v2, s[4:7], s47 offen sc1 lds
    s_add_u32 s54, s54, 1024
    s_mov_b32 m0, s54
    s_mov_b32 exec_lo, 0xffffffff
    s_mov_b32 exec_hi, 0xffff
    buffer_load_dwordx4 v3, s[4:7], s47 offen sc1 lds
    s_add_u32 s54, s54, 1024
    s_mov_b32 m0, s54
    s_mov_b32 exec_lo, 0xfffff000
    s_mov_b32 exec_hi, 0xffffffff
    buffer_load_dwordx4 v4, s[4:7], s47 offen sc1 lds
    s_add_u32 s54, s54, 1024
    s_mov_b32 m0, s54
    s_mov_b32 exec_lo, 0xffffffff
    s_mov_b32 exec_hi, 0xfffffff
    buffer_load_dwordx4 v5, s[4:7], s47 offen sc1 lds
    s_add_u32 s54, s54, 1024
    s_mov_b32 m0, s54
    s_mov_b32 exec_lo, 0xff000000
    s_mov_b32 exec_hi, 0xffffffff
    buffer_load_dwordx4 v6, s[4:7], s47 offen sc1 lds
    s_add_u32 s54, s54, 1024
    s_mov_b32 m0, s54
    s_mov_b32 exec_lo, 0xffffffff
    s_mov_b32 exec_hi, 0xffffffff
    buffer_load_dwordx4 v7, s[4:7], s47 offen sc1 lds
    s_add_u32 s54, s54, 1024
    s_mov_b32 m0, s54
    s_mov_b32 exec_lo, 0xff
    s_mov_b32 exec_hi, 0xfffffff0
    buffer_load_dwordx4 v8, s[4:7], s47 offen sc1 lds
    s_add_u32 s54, s54, 1024
    s_add_u32 s47, s47, 114688
    s_mov_b32 m0, s54
    s_mov_b32 exec_lo, 0xffffffff
    s_mov_b32 exec_hi, 0xffffffff
    buffer_load_dwordx4 v2, s[4:7], s47 offen sc1 lds
    s_add_u32 s54, s54, 1024
    s_mov_b32 m0, s54
    s_mov_b32 exec_lo, 0xfffff
    s_mov_b32 exec_hi, 0xffff0000
    buffer_load_dwordx4 v3, s[4:7], s47 offen sc1 lds
    s_add_u32 s54, s54, 1024
    s_mov_b32 m0, s54
    s_mov_b32 exec_lo, 0xffffffff
    s_mov_b32 exec_hi, 0xffffffff
    buffer_load_dwordx4 v4, s[4:7], s47 offen sc1 lds
    s_add_u32 s54, s54, 1024
    s_mov_b32 m0, s54
    s_mov_b32 exec_lo, 0xffffffff
    s_mov_b32 exec_hi, 0xf0000000
    buffer_load_dwordx4 v5, s[4:7], s47 offen sc1 lds
    s_add_u32 s54, s54, 1024
    s_mov_b32 m0, s54
    s_mov_b32 exec_lo, 0xffffffff
    s_mov_b32 exec_hi, 0xffffffff
    buffer_load_dwordx4 v6, s[4:7], s47 offen sc1 lds
    s_add_u32 s54, s54, 1024
    s_mov_b32 m0, s54
    s_mov_b32 exec_lo, 0xffffffff
    s_mov_b32 exec_hi, 0xfff
    buffer_load_dwordx4 v7, s[4:7], s47 offen sc1 lds
    s_add_u32 s54, s54, 1024
    s_mov_b32 m0, s54
    s_mov_b32 exec_lo, 0xffffff00
    s_mov_b32 exec_hi, 0xffffffff
    buffer_load_dwordx4 v8, s[4:7], s47 offen sc1 lds
    s_add_u32 s54, s54, 1024
    s_add_u32 s47, s47, 114688
    s_mov_b32 m0, s54
    s_mov_b32 exec_lo, 0xffffffff
    s_mov_b32 exec_hi, 0xffffff
    buffer_load_dwordx4 v2, s[4:7], s47 offen sc1 lds
    s_add_u32 s54, s54, 1024
    s_mov_b32 m0, s54
    s_mov_b32 exec_lo, 0xfff00000
    s_mov_b32 exec_hi, 0xffffffff
    buffer_load_dwordx4 v3, s[4:7], s47 offen sc1 lds
    s_add_u32 s54, s54, 1024
    s_mov_b32 m0, s54
    s_mov_b32 exec_lo, 0xffffffff
    s_mov_b32 exec_hi, 0xffffffff
    buffer_load_dwordx4 v4, s[4:7], s47 offen sc1 lds
    s_add_u32 s54, s54, 1024
    s_mov_b32 m0, s54
    s_mov_b32 exec_lo, 0xf
    s_mov_b32 exec_hi, 0xffffffff
    buffer_load_dwordx4 v5, s[4:7], s47 offen sc1 lds
    s_add_u32 s54, s54, 1024
    s_mov_b32 m0, s54
    s_mov_b32 exec_lo, 0xffffffff
    s_mov_b32 exec_hi, 0xffffffff
    buffer_load_dwordx4 v6, s[4:7], s47 offen sc1 lds
    s_add_u32 s54, s54, 1024
    s_mov_b32 m0, s54
    s_mov_b32 exec_lo, 0xffff
    s_mov_b32 exec_hi, 0xfffff000
    buffer_load_dwordx4 v7, s[4:7], s47 offen sc1 lds
    s_add_u32 s54, s54, 1024
    s_mov_b32 m0, s54
    s_mov_b32 exec_lo, 0xffffffff
    s_mov_b32 exec_hi, 0xffffffff
    buffer_load_dwordx4 v8, s[4:7], s47 offen sc1 lds
    s_add_u32 s54, s54, 1024
    s_add_u32 s47, s47, 114688
    s_mov_b32 m0, s54
    s_mov_b32 exec_lo, 0xfffffff
    s_mov_b32 exec_hi, 0xff000000
    buffer_load_dwordx4 v2, s[4:7], s47 offen sc1 lds
    s_add_u32 s54, s54, 1024
    s_mov_b32 m0, s54
    s_mov_b32 exec_lo, 0xffffffff
    s_mov_b32 exec_hi, 0xffffffff
    buffer_load_dwordx4 v3, s[4:7], s47 offen sc1 lds
    s_add_u32 s54, s54, 1024
    s_mov_b32 m0, s54
    s_mov_b32 exec_lo, 0xffffffff
    s_mov_b32 exec_hi, 0xff
    buffer_load_dwordx4 v4, s[4:7], s47 offen sc1 lds
    s_add_u32 s54, s54, 1024
    s_mov_b32 m0, s54
    s_mov_b32 exec_lo, 0xfffffff0
    s_mov_b32 exec_hi, 0xffffffff
    buffer_load_dwordx4 v5, s[4:7], s47 offen sc1 lds
    s_add_u32 s54, s54, 1024
    s_mov_b32 m0, s54
    s_mov_b32 exec_lo, 0xffffffff
    s_mov_b32 exec_hi, 0xfffff
    buffer_load_dwordx4 v6, s[4:7], s47 offen sc1 lds
    s_add_u32 s54, s54, 1024
    s_mov_b32 m0, s54
    s_mov_b32 exec_lo, 0xffff0000
    s_mov_b32 exec_hi, 0xffffffff
    buffer_load_dwordx4 v7, s[4:7], s47 offen sc1 lds
    s_add_u32 s54, s54, 1024
    s_mov_b32 m0, s54
    s_mov_b32 exec_lo, 0xffffffff
    s_mov_b32 exec_hi, 0xffffffff
    buffer_load_dwordx4 v8, s[4:7], s47 offen sc1 lds
    s_add_u32 s54, s54, 1024
    s_mov_b64 exec, -1
L_nio_114:
    s_add_u32 s16, s16, 1
    s_add_u32 s40, s40, 7168
    s_add_u32 s46, s46, 7168
    s_add_u32 s41, s41, 10240
    s_add_u32 s42, s42, 573440
    s_add_u32 s44, s44, 128
    s_add_u32 s43, s43, 128
    s_add_u32 s55, s55, s56
    s_sub_u32 s56, 0, s56
    s_branch L_VC_loop
L_VC_last:
    s_waitcnt vmcnt(0)
    v_mov_b32 v25, 1
    s_lshl_b32 s18, s12, 2
    v_mov_b32 v26, s18
    s_mov_b64 exec, 1
    buffer_store_dword v25, v26, s[4:7], s44 offen sc1
    s_mov_b64 exec, -1
    s_branch L_role_done
L_bulk:
    s_cmp_ge_u32 s18, 192
    s_cbranch_scc1 L_bl
    s_sub_u32 s19, s18, 64
    s_lshr_b32 s19, s19, 5
    s_lshl_b32 s19, s19, 2
    s_bfe_u32 s20, s18, 0x20003
    s_add_u32 s12, s19, s20
    s_bfe_u32 s13, s18, 0x10001
    s_and_b32 s38, s18, 1
    s_bitcmp1_b32 s18, 2
    s_cbranch_scc1 L_ZG
    s_mov_b32 s60, s12
    s_mul_i32 s18, s12, 401408
    s_mul_i32 s19, s15, 100352
    s_add_u32 s18, s18, s19
    s_add_u32 s20, s18, 0
    v_and_b32 v1, 63, v0
    v_lshlrev_b32 v1, 4, v1
    s_mov_b32 s40, s93
    s_cmp_ge_u32 s40, 160
    s_cbranch_scc1 M_end_120
    v_lshlrev_b32 v6, 4, v0
    v_mov_b32 v8, -1
    v_mov_b32 v12, 0
    v_mov_b32 v9, -1
    v_mov_b32 v13, 0
    v_mov_b32 v10, -1
    v_mov_b32 v14, 0
    v_mov_b32 v11, -1
    v_mov_b32 v15, 0
    s_lshl_b32 s42, s40, 12
    s_add_u32 s42, s42, 126763008
    s_mov_b32 s46, 126894080
    s_mov_b32 s44, s4
    s_mov_b32 s45, s5
    s_mov_b32 s47, 0x00020000
    buffer_store_dwordx4 v[12:15], v6, s[44:47], s42 offen sc1
    s_lshl_b32 s42, s40, 12
    s_add_u32 s42, s42, 32398336
    s_mov_b32 s46, 32849920
    s_mov_b32 s44, s4
    s_mov_b32 s45, s5
    s_mov_b32 s47, 0x00020000
    buffer_store_dwordx4 v[8:11], v6, s[44:47], s42 offen sc1
    s_lshl_b32 s42, s40, 12
    s_add_u32 s42, s42, 33315840
    s_mov_b32 s46, 33767424
    s_mov_b32 s44, s4
    s_mov_b32 s45, s5
    s_mov_b32 s47, 0x00020000
    buffer_store_dwordx4 v[8:11], v6, s[44:47], s42 offen sc1
    s_lshl_b32 s42, s40, 12
    s_add_u32 s42, s42, 34226176
    s_mov_b32 s46, 34881536
    s_mov_b32 s44, s4
    s_mov_b32 s45, s5
    s_mov_b32 s47, 0x00020000
    buffer_store_dwordx4 v[8:11], v6, s[44:47], s42 offen sc1
    s_lshl_b32 s42, s40, 12
    s_add_u32 s42, s42, 32857088
    s_mov_b32 s46, 33308672
    s_mov_b32 s44, s4
    s_mov_b32 s45, s5
    s_mov_b32 s47, 0x00020000
    buffer_store_dwordx4 v[8:11], v6, s[44:47], s42 offen sc1
    s_lshl_b32 s42, s40, 12
    s_add_u32 s42, s42, 33774592
    s_mov_b32 s46, 34226176
    s_mov_b32 s44, s4
    s_mov_b32 s45, s5
    s_mov_b32 s47, 0x00020000
    buffer_store_dwordx4 v[8:11], v6, s[44:47], s42 offen sc1
    s_lshl_b32 s42, s40, 12
    s_add_u32 s42, s42, 34881536
    s_mov_b32 s46, 35536896
    s_mov_b32 s44, s4
    s_mov_b32 s45, s5
    s_mov_b32 s47, 0x00020000
    buffer_store_dwordx4 v[8:11], v6, s[44:47], s42 offen sc1
    s_cmp_ge_u32 s40, 32
    s_cbranch_scc1 M_end_120
    s_load_dwordx2 s[8:9], s[34:35], 0
    s_waitcnt lgkmcnt(0)
    s_mov_b32 s10, 1835008
    s_mov_b32 s11, 0x00020000
    v_lshrrev_b32 v4, 3, v0
    v_and_b32 v5, 7, v0
    v_mul_u32_u24 v2, 896, v4
    v_lshl_add_u32 v2, v5, 4, v2
    v_mul_u32_u24 v3, 928, v4
    v_lshl_add_u32 v3, v5, 4, v3
    s_add_u32 s41, s40, 32
    s_mul_i32 s42, s41, 28672
    buffer_load_dwordx4 v[16:19], v2, s[8:11], s42 offen offset:0
    buffer_load_dwordx4 v[20:23], v2, s[8:11], s42 offen offset:128
    buffer_load_dwordx4 v[24:27], v2, s[8:11], s42 offen offset:256
    buffer_load_dwordx4 v[28:31], v2, s[8:11], s42 offen offset:384
    buffer_load_dwordx4 v[32:35], v2, s[8:11], s42 offen offset:512
    buffer_load_dwordx4 v[36:39], v2, s[8:11], s42 offen offset:640
    buffer_load_dwordx4 v[40:43], v2, s[8:11], s42 offen offset:768
    s_waitcnt vmcnt(0)
    v_lshlrev_b32 v48, 16, v16
    v_and_b32 v49, 0xffff0000, v16
    v_lshlrev_b32 v50, 16, v17
    v_and_b32 v51, 0xffff0000, v17
    v_lshlrev_b32 v52, 16, v18
    v_and_b32 v53, 0xffff0000, v18
    v_lshlrev_b32 v54, 16, v19
    v_and_b32 v55, 0xffff0000, v19
    v_lshlrev_b32 v56, 16, v20
    v_and_b32 v57, 0xffff0000, v20
    v_lshlrev_b32 v58, 16, v21
    v_and_b32 v59, 0xffff0000, v21
    v_lshlrev_b32 v60, 16, v22
    v_and_b32 v61, 0xffff0000, v22
    v_lshlrev_b32 v62, 16, v23
    v_and_b32 v63, 0xffff0000, v23
    v_lshlrev_b32 v64, 16, v24
    v_and_b32 v65, 0xffff0000, v24
    v_lshlrev_b32 v66, 16, v25
    v_and_b32 v67, 0xffff0000, v25
    v_lshlrev_b32 v68, 16, v26
    v_and_b32 v69, 0xffff0000, v26
    v_lshlrev_b32 v70, 16, v27
    v_and_b32 v71, 0xffff0000, v27
    v_lshlrev_b32 v72, 16, v28
    v_and_b32 v73, 0xffff0000, v28
    v_lshlrev_b32 v74, 16, v29
    v_and_b32 v75, 0xffff0000, v29
    v_lshlrev_b32 v76, 16, v30
    v_and_b32 v77, 0xffff0000, v30
    v_lshlrev_b32 v78, 16, v31
    v_and_b32 v79, 0xffff0000, v31
    v_lshlrev_b32 v80, 16, v32
    v_and_b32 v81, 0xffff0000, v32
    v_lshlrev_b32 v82, 16, v33
    v_and_b32 v83, 0xffff0000, v33
    v_lshlrev_b32 v84, 16, v34
    v_and_b32 v85, 0xffff0000, v34
    v_lshlrev_b32 v86, 16, v35
    v_and_b32 v87, 0xffff0000, v35
    v_lshlrev_b32 v88, 16, v36
    v_and_b32 v89, 0xffff0000, v36
    v_lshlrev_b32 v90, 16, v37
    v_and_b32 v91, 0xffff0000, v37
    v_lshlrev_b32 v92, 16, v38
    v_and_b32 v93, 0xffff0000, v38
    v_lshlrev_b32 v94, 16, v39
    v_and_b32 v95, 0xffff0000, v39
    v_lshlrev_b32 v96, 16, v40
    v_and_b32 v97, 0xffff0000, v40
    v_lshlrev_b32 v98, 16, v41
    v_and_b32 v99, 0xffff0000, v41
    v_lshlrev_b32 v100, 16, v42
    v_and_b32 v101, 0xffff0000, v42
    v_lshlrev_b32 v102, 16, v43
    v_and_b32 v103, 0xffff0000, v43
    v_pk_add_f32 v[6:7], v[48:49], v[50:51]
    v_pk_add_f32 v[8:9], v[52:53], v[54:55]
    v_pk_add_f32 v[6:7], v[6:7], v[56:57]
    v_pk_add_f32 v[8:9], v[8:9], v[58:59]
    v_pk_add_f32 v[6:7], v[6:7], v[60:61]
    v_pk_add_f32 v[8:9], v[8:9], v[62:63]
    v_pk_add_f32 v[6:7], v[6:7], v[64:65]
    v_pk_add_f32 v[8:9], v[8:9], v[66:67]
    v_pk_add_f32 v[6:7], v[6:7], v[68:69]
    v_pk_add_f32 v[8:9], v[8:9], v[70:71]
    v_pk_add_f32 v[6:7], v[6:7], v[72:73]
    v_pk_add_f32 v[8:9], v[8:9], v[74:75]
    v_pk_add_f32 v[6:7], v[6:7], v[76:77]
    v_pk_add_f32 v[8:9], v[8:9], v[78:79]
    v_pk_add_f32 v[6:7], v[6:7], v[80:81]
    v_pk_add_f32 v[8:9], v[8:9], v[82:83]
    v_pk_add_f32 v[6:7], v[6:7], v[84:85]
    v_pk_add_f32 v[8:9], v[8:9], v[86:87]
    v_pk_add_f32 v[6:7], v[6:7], v[88:89]
    v_pk_add_f32 v[8:9], v[8:9], v[90:91]
    v_pk_add_f32 v[6:7], v[6:7], v[92:93]
    v_pk_add_f32 v[8:9], v[8:9], v[94:95]
    v_pk_add_f32 v[6:7], v[6:7], v[96:97]
    v_pk_add_f32 v[8:9], v[8:9], v[98:99]
    v_pk_add_f32 v[6:7], v[6:7], v[100:101]
    v_pk_add_f32 v[8:9], v[8:9], v[102:103]
    v_pk_add_f32 v[6:7], v[6:7], v[8:9]
    v_add_f32 v4, v6, v7
    s_nop 1
    v_add_f32_dpp v4, v4, v4 quad_perm:[1,0,3,2] row_mask:0xf bank_mask:0xf
    s_nop 1
    v_add_f32_dpp v4, v4, v4 quad_perm:[2,3,0,1] row_mask:0xf bank_mask:0xf
    s_nop 1
    v_add_f32_dpp v4, v4, v4 row_half_mirror row_mask:0xf bank_mask:0xf
    v_mul_f32 v8, 0xbb124925, v4
    v_mov_b32 v9, v8
    v_pk_add_f32 v[48:49], v[48:49], v[8:9]
    v_pk_add_f32 v[50:51], v[50:51], v[8:9]
    v_pk_add_f32 v[52:53], v[52:53], v[8:9]
    v_pk_add_f32 v[54:55], v[54:55], v[8:9]
    v_pk_add_f32 v[56:57], v[56:57], v[8:9]
    v_pk_add_f32 v[58:59], v[58:59], v[8:9]
    v_pk_add_f32 v[60:61], v[60:61], v[8:9]
    v_pk_add_f32 v[62:63], v[62:63], v[8:9]
    v_pk_add_f32 v[64:65], v[64:65], v[8:9]
    v_pk_add_f32 v[66:67], v[66:67], v[8:9]
    v_pk_add_f32 v[68:69], v[68:69], v[8:9]
    v_pk_add_f32 v[70:71], v[70:71], v[8:9]
    v_pk_add_f32 v[72:73], v[72:73], v[8:9]
    v_pk_add_f32 v[74:75], v[74:75], v[8:9]
    v_pk_add_f32 v[76:77], v[76:77], v[8:9]
    v_pk_add_f32 v[78:79], v[78:79], v[8:9]
    v_pk_add_f32 v[80:81], v[80:81], v[8:9]
    v_pk_add_f32 v[82:83], v[82:83], v[8:9]
    v_pk_add_f32 v[84:85], v[84:85], v[8:9]
    v_pk_add_f32 v[86:87], v[86:87], v[8:9]
    v_pk_add_f32 v[88:89], v[88:89], v[8:9]
    v_pk_add_f32 v[90:91], v[90:91], v[8:9]
    v_pk_add_f32 v[92:93], v[92:93], v[8:9]
    v_pk_add_f32 v[94:95], v[94:95], v[8:9]
    v_pk_add_f32 v[96:97], v[96:97], v[8:9]
    v_pk_add_f32 v[98:99], v[98:99], v[8:9]
    v_pk_add_f32 v[100:101], v[100:101], v[8:9]
    v_pk_add_f32 v[102:103], v[102:103], v[8:9]
    v_pk_mul_f32 v[6:7], v[48:49], v[48:49]
    v_pk_mul_f32 v[8:9], v[50:51], v[50:51]
    v_pk_fma_f32 v[6:7], v[52:53], v[52:53], v[6:7]
    v_pk_fma_f32 v[8:9], v[54:55], v[54:55], v[8:9]
    v_pk_fma_f32 v[6:7], v[56:57], v[56:57], v[6:7]
    v_pk_fma_f32 v[8:9], v[58:59], v[58:59], v[8:9]
    v_pk_fma_f32 v[6:7], v[60:61], v[60:61], v[6:7]
    v_pk_fma_f32 v[8:9], v[62:63], v[62:63], v[8:9]
    v_pk_fma_f32 v[6:7], v[64:65], v[64:65], v[6:7]
    v_pk_fma_f32 v[8:9], v[66:67], v[66:67], v[8:9]
    v_pk_fma_f32 v[6:7], v[68:69], v[68:69], v[6:7]
    v_pk_fma_f32 v[8:9], v[70:71], v[70:71], v[8:9]
    v_pk_fma_f32 v[6:7], v[72:73], v[72:73], v[6:7]
    v_pk_fma_f32 v[8:9], v[74:75], v[74:75], v[8:9]
    v_pk_fma_f32 v[6:7], v[76:77], v[76:77], v[6:7]
    v_pk_fma_f32 v[8:9], v[78:79], v[78:79], v[8:9]
    v_pk_fma_f32 v[6:7], v[80:81], v[80:81], v[6:7]
    v_pk_fma_f32 v[8:9], v[82:83], v[82:83], v[8:9]
    v_pk_fma_f32 v[6:7], v[84:85], v[84:85], v[6:7]
    v_pk_fma_f32 v[8:9], v[86:87], v[86:87], v[8:9]
    v_pk_fma_f32 v[6:7], v[88:89], v[88:89], v[6:7]
    v_pk_fma_f32 v[8:9], v[90:91], v[90:91], v[8:9]
    v_pk_fma_f32 v[6:7], v[92:93], v[92:93], v[6:7]
    v_pk_fma_f32 v[8:9], v[94:95], v[94:95], v[8:9]
    v_pk_fma_f32 v[6:7], v[96:97], v[96:97], v[6:7]
    v_pk_fma_f32 v[8:9], v[98:99], v[98:99], v[8:9]
    v_pk_fma_f32 v[6:7], v[100:101], v[100:101], v[6:7]
    v_pk_fma_f32 v[8:9], v[102:103], v[102:103], v[8:9]
    v_pk_add_f32 v[6:7], v[6:7], v[8:9]
    v_add_f32 v4, v6, v7
    s_nop 1
    v_add_f32_dpp v4, v4, v4 quad_perm:[1,0,3,2] row_mask:0xf bank_mask:0xf
    s_nop 1
    v_add_f32_dpp v4, v4, v4 quad_perm:[2,3,0,1] row_mask:0xf bank_mask:0xf
    s_nop 1
    v_add_f32_dpp v4, v4, v4 row_half_mirror row_mask:0xf bank_mask:0xf
    v_mov_b32 v6, 0x3727c5ac
    v_fmac_f32 v6, 0x3b124925, v4
    v_rsq_f32 v6, v6
    s_nop 0
    v_mov_b32 v7, v6
    v_pk_mul_f32 v[48:49], v[48:49], v[6:7]
    v_cvt_pk_bf16_f32 v16, v48, v49
    v_pk_mul_f32 v[50:51], v[50:51], v[6:7]
    v_cvt_pk_bf16_f32 v17, v50, v51
    v_pk_mul_f32 v[52:53], v[52:53], v[6:7]
    v_cvt_pk_bf16_f32 v18, v52, v53
    v_pk_mul_f32 v[54:55], v[54:55], v[6:7]
    v_cvt_pk_bf16_f32 v19, v54, v55
    v_pk_mul_f32 v[56:57], v[56:57], v[6:7]
    v_cvt_pk_bf16_f32 v20, v56, v57
    v_pk_mul_f32 v[58:59], v[58:59], v[6:7]
    v_cvt_pk_bf16_f32 v21, v58, v59
    v_pk_mul_f32 v[60:61], v[60:61], v[6:7]
    v_cvt_pk_bf16_f32 v22, v60, v61
    v_pk_mul_f32 v[62:63], v[62:63], v[6:7]
    v_cvt_pk_bf16_f32 v23, v62, v63
    v_pk_mul_f32 v[64:65], v[64:65], v[6:7]
    v_cvt_pk_bf16_f32 v24, v64, v65
    v_pk_mul_f32 v[66:67], v[66:67], v[6:7]
    v_cvt_pk_bf16_f32 v25, v66, v67
    v_pk_mul_f32 v[68:69], v[68:69], v[6:7]
    v_cvt_pk_bf16_f32 v26, v68, v69
    v_pk_mul_f32 v[70:71], v[70:71], v[6:7]
    v_cvt_pk_bf16_f32 v27, v70, v71
    v_pk_mul_f32 v[72:73], v[72:73], v[6:7]
    v_cvt_pk_bf16_f32 v28, v72, v73
    v_pk_mul_f32 v[74:75], v[74:75], v[6:7]
    v_cvt_pk_bf16_f32 v29, v74, v75
    v_pk_mul_f32 v[76:77], v[76:77], v[6:7]
    v_cvt_pk_bf16_f32 v30, v76, v77
    v_pk_mul_f32 v[78:79], v[78:79], v[6:7]
    v_cvt_pk_bf16_f32 v31, v78, v79
    v_pk_mul_f32 v[80:81], v[80:81], v[6:7]
    v_cvt_pk_bf16_f32 v32, v80, v81
    v_pk_mul_f32 v[82:83], v[82:83], v[6:7]
    v_cvt_pk_bf16_f32 v33, v82, v83
    v_pk_mul_f32 v[84:85], v[84:85], v[6:7]
    v_cvt_pk_bf16_f32 v34, v84, v85
    v_pk_mul_f32 v[86:87], v[86:87], v[6:7]
    v_cvt_pk_bf16_f32 v35, v86, v87
    v_pk_mul_f32 v[88:89], v[88:89], v[6:7]
    v_cvt_pk_bf16_f32 v36, v88, v89
    v_pk_mul_f32 v[90:91], v[90:91], v[6:7]
    v_cvt_pk_bf16_f32 v37, v90, v91
    v_pk_mul_f32 v[92:93], v[92:93], v[6:7]
    v_cvt_pk_bf16_f32 v38, v92, v93
    v_pk_mul_f32 v[94:95], v[94:95], v[6:7]
    v_cvt_pk_bf16_f32 v39, v94, v95
    v_pk_mul_f32 v[96:97], v[96:97], v[6:7]
    v_cvt_pk_bf16_f32 v40, v96, v97
    v_pk_mul_f32 v[98:99], v[98:99], v[6:7]
    v_cvt_pk_bf16_f32 v41, v98, v99
    v_pk_mul_f32 v[100:101], v[100:101], v[6:7]
    v_cvt_pk_bf16_f32 v42, v100, v101
    v_pk_mul_f32 v[102:103], v[102:103], v[6:7]
    v_cvt_pk_bf16_f32 v43, v102, v103
    s_mul_i32 s42, s41, 29696
    s_add_u32 s42, s42, 19267584
    buffer_store_dwordx4 v[16:19], v3, s[4:7], s42 offen offset:0 sc1
    buffer_store_dwordx4 v[20:23], v3, s[4:7], s42 offen offset:128 sc1
    buffer_store_dwordx4 v[24:27], v3, s[4:7], s42 offen offset:256 sc1
    buffer_store_dwordx4 v[28:31], v3, s[4:7], s42 offen offset:384 sc1
    buffer_store_dwordx4 v[32:35], v3, s[4:7], s42 offen offset:512 sc1
    buffer_store_dwordx4 v[36:39], v3, s[4:7], s42 offen offset:640 sc1
    buffer_store_dwordx4 v[40:43], v3, s[4:7], s42 offen offset:768 sc1
    s_nop 1
M_end_120:
    v_and_b32 v1, 63, v0
    v_lshlrev_b32 v1, 4, v1
    s_waitcnt vmcnt(0)
    s_barrier
    s_cmp_lg_u32 s15, 0
    s_cbranch_scc1 L_ic_122
    v_mov_b32 v46, 32
    v_mov_b32 v47, 1
    s_mov_b64 exec, 1
    global_atomic_add v46, v47, s[36:37] sc1
    s_mov_b64 exec, -1
L_ic_122:
    s_mov_b32 s32, 400000
    v_mbcnt_lo_u32_b32 v45, -1, 0
    v_lshrrev_b32 v44, 3, v45
    v_add_u32 v44, s60, v44
    v_lshlrev_b32 v44, 7, v44
    v_and_b32 v45, 7, v45
    v_lshl_add_u32 v45, v45, 2, v44
    s_mov_b32 s61, 1
    s_mov_b32 s26, 126894176
    s_mov_b32 exec_lo, 0x7f
    s_mov_b32 exec_hi, 0
L_iw_126:
    buffer_load_dword v44, v45, s[4:7], s26 offen sc1
    s_waitcnt vmcnt(0)
    v_cmp_eq_u32 vcc, 0, v44
    s_nop 3
    s_cbranch_vccz L_iwok_123
    s_mov_b32 s61, 0
    s_mov_b32 s26, 126894080
    s_mov_b32 exec_lo, 0x7f
    s_mov_b32 exec_hi, 0
L_iw_127:
    buffer_load_dword v44, v45, s[4:7], s26 offen sc1
    s_waitcnt vmcnt(0)
    v_cmp_eq_u32 vcc, 0, v44
    s_nop 3
    s_cbranch_vccz L_iwok_123
    s_sleep 1
    s_sub_u32 s32, s32, 1
    s_cmp_lg_u32 s32, 0
    s_cbranch_scc1 L_iw_127
    s_branch L_fail
L_iwok_123:
    s_mov_b64 exec, -1
L_iwsk_124:
    s_add_u32 s21, s20, 0
    buffer_load_dwordx4 v[120:123], v1, s[4:7], s21 offen offset:0 sc1
    buffer_load_dwordx4 v[124:127], v1, s[4:7], s21 offen offset:1024 sc1
    buffer_load_dwordx4 v[128:131], v1, s[4:7], s21 offen offset:2048 sc1
    buffer_load_dwordx4 v[132:135], v1, s[4:7], s21 offen offset:3072 sc1
    s_add_u32 s21, s20, 14336
    buffer_load_dwordx4 v[176:179], v1, s[4:7], s21 offen offset:0 sc1
    buffer_load_dwordx4 v[180:183], v1, s[4:7], s21 offen offset:1024 sc1
    buffer_load_dwordx4 v[184:187], v1, s[4:7], s21 offen offset:2048 sc1
    buffer_load_dwordx4 v[188:191], v1, s[4:7], s21 offen offset:3072 sc1
    s_add_u32 s21, s20, 28672
    buffer_load_dwordx4 v[232:235], v1, s[4:7], s21 offen offset:0 sc1
    buffer_load_dwordx4 v[236:239], v1, s[4:7], s21 offen offset:1024 sc1
    buffer_load_dwordx4 v[240:243], v1, s[4:7], s21 offen offset:2048 sc1
    buffer_load_dwordx4 v[244:247], v1, s[4:7], s21 offen offset:3072 sc1
    s_add_u32 s21, s20, 43008
    buffer_load_dwordx4 a[32:35], v1, s[4:7], s21 offen offset:0 sc1
    buffer_load_dwordx4 a[36:39], v1, s[4:7], s21 offen offset:1024 sc1
    buffer_load_dwordx4 a[40:43], v1, s[4:7], s21 offen offset:2048 sc1
    buffer_load_dwordx4 a[44:47], v1, s[4:7], s21 offen offset:3072 sc1
    s_add_u32 s21, s20, 57344
    buffer_load_dwordx4 a[88:91], v1, s[4:7], s21 offen offset:0 sc1
    buffer_load_dwordx4 a[92:95], v1, s[4:7], s21 offen offset:1024 sc1
    buffer_load_dwordx4 a[96:99], v1, s[4:7], s21 offen offset:2048 sc1
    buffer_load_dwordx4 a[100:103], v1, s[4:7], s21 offen offset:3072 sc1
    s_add_u32 s21, s20, 71680
    buffer_load_dwordx4 a[144:147], v1, s[4:7], s21 offen offset:0 sc1
    buffer_load_dwordx4 a[148:151], v1, s[4:7], s21 offen offset:1024 sc1
    buffer_load_dwordx4 a[152:155], v1, s[4:7], s21 offen offset:2048 sc1
    buffer_load_dwordx4 a[156:159], v1, s[4:7], s21 offen offset:3072 sc1
    s_add_u32 s21, s20, 86016
    buffer_load_dwordx4 a[200:203], v1, s[4:7], s21 offen offset:0 sc1
    buffer_load_dwordx4 a[204:207], v1, s[4:7], s21 offen offset:1024 sc1
    buffer_load_dwordx4 a[208:211], v1, s[4:7], s21 offen offset:2048 sc1
    buffer_load_dwordx4 a[212:215], v1, s[4:7], s21 offen offset:3072 sc1
    s_cmp_eq_u32 s61, 1
    s_cbranch_scc1 L_iwsk_129
    s_mov_b32 s32, 400000
    s_mov_b32 s26, 126894112
    s_mov_b32 exec_lo, 0x7f
    s_mov_b32 exec_hi, 0
L_iw_130:
    buffer_load_dword v44, v45, s[4:7], s26 offen sc1
    s_waitcnt vmcnt(0)
    v_cmp_eq_u32 vcc, 0, v44
    s_nop 3
    s_cbranch_vccz L_iwok_128
    s_sleep 1
    s_sub_u32 s32, s32, 1
    s_cmp_lg_u32 s32, 0
    s_cbranch_scc1 L_iw_130
    s_branch L_fail
L_iwok_128:
    s_mov_b64 exec, -1
L_iwsk_129:
    s_add_u32 s21, s20, 4096
    buffer_load_dwordx4 v[136:139], v1, s[4:7], s21 offen offset:0 sc1
    buffer_load_dwordx4 v[140:143], v1, s[4:7], s21 offen offset:1024 sc1
    buffer_load_dwordx4 v[144:147], v1, s[4:7], s21 offen offset:2048 sc1
    buffer_load_dwordx4 v[148:151], v1, s[4:7], s21 offen offset:3072 sc1
    s_add_u32 s21, s20, 18432
    buffer_load_dwordx4 v[192:195], v1, s[4:7], s21 offen offset:0 sc1
    buffer_load_dwordx4 v[196:199], v1, s[4:7], s21 offen offset:1024 sc1
    buffer_load_dwordx4 v[200:203], v1, s[4:7], s21 offen offset:2048 sc1
    buffer_load_dwordx4 v[204:207], v1, s[4:7], s21 offen offset:3072 sc1
    s_add_u32 s21, s20, 32768
    buffer_load_dwordx4 v[248:251], v1, s[4:7], s21 offen offset:0 sc1
    buffer_load_dwordx4 v[252:255], v1, s[4:7], s21 offen offset:1024 sc1
    buffer_load_dwordx4 a[0:3], v1, s[4:7], s21 offen offset:2048 sc1
    buffer_load_dwordx4 a[4:7], v1, s[4:7], s21 offen offset:3072 sc1
    s_add_u32 s21, s20, 47104
    buffer_load_dwordx4 a[48:51], v1, s[4:7], s21 offen offset:0 sc1
    buffer_load_dwordx4 a[52:55], v1, s[4:7], s21 offen offset:1024 sc1
    buffer_load_dwordx4 a[56:59], v1, s[4:7], s21 offen offset:2048 sc1
    buffer_load_dwordx4 a[60:63], v1, s[4:7], s21 offen offset:3072 sc1
    s_add_u32 s21, s20, 61440
    buffer_load_dwordx4 a[104:107], v1, s[4:7], s21 offen offset:0 sc1
    buffer_load_dwordx4 a[108:111], v1, s[4:7], s21 offen offset:1024 sc1
    buffer_load_dwordx4 a[112:115], v1, s[4:7], s21 offen offset:2048 sc1
    buffer_load_dwordx4 a[116:119], v1, s[4:7], s21 offen offset:3072 sc1
    s_add_u32 s21, s20, 75776
    buffer_load_dwordx4 a[160:163], v1, s[4:7], s21 offen offset:0 sc1
    buffer_load_dwordx4 a[164:167], v1, s[4:7], s21 offen offset:1024 sc1
    buffer_load_dwordx4 a[168:171], v1, s[4:7], s21 offen offset:2048 sc1
    buffer_load_dwordx4 a[172:175], v1, s[4:7], s21 offen offset:3072 sc1
    s_add_u32 s21, s20, 90112
    buffer_load_dwordx4 a[216:219], v1, s[4:7], s21 offen offset:0 sc1
    buffer_load_dwordx4 a[220:223], v1, s[4:7], s21 offen offset:1024 sc1
    buffer_load_dwordx4 a[224:227], v1, s[4:7], s21 offen offset:2048 sc1
    buffer_load_dwordx4 a[228:231], v1, s[4:7], s21 offen offset:3072 sc1
    s_cmp_eq_u32 s61, 1
    s_cbranch_scc1 L_iwsk_132
    s_mov_b32 s32, 400000
    s_mov_b32 s26, 126894144
    s_mov_b32 exec_lo, 0x7f
    s_mov_b32 exec_hi, 0
L_iw_133:
    buffer_load_dword v44, v45, s[4:7], s26 offen sc1
    s_waitcnt vmcnt(0)
    v_cmp_eq_u32 vcc, 0, v44
    s_nop 3
    s_cbranch_vccz L_iwok_131
    s_sleep 1
    s_sub_u32 s32, s32, 1
    s_cmp_lg_u32 s32, 0
    s_cbranch_scc1 L_iw_133
    s_branch L_fail
L_iwok_131:
    s_mov_b64 exec, -1
L_iwsk_132:
    s_waitcnt vmcnt(28)
    s_add_u32 s21, s20, 8192
    buffer_load_dwordx4 v[152:155], v1, s[4:7], s21 offen offset:0 sc1
    buffer_load_dwordx4 v[156:159], v1, s[4:7], s21 offen offset:1024 sc1
    buffer_load_dwordx4 v[160:163], v1, s[4:7], s21 offen offset:2048 sc1
    buffer_load_dwordx4 v[164:167], v1, s[4:7], s21 offen offset:3072 sc1
    s_add_u32 s21, s20, 22528
    buffer_load_dwordx4 v[208:211], v1, s[4:7], s21 offen offset:0 sc1
    buffer_load_dwordx4 v[212:215], v1, s[4:7], s21 offen offset:1024 sc1
    buffer_load_dwordx4 v[216:219], v1, s[4:7], s21 offen offset:2048 sc1
    buffer_load_dwordx4 v[220:223], v1, s[4:7], s21 offen offset:3072 sc1
    s_add_u32 s21, s20, 36864
    buffer_load_dwordx4 a[8:11], v1, s[4:7], s21 offen offset:0 sc1
    buffer_load_dwordx4 a[12:15], v1, s[4:7], s21 offen offset:1024 sc1
    buffer_load_dwordx4 a[16:19], v1, s[4:7], s21 offen offset:2048 sc1
    buffer_load_dwordx4 a[20:23], v1, s[4:7], s21 offen offset:3072 sc1
    s_add_u32 s21, s20, 51200
    buffer_load_dwordx4 a[64:67], v1, s[4:7], s21 offen offset:0 sc1
    buffer_load_dwordx4 a[68:71], v1, s[4:7], s21 offen offset:1024 sc1
    buffer_load_dwordx4 a[72:75], v1, s[4:7], s21 offen offset:2048 sc1
    buffer_load_dwordx4 a[76:79], v1, s[4:7], s21 offen offset:3072 sc1
    s_add_u32 s21, s20, 65536
    buffer_load_dwordx4 a[120:123], v1, s[4:7], s21 offen offset:0 sc1
    buffer_load_dwordx4 a[124:127], v1, s[4:7], s21 offen offset:1024 sc1
    buffer_load_dwordx4 a[128:131], v1, s[4:7], s21 offen offset:2048 sc1
    buffer_load_dwordx4 a[132:135], v1, s[4:7], s21 offen offset:3072 sc1
    s_add_u32 s21, s20, 79872
    buffer_load_dwordx4 a[176:179], v1, s[4:7], s21 offen offset:0 sc1
    buffer_load_dwordx4 a[180:183], v1, s[4:7], s21 offen offset:1024 sc1
    buffer_load_dwordx4 a[184:187], v1, s[4:7], s21 offen offset:2048 sc1
    buffer_load_dwordx4 a[188:191], v1, s[4:7], s21 offen offset:3072 sc1
    s_add_u32 s21, s20, 94208
    buffer_load_dwordx4 a[232:235], v1, s[4:7], s21 offen offset:0 sc1
    buffer_load_dwordx4 a[236:239], v1, s[4:7], s21 offen offset:1024 sc1
    buffer_load_dwordx4 a[240:243], v1, s[4:7], s21 offen offset:2048 sc1
    buffer_load_dwordx4 a[244:247], v1, s[4:7], s21 offen offset:3072 sc1
    s_cmp_eq_u32 s61, 1
    s_cbranch_scc1 L_iwsk_135
    s_mov_b32 s32, 400000
    s_mov_b32 s26, 126894176
    s_mov_b32 exec_lo, 0x7f
    s_mov_b32 exec_hi, 0
L_iw_136:
    buffer_load_dword v44, v45, s[4:7], s26 offen sc1
    s_waitcnt vmcnt(0)
    v_cmp_eq_u32 vcc, 0, v44
    s_nop 3
    s_cbranch_vccz L_iwok_134
    s_sleep 1
    s_sub_u32 s32, s32, 1
    s_cmp_lg_u32 s32, 0
    s_cbranch_scc1 L_iw_136
    s_branch L_fail
L_iwok_134:
    s_mov_b64 exec, -1
L_iwsk_135:
    s_waitcnt vmcnt(28)
    v_mov_b32 v47, 32
    global_load_dword v46, v47, s[36:37] sc1
    s_add_u32 s21, s20, 12288
    buffer_load_dwordx4 v[168:171], v1, s[4:7], s21 offen offset:0 sc1
    buffer_load_dwordx4 v[172:175], v1, s[4:7], s21 offen offset:1024 sc1
    s_add_u32 s21, s20, 26624
    buffer_load_dwordx4 v[224:227], v1, s[4:7], s21 offen offset:0 sc1
    buffer_load_dwordx4 v[228:231], v1, s[4:7], s21 offen offset:1024 sc1
    s_add_u32 s21, s20, 40960
    buffer_load_dwordx4 a[24:27], v1, s[4:7], s21 offen offset:0 sc1
    buffer_load_dwordx4 a[28:31], v1, s[4:7], s21 offen offset:1024 sc1
    s_add_u32 s21, s20, 55296
    buffer_load_dwordx4 a[80:83], v1, s[4:7], s21 offen offset:0 sc1
    buffer_load_dwordx4 a[84:87], v1, s[4:7], s21 offen offset:1024 sc1
    s_add_u32 s21, s20, 69632
    buffer_load_dwordx4 a[136:139], v1, s[4:7], s21 offen offset:0 sc1
    buffer_load_dwordx4 a[140:143], v1, s[4:7], s21 offen offset:1024 sc1
    s_add_u32 s21, s20, 83968
    buffer_load_dwordx4 a[192:195], v1, s[4:7], s21 offen offset:0 sc1
    buffer_load_dwordx4 a[196:199], v1, s[4:7], s21 offen offset:1024 sc1
    s_add_u32 s21, s20, 98304
    buffer_load_dwordx4 a[248:251], v1, s[4:7], s21 offen offset:0 sc1
    buffer_load_dwordx4 a[252:255], v1, s[4:7], s21 offen offset:1024 sc1
    s_waitcnt vmcnt(0)
    s_mov_b32 s16, 2
    v_readfirstlane_b32 s59, v46
    s_cmp_ge_u32 s59, 256
    s_nop 2
    s_cbranch_scc1 L_iok_137
    s_mov_b32 s32, 400000
    v_mbcnt_lo_u32_b32 v45, -1, 0
    v_add_u32 v45, 8, v45
    v_lshlrev_b32 v45, 2, v45
    s_mov_b64 exec, 1
    s_nop 0
L_dw_138:
    global_load_dword v44, v45, s[36:37] sc1
    s_waitcnt vmcnt(0)
    v_cmp_gt_u32 vcc, 256, v44
    s_nop 3
    s_cbranch_vccz L_dwok_139
    s_sleep 1
    s_sub_u32 s32, s32, 1
    s_cmp_lg_u32 s32, 0
    s_cbranch_scc1 L_dw_138
    s_branch L_fail
L_dwok_139:
    s_mov_b64 exec, -1
L_iok_137:
    v_and_b32 v16, 63, v0
    v_and_b32 v17, 15, v16
    v_lshrrev_b32 v18, 4, v16
    v_mul_u32_u24 v2, 928, v17
    v_lshl_add_u32 v2, v18, 4, v2
    v_add_u32 v2, 0, v2
    v_add_u32 v3, 14848, v2
    v_and_b32 v16, 7, v0
    v_lshrrev_b32 v17, 3, v0
    v_add_u32 v18, 32, v17
    v_cmp_gt_u32 vcc, 192, v0
    s_nop 1
    v_cndmask_b32 v18, v17, v18, vcc
    v_lshlrev_b32 v6, 4, v16
    v_lshl_add_u32 v6, v17, 7, v6
    v_lshrrev_b32 v19, 3, v17
    v_lshlrev_b32 v8, 10, v19
    v_bfe_u32 v19, v17, 1, 2
    v_lshl_add_u32 v8, v19, 8, v8
    v_lshl_add_u32 v8, v16, 4, v8
    v_and_b32 v19, 1, v17
    v_lshl_add_u32 v8, v19, 3, v8
    v_add_u32 v8, 74240, v8
    v_mul_u32_u24 v10, 928, v16
    v_lshl_add_u32 v10, v17, 4, v10
    v_add_u32 v10, 59392, v10
    v_lshlrev_b32 v7, 4, v16
    v_lshl_add_u32 v7, v18, 7, v7
    v_lshrrev_b32 v19, 3, v18
    v_lshlrev_b32 v9, 10, v19
    v_bfe_u32 v19, v18, 1, 2
    v_lshl_add_u32 v9, v19, 8, v9
    v_lshl_add_u32 v9, v16, 4, v9
    v_and_b32 v19, 1, v18
    v_lshl_add_u32 v9, v19, 3, v9
    v_add_u32 v9, 74240, v9
    v_mul_u32_u24 v11, 928, v16
    v_lshl_add_u32 v11, v18, 4, v11
    v_add_u32 v11, 59392, v11
    v_and_b32 v16, 63, v0
    v_lshlrev_b32 v4, 4, v16
    v_mov_b32 v5, 0
    v_and_b32 v17, 15, v16
    v_lshrrev_b32 v18, 4, v16
    s_mul_i32 s18, s15, 224
    v_mul_u32_u24 v12, 928, v17
    v_add_u32 v12, s18, v12
    v_lshl_add_u32 v13, v18, 3, v12
    v_add_u32 v13, 192, v13
    v_lshl_add_u32 v12, v18, 4, v12
    s_mul_i32 s18, s15, 5120
    s_add_u32 s18, s18, 81408
    v_add_u32 v14, s18, v4
    s_lshl_b32 s18, s15, 4
    v_add_u32 v19, s18, v17
    v_lshlrev_b32 v15, 4, v19
    v_and_b32 v19, 1, v18
    v_lshl_add_u32 v15, v19, 3, v15
    v_lshrrev_b32 v19, 1, v18
    v_lshl_add_u32 v15, v19, 9, v15
    v_add_u32 v15, 101888, v15
    v_lshlrev_b32 v19, 2, v18
    v_add_u32 v20, 0, v19
    v_cmp_le_u32 s[48:49], v20, v17
    v_add_u32 v20, 1, v19
    v_cmp_le_u32 s[50:51], v20, v17
    v_add_u32 v20, 2, v19
    v_cmp_le_u32 s[52:53], v20, v17
    v_add_u32 v20, 3, v19
    v_cmp_le_u32 s[54:55], v20, v17
    v_cmp_gt_u32 s[56:57], 32, v16
    s_mov_b32 s45, 0x3db8aa3b
    v_mov_b32 v20, 0
    v_mov_b32 v21, 0
    v_mov_b32 v22, 0
    v_mov_b32 v23, 0
    v_lshlrev_b32 v19, 4, v0
    v_add_u32 v19, 66816, v19
    ds_write_b128 v19, v[20:23]
    v_cmp_gt_u32 vcc, 208, v0
    s_and_saveexec_b64 s[18:19], vcc
    ds_write_b128 v19, v[20:23] offset:4096
    s_mov_b64 exec, s[18:19]
    s_mov_b32 s16, s38
    s_nop 0
L_TP_loop:
    s_cmp_eq_u32 s13, 0
    s_cbranch_scc1 L_noxf_140
    s_cmp_eq_u32 s13, 0
    s_mov_b32 s40, 0x78fe000
    s_cselect_b32 s40, 0x78ee000, s40
    s_lshl_b32 s18, s16, 7
    s_add_u32 s40, s40, s18
    s_mov_b32 s32, 400000
    v_mbcnt_lo_u32_b32 v17, -1, 0
    v_lshlrev_b32 v17, 2, v17
    s_mov_b32 exec_lo, 0x3
    s_mov_b32 exec_hi, 0
L_wf_141:
    buffer_load_dword v16, v17, s[4:7], s40 offen sc1
    s_waitcnt vmcnt(0)
    v_cmp_eq_u32 vcc, 0, v16
    s_nop 3
    s_cbranch_vccz L_wfok_142
    s_sleep 1
    s_sub_u32 s32, s32, 1
    s_cmp_lg_u32 s32, 0
    s_cbranch_scc1 L_wf_141
    s_branch L_fail
L_wfok_142:
    s_mov_b64 exec, -1
L_noxf_140:
    s_cmp_eq_u32 s13, 0
    s_mov_b32 s43, 0x1431000
    s_cselect_b32 s43, 0x1260000, s43
    s_mul_i32 s18, s16, 29696
    s_add_u32 s43, s43, s18
    s_lshl_b32 s18, s15, 13
    s_min_u32 s18, s18, 21504
    s_add_u32 s41, s43, s18
    s_add_u32 s42, s18, 0
    s_mov_b32 m0, s42
    s_nop 0
    buffer_load_dwordx4 v4, s[4:7], s41 offen offset:0 sc1 lds
    buffer_load_dwordx4 v4, s[4:7], s41 offen offset:1024 sc1 lds
    buffer_load_dwordx4 v4, s[4:7], s41 offen offset:2048 sc1 lds
    buffer_load_dwordx4 v4, s[4:7], s41 offen offset:3072 sc1 lds
    s_add_u32 s42, s42, 4096
    s_add_u32 s41, s41, 4096
    s_mov_b32 m0, s42
    s_nop 0
    buffer_load_dwordx4 v4, s[4:7], s41 offen offset:0 sc1 lds
    buffer_load_dwordx4 v4, s[4:7], s41 offen offset:1024 sc1 lds
    buffer_load_dwordx4 v4, s[4:7], s41 offen offset:2048 sc1 lds
    buffer_load_dwordx4 v4, s[4:7], s41 offen offset:3072 sc1 lds
    s_waitcnt vmcnt(0)
    s_barrier
    ds_read_b128 v[48:51], v2 offset:0
    ds_read_b128 v[52:55], v3 offset:0
    ds_read_b128 v[56:59], v2 offset:64
    ds_read_b128 v[60:63], v3 offset:64
    s_waitcnt lgkmcnt(2)
    v_mfma_f32_16x16x32_bf16 v[64:67], v[120:123], v[48:51], 0
    v_mfma_f32_16x16x32_bf16 v[68:71], v[120:123], v[52:55], 0
    v_mfma_f32_16x16x32_bf16 v[72:75], v[176:179], v[48:51], 0
    v_mfma_f32_16x16x32_bf16 v[76:79], v[176:179], v[52:55], 0
    v_mfma_f32_16x16x32_bf16 v[80:83], v[232:235], v[48:51], 0
    v_mfma_f32_16x16x32_bf16 v[84:87], v[232:235], v[52:55], 0
    v_mfma_f32_16x16x32_bf16 v[88:91], a[32:35], v[48:51], 0
    v_mfma_f32_16x16x32_bf16 v[92:95], a[32:35], v[52:55], 0
    v_mfma_f32_16x16x32_bf16 v[96:99], a[88:91], v[48:51], 0
    v_mfma_f32_16x16x32_bf16 v[100:103], a[88:91], v[52:55], 0
    v_mfma_f32_16x16x32_bf16 v[104:107], a[144:147], v[48:51], 0
    v_mfma_f32_16x16x32_bf16 v[108:111], a[144:147], v[52:55], 0
    v_mfma_f32_16x16x32_bf16 v[112:115], a[200:203], v[48:51], 0
    v_mfma_f32_16x16x32_bf16 v[116:119], a[200:203], v[52:55], 0
    ds_read_b128 v[48:51], v2 offset:128
    ds_read_b128 v[52:55], v3 offset:128
    s_waitcnt lgkmcnt(2)
    v_mfma_f32_16x16x32_bf16 v[64:67], v[124:127], v[56:59], v[64:67]
    v_mfma_f32_16x16x32_bf16 v[68:71], v[124:127], v[60:63], v[68:71]
    v_mfma_f32_16x16x32_bf16 v[72:75], v[180:183], v[56:59], v[72:75]
    v_mfma_f32_16x16x32_bf16 v[76:79], v[180:183], v[60:63], v[76:79]
    v_mfma_f32_16x16x32_bf16 v[80:83], v[236:239], v[56:59], v[80:83]
    v_mfma_f32_16x16x32_bf16 v[84:87], v[236:239], v[60:63], v[84:87]
    v_mfma_f32_16x16x32_bf16 v[88:91], a[36:39], v[56:59], v[88:91]
    v_mfma_f32_16x16x32_bf16 v[92:95], a[36:39], v[60:63], v[92:95]
    v_mfma_f32_16x16x32_bf16 v[96:99], a[92:95], v[56:59], v[96:99]
    v_mfma_f32_16x16x32_bf16 v[100:103], a[92:95], v[60:63], v[100:103]
    v_mfma_f32_16x16x32_bf16 v[104:107], a[148:151], v[56:59], v[104:107]
    v_mfma_f32_16x16x32_bf16 v[108:111], a[148:151], v[60:63], v[108:111]
    v_mfma_f32_16x16x32_bf16 v[112:115], a[204:207], v[56:59], v[112:115]
    v_mfma_f32_16x16x32_bf16 v[116:119], a[204:207], v[60:63], v[116:119]
    ds_read_b128 v[56:59], v2 offset:192
    ds_read_b128 v[60:63], v3 offset:192
    s_waitcnt lgkmcnt(2)
    v_mfma_f32_16x16x32_bf16 v[64:67], v[128:131], v[48:51], v[64:67]
    v_mfma_f32_16x16x32_bf16 v[68:71], v[128:131], v[52:55], v[68:71]
    v_mfma_f32_16x16x32_bf16 v[72:75], v[184:187], v[48:51], v[72:75]
    v_mfma_f32_16x16x32_bf16 v[76:79], v[184:187], v[52:55], v[76:79]
    v_mfma_f32_16x16x32_bf16 v[80:83], v[240:243], v[48:51], v[80:83]
    v_mfma_f32_16x16x32_bf16 v[84:87], v[240:243], v[52:55], v[84:87]
    v_mfma_f32_16x16x32_bf16 v[88:91], a[40:43], v[48:51], v[88:91]
    v_mfma_f32_16x16x32_bf16 v[92:95], a[40:43], v[52:55], v[92:95]
    v_mfma_f32_16x16x32_bf16 v[96:99], a[96:99], v[48:51], v[96:99]
    v_mfma_f32_16x16x32_bf16 v[100:103], a[96:99], v[52:55], v[100:103]
    v_mfma_f32_16x16x32_bf16 v[104:107], a[152:155], v[48:51], v[104:107]
    v_mfma_f32_16x16x32_bf16 v[108:111], a[152:155], v[52:55], v[108:111]
    v_mfma_f32_16x16x32_bf16 v[112:115], a[208:211], v[48:51], v[112:115]
    v_mfma_f32_16x16x32_bf16 v[116:119], a[208:211], v[52:55], v[116:119]
    ds_read_b128 v[48:51], v2 offset:256
    ds_read_b128 v[52:55], v3 offset:256
    s_waitcnt lgkmcnt(2)
    v_mfma_f32_16x16x32_bf16 v[64:67], v[132:135], v[56:59], v[64:67]
    v_mfma_f32_16x16x32_bf16 v[68:71], v[132:135], v[60:63], v[68:71]
    v_mfma_f32_16x16x32_bf16 v[72:75], v[188:191], v[56:59], v[72:75]
    v_mfma_f32_16x16x32_bf16 v[76:79], v[188:191], v[60:63], v[76:79]
    v_mfma_f32_16x16x32_bf16 v[80:83], v[244:247], v[56:59], v[80:83]
    v_mfma_f32_16x16x32_bf16 v[84:87], v[244:247], v[60:63], v[84:87]
    v_mfma_f32_16x16x32_bf16 v[88:91], a[44:47], v[56:59], v[88:91]
    v_mfma_f32_16x16x32_bf16 v[92:95], a[44:47], v[60:63], v[92:95]
    v_mfma_f32_16x16x32_bf16 v[96:99], a[100:103], v[56:59], v[96:99]
    v_mfma_f32_16x16x32_bf16 v[100:103], a[100:103], v[60:63], v[100:103]
    v_mfma_f32_16x16x32_bf16 v[104:107], a[156:159], v[56:59], v[104:107]
    v_mfma_f32_16x16x32_bf16 v[108:111], a[156:159], v[60:63], v[108:111]
    v_mfma_f32_16x16x32_bf16 v[112:115], a[212:215], v[56:59], v[112:115]
    v_mfma_f32_16x16x32_bf16 v[116:119], a[212:215], v[60:63], v[116:119]
    ds_read_b128 v[56:59], v2 offset:320
    ds_read_b128 v[60:63], v3 offset:320
    s_waitcnt lgkmcnt(2)
    v_mfma_f32_16x16x32_bf16 v[64:67], v[136:139], v[48:51], v[64:67]
    v_mfma_f32_16x16x32_bf16 v[68:71], v[136:139], v[52:55], v[68:71]
    v_mfma_f32_16x16x32_bf16 v[72:75], v[192:195], v[48:51], v[72:75]
    v_mfma_f32_16x16x32_bf16 v[76:79], v[192:195], v[52:55], v[76:79]
    v_mfma_f32_16x16x32_bf16 v[80:83], v[248:251], v[48:51], v[80:83]
    v_mfma_f32_16x16x32_bf16 v[84:87], v[248:251], v[52:55], v[84:87]
    v_mfma_f32_16x16x32_bf16 v[88:91], a[48:51], v[48:51], v[88:91]
    v_mfma_f32_16x16x32_bf16 v[92:95], a[48:51], v[52:55], v[92:95]
    v_mfma_f32_16x16x32_bf16 v[96:99], a[104:107], v[48:51], v[96:99]
    v_mfma_f32_16x16x32_bf16 v[100:103], a[104:107], v[52:55], v[100:103]
    v_mfma_f32_16x16x32_bf16 v[104:107], a[160:163], v[48:51], v[104:107]
    v_mfma_f32_16x16x32_bf16 v[108:111], a[160:163], v[52:55], v[108:111]
    v_mfma_f32_16x16x32_bf16 v[112:115], a[216:219], v[48:51], v[112:115]
    v_mfma_f32_16x16x32_bf16 v[116:119], a[216:219], v[52:55], v[116:119]
    ds_read_b128 v[48:51], v2 offset:384
    ds_read_b128 v[52:55], v3 offset:384
    s_waitcnt lgkmcnt(2)
    v_mfma_f32_16x16x32_bf16 v[64:67], v[140:143], v[56:59], v[64:67]
    v_mfma_f32_16x16x32_bf16 v[68:71], v[140:143], v[60:63], v[68:71]
    v_mfma_f32_16x16x32_bf16 v[72:75], v[196:199], v[56:59], v[72:75]
    v_mfma_f32_16x16x32_bf16 v[76:79], v[196:199], v[60:63], v[76:79]
    v_mfma_f32_16x16x32_bf16 v[80:83], v[252:255], v[56:59], v[80:83]
    v_mfma_f32_16x16x32_bf16 v[84:87], v[252:255], v[60:63], v[84:87]
    v_mfma_f32_16x16x32_bf16 v[88:91], a[52:55], v[56:59], v[88:91]
    v_mfma_f32_16x16x32_bf16 v[92:95], a[52:55], v[60:63], v[92:95]
    v_mfma_f32_16x16x32_bf16 v[96:99], a[108:111], v[56:59], v[96:99]
    v_mfma_f32_16x16x32_bf16 v[100:103], a[108:111], v[60:63], v[100:103]
    v_mfma_f32_16x16x32_bf16 v[104:107], a[164:167], v[56:59], v[104:107]
    v_mfma_f32_16x16x32_bf16 v[108:111], a[164:167], v[60:63], v[108:111]
    v_mfma_f32_16x16x32_bf16 v[112:115], a[220:223], v[56:59], v[112:115]
    v_mfma_f32_16x16x32_bf16 v[116:119], a[220:223], v[60:63], v[116:119]
    ds_read_b128 v[56:59], v2 offset:448
    ds_read_b128 v[60:63], v3 offset:448
    s_waitcnt lgkmcnt(2)
    v_mfma_f32_16x16x32_bf16 v[64:67], v[144:147], v[48:51], v[64:67]
    v_mfma_f32_16x16x32_bf16 v[68:71], v[144:147], v[52:55], v[68:71]
    v_mfma_f32_16x16x32_bf16 v[72:75], v[200:203], v[48:51], v[72:75]
    v_mfma_f32_16x16x32_bf16 v[76:79], v[200:203], v[52:55], v[76:79]
    v_mfma_f32_16x16x32_bf16 v[80:83], a[0:3], v[48:51], v[80:83]
    v_mfma_f32_16x16x32_bf16 v[84:87], a[0:3], v[52:55], v[84:87]
    v_mfma_f32_16x16x32_bf16 v[88:91], a[56:59], v[48:51], v[88:91]
    v_mfma_f32_16x16x32_bf16 v[92:95], a[56:59], v[52:55], v[92:95]
    v_mfma_f32_16x16x32_bf16 v[96:99], a[112:115], v[48:51], v[96:99]
    v_mfma_f32_16x16x32_bf16 v[100:103], a[112:115], v[52:55], v[100:103]
    v_mfma_f32_16x16x32_bf16 v[104:107], a[168:171], v[48:51], v[104:107]
    v_mfma_f32_16x16x32_bf16 v[108:111], a[168:171], v[52:55], v[108:111]
    v_mfma_f32_16x16x32_bf16 v[112:115], a[224:227], v[48:51], v[112:115]
    v_mfma_f32_16x16x32_bf16 v[116:119], a[224:227], v[52:55], v[116:119]
    ds_read_b128 v[48:51], v2 offset:512
    ds_read_b128 v[52:55], v3 offset:512
    s_waitcnt lgkmcnt(2)
    v_mfma_f32_16x16x32_bf16 v[64:67], v[148:151], v[56:59], v[64:67]
    v_mfma_f32_16x16x32_bf16 v[68:71], v[148:151], v[60:63], v[68:71]
    v_mfma_f32_16x16x32_bf16 v[72:75], v[204:207], v[56:59], v[72:75]
    v_mfma_f32_16x16x32_bf16 v[76:79], v[204:207], v[60:63], v[76:79]
    v_mfma_f32_16x16x32_bf16 v[80:83], a[4:7], v[56:59], v[80:83]
    v_mfma_f32_16x16x32_bf16 v[84:87], a[4:7], v[60:63], v[84:87]
    v_mfma_f32_16x16x32_bf16 v[88:91], a[60:63], v[56:59], v[88:91]
    v_mfma_f32_16x16x32_bf16 v[92:95], a[60:63], v[60:63], v[92:95]
    v_mfma_f32_16x16x32_bf16 v[96:99], a[116:119], v[56:59], v[96:99]
    v_mfma_f32_16x16x32_bf16 v[100:103], a[116:119], v[60:63], v[100:103]
    v_mfma_f32_16x16x32_bf16 v[104:107], a[172:175], v[56:59], v[104:107]
    v_mfma_f32_16x16x32_bf16 v[108:111], a[172:175], v[60:63], v[108:111]
    v_mfma_f32_16x16x32_bf16 v[112:115], a[228:231], v[56:59], v[112:115]
    v_mfma_f32_16x16x32_bf16 v[116:119], a[228:231], v[60:63], v[116:119]
    ds_read_b128 v[56:59], v2 offset:576
    ds_read_b128 v[60:63], v3 offset:576
    s_waitcnt lgkmcnt(2)
    v_mfma_f32_16x16x32_bf16 v[64:67], v[152:155], v[48:51], v[64:67]
    v_mfma_f32_16x16x32_bf16 v[68:71], v[152:155], v[52:55], v[68:71]
    v_mfma_f32_16x16x32_bf16 v[72:75], v[208:211], v[48:51], v[72:75]
    v_mfma_f32_16x16x32_bf16 v[76:79], v[208:211], v[52:55], v[76:79]
    v_mfma_f32_16x16x32_bf16 v[80:83], a[8:11], v[48:51], v[80:83]
    v_mfma_f32_16x16x32_bf16 v[84:87], a[8:11], v[52:55], v[84:87]
    v_mfma_f32_16x16x32_bf16 v[88:91], a[64:67], v[48:51], v[88:91]
    v_mfma_f32_16x16x32_bf16 v[92:95], a[64:67], v[52:55], v[92:95]
    v_mfma_f32_16x16x32_bf16 v[96:99], a[120:123], v[48:51], v[96:99]
    v_mfma_f32_16x16x32_bf16 v[100:103], a[120:123], v[52:55], v[100:103]
    v_mfma_f32_16x16x32_bf16 v[104:107], a[176:179], v[48:51], v[104:107]
    v_mfma_f32_16x16x32_bf16 v[108:111], a[176:179], v[52:55], v[108:111]
    v_mfma_f32_16x16x32_bf16 v[112:115], a[232:235], v[48:51], v[112:115]
    v_mfma_f32_16x16x32_bf16 v[116:119], a[232:235], v[52:55], v[116:119]
    ds_read_b128 v[48:51], v2 offset:640
    ds_read_b128 v[52:55], v3 offset:640
    s_waitcnt lgkmcnt(2)
    v_mfma_f32_16x16x32_bf16 v[64:67], v[156:159], v[56:59], v[64:67]
    v_mfma_f32_16x16x32_bf16 v[68:71], v[156:159], v[60:63], v[68:71]
    v_mfma_f32_16x16x32_bf16 v[72:75], v[212:215], v[56:59], v[72:75]
    v_mfma_f32_16x16x32_bf16 v[76:79], v[212:215], v[60:63], v[76:79]
    v_mfma_f32_16x16x32_bf16 v[80:83], a[12:15], v[56:59], v[80:83]
    v_mfma_f32_16x16x32_bf16 v[84:87], a[12:15], v[60:63], v[84:87]
    v_mfma_f32_16x16x32_bf16 v[88:91], a[68:71], v[56:59], v[88:91]
    v_mfma_f32_16x16x32_bf16 v[92:95], a[68:71], v[60:63], v[92:95]
    v_mfma_f32_16x16x32_bf16 v[96:99], a[124:127], v[56:59], v[96:99]
    v_mfma_f32_16x16x32_bf16 v[100:103], a[124:127], v[60:63], v[100:103]
    v_mfma_f32_16x16x32_bf16 v[104:107], a[180:183], v[56:59], v[104:107]
    v_mfma_f32_16x16x32_bf16 v[108:111], a[180:183], v[60:63], v[108:111]
    v_mfma_f32_16x16x32_bf16 v[112:115], a[236:239], v[56:59], v[112:115]
    v_mfma_f32_16x16x32_bf16 v[116:119], a[236:239], v[60:63], v[116:119]
    ds_read_b128 v[56:59], v2 offset:704
    ds_read_b128 v[60:63], v3 offset:704
    s_waitcnt lgkmcnt(2)
    v_mfma_f32_16x16x32_bf16 v[64:67], v[160:163], v[48:51], v[64:67]
    v_mfma_f32_16x16x32_bf16 v[68:71], v[160:163], v[52:55], v[68:71]
    v_mfma_f32_16x16x32_bf16 v[72:75], v[216:219], v[48:51], v[72:75]
    v_mfma_f32_16x16x32_bf16 v[76:79], v[216:219], v[52:55], v[76:79]
    v_mfma_f32_16x16x32_bf16 v[80:83], a[16:19], v[48:51], v[80:83]
    v_mfma_f32_16x16x32_bf16 v[84:87], a[16:19], v[52:55], v[84:87]
    v_mfma_f32_16x16x32_bf16 v[88:91], a[72:75], v[48:51], v[88:91]
    v_mfma_f32_16x16x32_bf16 v[92:95], a[72:75], v[52:55], v[92:95]
    v_mfma_f32_16x16x32_bf16 v[96:99], a[128:131], v[48:51], v[96:99]
    v_mfma_f32_16x16x32_bf16 v[100:103], a[128:131], v[52:55], v[100:103]
    v_mfma_f32_16x16x32_bf16 v[104:107], a[184:187], v[48:51], v[104:107]
    v_mfma_f32_16x16x32_bf16 v[108:111], a[184:187], v[52:55], v[108:111]
    v_mfma_f32_16x16x32_bf16 v[112:115], a[240:243], v[48:51], v[112:115]
    v_mfma_f32_16x16x32_bf16 v[116:119], a[240:243], v[52:55], v[116:119]
    ds_read_b128 v[48:51], v2 offset:768
    ds_read_b128 v[52:55], v3 offset:768
    s_waitcnt lgkmcnt(2)
    v_mfma_f32_16x16x32_bf16 v[64:67], v[164:167], v[56:59], v[64:67]
    v_mfma_f32_16x16x32_bf16 v[68:71], v[164:167], v[60:63], v[68:71]
    v_mfma_f32_16x16x32_bf16 v[72:75], v[220:223], v[56:59], v[72:75]
    v_mfma_f32_16x16x32_bf16 v[76:79], v[220:223], v[60:63], v[76:79]
    v_mfma_f32_16x16x32_bf16 v[80:83], a[20:23], v[56:59], v[80:83]
    v_mfma_f32_16x16x32_bf16 v[84:87], a[20:23], v[60:63], v[84:87]
    v_mfma_f32_16x16x32_bf16 v[88:91], a[76:79], v[56:59], v[88:91]
    v_mfma_f32_16x16x32_bf16 v[92:95], a[76:79], v[60:63], v[92:95]
    v_mfma_f32_16x16x32_bf16 v[96:99], a[132:135], v[56:59], v[96:99]
    v_mfma_f32_16x16x32_bf16 v[100:103], a[132:135], v[60:63], v[100:103]
    v_mfma_f32_16x16x32_bf16 v[104:107], a[188:191], v[56:59], v[104:107]
    v_mfma_f32_16x16x32_bf16 v[108:111], a[188:191], v[60:63], v[108:111]
    v_mfma_f32_16x16x32_bf16 v[112:115], a[244:247], v[56:59], v[112:115]
    v_mfma_f32_16x16x32_bf16 v[116:119], a[244:247], v[60:63], v[116:119]
    ds_read_b128 v[56:59], v2 offset:832
    ds_read_b128 v[60:63], v3 offset:832
    s_waitcnt lgkmcnt(2)
    v_mfma_f32_16x16x32_bf16 v[64:67], v[168:171], v[48:51], v[64:67]
    v_mfma_f32_16x16x32_bf16 v[68:71], v[168:171], v[52:55], v[68:71]
    v_mfma_f32_16x16x32_bf16 v[72:75], v[224:227], v[48:51], v[72:75]
    v_mfma_f32_16x16x32_bf16 v[76:79], v[224:227], v[52:55], v[76:79]
    v_mfma_f32_16x16x32_bf16 v[80:83], a[24:27], v[48:51], v[80:83]
    v_mfma_f32_16x16x32_bf16 v[84:87], a[24:27], v[52:55], v[84:87]
    v_mfma_f32_16x16x32_bf16 v[88:91], a[80:83], v[48:51], v[88:91]
    v_mfma_f32_16x16x32_bf16 v[92:95], a[80:83], v[52:55], v[92:95]
    v_mfma_f32_16x16x32_bf16 v[96:99], a[136:139], v[48:51], v[96:99]
    v_mfma_f32_16x16x32_bf16 v[100:103], a[136:139], v[52:55], v[100:103]
    v_mfma_f32_16x16x32_bf16 v[104:107], a[192:195], v[48:51], v[104:107]
    v_mfma_f32_16x16x32_bf16 v[108:111], a[192:195], v[52:55], v[108:111]
    v_mfma_f32_16x16x32_bf16 v[112:115], a[248:251], v[48:51], v[112:115]
    v_mfma_f32_16x16x32_bf16 v[116:119], a[248:251], v[52:55], v[116:119]
    s_waitcnt lgkmcnt(0)
    v_mfma_f32_16x16x32_bf16 v[64:67], v[172:175], v[56:59], v[64:67]
    v_mfma_f32_16x16x32_bf16 v[68:71], v[172:175], v[60:63], v[68:71]
    v_mfma_f32_16x16x32_bf16 v[72:75], v[228:231], v[56:59], v[72:75]
    v_mfma_f32_16x16x32_bf16 v[76:79], v[228:231], v[60:63], v[76:79]
    v_mfma_f32_16x16x32_bf16 v[80:83], a[28:31], v[56:59], v[80:83]
    v_mfma_f32_16x16x32_bf16 v[84:87], a[28:31], v[60:63], v[84:87]
    v_mfma_f32_16x16x32_bf16 v[88:91], a[84:87], v[56:59], v[88:91]
    v_mfma_f32_16x16x32_bf16 v[92:95], a[84:87], v[60:63], v[92:95]
    v_mfma_f32_16x16x32_bf16 v[96:99], a[140:143], v[56:59], v[96:99]
    v_mfma_f32_16x16x32_bf16 v[100:103], a[140:143], v[60:63], v[100:103]
    v_mfma_f32_16x16x32_bf16 v[104:107], a[196:199], v[56:59], v[104:107]
    v_mfma_f32_16x16x32_bf16 v[108:111], a[196:199], v[60:63], v[108:111]
    v_mfma_f32_16x16x32_bf16 v[112:115], a[252:255], v[56:59], v[112:115]
    v_mfma_f32_16x16x32_bf16 v[116:119], a[252:255], v[60:63], v[116:119]
    v_cvt_pk_bf16_f32 v64, v64, v65
    v_cvt_pk_bf16_f32 v65, v66, v67
    v_cvt_pk_bf16_f32 v66, v72, v73
    v_cvt_pk_bf16_f32 v67, v74, v75
    v_cvt_pk_bf16_f32 v80, v80, v81
    v_cvt_pk_bf16_f32 v81, v82, v83
    v_cvt_pk_bf16_f32 v82, v88, v89
    v_cvt_pk_bf16_f32 v83, v90, v91
    v_cvt_pk_bf16_f32 v96, v96, v97
    v_cvt_pk_bf16_f32 v97, v98, v99
    v_cvt_pk_bf16_f32 v98, v104, v105
    v_cvt_pk_bf16_f32 v99, v106, v107
    v_cvt_pk_bf16_f32 v112, v112, v113
    v_cvt_pk_bf16_f32 v113, v114, v115
    v_cvt_pk_bf16_f32 v68, v68, v69
    v_cvt_pk_bf16_f32 v69, v70, v71
    v_cvt_pk_bf16_f32 v70, v76, v77
    v_cvt_pk_bf16_f32 v71, v78, v79
    v_cvt_pk_bf16_f32 v84, v84, v85
    v_cvt_pk_bf16_f32 v85, v86, v87
    v_cvt_pk_bf16_f32 v86, v92, v93
    v_cvt_pk_bf16_f32 v87, v94, v95
    v_cvt_pk_bf16_f32 v100, v100, v101
    v_cvt_pk_bf16_f32 v101, v102, v103
    v_cvt_pk_bf16_f32 v102, v108, v109
    v_cvt_pk_bf16_f32 v103, v110, v111
    v_cvt_pk_bf16_f32 v116, v116, v117
    v_cvt_pk_bf16_f32 v117, v118, v119
    ds_read_b128 v[48:51], v12 offset:0
    ds_read_b128 v[52:55], v12 offset:14848
    s_waitcnt lgkmcnt(0)
    v_mfma_f32_16x16x32_bf16 v[36:39], v[48:51], v[64:67], 0
    v_mfma_f32_16x16x32_bf16 v[40:43], v[48:51], v[68:71], 0
    v_mfma_f32_16x16x32_bf16 v[44:47], v[52:55], v[68:71], 0
    ds_read_b128 v[56:59], v12 offset:64
    ds_read_b128 v[60:63], v12 offset:14912
    s_waitcnt lgkmcnt(0)
    v_mfma_f32_16x16x32_bf16 v[36:39], v[56:59], v[80:83], v[36:39]
    v_mfma_f32_16x16x32_bf16 v[40:43], v[56:59], v[84:87], v[40:43]
    v_mfma_f32_16x16x32_bf16 v[44:47], v[60:63], v[84:87], v[44:47]
    ds_read_b128 v[48:51], v12 offset:128
    ds_read_b128 v[52:55], v12 offset:14976
    s_waitcnt lgkmcnt(0)
    v_mfma_f32_16x16x32_bf16 v[36:39], v[48:51], v[96:99], v[36:39]
    v_mfma_f32_16x16x32_bf16 v[40:43], v[48:51], v[100:103], v[40:43]
    v_mfma_f32_16x16x32_bf16 v[44:47], v[52:55], v[100:103], v[44:47]
    ds_read_b64 v[56:57], v13 offset:0
    ds_read_b64 v[60:61], v13 offset:14848
    s_waitcnt lgkmcnt(0)
    v_mfma_f32_16x16x16_bf16 v[36:39], v[56:57], v[112:113], v[36:39]
    v_mfma_f32_16x16x16_bf16 v[40:43], v[56:57], v[116:117], v[40:43]
    v_mfma_f32_16x16x16_bf16 v[44:47], v[60:61], v[116:117], v[44:47]
    s_cmp_eq_u32 s13, 0
    s_mov_b32 s43, 0x2034000
    s_cselect_b32 s43, 0x1fc4000, s43
    s_mul_i32 s18, s16, 7168
    s_add_u32 s43, s43, s18
    s_mov_b32 s32, 400000
    s_nop 1
L_mpoll_144:
    buffer_load_dwordx4 v[20:23], v6, s[4:7], s43 offen sc1
    buffer_load_dwordx4 v[24:27], v7, s[4:7], s43 offen sc1
    s_waitcnt vmcnt(0)
    v_max3_u32 v16, v20, v21, v22
    v_max3_u32 v17, v23, v24, v25
    v_max3_u32 v16, v16, v26, v27
    v_max_u32 v16, v16, v17
    v_cmp_eq_u32 vcc, -1, v16
    s_nop 3
    s_cbranch_vccz L_mgot_145
    s_sleep 1
    s_sub_u32 s32, s32, 1
    s_cmp_lg_u32 s32, 0
    s_cbranch_scc1 L_mpoll_144
    s_branch L_fail
L_mgot_145:
    ds_write2_b32 v8, v20, v22 offset0:0 offset1:1
    ds_write2_b32 v8, v21, v23 offset0:32 offset1:33
    ds_write_b128 v10, v[20:23]
    ds_write2_b32 v9, v24, v26 offset0:0 offset1:1
    ds_write2_b32 v9, v25, v27 offset0:32 offset1:33
    ds_write_b128 v11, v[24:27]
    s_waitcnt lgkmcnt(0)
    s_barrier
    ds_read_b128 v[48:51], v12 offset:59392
    ds_read_b128 v[52:55], v12 offset:59456
    ds_read_b128 v[56:59], v12 offset:59520
    ds_read_b64 v[60:61], v13 offset:59392
    s_waitcnt lgkmcnt(0)
    v_mfma_f32_16x16x32_bf16 v[28:31], v[48:51], v[64:67], 0
    v_mfma_f32_16x16x32_bf16 v[32:35], v[48:51], v[68:71], 0
    v_mfma_f32_16x16x32_bf16 v[28:31], v[52:55], v[80:83], v[28:31]
    v_mfma_f32_16x16x32_bf16 v[32:35], v[52:55], v[84:87], v[32:35]
    v_mfma_f32_16x16x32_bf16 v[28:31], v[56:59], v[96:99], v[28:31]
    v_mfma_f32_16x16x32_bf16 v[32:35], v[56:59], v[100:103], v[32:35]
    v_mfma_f32_16x16x16_bf16 v[28:31], v[60:61], v[112:113], v[28:31]
    v_mfma_f32_16x16x16_bf16 v[32:35], v[60:61], v[116:117], v[32:35]
    s_nop 6
    ds_write_b128 v14, v[28:31] offset:0
    ds_write_b128 v14, v[32:35] offset:1024
    ds_write_b128 v14, v[36:39] offset:2048
    ds_write_b128 v14, v[40:43] offset:3072
    ds_write_b128 v14, v[44:47] offset:4096
    s_waitcnt lgkmcnt(0)
    s_barrier
    s_cmp_ge_u32 s15, 2
    s_cbranch_scc1 L_TP_nosm_146
    s_mul_i32 s18, s15, 4096
    v_subrev_u32 v19, s18, v14
    v_add_u32 v20, 81408, v4
    ds_read_b128 v[64:67], v19 offset:0
    ds_read_b128 v[68:71], v19 offset:2048
    ds_read_b128 v[72:75], v20 offset:4096
    ds_read_b128 v[76:79], v19 offset:5120
    ds_read_b128 v[80:83], v19 offset:7168
    ds_read_b128 v[84:87], v20 offset:9216
    ds_read_b128 v[88:91], v19 offset:10240
    ds_read_b128 v[92:95], v19 offset:12288
    ds_read_b128 v[96:99], v20 offset:14336
    ds_read_b128 v[100:103], v19 offset:15360
    ds_read_b128 v[104:107], v19 offset:17408
    ds_read_b128 v[108:111], v20 offset:19456
    s_waitcnt lgkmcnt(6)
    v_add_f32 v28, v64, v76
    v_add_f32 v29, v65, v77
    v_add_f32 v30, v66, v78
    v_add_f32 v31, v67, v79
    v_add_f32 v32, v68, v80
    v_add_f32 v33, v69, v81
    v_add_f32 v34, v70, v82
    v_add_f32 v35, v71, v83
    v_add_f32 v36, v72, v84
    v_add_f32 v37, v73, v85
    v_add_f32 v38, v74, v86
    v_add_f32 v39, v75, v87
    s_waitcnt lgkmcnt(0)
    v_add_f32 v88, v88, v100
    v_add_f32 v89, v89, v101
    v_add_f32 v90, v90, v102
    v_add_f32 v91, v91, v103
    v_add_f32 v92, v92, v104
    v_add_f32 v93, v93, v105
    v_add_f32 v94, v94, v106
    v_add_f32 v95, v95, v107
    v_add_f32 v96, v96, v108
    v_add_f32 v97, v97, v109
    v_add_f32 v98, v98, v110
    v_add_f32 v99, v99, v111
    v_add_f32 v28, v28, v88
    v_add_f32 v29, v29, v89
    v_add_f32 v30, v30, v90
    v_add_f32 v31, v31, v91
    v_add_f32 v32, v32, v92
    v_add_f32 v33, v33, v93
    v_add_f32 v34, v34, v94
    v_add_f32 v35, v35, v95
    v_add_f32 v36, v36, v96
    v_add_f32 v37, v37, v97
    v_add_f32 v38, v38, v98
    v_add_f32 v39, v39, v99
    v_mov_b32 v18, 0xff800000
    v_cndmask_b32 v28, v18, v28, s[56:57]
    v_cndmask_b32 v29, v18, v29, s[56:57]
    v_cndmask_b32 v30, v18, v30, s[56:57]
    v_cndmask_b32 v31, v18, v31, s[56:57]
    s_cmp_eq_u32 s15, 1
    s_cbranch_scc1 L_TPw1_147
    v_cndmask_b32 v32, v18, v32, s[48:49]
    v_mov_b32 v36, v18
    v_cndmask_b32 v33, v18, v33, s[50:51]
    v_mov_b32 v37, v18
    v_cndmask_b32 v34, v18, v34, s[52:53]
    v_mov_b32 v38, v18
    v_cndmask_b32 v35, v18, v35, s[54:55]
    v_mov_b32 v39, v18
    s_nop 0
    s_branch L_TPwj_148
L_TPw1_147:
    v_cndmask_b32 v36, v18, v36, s[48:49]
    v_cndmask_b32 v37, v18, v37, s[50:51]
    v_cndmask_b32 v38, v18, v38, s[52:53]
    v_cndmask_b32 v39, v18, v39, s[54:55]
    s_nop 1
L_TPwj_148:
    v_max3_f32 v16, v28, v29, v30
    v_max3_f32 v17, v31, v32, v33
    v_max3_f32 v16, v16, v34, v35
    v_max3_f32 v17, v17, v36, v37
    v_max3_f32 v16, v16, v38, v39
    v_max_f32 v16, v16, v17
    v_mov_b32 v17, v16
    s_nop 1
    v_permlane16_swap_b32 v17, v16
    v_max_f32 v16, v16, v17
    v_mov_b32 v17, v16
    s_nop 1
    v_permlane32_swap_b32 v17, v16
    v_max_f32 v16, v16, v17
    v_mul_f32 v16, s45, v16
    v_fma_f32 v28, v28, s45, -v16
    v_fma_f32 v29, v29, s45, -v16
    v_fma_f32 v30, v30, s45, -v16
    v_fma_f32 v31, v31, s45, -v16
    v_fma_f32 v32, v32, s45, -v16
    v_fma_f32 v33, v33, s45, -v16
    v_fma_f32 v34, v34, s45, -v16
    v_fma_f32 v35, v35, s45, -v16
    v_fma_f32 v36, v36, s45, -v16
    v_fma_f32 v37, v37, s45, -v16
    v_fma_f32 v38, v38, s45, -v16
    v_fma_f32 v39, v39, s45, -v16
    v_exp_f32 v28, v28
    v_exp_f32 v29, v29
    v_exp_f32 v30, v30
    v_exp_f32 v31, v31
    v_exp_f32 v32, v32
    v_exp_f32 v33, v33
    v_exp_f32 v34, v34
    v_exp_f32 v35, v35
    v_exp_f32 v36, v36
    v_exp_f32 v37, v37
    v_exp_f32 v38, v38
    v_exp_f32 v39, v39
    v_add_f32 v16, v28, v29
    v_add_f32 v17, v30, v31
    v_add_f32 v16, v16, v32
    v_add_f32 v17, v17, v33
    v_add_f32 v16, v16, v34
    v_add_f32 v17, v17, v35
    v_add_f32 v16, v16, v36
    v_add_f32 v17, v17, v37
    v_add_f32 v16, v16, v38
    v_add_f32 v17, v17, v39
    v_add_f32 v16, v16, v17
    v_mov_b32 v17, v16
    s_nop 1
    v_permlane16_swap_b32 v17, v16
    v_add_f32 v16, v16, v17
    v_mov_b32 v17, v16
    s_nop 1
    v_permlane32_swap_b32 v17, v16
    v_add_f32 v16, v16, v17
    v_rcp_f32 v16, v16
    s_nop 0
    v_mul_f32 v28, v28, v16
    v_mul_f32 v29, v29, v16
    v_mul_f32 v30, v30, v16
    v_mul_f32 v31, v31, v16
    v_mul_f32 v32, v32, v16
    v_mul_f32 v33, v33, v16
    v_mul_f32 v34, v34, v16
    v_mul_f32 v35, v35, v16
    v_mul_f32 v36, v36, v16
    v_mul_f32 v37, v37, v16
    v_mul_f32 v38, v38, v16
    v_mul_f32 v39, v39, v16
    v_cvt_pk_bf16_f32 v64, v28, v29
    v_cvt_pk_bf16_f32 v65, v30, v31
    v_cvt_pk_bf16_f32 v66, v32, v33
    v_cvt_pk_bf16_f32 v67, v34, v35
    v_cvt_pk_bf16_f32 v68, v36, v37
    v_cvt_pk_bf16_f32 v69, v38, v39
    ds_write_b64 v15, v[66:67] offset:512
    ds_write_b64 v15, v[68:69] offset:1536
    s_mov_b64 exec, s[56:57]
    ds_write_b64 v15, v[64:65]
    s_mov_b64 exec, -1
    s_waitcnt lgkmcnt(0)
L_TP_nosm_146:
    s_barrier
    s_cmp_eq_u32 s13, 0
    s_mov_b32 s44, 0x6a64000
    s_cselect_b32 s44, 0x67e4000, s44
    s_mul_i32 s18, s16, 40960
    s_add_u32 s44, s44, s18
    s_mul_i32 s18, s12, 2560
    s_add_u32 s44, s44, s18
    v_lshlrev_b32 v16, 4, v0
    v_add_u32 v17, 101888, v16
    v_cmp_gt_u32 vcc, 160, v0
    s_and_saveexec_b64 s[20:21], vcc
    s_nop 2
    s_cbranch_execz L_px_149
    ds_read_b128 v[20:23], v17
    s_waitcnt lgkmcnt(0)
    buffer_store_dwordx4 v[20:23], v16, s[4:7], s44 offen sc1
    s_nop 1
L_px_149:
    s_mov_b64 exec, s[20:21]
    s_cmp_eq_u32 s13, 0
    s_mov_b32 s40, 0x78f6000
    s_cselect_b32 s40, 0x78e6000, s40
    s_lshl_b32 s18, s16, 7
    s_add_u32 s40, s40, s18
    s_waitcnt vmcnt(0)
    s_barrier
    s_cmp_lg_u32 s15, 0
    s_cbranch_scc1 L_sig_150
    v_mov_b32 v16, 1
    s_lshl_b32 s18, s12, 2
    v_mov_b32 v17, s18
    s_mov_b64 exec, 1
    buffer_store_dword v16, v17, s[4:7], s40 offen sc1
    s_mov_b64 exec, -1
L_sig_150:
    s_add_u32 s16, s16, 2
    s_cmp_lt_u32 s16, 64
    s_cbranch_scc1 L_TP_loop
    s_branch L_role_done
L_ZG:
    s_add_u32 s60, s12, 16
    s_mul_i32 s18, s12, 401408
    s_mul_i32 s19, s15, 100352
    s_add_u32 s18, s18, s19
    s_add_u32 s20, s18, 6422528
    v_and_b32 v1, 63, v0
    v_lshlrev_b32 v1, 4, v1
    s_mov_b32 s40, s93
    s_cmp_ge_u32 s40, 160
    s_cbranch_scc1 M_end_151
    v_lshlrev_b32 v6, 4, v0
    v_mov_b32 v8, -1
    v_mov_b32 v12, 0
    v_mov_b32 v9, -1
    v_mov_b32 v13, 0
    v_mov_b32 v10, -1
    v_mov_b32 v14, 0
    v_mov_b32 v11, -1
    v_mov_b32 v15, 0
    s_lshl_b32 s42, s40, 12
    s_add_u32 s42, s42, 126763008
    s_mov_b32 s46, 126894080
    s_mov_b32 s44, s4
    s_mov_b32 s45, s5
    s_mov_b32 s47, 0x00020000
    buffer_store_dwordx4 v[12:15], v6, s[44:47], s42 offen sc1
    s_lshl_b32 s42, s40, 12
    s_add_u32 s42, s42, 32398336
    s_mov_b32 s46, 32849920
    s_mov_b32 s44, s4
    s_mov_b32 s45, s5
    s_mov_b32 s47, 0x00020000
    buffer_store_dwordx4 v[8:11], v6, s[44:47], s42 offen sc1
    s_lshl_b32 s42, s40, 12
    s_add_u32 s42, s42, 33315840
    s_mov_b32 s46, 33767424
    s_mov_b32 s44, s4
    s_mov_b32 s45, s5
    s_mov_b32 s47, 0x00020000
    buffer_store_dwordx4 v[8:11], v6, s[44:47], s42 offen sc1
    s_lshl_b32 s42, s40, 12
    s_add_u32 s42, s42, 34226176
    s_mov_b32 s46, 34881536
    s_mov_b32 s44, s4
    s_mov_b32 s45, s5
    s_mov_b32 s47, 0x00020000
    buffer_store_dwordx4 v[8:11], v6, s[44:47], s42 offen sc1
    s_lshl_b32 s42, s40, 12
    s_add_u32 s42, s42, 32857088
    s_mov_b32 s46, 33308672
    s_mov_b32 s44, s4
    s_mov_b32 s45, s5
    s_mov_b32 s47, 0x00020000
    buffer_store_dwordx4 v[8:11], v6, s[44:47], s42 offen sc1
    s_lshl_b32 s42, s40, 12
    s_add_u32 s42, s42, 33774592
    s_mov_b32 s46, 34226176
    s_mov_b32 s44, s4
    s_mov_b32 s45, s5
    s_mov_b32 s47, 0x00020000
    buffer_store_dwordx4 v[8:11], v6, s[44:47], s42 offen sc1
    s_lshl_b32 s42, s40, 12
    s_add_u32 s42, s42, 34881536
    s_mov_b32 s46, 35536896
    s_mov_b32 s44, s4
    s_mov_b32 s45, s5
    s_mov_b32 s47, 0x00020000
    buffer_store_dwordx4 v[8:11], v6, s[44:47], s42 offen sc1
    s_cmp_ge_u32 s40, 32
    s_cbranch_scc1 M_end_151
    s_load_dwordx2 s[8:9], s[34:35], 0
    s_waitcnt lgkmcnt(0)
    s_mov_b32 s10, 1835008
    s_mov_b32 s11, 0x00020000
    v_lshrrev_b32 v4, 3, v0
    v_and_b32 v5, 7, v0
    v_mul_u32_u24 v2, 896, v4
    v_lshl_add_u32 v2, v5, 4, v2
    v_mul_u32_u24 v3, 928, v4
    v_lshl_add_u32 v3, v5, 4, v3
    s_add_u32 s41, s40, 32
    s_mul_i32 s42, s41, 28672
    buffer_load_dwordx4 v[16:19], v2, s[8:11], s42 offen offset:0
    buffer_load_dwordx4 v[20:23], v2, s[8:11], s42 offen offset:128
    buffer_load_dwordx4 v[24:27], v2, s[8:11], s42 offen offset:256
    buffer_load_dwordx4 v[28:31], v2, s[8:11], s42 offen offset:384
    buffer_load_dwordx4 v[32:35], v2, s[8:11], s42 offen offset:512
    buffer_load_dwordx4 v[36:39], v2, s[8:11], s42 offen offset:640
    buffer_load_dwordx4 v[40:43], v2, s[8:11], s42 offen offset:768
    s_waitcnt vmcnt(0)
    v_lshlrev_b32 v48, 16, v16
    v_and_b32 v49, 0xffff0000, v16
    v_lshlrev_b32 v50, 16, v17
    v_and_b32 v51, 0xffff0000, v17
    v_lshlrev_b32 v52, 16, v18
    v_and_b32 v53, 0xffff0000, v18
    v_lshlrev_b32 v54, 16, v19
    v_and_b32 v55, 0xffff0000, v19
    v_lshlrev_b32 v56, 16, v20
    v_and_b32 v57, 0xffff0000, v20
    v_lshlrev_b32 v58, 16, v21
    v_and_b32 v59, 0xffff0000, v21
    v_lshlrev_b32 v60, 16, v22
    v_and_b32 v61, 0xffff0000, v22
    v_lshlrev_b32 v62, 16, v23
    v_and_b32 v63, 0xffff0000, v23
    v_lshlrev_b32 v64, 16, v24
    v_and_b32 v65, 0xffff0000, v24
    v_lshlrev_b32 v66, 16, v25
    v_and_b32 v67, 0xffff0000, v25
    v_lshlrev_b32 v68, 16, v26
    v_and_b32 v69, 0xffff0000, v26
    v_lshlrev_b32 v70, 16, v27
    v_and_b32 v71, 0xffff0000, v27
    v_lshlrev_b32 v72, 16, v28
    v_and_b32 v73, 0xffff0000, v28
    v_lshlrev_b32 v74, 16, v29
    v_and_b32 v75, 0xffff0000, v29
    v_lshlrev_b32 v76, 16, v30
    v_and_b32 v77, 0xffff0000, v30
    v_lshlrev_b32 v78, 16, v31
    v_and_b32 v79, 0xffff0000, v31
    v_lshlrev_b32 v80, 16, v32
    v_and_b32 v81, 0xffff0000, v32
    v_lshlrev_b32 v82, 16, v33
    v_and_b32 v83, 0xffff0000, v33
    v_lshlrev_b32 v84, 16, v34
    v_and_b32 v85, 0xffff0000, v34
    v_lshlrev_b32 v86, 16, v35
    v_and_b32 v87, 0xffff0000, v35
    v_lshlrev_b32 v88, 16, v36
    v_and_b32 v89, 0xffff0000, v36
    v_lshlrev_b32 v90, 16, v37
    v_and_b32 v91, 0xffff0000, v37
    v_lshlrev_b32 v92, 16, v38
    v_and_b32 v93, 0xffff0000, v38
    v_lshlrev_b32 v94, 16, v39
    v_and_b32 v95, 0xffff0000, v39
    v_lshlrev_b32 v96, 16, v40
    v_and_b32 v97, 0xffff0000, v40
    v_lshlrev_b32 v98, 16, v41
    v_and_b32 v99, 0xffff0000, v41
    v_lshlrev_b32 v100, 16, v42
    v_and_b32 v101, 0xffff0000, v42
    v_lshlrev_b32 v102, 16, v43
    v_and_b32 v103, 0xffff0000, v43
    v_pk_add_f32 v[6:7], v[48:49], v[50:51]
    v_pk_add_f32 v[8:9], v[52:53], v[54:55]
    v_pk_add_f32 v[6:7], v[6:7], v[56:57]
    v_pk_add_f32 v[8:9], v[8:9], v[58:59]
    v_pk_add_f32 v[6:7], v[6:7], v[60:61]
    v_pk_add_f32 v[8:9], v[8:9], v[62:63]
    v_pk_add_f32 v[6:7], v[6:7], v[64:65]
    v_pk_add_f32 v[8:9], v[8:9], v[66:67]
    v_pk_add_f32 v[6:7], v[6:7], v[68:69]
    v_pk_add_f32 v[8:9], v[8:9], v[70:71]
    v_pk_add_f32 v[6:7], v[6:7], v[72:73]
    v_pk_add_f32 v[8:9], v[8:9], v[74:75]
    v_pk_add_f32 v[6:7], v[6:7], v[76:77]
    v_pk_add_f32 v[8:9], v[8:9], v[78:79]
    v_pk_add_f32 v[6:7], v[6:7], v[80:81]
    v_pk_add_f32 v[8:9], v[8:9], v[82:83]
    v_pk_add_f32 v[6:7], v[6:7], v[84:85]
    v_pk_add_f32 v[8:9], v[8:9], v[86:87]
    v_pk_add_f32 v[6:7], v[6:7], v[88:89]
    v_pk_add_f32 v[8:9], v[8:9], v[90:91]
    v_pk_add_f32 v[6:7], v[6:7], v[92:93]
    v_pk_add_f32 v[8:9], v[8:9], v[94:95]
    v_pk_add_f32 v[6:7], v[6:7], v[96:97]
    v_pk_add_f32 v[8:9], v[8:9], v[98:99]
    v_pk_add_f32 v[6:7], v[6:7], v[100:101]
    v_pk_add_f32 v[8:9], v[8:9], v[102:103]
    v_pk_add_f32 v[6:7], v[6:7], v[8:9]
    v_add_f32 v4, v6, v7
    s_nop 1
    v_add_f32_dpp v4, v4, v4 quad_perm:[1,0,3,2] row_mask:0xf bank_mask:0xf
    s_nop 1
    v_add_f32_dpp v4, v4, v4 quad_perm:[2,3,0,1] row_mask:0xf bank_mask:0xf
    s_nop 1
    v_add_f32_dpp v4, v4, v4 row_half_mirror row_mask:0xf bank_mask:0xf
    v_mul_f32 v8, 0xbb124925, v4
    v_mov_b32 v9, v8
    v_pk_add_f32 v[48:49], v[48:49], v[8:9]
    v_pk_add_f32 v[50:51], v[50:51], v[8:9]
    v_pk_add_f32 v[52:53], v[52:53], v[8:9]
    v_pk_add_f32 v[54:55], v[54:55], v[8:9]
    v_pk_add_f32 v[56:57], v[56:57], v[8:9]
    v_pk_add_f32 v[58:59], v[58:59], v[8:9]
    v_pk_add_f32 v[60:61], v[60:61], v[8:9]
    v_pk_add_f32 v[62:63], v[62:63], v[8:9]
    v_pk_add_f32 v[64:65], v[64:65], v[8:9]
    v_pk_add_f32 v[66:67], v[66:67], v[8:9]
    v_pk_add_f32 v[68:69], v[68:69], v[8:9]
    v_pk_add_f32 v[70:71], v[70:71], v[8:9]
    v_pk_add_f32 v[72:73], v[72:73], v[8:9]
    v_pk_add_f32 v[74:75], v[74:75], v[8:9]
    v_pk_add_f32 v[76:77], v[76:77], v[8:9]
    v_pk_add_f32 v[78:79], v[78:79], v[8:9]
    v_pk_add_f32 v[80:81], v[80:81], v[8:9]
    v_pk_add_f32 v[82:83], v[82:83], v[8:9]
    v_pk_add_f32 v[84:85], v[84:85], v[8:9]
    v_pk_add_f32 v[86:87], v[86:87], v[8:9]
    v_pk_add_f32 v[88:89], v[88:89], v[8:9]
    v_pk_add_f32 v[90:91], v[90:91], v[8:9]
    v_pk_add_f32 v[92:93], v[92:93], v[8:9]
    v_pk_add_f32 v[94:95], v[94:95], v[8:9]
    v_pk_add_f32 v[96:97], v[96:97], v[8:9]
    v_pk_add_f32 v[98:99], v[98:99], v[8:9]
    v_pk_add_f32 v[100:101], v[100:101], v[8:9]
    v_pk_add_f32 v[102:103], v[102:103], v[8:9]
    v_pk_mul_f32 v[6:7], v[48:49], v[48:49]
    v_pk_mul_f32 v[8:9], v[50:51], v[50:51]
    v_pk_fma_f32 v[6:7], v[52:53], v[52:53], v[6:7]
    v_pk_fma_f32 v[8:9], v[54:55], v[54:55], v[8:9]
    v_pk_fma_f32 v[6:7], v[56:57], v[56:57], v[6:7]
    v_pk_fma_f32 v[8:9], v[58:59], v[58:59], v[8:9]
    v_pk_fma_f32 v[6:7], v[60:61], v[60:61], v[6:7]
    v_pk_fma_f32 v[8:9], v[62:63], v[62:63], v[8:9]
    v_pk_fma_f32 v[6:7], v[64:65], v[64:65], v[6:7]
    v_pk_fma_f32 v[8:9], v[66:67], v[66:67], v[8:9]
    v_pk_fma_f32 v[6:7], v[68:69], v[68:69], v[6:7]
    v_pk_fma_f32 v[8:9], v[70:71], v[70:71], v[8:9]
    v_pk_fma_f32 v[6:7], v[72:73], v[72:73], v[6:7]
    v_pk_fma_f32 v[8:9], v[74:75], v[74:75], v[8:9]
    v_pk_fma_f32 v[6:7], v[76:77], v[76:77], v[6:7]
    v_pk_fma_f32 v[8:9], v[78:79], v[78:79], v[8:9]
    v_pk_fma_f32 v[6:7], v[80:81], v[80:81], v[6:7]
    v_pk_fma_f32 v[8:9], v[82:83], v[82:83], v[8:9]
    v_pk_fma_f32 v[6:7], v[84:85], v[84:85], v[6:7]
    v_pk_fma_f32 v[8:9], v[86:87], v[86:87], v[8:9]
    v_pk_fma_f32 v[6:7], v[88:89], v[88:89], v[6:7]
    v_pk_fma_f32 v[8:9], v[90:91], v[90:91], v[8:9]
    v_pk_fma_f32 v[6:7], v[92:93], v[92:93], v[6:7]
    v_pk_fma_f32 v[8:9], v[94:95], v[94:95], v[8:9]
    v_pk_fma_f32 v[6:7], v[96:97], v[96:97], v[6:7]
    v_pk_fma_f32 v[8:9], v[98:99], v[98:99], v[8:9]
    v_pk_fma_f32 v[6:7], v[100:101], v[100:101], v[6:7]
    v_pk_fma_f32 v[8:9], v[102:103], v[102:103], v[8:9]
    v_pk_add_f32 v[6:7], v[6:7], v[8:9]
    v_add_f32 v4, v6, v7
    s_nop 1
    v_add_f32_dpp v4, v4, v4 quad_perm:[1,0,3,2] row_mask:0xf bank_mask:0xf
    s_nop 1
    v_add_f32_dpp v4, v4, v4 quad_perm:[2,3,0,1] row_mask:0xf bank_mask:0xf
    s_nop 1
    v_add_f32_dpp v4, v4, v4 row_half_mirror row_mask:0xf bank_mask:0xf
    v_mov_b32 v6, 0x3727c5ac
    v_fmac_f32 v6, 0x3b124925, v4
    v_rsq_f32 v6, v6
    s_nop 0
    v_mov_b32 v7, v6
    v_pk_mul_f32 v[48:49], v[48:49], v[6:7]
    v_cvt_pk_bf16_f32 v16, v48, v49
    v_pk_mul_f32 v[50:51], v[50:51], v[6:7]
    v_cvt_pk_bf16_f32 v17, v50, v51
    v_pk_mul_f32 v[52:53], v[52:53], v[6:7]
    v_cvt_pk_bf16_f32 v18, v52, v53
    v_pk_mul_f32 v[54:55], v[54:55], v[6:7]
    v_cvt_pk_bf16_f32 v19, v54, v55
    v_pk_mul_f32 v[56:57], v[56:57], v[6:7]
    v_cvt_pk_bf16_f32 v20, v56, v57
    v_pk_mul_f32 v[58:59], v[58:59], v[6:7]
    v_cvt_pk_bf16_f32 v21, v58, v59
    v_pk_mul_f32 v[60:61], v[60:61], v[6:7]
    v_cvt_pk_bf16_f32 v22, v60, v61
    v_pk_mul_f32 v[62:63], v[62:63], v[6:7]
    v_cvt_pk_bf16_f32 v23, v62, v63
    v_pk_mul_f32 v[64:65], v[64:65], v[6:7]
    v_cvt_pk_bf16_f32 v24, v64, v65
    v_pk_mul_f32 v[66:67], v[66:67], v[6:7]
    v_cvt_pk_bf16_f32 v25, v66, v67
    v_pk_mul_f32 v[68:69], v[68:69], v[6:7]
    v_cvt_pk_bf16_f32 v26, v68, v69
    v_pk_mul_f32 v[70:71], v[70:71], v[6:7]
    v_cvt_pk_bf16_f32 v27, v70, v71
    v_pk_mul_f32 v[72:73], v[72:73], v[6:7]
    v_cvt_pk_bf16_f32 v28, v72, v73
    v_pk_mul_f32 v[74:75], v[74:75], v[6:7]
    v_cvt_pk_bf16_f32 v29, v74, v75
    v_pk_mul_f32 v[76:77], v[76:77], v[6:7]
    v_cvt_pk_bf16_f32 v30, v76, v77
    v_pk_mul_f32 v[78:79], v[78:79], v[6:7]
    v_cvt_pk_bf16_f32 v31, v78, v79
    v_pk_mul_f32 v[80:81], v[80:81], v[6:7]
    v_cvt_pk_bf16_f32 v32, v80, v81
    v_pk_mul_f32 v[82:83], v[82:83], v[6:7]
    v_cvt_pk_bf16_f32 v33, v82, v83
    v_pk_mul_f32 v[84:85], v[84:85], v[6:7]
    v_cvt_pk_bf16_f32 v34, v84, v85
    v_pk_mul_f32 v[86:87], v[86:87], v[6:7]
    v_cvt_pk_bf16_f32 v35, v86, v87
    v_pk_mul_f32 v[88:89], v[88:89], v[6:7]
    v_cvt_pk_bf16_f32 v36, v88, v89
    v_pk_mul_f32 v[90:91], v[90:91], v[6:7]
    v_cvt_pk_bf16_f32 v37, v90, v91
    v_pk_mul_f32 v[92:93], v[92:93], v[6:7]
    v_cvt_pk_bf16_f32 v38, v92, v93
    v_pk_mul_f32 v[94:95], v[94:95], v[6:7]
    v_cvt_pk_bf16_f32 v39, v94, v95
    v_pk_mul_f32 v[96:97], v[96:97], v[6:7]
    v_cvt_pk_bf16_f32 v40, v96, v97
    v_pk_mul_f32 v[98:99], v[98:99], v[6:7]
    v_cvt_pk_bf16_f32 v41, v98, v99
    v_pk_mul_f32 v[100:101], v[100:101], v[6:7]
    v_cvt_pk_bf16_f32 v42, v100, v101
    v_pk_mul_f32 v[102:103], v[102:103], v[6:7]
    v_cvt_pk_bf16_f32 v43, v102, v103
    s_mul_i32 s42, s41, 29696
    s_add_u32 s42, s42, 19267584
    buffer_store_dwordx4 v[16:19], v3, s[4:7], s42 offen offset:0 sc1
    buffer_store_dwordx4 v[20:23], v3, s[4:7], s42 offen offset:128 sc1
    buffer_store_dwordx4 v[24:27], v3, s[4:7], s42 offen offset:256 sc1
    buffer_store_dwordx4 v[28:31], v3, s[4:7], s42 offen offset:384 sc1
    buffer_store_dwordx4 v[32:35], v3, s[4:7], s42 offen offset:512 sc1
    buffer_store_dwordx4 v[36:39], v3, s[4:7], s42 offen offset:640 sc1
    buffer_store_dwordx4 v[40:43], v3, s[4:7], s42 offen offset:768 sc1
    s_nop 1
M_end_151:
    v_and_b32 v1, 63, v0
    v_lshlrev_b32 v1, 4, v1
    s_waitcnt vmcnt(0)
    s_barrier
    s_cmp_lg_u32 s15, 0
    s_cbranch_scc1 L_ic_153
    v_mov_b32 v46, 32
    v_mov_b32 v47, 1
    s_mov_b64 exec, 1
    global_atomic_add v46, v47, s[36:37] sc1
    s_mov_b64 exec, -1
L_ic_153:
    s_mov_b32 s32, 400000
    v_mbcnt_lo_u32_b32 v45, -1, 0
    v_lshrrev_b32 v44, 3, v45
    v_add_u32 v44, s60, v44
    v_lshlrev_b32 v44, 7, v44
    v_and_b32 v45, 7, v45
    v_lshl_add_u32 v45, v45, 2, v44
    s_mov_b32 s61, 1
    s_mov_b32 s26, 126894176
    s_mov_b32 exec_lo, 0x7f
    s_mov_b32 exec_hi, 0
L_iw_157:
    buffer_load_dword v44, v45, s[4:7], s26 offen sc1
    s_waitcnt vmcnt(0)
    v_cmp_eq_u32 vcc, 0, v44
    s_nop 3
    s_cbranch_vccz L_iwok_154
    s_mov_b32 s61, 0
    s_mov_b32 s26, 126894080
    s_mov_b32 exec_lo, 0x7f
    s_mov_b32 exec_hi, 0
L_iw_158:
    buffer_load_dword v44, v45, s[4:7], s26 offen sc1
    s_waitcnt vmcnt(0)
    v_cmp_eq_u32 vcc, 0, v44
    s_nop 3
    s_cbranch_vccz L_iwok_154
    s_sleep 1
    s_sub_u32 s32, s32, 1
    s_cmp_lg_u32 s32, 0
    s_cbranch_scc1 L_iw_158
    s_branch L_fail
L_iwok_154:
    s_mov_b64 exec, -1
L_iwsk_155:
    s_add_u32 s21, s20, 0
    buffer_load_dwordx4 v[120:123], v1, s[4:7], s21 offen offset:0 sc1
    buffer_load_dwordx4 v[124:127], v1, s[4:7], s21 offen offset:1024 sc1
    buffer_load_dwordx4 v[128:131], v1, s[4:7], s21 offen offset:2048 sc1
    buffer_load_dwordx4 v[132:135], v1, s[4:7], s21 offen offset:3072 sc1
    s_add_u32 s21, s20, 14336
    buffer_load_dwordx4 v[176:179], v1, s[4:7], s21 offen offset:0 sc1
    buffer_load_dwordx4 v[180:183], v1, s[4:7], s21 offen offset:1024 sc1
    buffer_load_dwordx4 v[184:187], v1, s[4:7], s21 offen offset:2048 sc1
    buffer_load_dwordx4 v[188:191], v1, s[4:7], s21 offen offset:3072 sc1
    s_add_u32 s21, s20, 28672
    buffer_load_dwordx4 v[232:235], v1, s[4:7], s21 offen offset:0 sc1
    buffer_load_dwordx4 v[236:239], v1, s[4:7], s21 offen offset:1024 sc1
    buffer_load_dwordx4 v[240:243], v1, s[4:7], s21 offen offset:2048 sc1
    buffer_load_dwordx4 v[244:247], v1, s[4:7], s21 offen offset:3072 sc1
    s_add_u32 s21, s20, 43008
    buffer_load_dwordx4 a[32:35], v1, s[4:7], s21 offen offset:0 sc1
    buffer_load_dwordx4 a[36:39], v1, s[4:7], s21 offen offset:1024 sc1
    buffer_load_dwordx4 a[40:43], v1, s[4:7], s21 offen offset:2048 sc1
    buffer_load_dwordx4 a[44:47], v1, s[4:7], s21 offen offset:3072 sc1
    s_add_u32 s21, s20, 57344
    buffer_load_dwordx4 a[88:91], v1, s[4:7], s21 offen offset:0 sc1
    buffer_load_dwordx4 a[92:95], v1, s[4:7], s21 offen offset:1024 sc1
    buffer_load_dwordx4 a[96:99], v1, s[4:7], s21 offen offset:2048 sc1
    buffer_load_dwordx4 a[100:103], v1, s[4:7], s21 offen offset:3072 sc1
    s_add_u32 s21, s20, 71680
    buffer_load_dwordx4 a[144:147], v1, s[4:7], s21 offen offset:0 sc1
    buffer_load_dwordx4 a[148:151], v1, s[4:7], s21 offen offset:1024 sc1
    buffer_load_dwordx4 a[152:155], v1, s[4:7], s21 offen offset:2048 sc1
    buffer_load_dwordx4 a[156:159], v1, s[4:7], s21 offen offset:3072 sc1
    s_add_u32 s21, s20, 86016
    buffer_load_dwordx4 a[200:203], v1, s[4:7], s21 offen offset:0 sc1
    buffer_load_dwordx4 a[204:207], v1, s[4:7], s21 offen offset:1024 sc1
    buffer_load_dwordx4 a[208:211], v1, s[4:7], s21 offen offset:2048 sc1
    buffer_load_dwordx4 a[212:215], v1, s[4:7], s21 offen offset:3072 sc1
    s_cmp_eq_u32 s61, 1
    s_cbranch_scc1 L_iwsk_160
    s_mov_b32 s32, 400000
    s_mov_b32 s26, 126894112
    s_mov_b32 exec_lo, 0x7f
    s_mov_b32 exec_hi, 0
L_iw_161:
    buffer_load_dword v44, v45, s[4:7], s26 offen sc1
    s_waitcnt vmcnt(0)
    v_cmp_eq_u32 vcc, 0, v44
    s_nop 3
    s_cbranch_vccz L_iwok_159
    s_sleep 1
    s_sub_u32 s32, s32, 1
    s_cmp_lg_u32 s32, 0
    s_cbranch_scc1 L_iw_161
    s_branch L_fail
L_iwok_159:
    s_mov_b64 exec, -1
L_iwsk_160:
    s_add_u32 s21, s20, 4096
    buffer_load_dwordx4 v[136:139], v1, s[4:7], s21 offen offset:0 sc1
    buffer_load_dwordx4 v[140:143], v1, s[4:7], s21 offen offset:1024 sc1
    buffer_load_dwordx4 v[144:147], v1, s[4:7], s21 offen offset:2048 sc1
    buffer_load_dwordx4 v[148:151], v1, s[4:7], s21 offen offset:3072 sc1
    s_add_u32 s21, s20, 18432
    buffer_load_dwordx4 v[192:195], v1, s[4:7], s21 offen offset:0 sc1
    buffer_load_dwordx4 v[196:199], v1, s[4:7], s21 offen offset:1024 sc1
    buffer_load_dwordx4 v[200:203], v1, s[4:7], s21 offen offset:2048 sc1
    buffer_load_dwordx4 v[204:207], v1, s[4:7], s21 offen offset:3072 sc1
    s_add_u32 s21, s20, 32768
    buffer_load_dwordx4 v[248:251], v1, s[4:7], s21 offen offset:0 sc1
    buffer_load_dwordx4 v[252:255], v1, s[4:7], s21 offen offset:1024 sc1
    buffer_load_dwordx4 a[0:3], v1, s[4:7], s21 offen offset:2048 sc1
    buffer_load_dwordx4 a[4:7], v1, s[4:7], s21 offen offset:3072 sc1
    s_add_u32 s21, s20, 47104
    buffer_load_dwordx4 a[48:51], v1, s[4:7], s21 offen offset:0 sc1
    buffer_load_dwordx4 a[52:55], v1, s[4:7], s21 offen offset:1024 sc1
    buffer_load_dwordx4 a[56:59], v1, s[4:7], s21 offen offset:2048 sc1
    buffer_load_dwordx4 a[60:63], v1, s[4:7], s21 offen offset:3072 sc1
    s_add_u32 s21, s20, 61440
    buffer_load_dwordx4 a[104:107], v1, s[4:7], s21 offen offset:0 sc1
    buffer_load_dwordx4 a[108:111], v1, s[4:7], s21 offen offset:1024 sc1
    buffer_load_dwordx4 a[112:115], v1, s[4:7], s21 offen offset:2048 sc1
    buffer_load_dwordx4 a[116:119], v1, s[4:7], s21 offen offset:3072 sc1
    s_add_u32 s21, s20, 75776
    buffer_load_dwordx4 a[160:163], v1, s[4:7], s21 offen offset:0 sc1
    buffer_load_dwordx4 a[164:167], v1, s[4:7], s21 offen offset:1024 sc1
    buffer_load_dwordx4 a[168:171], v1, s[4:7], s21 offen offset:2048 sc1
    buffer_load_dwordx4 a[172:175], v1, s[4:7], s21 offen offset:3072 sc1
    s_add_u32 s21, s20, 90112
    buffer_load_dwordx4 a[216:219], v1, s[4:7], s21 offen offset:0 sc1
    buffer_load_dwordx4 a[220:223], v1, s[4:7], s21 offen offset:1024 sc1
    buffer_load_dwordx4 a[224:227], v1, s[4:7], s21 offen offset:2048 sc1
    buffer_load_dwordx4 a[228:231], v1, s[4:7], s21 offen offset:3072 sc1
    s_cmp_eq_u32 s61, 1
    s_cbranch_scc1 L_iwsk_163
    s_mov_b32 s32, 400000
    s_mov_b32 s26, 126894144
    s_mov_b32 exec_lo, 0x7f
    s_mov_b32 exec_hi, 0
L_iw_164:
    buffer_load_dword v44, v45, s[4:7], s26 offen sc1
    s_waitcnt vmcnt(0)
    v_cmp_eq_u32 vcc, 0, v44
    s_nop 3
    s_cbranch_vccz L_iwok_162
    s_sleep 1
    s_sub_u32 s32, s32, 1
    s_cmp_lg_u32 s32, 0
    s_cbranch_scc1 L_iw_164
    s_branch L_fail
L_iwok_162:
    s_mov_b64 exec, -1
L_iwsk_163:
    s_waitcnt vmcnt(28)
    s_add_u32 s21, s20, 8192
    buffer_load_dwordx4 v[152:155], v1, s[4:7], s21 offen offset:0 sc1
    buffer_load_dwordx4 v[156:159], v1, s[4:7], s21 offen offset:1024 sc1
    buffer_load_dwordx4 v[160:163], v1, s[4:7], s21 offen offset:2048 sc1
    buffer_load_dwordx4 v[164:167], v1, s[4:7], s21 offen offset:3072 sc1
    s_add_u32 s21, s20, 22528
    buffer_load_dwordx4 v[208:211], v1, s[4:7], s21 offen offset:0 sc1
    buffer_load_dwordx4 v[212:215], v1, s[4:7], s21 offen offset:1024 sc1
    buffer_load_dwordx4 v[216:219], v1, s[4:7], s21 offen offset:2048 sc1
    buffer_load_dwordx4 v[220:223], v1, s[4:7], s21 offen offset:3072 sc1
    s_add_u32 s21, s20, 36864
    buffer_load_dwordx4 a[8:11], v1, s[4:7], s21 offen offset:0 sc1
    buffer_load_dwordx4 a[12:15], v1, s[4:7], s21 offen offset:1024 sc1
    buffer_load_dwordx4 a[16:19], v1, s[4:7], s21 offen offset:2048 sc1
    buffer_load_dwordx4 a[20:23], v1, s[4:7], s21 offen offset:3072 sc1
    s_add_u32 s21, s20, 51200
    buffer_load_dwordx4 a[64:67], v1, s[4:7], s21 offen offset:0 sc1
    buffer_load_dwordx4 a[68:71], v1, s[4:7], s21 offen offset:1024 sc1
    buffer_load_dwordx4 a[72:75], v1, s[4:7], s21 offen offset:2048 sc1
    buffer_load_dwordx4 a[76:79], v1, s[4:7], s21 offen offset:3072 sc1
    s_add_u32 s21, s20, 65536
    buffer_load_dwordx4 a[120:123], v1, s[4:7], s21 offen offset:0 sc1
    buffer_load_dwordx4 a[124:127], v1, s[4:7], s21 offen offset:1024 sc1
    buffer_load_dwordx4 a[128:131], v1, s[4:7], s21 offen offset:2048 sc1
    buffer_load_dwordx4 a[132:135], v1, s[4:7], s21 offen offset:3072 sc1
    s_add_u32 s21, s20, 79872
    buffer_load_dwordx4 a[176:179], v1, s[4:7], s21 offen offset:0 sc1
    buffer_load_dwordx4 a[180:183], v1, s[4:7], s21 offen offset:1024 sc1
    buffer_load_dwordx4 a[184:187], v1, s[4:7], s21 offen offset:2048 sc1
    buffer_load_dwordx4 a[188:191], v1, s[4:7], s21 offen offset:3072 sc1
    s_add_u32 s21, s20, 94208
    buffer_load_dwordx4 a[232:235], v1, s[4:7], s21 offen offset:0 sc1
    buffer_load_dwordx4 a[236:239], v1, s[4:7], s21 offen offset:1024 sc1
    buffer_load_dwordx4 a[240:243], v1, s[4:7], s21 offen offset:2048 sc1
    buffer_load_dwordx4 a[244:247], v1, s[4:7], s21 offen offset:3072 sc1
    s_cmp_eq_u32 s61, 1
    s_cbranch_scc1 L_iwsk_166
    s_mov_b32 s32, 400000
    s_mov_b32 s26, 126894176
    s_mov_b32 exec_lo, 0x7f
    s_mov_b32 exec_hi, 0
L_iw_167:
    buffer_load_dword v44, v45, s[4:7], s26 offen sc1
    s_waitcnt vmcnt(0)
    v_cmp_eq_u32 vcc, 0, v44
    s_nop 3
    s_cbranch_vccz L_iwok_165
    s_sleep 1
    s_sub_u32 s32, s32, 1
    s_cmp_lg_u32 s32, 0
    s_cbranch_scc1 L_iw_167
    s_branch L_fail
L_iwok_165:
    s_mov_b64 exec, -1
L_iwsk_166:
    s_waitcnt vmcnt(28)
    v_mov_b32 v47, 32
    global_load_dword v46, v47, s[36:37] sc1
    s_add_u32 s21, s20, 12288
    buffer_load_dwordx4 v[168:171], v1, s[4:7], s21 offen offset:0 sc1
    buffer_load_dwordx4 v[172:175], v1, s[4:7], s21 offen offset:1024 sc1
    s_add_u32 s21, s20, 26624
    buffer_load_dwordx4 v[224:227], v1, s[4:7], s21 offen offset:0 sc1
    buffer_load_dwordx4 v[228:231], v1, s[4:7], s21 offen offset:1024 sc1
    s_add_u32 s21, s20, 40960
    buffer_load_dwordx4 a[24:27], v1, s[4:7], s21 offen offset:0 sc1
    buffer_load_dwordx4 a[28:31], v1, s[4:7], s21 offen offset:1024 sc1
    s_add_u32 s21, s20, 55296
    buffer_load_dwordx4 a[80:83], v1, s[4:7], s21 offen offset:0 sc1
    buffer_load_dwordx4 a[84:87], v1, s[4:7], s21 offen offset:1024 sc1
    s_add_u32 s21, s20, 69632
    buffer_load_dwordx4 a[136:139], v1, s[4:7], s21 offen offset:0 sc1
    buffer_load_dwordx4 a[140:143], v1, s[4:7], s21 offen offset:1024 sc1
    s_add_u32 s21, s20, 83968
    buffer_load_dwordx4 a[192:195], v1, s[4:7], s21 offen offset:0 sc1
    buffer_load_dwordx4 a[196:199], v1, s[4:7], s21 offen offset:1024 sc1
    s_add_u32 s21, s20, 98304
    buffer_load_dwordx4 a[248:251], v1, s[4:7], s21 offen offset:0 sc1
    buffer_load_dwordx4 a[252:255], v1, s[4:7], s21 offen offset:1024 sc1
    s_waitcnt vmcnt(0)
    s_mov_b32 s16, 2
    v_readfirstlane_b32 s59, v46
    s_cmp_ge_u32 s59, 256
    s_nop 2
    s_cbranch_scc1 L_iok_168
    s_mov_b32 s32, 400000
    v_mbcnt_lo_u32_b32 v45, -1, 0
    v_add_u32 v45, 8, v45
    v_lshlrev_b32 v45, 2, v45
    s_mov_b64 exec, 1
    s_nop 0
L_dw_169:
    global_load_dword v44, v45, s[36:37] sc1
    s_waitcnt vmcnt(0)
    v_cmp_gt_u32 vcc, 256, v44
    s_nop 3
    s_cbranch_vccz L_dwok_170
    s_sleep 1
    s_sub_u32 s32, s32, 1
    s_cmp_lg_u32 s32, 0
    s_cbranch_scc1 L_dw_169
    s_branch L_fail
L_dwok_170:
    s_mov_b64 exec, -1
L_iok_168:
    v_and_b32 v8, 63, v0
    v_and_b32 v9, 15, v8
    v_lshrrev_b32 v10, 4, v8
    v_mul_u32_u24 v2, 928, v9
    v_lshl_add_u32 v2, v10, 4, v2
    v_add_u32 v2, 0, v2
    v_add_u32 v3, 14848, v2
    v_and_b32 v8, 63, v0
    v_lshlrev_b32 v4, 4, v8
    v_mov_b32 v5, 0
    v_mov_b32 v7, 0
    v_lshrrev_b32 v9, 5, v8
    s_lshl_b32 s18, s38, 1
    s_add_u32 s18, s18, 1
    v_add_u32 v9, s18, v9
    v_mul_u32_u24 v6, 7168, v9
    v_and_b32 v9, 15, v8
    v_lshl_add_u32 v6, v9, 4, v6
    v_bfe_u32 v9, v8, 4, 1
    v_lshl_add_u32 v6, v9, 3, v6
    s_mul_i32 s18, s12, 35840
    s_mul_i32 s19, s15, 1792
    s_add_u32 s18, s18, s19
    v_add_u32 v6, s18, v6
    s_cmp_eq_u32 s13, 0
    s_mov_b32 s43, 0x1431000
    s_cselect_b32 s43, 0x1260000, s43
    s_cmp_eq_u32 s13, 0
    s_mov_b32 s44, 0x44e4000
    s_cselect_b32 s44, 0x21e4000, s44
    s_mul_i32 s18, s38, 14848
    s_add_u32 s43, s43, s18
    s_cmp_eq_u32 s13, 0
    s_mov_b32 s45, 0x78fe000
    s_cselect_b32 s45, 0x78ee000, s45
    s_lshl_b32 s18, s38, 2
    s_add_u32 s45, s45, s18
    s_cmp_eq_u32 s13, 0
    s_mov_b32 s46, 0x78f4000
    s_cselect_b32 s46, 0x78e4000, s46
    s_lshl_b32 s49, s38, 4
    s_add_u32 s49, s49, s12
    s_mov_b32 s47, 0
    s_mov_b32 s48, 0
    s_mov_b32 s16, 0
L_ZG_loop:
    s_cmp_eq_u32 s48, 1
    s_cbranch_scc1 L_Zrdy_171
    s_cmp_eq_u32 s13, 0
    s_cbranch_scc1 L_Znf_172
    s_mov_b32 s32, 400000
    v_mbcnt_lo_u32_b32 v9, -1, 0
    v_lshlrev_b32 v9, 2, v9
    s_mov_b32 exec_lo, 0x1
    s_mov_b32 exec_hi, 0
L_wf_173:
    buffer_load_dword v8, v9, s[4:7], s45 offen sc1
    s_waitcnt vmcnt(0)
    v_cmp_eq_u32 vcc, 0, v8
    s_nop 3
    s_cbranch_vccz L_wfok_174
    s_sleep 1
    s_sub_u32 s32, s32, 1
    s_cmp_lg_u32 s32, 0
    s_cbranch_scc1 L_wf_173
    s_branch L_fail
L_wfok_174:
    s_mov_b64 exec, -1
L_Znf_172:
    s_lshl_b32 s18, s15, 12
    s_min_u32 s18, s18, 11264
    s_add_u32 s41, s43, s18
    s_mov_b32 s42, s47
    s_add_u32 s42, s42, s18
    s_mov_b32 m0, s42
    s_nop 0
    buffer_load_dwordx4 v4, s[4:7], s41 offen offset:0 sc1 lds
    buffer_load_dwordx4 v4, s[4:7], s41 offen offset:1024 sc1 lds
    buffer_load_dwordx4 v4, s[4:7], s41 offen offset:2048 sc1 lds
    s_cmp_eq_u32 s15, 3
    s_cselect_b32 exec_hi, 0, -1
    buffer_load_dwordx4 v4, s[4:7], s41 offen offset:3072 sc1 lds
    s_mov_b32 exec_hi, -1
L_Zrdy_171:
    s_add_u32 s40, s45, 128
    v_mbcnt_lo_u32_b32 v8, -1, 0
    v_lshlrev_b32 v8, 2, v8
    s_mov_b32 exec_lo, -1
    s_mov_b32 exec_hi, 0
    buffer_load_dword v7, v8, s[4:7], s40 offen sc1
    s_mov_b64 exec, -1
    s_waitcnt vmcnt(1)
    s_barrier
    v_add_u32 v10, s47, v2
    ds_read_b128 v[48:51], v10 offset:0
    ds_read_b128 v[56:59], v10 offset:64
    s_waitcnt lgkmcnt(1)
    v_mfma_f32_16x16x32_bf16 v[64:67], v[48:51], v[120:123], 0
    v_mfma_f32_16x16x32_bf16 v[72:75], v[48:51], v[176:179], 0
    v_mfma_f32_16x16x32_bf16 v[80:83], v[48:51], v[232:235], 0
    v_mfma_f32_16x16x32_bf16 v[88:91], v[48:51], a[32:35], 0
    v_mfma_f32_16x16x32_bf16 v[96:99], v[48:51], a[88:91], 0
    v_mfma_f32_16x16x32_bf16 v[104:107], v[48:51], a[144:147], 0
    v_mfma_f32_16x16x32_bf16 v[112:115], v[48:51], a[200:203], 0
    ds_read_b128 v[48:51], v10 offset:128
    s_waitcnt lgkmcnt(1)
    v_mfma_f32_16x16x32_bf16 v[64:67], v[56:59], v[124:127], v[64:67]
    v_mfma_f32_16x16x32_bf16 v[72:75], v[56:59], v[180:183], v[72:75]
    v_mfma_f32_16x16x32_bf16 v[80:83], v[56:59], v[236:239], v[80:83]
    v_mfma_f32_16x16x32_bf16 v[88:91], v[56:59], a[36:39], v[88:91]
    v_mfma_f32_16x16x32_bf16 v[96:99], v[56:59], a[92:95], v[96:99]
    v_mfma_f32_16x16x32_bf16 v[104:107], v[56:59], a[148:151], v[104:107]
    v_mfma_f32_16x16x32_bf16 v[112:115], v[56:59], a[204:207], v[112:115]
    ds_read_b128 v[56:59], v10 offset:192
    s_waitcnt lgkmcnt(1)
    v_mfma_f32_16x16x32_bf16 v[64:67], v[48:51], v[128:131], v[64:67]
    v_mfma_f32_16x16x32_bf16 v[72:75], v[48:51], v[184:187], v[72:75]
    v_mfma_f32_16x16x32_bf16 v[80:83], v[48:51], v[240:243], v[80:83]
    v_mfma_f32_16x16x32_bf16 v[88:91], v[48:51], a[40:43], v[88:91]
    v_mfma_f32_16x16x32_bf16 v[96:99], v[48:51], a[96:99], v[96:99]
    v_mfma_f32_16x16x32_bf16 v[104:107], v[48:51], a[152:155], v[104:107]
    v_mfma_f32_16x16x32_bf16 v[112:115], v[48:51], a[208:211], v[112:115]
    ds_read_b128 v[48:51], v10 offset:256
    s_waitcnt lgkmcnt(1)
    v_mfma_f32_16x16x32_bf16 v[64:67], v[56:59], v[132:135], v[64:67]
    v_mfma_f32_16x16x32_bf16 v[72:75], v[56:59], v[188:191], v[72:75]
    v_mfma_f32_16x16x32_bf16 v[80:83], v[56:59], v[244:247], v[80:83]
    v_mfma_f32_16x16x32_bf16 v[88:91], v[56:59], a[44:47], v[88:91]
    v_mfma_f32_16x16x32_bf16 v[96:99], v[56:59], a[100:103], v[96:99]
    v_mfma_f32_16x16x32_bf16 v[104:107], v[56:59], a[156:159], v[104:107]
    v_mfma_f32_16x16x32_bf16 v[112:115], v[56:59], a[212:215], v[112:115]
    ds_read_b128 v[56:59], v10 offset:320
    s_waitcnt lgkmcnt(1)
    v_mfma_f32_16x16x32_bf16 v[64:67], v[48:51], v[136:139], v[64:67]
    v_mfma_f32_16x16x32_bf16 v[72:75], v[48:51], v[192:195], v[72:75]
    v_mfma_f32_16x16x32_bf16 v[80:83], v[48:51], v[248:251], v[80:83]
    v_mfma_f32_16x16x32_bf16 v[88:91], v[48:51], a[48:51], v[88:91]
    v_mfma_f32_16x16x32_bf16 v[96:99], v[48:51], a[104:107], v[96:99]
    v_mfma_f32_16x16x32_bf16 v[104:107], v[48:51], a[160:163], v[104:107]
    v_mfma_f32_16x16x32_bf16 v[112:115], v[48:51], a[216:219], v[112:115]
    ds_read_b128 v[48:51], v10 offset:384
    s_waitcnt lgkmcnt(1)
    v_mfma_f32_16x16x32_bf16 v[64:67], v[56:59], v[140:143], v[64:67]
    v_mfma_f32_16x16x32_bf16 v[72:75], v[56:59], v[196:199], v[72:75]
    v_mfma_f32_16x16x32_bf16 v[80:83], v[56:59], v[252:255], v[80:83]
    v_mfma_f32_16x16x32_bf16 v[88:91], v[56:59], a[52:55], v[88:91]
    v_mfma_f32_16x16x32_bf16 v[96:99], v[56:59], a[108:111], v[96:99]
    v_mfma_f32_16x16x32_bf16 v[104:107], v[56:59], a[164:167], v[104:107]
    v_mfma_f32_16x16x32_bf16 v[112:115], v[56:59], a[220:223], v[112:115]
    ds_read_b128 v[56:59], v10 offset:448
    s_waitcnt lgkmcnt(1)
    v_mfma_f32_16x16x32_bf16 v[64:67], v[48:51], v[144:147], v[64:67]
    v_mfma_f32_16x16x32_bf16 v[72:75], v[48:51], v[200:203], v[72:75]
    v_mfma_f32_16x16x32_bf16 v[80:83], v[48:51], a[0:3], v[80:83]
    v_mfma_f32_16x16x32_bf16 v[88:91], v[48:51], a[56:59], v[88:91]
    v_mfma_f32_16x16x32_bf16 v[96:99], v[48:51], a[112:115], v[96:99]
    v_mfma_f32_16x16x32_bf16 v[104:107], v[48:51], a[168:171], v[104:107]
    v_mfma_f32_16x16x32_bf16 v[112:115], v[48:51], a[224:227], v[112:115]
    ds_read_b128 v[48:51], v10 offset:512
    s_waitcnt lgkmcnt(1)
    v_mfma_f32_16x16x32_bf16 v[64:67], v[56:59], v[148:151], v[64:67]
    v_mfma_f32_16x16x32_bf16 v[72:75], v[56:59], v[204:207], v[72:75]
    v_mfma_f32_16x16x32_bf16 v[80:83], v[56:59], a[4:7], v[80:83]
    v_mfma_f32_16x16x32_bf16 v[88:91], v[56:59], a[60:63], v[88:91]
    v_mfma_f32_16x16x32_bf16 v[96:99], v[56:59], a[116:119], v[96:99]
    v_mfma_f32_16x16x32_bf16 v[104:107], v[56:59], a[172:175], v[104:107]
    v_mfma_f32_16x16x32_bf16 v[112:115], v[56:59], a[228:231], v[112:115]
    ds_read_b128 v[56:59], v10 offset:576
    s_waitcnt lgkmcnt(1)
    v_mfma_f32_16x16x32_bf16 v[64:67], v[48:51], v[152:155], v[64:67]
    v_mfma_f32_16x16x32_bf16 v[72:75], v[48:51], v[208:211], v[72:75]
    v_mfma_f32_16x16x32_bf16 v[80:83], v[48:51], a[8:11], v[80:83]
    v_mfma_f32_16x16x32_bf16 v[88:91], v[48:51], a[64:67], v[88:91]
    v_mfma_f32_16x16x32_bf16 v[96:99], v[48:51], a[120:123], v[96:99]
    v_mfma_f32_16x16x32_bf16 v[104:107], v[48:51], a[176:179], v[104:107]
    v_mfma_f32_16x16x32_bf16 v[112:115], v[48:51], a[232:235], v[112:115]
    ds_read_b128 v[48:51], v10 offset:640
    s_waitcnt lgkmcnt(1)
    v_mfma_f32_16x16x32_bf16 v[64:67], v[56:59], v[156:159], v[64:67]
    v_mfma_f32_16x16x32_bf16 v[72:75], v[56:59], v[212:215], v[72:75]
    v_mfma_f32_16x16x32_bf16 v[80:83], v[56:59], a[12:15], v[80:83]
    v_mfma_f32_16x16x32_bf16 v[88:91], v[56:59], a[68:71], v[88:91]
    v_mfma_f32_16x16x32_bf16 v[96:99], v[56:59], a[124:127], v[96:99]
    v_mfma_f32_16x16x32_bf16 v[104:107], v[56:59], a[180:183], v[104:107]
    v_mfma_f32_16x16x32_bf16 v[112:115], v[56:59], a[236:239], v[112:115]
    ds_read_b128 v[56:59], v10 offset:704
    s_waitcnt lgkmcnt(1)
    v_mfma_f32_16x16x32_bf16 v[64:67], v[48:51], v[160:163], v[64:67]
    v_mfma_f32_16x16x32_bf16 v[72:75], v[48:51], v[216:219], v[72:75]
    v_mfma_f32_16x16x32_bf16 v[80:83], v[48:51], a[16:19], v[80:83]
    v_mfma_f32_16x16x32_bf16 v[88:91], v[48:51], a[72:75], v[88:91]
    v_mfma_f32_16x16x32_bf16 v[96:99], v[48:51], a[128:131], v[96:99]
    v_mfma_f32_16x16x32_bf16 v[104:107], v[48:51], a[184:187], v[104:107]
    v_mfma_f32_16x16x32_bf16 v[112:115], v[48:51], a[240:243], v[112:115]
    ds_read_b128 v[48:51], v10 offset:768
    s_waitcnt lgkmcnt(1)
    v_mfma_f32_16x16x32_bf16 v[64:67], v[56:59], v[164:167], v[64:67]
    v_mfma_f32_16x16x32_bf16 v[72:75], v[56:59], v[220:223], v[72:75]
    v_mfma_f32_16x16x32_bf16 v[80:83], v[56:59], a[20:23], v[80:83]
    v_mfma_f32_16x16x32_bf16 v[88:91], v[56:59], a[76:79], v[88:91]
    v_mfma_f32_16x16x32_bf16 v[96:99], v[56:59], a[132:135], v[96:99]
    v_mfma_f32_16x16x32_bf16 v[104:107], v[56:59], a[188:191], v[104:107]
    v_mfma_f32_16x16x32_bf16 v[112:115], v[56:59], a[244:247], v[112:115]
    ds_read_b128 v[56:59], v10 offset:832
    s_waitcnt lgkmcnt(1)
    v_mfma_f32_16x16x32_bf16 v[64:67], v[48:51], v[168:171], v[64:67]
    v_mfma_f32_16x16x32_bf16 v[72:75], v[48:51], v[224:227], v[72:75]
    v_mfma_f32_16x16x32_bf16 v[80:83], v[48:51], a[24:27], v[80:83]
    v_mfma_f32_16x16x32_bf16 v[88:91], v[48:51], a[80:83], v[88:91]
    v_mfma_f32_16x16x32_bf16 v[96:99], v[48:51], a[136:139], v[96:99]
    v_mfma_f32_16x16x32_bf16 v[104:107], v[48:51], a[192:195], v[104:107]
    v_mfma_f32_16x16x32_bf16 v[112:115], v[48:51], a[248:251], v[112:115]
    s_waitcnt lgkmcnt(0)
    v_mfma_f32_16x16x32_bf16 v[64:67], v[56:59], v[172:175], v[64:67]
    v_mfma_f32_16x16x32_bf16 v[72:75], v[56:59], v[228:231], v[72:75]
    v_mfma_f32_16x16x32_bf16 v[80:83], v[56:59], a[28:31], v[80:83]
    v_mfma_f32_16x16x32_bf16 v[88:91], v[56:59], a[84:87], v[88:91]
    v_mfma_f32_16x16x32_bf16 v[96:99], v[56:59], a[140:143], v[96:99]
    v_mfma_f32_16x16x32_bf16 v[104:107], v[56:59], a[196:199], v[104:107]
    v_mfma_f32_16x16x32_bf16 v[112:115], v[56:59], a[252:255], v[112:115]
    s_nop 1
    v_cvt_pk_bf16_f32 v64, v64, v65
    v_cvt_pk_bf16_f32 v65, v66, v67
    buffer_store_dwordx2 v[64:65], v6, s[4:7], s44 offen offset:0 sc1
    v_cvt_pk_bf16_f32 v72, v72, v73
    v_cvt_pk_bf16_f32 v73, v74, v75
    buffer_store_dwordx2 v[72:73], v6, s[4:7], s44 offen offset:256 sc1
    v_cvt_pk_bf16_f32 v80, v80, v81
    v_cvt_pk_bf16_f32 v81, v82, v83
    buffer_store_dwordx2 v[80:81], v6, s[4:7], s44 offen offset:512 sc1
    v_cvt_pk_bf16_f32 v88, v88, v89
    v_cvt_pk_bf16_f32 v89, v90, v91
    buffer_store_dwordx2 v[88:89], v6, s[4:7], s44 offen offset:768 sc1
    v_cvt_pk_bf16_f32 v96, v96, v97
    v_cvt_pk_bf16_f32 v97, v98, v99
    buffer_store_dwordx2 v[96:97], v6, s[4:7], s44 offen offset:1024 sc1
    v_cvt_pk_bf16_f32 v104, v104, v105
    v_cvt_pk_bf16_f32 v105, v106, v107
    buffer_store_dwordx2 v[104:105], v6, s[4:7], s44 offen offset:1280 sc1
    v_cvt_pk_bf16_f32 v112, v112, v113
    v_cvt_pk_bf16_f32 v113, v114, v115
    buffer_store_dwordx2 v[112:113], v6, s[4:7], s44 offen offset:1536 sc1
    s_mov_b32 s48, 0
    s_cmp_ge_u32 s16, 63
    s_cbranch_scc1 L_Znp_176
    s_cmp_eq_u32 s13, 0
    s_cbranch_scc1 L_Zpf_178
    s_waitcnt vmcnt(7)
    s_mov_b32 exec_lo, 0x1
    s_mov_b32 exec_hi, 0
    v_cmp_eq_u32 vcc, 0, v7
    s_mov_b64 exec, -1
    s_nop 2
    s_cbranch_vccz L_Zpf_178
    s_branch L_Znp_176
L_Zpf_178:
    s_lshl_b32 s18, s15, 12
    s_min_u32 s18, s18, 11264
    s_add_u32 s41, s43, s18
    s_add_u32 s41, s41, 29696
    s_xor_b32 s42, s47, 15360
    s_add_u32 s42, s42, s18
    s_mov_b32 m0, s42
    s_nop 0
    buffer_load_dwordx4 v4, s[4:7], s41 offen offset:0 sc1 lds
    buffer_load_dwordx4 v4, s[4:7], s41 offen offset:1024 sc1 lds
    buffer_load_dwordx4 v4, s[4:7], s41 offen offset:2048 sc1 lds
    s_cmp_eq_u32 s15, 3
    s_cselect_b32 exec_hi, 0, -1
    buffer_load_dwordx4 v4, s[4:7], s41 offen offset:3072 sc1 lds
    s_mov_b32 exec_hi, -1
    s_mov_b32 s48, 1
    s_waitcnt vmcnt(4)
    s_branch L_Zsg_177
L_Znp_176:
    s_waitcnt vmcnt(0)
L_Zsg_177:
    s_barrier
    s_cmp_lg_u32 s15, 0
    s_cbranch_scc1 L_Zx_179
    v_mov_b32 v8, 1
    s_lshl_b32 s18, s49, 2
    v_mov_b32 v9, s18
    s_mov_b64 exec, 1
    buffer_store_dword v8, v9, s[4:7], s46 offen sc1
    s_mov_b64 exec, -1
L_Zx_179:
    s_add_u32 s43, s43, 29696
    s_add_u32 s44, s44, 573440
    s_add_u32 s45, s45, 128
    s_add_u32 s46, s46, 128
    s_xor_b32 s47, s47, 15360
    s_add_u32 s16, s16, 1
    s_cmp_lt_u32 s16, 64
    s_cbranch_scc1 L_ZG_loop
    s_branch L_role_done
L_bl:
    s_lshr_b32 s13, s18, 5
    s_sub_u32 s13, s13, 6
    s_and_b32 s19, s18, 31
    s_cmp_ge_u32 s19, 14
    s_cbranch_scc1 L_nCB
    s_cmp_ge_u32 s19, 7
    s_cselect_b32 s38, 1, 0
    s_mul_i32 s20, s38, 7
    s_sub_u32 s12, s19, s20
    s_mov_b32 s40, s93
    s_cmp_ge_u32 s40, 160
    s_cbranch_scc1 M_end_180
    v_lshlrev_b32 v6, 4, v0
    v_mov_b32 v8, -1
    v_mov_b32 v12, 0
    v_mov_b32 v9, -1
    v_mov_b32 v13, 0
    v_mov_b32 v10, -1
    v_mov_b32 v14, 0
    v_mov_b32 v11, -1
    v_mov_b32 v15, 0
    s_lshl_b32 s42, s40, 12
    s_add_u32 s42, s42, 126763008
    s_mov_b32 s46, 126894080
    s_mov_b32 s44, s4
    s_mov_b32 s45, s5
    s_mov_b32 s47, 0x00020000
    buffer_store_dwordx4 v[12:15], v6, s[44:47], s42 offen sc1
    s_lshl_b32 s42, s40, 12
    s_add_u32 s42, s42, 32398336
    s_mov_b32 s46, 32849920
    s_mov_b32 s44, s4
    s_mov_b32 s45, s5
    s_mov_b32 s47, 0x00020000
    buffer_store_dwordx4 v[8:11], v6, s[44:47], s42 offen sc1
    s_lshl_b32 s42, s40, 12
    s_add_u32 s42, s42, 33315840
    s_mov_b32 s46, 33767424
    s_mov_b32 s44, s4
    s_mov_b32 s45, s5
    s_mov_b32 s47, 0x00020000
    buffer_store_dwordx4 v[8:11], v6, s[44:47], s42 offen sc1
    s_lshl_b32 s42, s40, 12
    s_add_u32 s42, s42, 34226176
    s_mov_b32 s46, 34881536
    s_mov_b32 s44, s4
    s_mov_b32 s45, s5
    s_mov_b32 s47, 0x00020000
    buffer_store_dwordx4 v[8:11], v6, s[44:47], s42 offen sc1
    s_lshl_b32 s42, s40, 12
    s_add_u32 s42, s42, 32857088
    s_mov_b32 s46, 33308672
    s_mov_b32 s44, s4
    s_mov_b32 s45, s5
    s_mov_b32 s47, 0x00020000
    buffer_store_dwordx4 v[8:11], v6, s[44:47], s42 offen sc1
    s_lshl_b32 s42, s40, 12
    s_add_u32 s42, s42, 33774592
    s_mov_b32 s46, 34226176
    s_mov_b32 s44, s4
    s_mov_b32 s45, s5
    s_mov_b32 s47, 0x00020000
    buffer_store_dwordx4 v[8:11], v6, s[44:47], s42 offen sc1
    s_lshl_b32 s42, s40, 12
    s_add_u32 s42, s42, 34881536
    s_mov_b32 s46, 35536896
    s_mov_b32 s44, s4
    s_mov_b32 s45, s5
    s_mov_b32 s47, 0x00020000
    buffer_store_dwordx4 v[8:11], v6, s[44:47], s42 offen sc1
    s_cmp_ge_u32 s40, 32
    s_cbranch_scc1 M_end_180
    s_load_dwordx2 s[8:9], s[34:35], 0
    s_waitcnt lgkmcnt(0)
    s_mov_b32 s10, 1835008
    s_mov_b32 s11, 0x00020000
    v_lshrrev_b32 v4, 3, v0
    v_and_b32 v5, 7, v0
    v_mul_u32_u24 v2, 896, v4
    v_lshl_add_u32 v2, v5, 4, v2
    v_mul_u32_u24 v3, 928, v4
    v_lshl_add_u32 v3, v5, 4, v3
    s_add_u32 s41, s40, 32
    s_mul_i32 s42, s41, 28672
    buffer_load_dwordx4 v[16:19], v2, s[8:11], s42 offen offset:0
    buffer_load_dwordx4 v[20:23], v2, s[8:11], s42 offen offset:128
    buffer_load_dwordx4 v[24:27], v2, s[8:11], s42 offen offset:256
    buffer_load_dwordx4 v[28:31], v2, s[8:11], s42 offen offset:384
    buffer_load_dwordx4 v[32:35], v2, s[8:11], s42 offen offset:512
    buffer_load_dwordx4 v[36:39], v2, s[8:11], s42 offen offset:640
    buffer_load_dwordx4 v[40:43], v2, s[8:11], s42 offen offset:768
    s_waitcnt vmcnt(0)
    v_lshlrev_b32 v48, 16, v16
    v_and_b32 v49, 0xffff0000, v16
    v_lshlrev_b32 v50, 16, v17
    v_and_b32 v51, 0xffff0000, v17
    v_lshlrev_b32 v52, 16, v18
    v_and_b32 v53, 0xffff0000, v18
    v_lshlrev_b32 v54, 16, v19
    v_and_b32 v55, 0xffff0000, v19
    v_lshlrev_b32 v56, 16, v20
    v_and_b32 v57, 0xffff0000, v20
    v_lshlrev_b32 v58, 16, v21
    v_and_b32 v59, 0xffff0000, v21
    v_lshlrev_b32 v60, 16, v22
    v_and_b32 v61, 0xffff0000, v22
    v_lshlrev_b32 v62, 16, v23
    v_and_b32 v63, 0xffff0000, v23
    v_lshlrev_b32 v64, 16, v24
    v_and_b32 v65, 0xffff0000, v24
    v_lshlrev_b32 v66, 16, v25
    v_and_b32 v67, 0xffff0000, v25
    v_lshlrev_b32 v68, 16, v26
    v_and_b32 v69, 0xffff0000, v26
    v_lshlrev_b32 v70, 16, v27
    v_and_b32 v71, 0xffff0000, v27
    v_lshlrev_b32 v72, 16, v28
    v_and_b32 v73, 0xffff0000, v28
    v_lshlrev_b32 v74, 16, v29
    v_and_b32 v75, 0xffff0000, v29
    v_lshlrev_b32 v76, 16, v30
    v_and_b32 v77, 0xffff0000, v30
    v_lshlrev_b32 v78, 16, v31
    v_and_b32 v79, 0xffff0000, v31
    v_lshlrev_b32 v80, 16, v32
    v_and_b32 v81, 0xffff0000, v32
    v_lshlrev_b32 v82, 16, v33
    v_and_b32 v83, 0xffff0000, v33
    v_lshlrev_b32 v84, 16, v34
    v_and_b32 v85, 0xffff0000, v34
    v_lshlrev_b32 v86, 16, v35
    v_and_b32 v87, 0xffff0000, v35
    v_lshlrev_b32 v88, 16, v36
    v_and_b32 v89, 0xffff0000, v36
    v_lshlrev_b32 v90, 16, v37
    v_and_b32 v91, 0xffff0000, v37
    v_lshlrev_b32 v92, 16, v38
    v_and_b32 v93, 0xffff0000, v38
    v_lshlrev_b32 v94, 16, v39
    v_and_b32 v95, 0xffff0000, v39
    v_lshlrev_b32 v96, 16, v40
    v_and_b32 v97, 0xffff0000, v40
    v_lshlrev_b32 v98, 16, v41
    v_and_b32 v99, 0xffff0000, v41
    v_lshlrev_b32 v100, 16, v42
    v_and_b32 v101, 0xffff0000, v42
    v_lshlrev_b32 v102, 16, v43
    v_and_b32 v103, 0xffff0000, v43
    v_pk_add_f32 v[6:7], v[48:49], v[50:51]
    v_pk_add_f32 v[8:9], v[52:53], v[54:55]
    v_pk_add_f32 v[6:7], v[6:7], v[56:57]
    v_pk_add_f32 v[8:9], v[8:9], v[58:59]
    v_pk_add_f32 v[6:7], v[6:7], v[60:61]
    v_pk_add_f32 v[8:9], v[8:9], v[62:63]
    v_pk_add_f32 v[6:7], v[6:7], v[64:65]
    v_pk_add_f32 v[8:9], v[8:9], v[66:67]
    v_pk_add_f32 v[6:7], v[6:7], v[68:69]
    v_pk_add_f32 v[8:9], v[8:9], v[70:71]
    v_pk_add_f32 v[6:7], v[6:7], v[72:73]
    v_pk_add_f32 v[8:9], v[8:9], v[74:75]
    v_pk_add_f32 v[6:7], v[6:7], v[76:77]
    v_pk_add_f32 v[8:9], v[8:9], v[78:79]
    v_pk_add_f32 v[6:7], v[6:7], v[80:81]
    v_pk_add_f32 v[8:9], v[8:9], v[82:83]
    v_pk_add_f32 v[6:7], v[6:7], v[84:85]
    v_pk_add_f32 v[8:9], v[8:9], v[86:87]
    v_pk_add_f32 v[6:7], v[6:7], v[88:89]
    v_pk_add_f32 v[8:9], v[8:9], v[90:91]
    v_pk_add_f32 v[6:7], v[6:7], v[92:93]
    v_pk_add_f32 v[8:9], v[8:9], v[94:95]
    v_pk_add_f32 v[6:7], v[6:7], v[96:97]
    v_pk_add_f32 v[8:9], v[8:9], v[98:99]
    v_pk_add_f32 v[6:7], v[6:7], v[100:101]
    v_pk_add_f32 v[8:9], v[8:9], v[102:103]
    v_pk_add_f32 v[6:7], v[6:7], v[8:9]
    v_add_f32 v4, v6, v7
    s_nop 1
    v_add_f32_dpp v4, v4, v4 quad_perm:[1,0,3,2] row_mask:0xf bank_mask:0xf
    s_nop 1
    v_add_f32_dpp v4, v4, v4 quad_perm:[2,3,0,1] row_mask:0xf bank_mask:0xf
    s_nop 1
    v_add_f32_dpp v4, v4, v4 row_half_mirror row_mask:0xf bank_mask:0xf
    v_mul_f32 v8, 0xbb124925, v4
    v_mov_b32 v9, v8
    v_pk_add_f32 v[48:49], v[48:49], v[8:9]
    v_pk_add_f32 v[50:51], v[50:51], v[8:9]
    v_pk_add_f32 v[52:53], v[52:53], v[8:9]
    v_pk_add_f32 v[54:55], v[54:55], v[8:9]
    v_pk_add_f32 v[56:57], v[56:57], v[8:9]
    v_pk_add_f32 v[58:59], v[58:59], v[8:9]
    v_pk_add_f32 v[60:61], v[60:61], v[8:9]
    v_pk_add_f32 v[62:63], v[62:63], v[8:9]
    v_pk_add_f32 v[64:65], v[64:65], v[8:9]
    v_pk_add_f32 v[66:67], v[66:67], v[8:9]
    v_pk_add_f32 v[68:69], v[68:69], v[8:9]
    v_pk_add_f32 v[70:71], v[70:71], v[8:9]
    v_pk_add_f32 v[72:73], v[72:73], v[8:9]
    v_pk_add_f32 v[74:75], v[74:75], v[8:9]
    v_pk_add_f32 v[76:77], v[76:77], v[8:9]
    v_pk_add_f32 v[78:79], v[78:79], v[8:9]
    v_pk_add_f32 v[80:81], v[80:81], v[8:9]
    v_pk_add_f32 v[82:83], v[82:83], v[8:9]
    v_pk_add_f32 v[84:85], v[84:85], v[8:9]
    v_pk_add_f32 v[86:87], v[86:87], v[8:9]
    v_pk_add_f32 v[88:89], v[88:89], v[8:9]
    v_pk_add_f32 v[90:91], v[90:91], v[8:9]
    v_pk_add_f32 v[92:93], v[92:93], v[8:9]
    v_pk_add_f32 v[94:95], v[94:95], v[8:9]
    v_pk_add_f32 v[96:97], v[96:97], v[8:9]
    v_pk_add_f32 v[98:99], v[98:99], v[8:9]
    v_pk_add_f32 v[100:101], v[100:101], v[8:9]
    v_pk_add_f32 v[102:103], v[102:103], v[8:9]
    v_pk_mul_f32 v[6:7], v[48:49], v[48:49]
    v_pk_mul_f32 v[8:9], v[50:51], v[50:51]
    v_pk_fma_f32 v[6:7], v[52:53], v[52:53], v[6:7]
    v_pk_fma_f32 v[8:9], v[54:55], v[54:55], v[8:9]
    v_pk_fma_f32 v[6:7], v[56:57], v[56:57], v[6:7]
    v_pk_fma_f32 v[8:9], v[58:59], v[58:59], v[8:9]
    v_pk_fma_f32 v[6:7], v[60:61], v[60:61], v[6:7]
    v_pk_fma_f32 v[8:9], v[62:63], v[62:63], v[8:9]
    v_pk_fma_f32 v[6:7], v[64:65], v[64:65], v[6:7]
    v_pk_fma_f32 v[8:9], v[66:67], v[66:67], v[8:9]
    v_pk_fma_f32 v[6:7], v[68:69], v[68:69], v[6:7]
    v_pk_fma_f32 v[8:9], v[70:71], v[70:71], v[8:9]
    v_pk_fma_f32 v[6:7], v[72:73], v[72:73], v[6:7]
    v_pk_fma_f32 v[8:9], v[74:75], v[74:75], v[8:9]
    v_pk_fma_f32 v[6:7], v[76:77], v[76:77], v[6:7]
    v_pk_fma_f32 v[8:9], v[78:79], v[78:79], v[8:9]
    v_pk_fma_f32 v[6:7], v[80:81], v[80:81], v[6:7]
    v_pk_fma_f32 v[8:9], v[82:83], v[82:83], v[8:9]
    v_pk_fma_f32 v[6:7], v[84:85], v[84:85], v[6:7]
    v_pk_fma_f32 v[8:9], v[86:87], v[86:87], v[8:9]
    v_pk_fma_f32 v[6:7], v[88:89], v[88:89], v[6:7]
    v_pk_fma_f32 v[8:9], v[90:91], v[90:91], v[8:9]
    v_pk_fma_f32 v[6:7], v[92:93], v[92:93], v[6:7]
    v_pk_fma_f32 v[8:9], v[94:95], v[94:95], v[8:9]
    v_pk_fma_f32 v[6:7], v[96:97], v[96:97], v[6:7]
    v_pk_fma_f32 v[8:9], v[98:99], v[98:99], v[8:9]
    v_pk_fma_f32 v[6:7], v[100:101], v[100:101], v[6:7]
    v_pk_fma_f32 v[8:9], v[102:103], v[102:103], v[8:9]
    v_pk_add_f32 v[6:7], v[6:7], v[8:9]
    v_add_f32 v4, v6, v7
    s_nop 1
    v_add_f32_dpp v4, v4, v4 quad_perm:[1,0,3,2] row_mask:0xf bank_mask:0xf
    s_nop 1
    v_add_f32_dpp v4, v4, v4 quad_perm:[2,3,0,1] row_mask:0xf bank_mask:0xf
    s_nop 1
    v_add_f32_dpp v4, v4, v4 row_half_mirror row_mask:0xf bank_mask:0xf
    v_mov_b32 v6, 0x3727c5ac
    v_fmac_f32 v6, 0x3b124925, v4
    v_rsq_f32 v6, v6
    s_nop 0
    v_mov_b32 v7, v6
    v_pk_mul_f32 v[48:49], v[48:49], v[6:7]
    v_cvt_pk_bf16_f32 v16, v48, v49
    v_pk_mul_f32 v[50:51], v[50:51], v[6:7]
    v_cvt_pk_bf16_f32 v17, v50, v51
    v_pk_mul_f32 v[52:53], v[52:53], v[6:7]
    v_cvt_pk_bf16_f32 v18, v52, v53
    v_pk_mul_f32 v[54:55], v[54:55], v[6:7]
    v_cvt_pk_bf16_f32 v19, v54, v55
    v_pk_mul_f32 v[56:57], v[56:57], v[6:7]
    v_cvt_pk_bf16_f32 v20, v56, v57
    v_pk_mul_f32 v[58:59], v[58:59], v[6:7]
    v_cvt_pk_bf16_f32 v21, v58, v59
    v_pk_mul_f32 v[60:61], v[60:61], v[6:7]
    v_cvt_pk_bf16_f32 v22, v60, v61
    v_pk_mul_f32 v[62:63], v[62:63], v[6:7]
    v_cvt_pk_bf16_f32 v23, v62, v63
    v_pk_mul_f32 v[64:65], v[64:65], v[6:7]
    v_cvt_pk_bf16_f32 v24, v64, v65
    v_pk_mul_f32 v[66:67], v[66:67], v[6:7]
    v_cvt_pk_bf16_f32 v25, v66, v67
    v_pk_mul_f32 v[68:69], v[68:69], v[6:7]
    v_cvt_pk_bf16_f32 v26, v68, v69
    v_pk_mul_f32 v[70:71], v[70:71], v[6:7]
    v_cvt_pk_bf16_f32 v27, v70, v71
    v_pk_mul_f32 v[72:73], v[72:73], v[6:7]
    v_cvt_pk_bf16_f32 v28, v72, v73
    v_pk_mul_f32 v[74:75], v[74:75], v[6:7]
    v_cvt_pk_bf16_f32 v29, v74, v75
    v_pk_mul_f32 v[76:77], v[76:77], v[6:7]
    v_cvt_pk_bf16_f32 v30, v76, v77
    v_pk_mul_f32 v[78:79], v[78:79], v[6:7]
    v_cvt_pk_bf16_f32 v31, v78, v79
    v_pk_mul_f32 v[80:81], v[80:81], v[6:7]
    v_cvt_pk_bf16_f32 v32, v80, v81
    v_pk_mul_f32 v[82:83], v[82:83], v[6:7]
    v_cvt_pk_bf16_f32 v33, v82, v83
    v_pk_mul_f32 v[84:85], v[84:85], v[6:7]
    v_cvt_pk_bf16_f32 v34, v84, v85
    v_pk_mul_f32 v[86:87], v[86:87], v[6:7]
    v_cvt_pk_bf16_f32 v35, v86, v87
    v_pk_mul_f32 v[88:89], v[88:89], v[6:7]
    v_cvt_pk_bf16_f32 v36, v88, v89
    v_pk_mul_f32 v[90:91], v[90:91], v[6:7]
    v_cvt_pk_bf16_f32 v37, v90, v91
    v_pk_mul_f32 v[92:93], v[92:93], v[6:7]
    v_cvt_pk_bf16_f32 v38, v92, v93
    v_pk_mul_f32 v[94:95], v[94:95], v[6:7]
    v_cvt_pk_bf16_f32 v39, v94, v95
    v_pk_mul_f32 v[96:97], v[96:97], v[6:7]
    v_cvt_pk_bf16_f32 v40, v96, v97
    v_pk_mul_f32 v[98:99], v[98:99], v[6:7]
    v_cvt_pk_bf16_f32 v41, v98, v99
    v_pk_mul_f32 v[100:101], v[100:101], v[6:7]
    v_cvt_pk_bf16_f32 v42, v100, v101
    v_pk_mul_f32 v[102:103], v[102:103], v[6:7]
    v_cvt_pk_bf16_f32 v43, v102, v103
    s_mul_i32 s42, s41, 29696
    s_add_u32 s42, s42, 19267584
    buffer_store_dwordx4 v[16:19], v3, s[4:7], s42 offen offset:0 sc1
    buffer_store_dwordx4 v[20:23], v3, s[4:7], s42 offen offset:128 sc1
    buffer_store_dwordx4 v[24:27], v3, s[4:7], s42 offen offset:256 sc1
    buffer_store_dwordx4 v[28:31], v3, s[4:7], s42 offen offset:384 sc1
    buffer_store_dwordx4 v[32:35], v3, s[4:7], s42 offen offset:512 sc1
    buffer_store_dwordx4 v[36:39], v3, s[4:7], s42 offen offset:640 sc1
    buffer_store_dwordx4 v[40:43], v3, s[4:7], s42 offen offset:768 sc1
    s_nop 1
M_end_180:
    s_waitcnt vmcnt(0)
    s_barrier
    s_cmp_lg_u32 s15, 0
    s_cbranch_scc1 L_ic_182
    v_mov_b32 v46, 32
    v_mov_b32 v47, 1
    s_mov_b64 exec, 1
    global_atomic_add v46, v47, s[36:37] sc1
    s_mov_b64 exec, -1
L_ic_182:
    s_load_dwordx2 s[8:9], s[34:35], 0
    s_waitcnt lgkmcnt(0)
    s_mov_b32 s10, 1835008
    s_mov_b32 s11, 0x00020000
    v_and_b32 v10, 63, v0
    v_lshlrev_b32 v6, 4, v10
    v_and_b32 v11, 15, v10
    v_lshrrev_b32 v12, 4, v10
    v_mov_b32 v7, 0
    s_lshl_b32 s18, s12, 6
    s_lshl_b32 s19, s15, 4
    s_add_u32 s18, s18, s19
    v_add_u32 v13, s18, v11
    v_lshlrev_b32 v13, 4, v13
    v_add_u32 v14, 1, v12
    v_mul_u32_u24 v2, 7168, v14
    v_add_u32 v2, v2, v13
    s_mov_b32 s19, 35840
    v_mul_lo_u32 v3, v12, s19
    v_add_u32 v3, v3, v13
    v_lshlrev_b32 v4, 9, v14
    v_lshl_add_u32 v4, v11, 4, v4
    v_mul_u32_u24 v5, 2560, v12
    v_lshl_add_u32 v5, v11, 4, v5
    v_mul_u32_u24 v8, 896, v11
    v_lshl_add_u32 v8, v12, 3, v8
    s_lshl_b32 s18, s18, 1
    v_add_u32 v8, s18, v8
    s_mov_b32 s32, 400000
    v_mbcnt_lo_u32_b32 v45, -1, 0
    v_add_u32 v45, 8, v45
    v_lshlrev_b32 v45, 2, v45
    s_mov_b64 exec, 1
    s_nop 0
L_dw_184:
    global_load_dword v44, v45, s[36:37] sc1
    s_waitcnt vmcnt(0)
    v_cmp_gt_u32 vcc, 256, v44
    s_nop 3
    s_cbranch_vccz L_dwok_185
    s_sleep 1
    s_sub_u32 s32, s32, 1
    s_cmp_lg_u32 s32, 0
    s_cbranch_scc1 L_dw_184
    s_branch L_fail
L_dwok_185:
    s_mov_b64 exec, -1
L_iok_183:
    s_mov_b32 s16, s38
L_CB_loop:
    s_cmp_eq_u32 s13, 0
    s_mov_b32 s43, 0x44e4000
    s_cselect_b32 s43, 0x21e4000, s43
    s_mul_i32 s18, s16, 573440
    s_add_u32 s43, s43, s18
    s_cmp_eq_u32 s13, 0
    s_mov_b32 s40, 0x78f4000
    s_cselect_b32 s40, 0x78e4000, s40
    s_lshl_b32 s18, s16, 7
    s_add_u32 s40, s40, s18
    s_mov_b32 s32, 400000
    v_mbcnt_lo_u32_b32 v11, -1, 0
    v_lshlrev_b32 v11, 2, v11
    s_mov_b32 exec_lo, 0xffffffff
    s_mov_b32 exec_hi, 0
L_wf_186:
    buffer_load_dword v10, v11, s[4:7], s40 offen sc1
    s_waitcnt vmcnt(0)
    v_cmp_eq_u32 vcc, 0, v10
    s_nop 3
    s_cbranch_vccz L_wfok_187
    s_sleep 1
    s_sub_u32 s32, s32, 1
    s_cmp_lg_u32 s32, 0
    s_cbranch_scc1 L_wf_186
    s_branch L_fail
L_wfok_187:
    s_mov_b64 exec, -1
    s_mov_b32 s41, s43
    buffer_load_dwordx4 v[120:123], v2, s[4:7], s41 offen sc1
    s_add_u32 s41, s41, 35840
    buffer_load_dwordx4 v[124:127], v2, s[4:7], s41 offen sc1
    s_add_u32 s41, s41, 35840
    buffer_load_dwordx4 v[128:131], v2, s[4:7], s41 offen sc1
    s_add_u32 s41, s41, 35840
    buffer_load_dwordx4 v[132:135], v2, s[4:7], s41 offen sc1
    s_add_u32 s41, s41, 35840
    buffer_load_dwordx4 v[136:139], v2, s[4:7], s41 offen sc1
    s_add_u32 s41, s41, 35840
    buffer_load_dwordx4 v[140:143], v2, s[4:7], s41 offen sc1
    s_add_u32 s41, s41, 35840
    buffer_load_dwordx4 v[144:147], v2, s[4:7], s41 offen sc1
    s_add_u32 s41, s41, 35840
    buffer_load_dwordx4 v[148:151], v2, s[4:7], s41 offen sc1
    s_add_u32 s41, s41, 35840
    buffer_load_dwordx4 v[152:155], v2, s[4:7], s41 offen sc1
    s_add_u32 s41, s41, 35840
    buffer_load_dwordx4 v[156:159], v2, s[4:7], s41 offen sc1
    s_add_u32 s41, s41, 35840
    buffer_load_dwordx4 v[160:163], v2, s[4:7], s41 offen sc1
    s_add_u32 s41, s41, 35840
    buffer_load_dwordx4 v[164:167], v2, s[4:7], s41 offen sc1
    s_add_u32 s41, s41, 35840
    buffer_load_dwordx4 v[168:171], v2, s[4:7], s41 offen sc1
    s_add_u32 s41, s41, 35840
    buffer_load_dwordx4 v[172:175], v2, s[4:7], s41 offen sc1
    s_add_u32 s41, s41, 35840
    buffer_load_dwordx4 v[176:179], v2, s[4:7], s41 offen sc1
    s_add_u32 s41, s41, 35840
    buffer_load_dwordx4 v[180:183], v2, s[4:7], s41 offen sc1
    s_add_u32 s41, s41, 35840
    s_mul_i32 s45, s16, 28672
    s_add_u32 s20, s45, 14336
    s_cmp_eq_u32 s13, 1
    s_cbranch_scc1 L_res1_189
    buffer_load_dwordx2 v[72:73], v8, s[8:11], s45 offen
    buffer_load_dwordx2 v[74:75], v8, s[8:11], s20 offen
    s_branch L_resj_190
L_res1_189:
    s_add_u32 s45, s45, 23076864
    s_add_u32 s20, s20, 23076864
    buffer_load_dwordx2 v[72:73], v8, s[4:7], s45 offen sc1
    buffer_load_dwordx2 v[74:75], v8, s[4:7], s20 offen sc1
L_resj_190:
    s_cmp_eq_u32 s13, 0
    s_mov_b32 s40, 0x7902000
    s_cselect_b32 s40, 0x78f2000, s40
    s_lshl_b32 s18, s16, 7
    s_add_u32 s40, s40, s18
    s_mov_b32 s32, 400000
    v_mbcnt_lo_u32_b32 v11, -1, 0
    v_lshlrev_b32 v11, 2, v11
    s_mov_b32 exec_lo, 0xffff
    s_mov_b32 exec_hi, 0
L_wf_191:
    buffer_load_dword v10, v11, s[4:7], s40 offen sc1
    s_waitcnt vmcnt(0)
    v_cmp_eq_u32 vcc, 0, v10
    s_nop 3
    s_cbranch_vccz L_wfok_192
    s_sleep 1
    s_sub_u32 s32, s32, 1
    s_cmp_lg_u32 s32, 0
    s_cbranch_scc1 L_wf_191
    s_branch L_fail
L_wfok_192:
    s_mov_b64 exec, -1
    s_mov_b32 s41, s43
    buffer_load_dwordx4 v[184:187], v3, s[4:7], s41 offen sc1
    s_add_u32 s41, s41, 143360
    buffer_load_dwordx4 v[188:191], v3, s[4:7], s41 offen sc1
    s_add_u32 s41, s41, 143360
    buffer_load_dwordx4 v[192:195], v3, s[4:7], s41 offen sc1
    s_add_u32 s41, s41, 143360
    buffer_load_dwordx4 v[196:199], v3, s[4:7], s41 offen sc1
    s_add_u32 s41, s41, 143360
    s_cmp_eq_u32 s13, 0
    s_mov_b32 s40, 0x78f6000
    s_cselect_b32 s40, 0x78e6000, s40
    s_lshl_b32 s18, s16, 7
    s_add_u32 s40, s40, s18
    s_mov_b32 s32, 400000
    v_mbcnt_lo_u32_b32 v11, -1, 0
    v_lshlrev_b32 v11, 2, v11
    s_mov_b32 exec_lo, 0xffff
    s_mov_b32 exec_hi, 0
L_wf_194:
    buffer_load_dword v10, v11, s[4:7], s40 offen sc1
    s_waitcnt vmcnt(0)
    v_cmp_eq_u32 vcc, 0, v10
    s_nop 3
    s_cbranch_vccz L_wfok_195
    s_sleep 1
    s_sub_u32 s32, s32, 1
    s_cmp_lg_u32 s32, 0
    s_cbranch_scc1 L_wf_194
    s_branch L_fail
L_wfok_195:
    s_mov_b64 exec, -1
    s_cmp_eq_u32 s13, 0
    s_mov_b32 s43, 0x6a64000
    s_cselect_b32 s43, 0x67e4000, s43
    s_mul_i32 s18, s16, 40960
    s_add_u32 s43, s43, s18
    s_mul_i32 s18, s15, 10240
    s_add_u32 s41, s43, s18
    s_mov_b32 s42, s18
    s_mov_b32 m0, s42
    s_nop 0
    buffer_load_dwordx4 v6, s[4:7], s41 offen offset:0 sc1 lds
    buffer_load_dwordx4 v6, s[4:7], s41 offen offset:1024 sc1 lds
    buffer_load_dwordx4 v6, s[4:7], s41 offen offset:2048 sc1 lds
    buffer_load_dwordx4 v6, s[4:7], s41 offen offset:3072 sc1 lds
    s_add_u32 s41, s41, 4096
    s_add_u32 s42, s42, 4096
    s_mov_b32 m0, s42
    s_nop 0
    buffer_load_dwordx4 v6, s[4:7], s41 offen offset:0 sc1 lds
    buffer_load_dwordx4 v6, s[4:7], s41 offen offset:1024 sc1 lds
    buffer_load_dwordx4 v6, s[4:7], s41 offen offset:2048 sc1 lds
    buffer_load_dwordx4 v6, s[4:7], s41 offen offset:3072 sc1 lds
    s_add_u32 s41, s41, 4096
    s_add_u32 s42, s42, 4096
    s_mov_b32 m0, s42
    s_nop 0
    buffer_load_dwordx4 v6, s[4:7], s41 offen offset:0 sc1 lds
    buffer_load_dwordx4 v6, s[4:7], s41 offen offset:1024 sc1 lds
    s_waitcnt vmcnt(0)
    s_barrier
    ds_read_b128 v[48:51], v4 offset:0
    ds_read_b128 v[52:55], v4 offset:256
    ds_read_b128 v[56:59], v4 offset:2560
    ds_read_b128 v[60:63], v4 offset:2816
    s_waitcnt lgkmcnt(2)
    v_mfma_f32_16x16x32_bf16 v[64:67], v[120:123], v[48:51], 0
    v_mfma_f32_16x16x32_bf16 v[68:71], v[120:123], v[52:55], 0
    ds_read_b128 v[48:51], v4 offset:5120
    ds_read_b128 v[52:55], v4 offset:5376
    s_waitcnt lgkmcnt(2)
    v_mfma_f32_16x16x32_bf16 v[64:67], v[124:127], v[56:59], v[64:67]
    v_mfma_f32_16x16x32_bf16 v[68:71], v[124:127], v[60:63], v[68:71]
    ds_read_b128 v[56:59], v4 offset:7680
    ds_read_b128 v[60:63], v4 offset:7936
    s_waitcnt lgkmcnt(2)
    v_mfma_f32_16x16x32_bf16 v[64:67], v[128:131], v[48:51], v[64:67]
    v_mfma_f32_16x16x32_bf16 v[68:71], v[128:131], v[52:55], v[68:71]
    ds_read_b128 v[48:51], v4 offset:10240
    ds_read_b128 v[52:55], v4 offset:10496
    s_waitcnt lgkmcnt(2)
    v_mfma_f32_16x16x32_bf16 v[64:67], v[132:135], v[56:59], v[64:67]
    v_mfma_f32_16x16x32_bf16 v[68:71], v[132:135], v[60:63], v[68:71]
    ds_read_b128 v[56:59], v4 offset:12800
    ds_read_b128 v[60:63], v4 offset:13056
    s_waitcnt lgkmcnt(2)
    v_mfma_f32_16x16x32_bf16 v[64:67], v[136:139], v[48:51], v[64:67]
    v_mfma_f32_16x16x32_bf16 v[68:71], v[136:139], v[52:55], v[68:71]
    ds_read_b128 v[48:51], v4 offset:15360
    ds_read_b128 v[52:55], v4 offset:15616
    s_waitcnt lgkmcnt(2)
    v_mfma_f32_16x16x32_bf16 v[64:67], v[140:143], v[56:59], v[64:67]
    v_mfma_f32_16x16x32_bf16 v[68:71], v[140:143], v[60:63], v[68:71]
    ds_read_b128 v[56:59], v4 offset:17920
    ds_read_b128 v[60:63], v4 offset:18176
    s_waitcnt lgkmcnt(2)
    v_mfma_f32_16x16x32_bf16 v[64:67], v[144:147], v[48:51], v[64:67]
    v_mfma_f32_16x16x32_bf16 v[68:71], v[144:147], v[52:55], v[68:71]
    ds_read_b128 v[48:51], v4 offset:20480
    ds_read_b128 v[52:55], v4 offset:20736
    s_waitcnt lgkmcnt(2)
    v_mfma_f32_16x16x32_bf16 v[64:67], v[148:151], v[56:59], v[64:67]
    v_mfma_f32_16x16x32_bf16 v[68:71], v[148:151], v[60:63], v[68:71]
    ds_read_b128 v[56:59], v4 offset:23040
    ds_read_b128 v[60:63], v4 offset:23296
    s_waitcnt lgkmcnt(2)
    v_mfma_f32_16x16x32_bf16 v[64:67], v[152:155], v[48:51], v[64:67]
    v_mfma_f32_16x16x32_bf16 v[68:71], v[152:155], v[52:55], v[68:71]
    ds_read_b128 v[48:51], v4 offset:25600
    ds_read_b128 v[52:55], v4 offset:25856
    s_waitcnt lgkmcnt(2)
    v_mfma_f32_16x16x32_bf16 v[64:67], v[156:159], v[56:59], v[64:67]
    v_mfma_f32_16x16x32_bf16 v[68:71], v[156:159], v[60:63], v[68:71]
    ds_read_b128 v[56:59], v4 offset:28160
    ds_read_b128 v[60:63], v4 offset:28416
    s_waitcnt lgkmcnt(2)
    v_mfma_f32_16x16x32_bf16 v[64:67], v[160:163], v[48:51], v[64:67]
    v_mfma_f32_16x16x32_bf16 v[68:71], v[160:163], v[52:55], v[68:71]
    ds_read_b128 v[48:51], v4 offset:30720
    ds_read_b128 v[52:55], v4 offset:30976
    s_waitcnt lgkmcnt(2)
    v_mfma_f32_16x16x32_bf16 v[64:67], v[164:167], v[56:59], v[64:67]
    v_mfma_f32_16x16x32_bf16 v[68:71], v[164:167], v[60:63], v[68:71]
    ds_read_b128 v[56:59], v4 offset:33280
    ds_read_b128 v[60:63], v4 offset:33536
    s_waitcnt lgkmcnt(2)
    v_mfma_f32_16x16x32_bf16 v[64:67], v[168:171], v[48:51], v[64:67]
    v_mfma_f32_16x16x32_bf16 v[68:71], v[168:171], v[52:55], v[68:71]
    ds_read_b128 v[48:51], v4 offset:35840
    ds_read_b128 v[52:55], v4 offset:36096
    s_waitcnt lgkmcnt(2)
    v_mfma_f32_16x16x32_bf16 v[64:67], v[172:175], v[56:59], v[64:67]
    v_mfma_f32_16x16x32_bf16 v[68:71], v[172:175], v[60:63], v[68:71]
    ds_read_b128 v[56:59], v4 offset:38400
    ds_read_b128 v[60:63], v4 offset:38656
    s_waitcnt lgkmcnt(2)
    v_mfma_f32_16x16x32_bf16 v[64:67], v[176:179], v[48:51], v[64:67]
    v_mfma_f32_16x16x32_bf16 v[68:71], v[176:179], v[52:55], v[68:71]
    ds_read_b128 v[48:51], v5 offset:0
    ds_read_b128 v[52:55], v5 offset:256
    s_waitcnt lgkmcnt(2)
    v_mfma_f32_16x16x32_bf16 v[64:67], v[180:183], v[56:59], v[64:67]
    v_mfma_f32_16x16x32_bf16 v[68:71], v[180:183], v[60:63], v[68:71]
    ds_read_b128 v[56:59], v5 offset:10240
    ds_read_b128 v[60:63], v5 offset:10496
    s_waitcnt lgkmcnt(2)
    v_mfma_f32_16x16x32_bf16 v[64:67], v[184:187], v[48:51], v[64:67]
    v_mfma_f32_16x16x32_bf16 v[68:71], v[184:187], v[52:55], v[68:71]
    ds_read_b128 v[48:51], v5 offset:20480
    ds_read_b128 v[52:55], v5 offset:20736
    s_waitcnt lgkmcnt(2)
    v_mfma_f32_16x16x32_bf16 v[64:67], v[188:191], v[56:59], v[64:67]
    v_mfma_f32_16x16x32_bf16 v[68:71], v[188:191], v[60:63], v[68:71]
    ds_read_b128 v[56:59], v5 offset:30720
    ds_read_b128 v[60:63], v5 offset:30976
    s_waitcnt lgkmcnt(2)
    v_mfma_f32_16x16x32_bf16 v[64:67], v[192:195], v[48:51], v[64:67]
    v_mfma_f32_16x16x32_bf16 v[68:71], v[192:195], v[52:55], v[68:71]
    s_waitcnt lgkmcnt(0)
    v_mfma_f32_16x16x32_bf16 v[64:67], v[196:199], v[56:59], v[64:67]
    v_mfma_f32_16x16x32_bf16 v[68:71], v[196:199], v[60:63], v[68:71]
    s_cmp_eq_u32 s13, 0
    s_mov_b32 s44, 0x1982000
    s_cselect_b32 s44, 0x17c2000, s44
    s_mul_i32 s18, s16, 28672
    s_add_u32 s44, s44, s18
    v_lshlrev_b32 v10, 16, v72
    v_and_b32 v11, 0xffff0000, v72
    v_lshlrev_b32 v12, 16, v73
    v_and_b32 v13, 0xffff0000, v73
    v_add_f32 v64, v64, v10
    v_add_f32 v65, v65, v11
    v_add_f32 v66, v66, v12
    v_add_f32 v67, v67, v13
    v_cvt_pk_bf16_f32 v64, v64, v65
    v_cvt_pk_bf16_f32 v65, v66, v67
    s_cmp_lg_u32 s14, 0
    s_cbranch_scc1 L_slow_197
    buffer_store_dwordx2 v[64:65], v8, s[4:7], s44 offen
    s_branch L_md_198
L_slow_197:
    buffer_store_dwordx2 v[64:65], v8, s[4:7], s44 offen sc1
L_md_198:
    v_lshlrev_b32 v10, 16, v74
    v_and_b32 v11, 0xffff0000, v74
    v_lshlrev_b32 v12, 16, v75
    v_and_b32 v13, 0xffff0000, v75
    v_add_f32 v68, v68, v10
    v_add_f32 v69, v69, v11
    v_add_f32 v70, v70, v12
    v_add_f32 v71, v71, v13
    v_cvt_pk_bf16_f32 v68, v68, v69
    v_cvt_pk_bf16_f32 v69, v70, v71
    s_add_u32 s44, s44, 14336
    s_cmp_lg_u32 s14, 0
    s_cbranch_scc1 L_slow_199
    buffer_store_dwordx2 v[68:69], v8, s[4:7], s44 offen
    s_branch L_md_200
L_slow_199:
    buffer_store_dwordx2 v[68:69], v8, s[4:7], s44 offen sc1
L_md_200:
    s_cmp_eq_u32 s13, 0
    s_mov_b32 s40, 0x78f8000
    s_cselect_b32 s40, 0x78e8000, s40
    s_lshl_b32 s18, s16, 7
    s_add_u32 s40, s40, s18
    s_waitcnt vmcnt(0)
    s_barrier
    s_cmp_lg_u32 s15, 0
    s_cbranch_scc1 L_sig_201
    v_mov_b32 v10, 1
    s_lshl_b32 s18, s12, 2
    v_mov_b32 v11, s18
    s_mov_b64 exec, 1
    s_cmp_lg_u32 s14, 0
    s_cbranch_scc1 L_slow_202
    buffer_store_dword v10, v11, s[4:7], s40 offen
    s_branch L_md_203
L_slow_202:
    buffer_store_dword v10, v11, s[4:7], s40 offen sc1
L_md_203:
    s_mov_b64 exec, -1
L_sig_201:
    s_add_u32 s16, s16, 2
    s_cmp_lt_u32 s16, 64
    s_cbranch_scc1 L_CB_loop
    s_branch L_role_done
L_nCB:
    s_cmp_ge_u32 s19, 20
    s_cbranch_scc1 L_nQKV
    s_mov_b32 s38, 0
    s_sub_u32 s12, s19, 14
    s_mov_b32 s40, s93
    s_cmp_ge_u32 s40, 160
    s_cbranch_scc1 M_end_204
    v_lshlrev_b32 v6, 4, v0
    v_mov_b32 v8, -1
    v_mov_b32 v12, 0
    v_mov_b32 v9, -1
    v_mov_b32 v13, 0
    v_mov_b32 v10, -1
    v_mov_b32 v14, 0
    v_mov_b32 v11, -1
    v_mov_b32 v15, 0
    s_lshl_b32 s42, s40, 12
    s_add_u32 s42, s42, 126763008
    s_mov_b32 s46, 126894080
    s_mov_b32 s44, s4
    s_mov_b32 s45, s5
    s_mov_b32 s47, 0x00020000
    buffer_store_dwordx4 v[12:15], v6, s[44:47], s42 offen sc1
    s_lshl_b32 s42, s40, 12
    s_add_u32 s42, s42, 32398336
    s_mov_b32 s46, 32849920
    s_mov_b32 s44, s4
    s_mov_b32 s45, s5
    s_mov_b32 s47, 0x00020000
    buffer_store_dwordx4 v[8:11], v6, s[44:47], s42 offen sc1
    s_lshl_b32 s42, s40, 12
    s_add_u32 s42, s42, 33315840
    s_mov_b32 s46, 33767424
    s_mov_b32 s44, s4
    s_mov_b32 s45, s5
    s_mov_b32 s47, 0x00020000
    buffer_store_dwordx4 v[8:11], v6, s[44:47], s42 offen sc1
    s_lshl_b32 s42, s40, 12
    s_add_u32 s42, s42, 34226176
    s_mov_b32 s46, 34881536
    s_mov_b32 s44, s4
    s_mov_b32 s45, s5
    s_mov_b32 s47, 0x00020000
    buffer_store_dwordx4 v[8:11], v6, s[44:47], s42 offen sc1
    s_lshl_b32 s42, s40, 12
    s_add_u32 s42, s42, 32857088
    s_mov_b32 s46, 33308672
    s_mov_b32 s44, s4
    s_mov_b32 s45, s5
    s_mov_b32 s47, 0x00020000
    buffer_store_dwordx4 v[8:11], v6, s[44:47], s42 offen sc1
    s_lshl_b32 s42, s40, 12
    s_add_u32 s42, s42, 33774592
    s_mov_b32 s46, 34226176
    s_mov_b32 s44, s4
    s_mov_b32 s45, s5
    s_mov_b32 s47, 0x00020000
    buffer_store_dwordx4 v[8:11], v6, s[44:47], s42 offen sc1
    s_lshl_b32 s42, s40, 12
    s_add_u32 s42, s42, 34881536
    s_mov_b32 s46, 35536896
    s_mov_b32 s44, s4
    s_mov_b32 s45, s5
    s_mov_b32 s47, 0x00020000
    buffer_store_dwordx4 v[8:11], v6, s[44:47], s42 offen sc1
    s_cmp_ge_u32 s40, 32
    s_cbranch_scc1 M_end_204
    s_load_dwordx2 s[8:9], s[34:35], 0
    s_waitcnt lgkmcnt(0)
    s_mov_b32 s10, 1835008
    s_mov_b32 s11, 0x00020000
    v_lshrrev_b32 v4, 3, v0
    v_and_b32 v5, 7, v0
    v_mul_u32_u24 v2, 896, v4
    v_lshl_add_u32 v2, v5, 4, v2
    v_mul_u32_u24 v3, 928, v4
    v_lshl_add_u32 v3, v5, 4, v3
    s_add_u32 s41, s40, 32
    s_mul_i32 s42, s41, 28672
    buffer_load_dwordx4 v[16:19], v2, s[8:11], s42 offen offset:0
    buffer_load_dwordx4 v[20:23], v2, s[8:11], s42 offen offset:128
    buffer_load_dwordx4 v[24:27], v2, s[8:11], s42 offen offset:256
    buffer_load_dwordx4 v[28:31], v2, s[8:11], s42 offen offset:384
    buffer_load_dwordx4 v[32:35], v2, s[8:11], s42 offen offset:512
    buffer_load_dwordx4 v[36:39], v2, s[8:11], s42 offen offset:640
    buffer_load_dwordx4 v[40:43], v2, s[8:11], s42 offen offset:768
    s_waitcnt vmcnt(0)
    v_lshlrev_b32 v48, 16, v16
    v_and_b32 v49, 0xffff0000, v16
    v_lshlrev_b32 v50, 16, v17
    v_and_b32 v51, 0xffff0000, v17
    v_lshlrev_b32 v52, 16, v18
    v_and_b32 v53, 0xffff0000, v18
    v_lshlrev_b32 v54, 16, v19
    v_and_b32 v55, 0xffff0000, v19
    v_lshlrev_b32 v56, 16, v20
    v_and_b32 v57, 0xffff0000, v20
    v_lshlrev_b32 v58, 16, v21
    v_and_b32 v59, 0xffff0000, v21
    v_lshlrev_b32 v60, 16, v22
    v_and_b32 v61, 0xffff0000, v22
    v_lshlrev_b32 v62, 16, v23
    v_and_b32 v63, 0xffff0000, v23
    v_lshlrev_b32 v64, 16, v24
    v_and_b32 v65, 0xffff0000, v24
    v_lshlrev_b32 v66, 16, v25
    v_and_b32 v67, 0xffff0000, v25
    v_lshlrev_b32 v68, 16, v26
    v_and_b32 v69, 0xffff0000, v26
    v_lshlrev_b32 v70, 16, v27
    v_and_b32 v71, 0xffff0000, v27
    v_lshlrev_b32 v72, 16, v28
    v_and_b32 v73, 0xffff0000, v28
    v_lshlrev_b32 v74, 16, v29
    v_and_b32 v75, 0xffff0000, v29
    v_lshlrev_b32 v76, 16, v30
    v_and_b32 v77, 0xffff0000, v30
    v_lshlrev_b32 v78, 16, v31
    v_and_b32 v79, 0xffff0000, v31
    v_lshlrev_b32 v80, 16, v32
    v_and_b32 v81, 0xffff0000, v32
    v_lshlrev_b32 v82, 16, v33
    v_and_b32 v83, 0xffff0000, v33
    v_lshlrev_b32 v84, 16, v34
    v_and_b32 v85, 0xffff0000, v34
    v_lshlrev_b32 v86, 16, v35
    v_and_b32 v87, 0xffff0000, v35
    v_lshlrev_b32 v88, 16, v36
    v_and_b32 v89, 0xffff0000, v36
    v_lshlrev_b32 v90, 16, v37
    v_and_b32 v91, 0xffff0000, v37
    v_lshlrev_b32 v92, 16, v38
    v_and_b32 v93, 0xffff0000, v38
    v_lshlrev_b32 v94, 16, v39
    v_and_b32 v95, 0xffff0000, v39
    v_lshlrev_b32 v96, 16, v40
    v_and_b32 v97, 0xffff0000, v40
    v_lshlrev_b32 v98, 16, v41
    v_and_b32 v99, 0xffff0000, v41
    v_lshlrev_b32 v100, 16, v42
    v_and_b32 v101, 0xffff0000, v42
    v_lshlrev_b32 v102, 16, v43
    v_and_b32 v103, 0xffff0000, v43
    v_pk_add_f32 v[6:7], v[48:49], v[50:51]
    v_pk_add_f32 v[8:9], v[52:53], v[54:55]
    v_pk_add_f32 v[6:7], v[6:7], v[56:57]
    v_pk_add_f32 v[8:9], v[8:9], v[58:59]
    v_pk_add_f32 v[6:7], v[6:7], v[60:61]
    v_pk_add_f32 v[8:9], v[8:9], v[62:63]
    v_pk_add_f32 v[6:7], v[6:7], v[64:65]
    v_pk_add_f32 v[8:9], v[8:9], v[66:67]
    v_pk_add_f32 v[6:7], v[6:7], v[68:69]
    v_pk_add_f32 v[8:9], v[8:9], v[70:71]
    v_pk_add_f32 v[6:7], v[6:7], v[72:73]
    v_pk_add_f32 v[8:9], v[8:9], v[74:75]
    v_pk_add_f32 v[6:7], v[6:7], v[76:77]
    v_pk_add_f32 v[8:9], v[8:9], v[78:79]
    v_pk_add_f32 v[6:7], v[6:7], v[80:81]
    v_pk_add_f32 v[8:9], v[8:9], v[82:83]
    v_pk_add_f32 v[6:7], v[6:7], v[84:85]
    v_pk_add_f32 v[8:9], v[8:9], v[86:87]
    v_pk_add_f32 v[6:7], v[6:7], v[88:89]
    v_pk_add_f32 v[8:9], v[8:9], v[90:91]
    v_pk_add_f32 v[6:7], v[6:7], v[92:93]
    v_pk_add_f32 v[8:9], v[8:9], v[94:95]
    v_pk_add_f32 v[6:7], v[6:7], v[96:97]
    v_pk_add_f32 v[8:9], v[8:9], v[98:99]
    v_pk_add_f32 v[6:7], v[6:7], v[100:101]
    v_pk_add_f32 v[8:9], v[8:9], v[102:103]
    v_pk_add_f32 v[6:7], v[6:7], v[8:9]
    v_add_f32 v4, v6, v7
    s_nop 1
    v_add_f32_dpp v4, v4, v4 quad_perm:[1,0,3,2] row_mask:0xf bank_mask:0xf
    s_nop 1
    v_add_f32_dpp v4, v4, v4 quad_perm:[2,3,0,1] row_mask:0xf bank_mask:0xf
    s_nop 1
    v_add_f32_dpp v4, v4, v4 row_half_mirror row_mask:0xf bank_mask:0xf
    v_mul_f32 v8, 0xbb124925, v4
    v_mov_b32 v9, v8
    v_pk_add_f32 v[48:49], v[48:49], v[8:9]
    v_pk_add_f32 v[50:51], v[50:51], v[8:9]
    v_pk_add_f32 v[52:53], v[52:53], v[8:9]
    v_pk_add_f32 v[54:55], v[54:55], v[8:9]
    v_pk_add_f32 v[56:57], v[56:57], v[8:9]
    v_pk_add_f32 v[58:59], v[58:59], v[8:9]
    v_pk_add_f32 v[60:61], v[60:61], v[8:9]
    v_pk_add_f32 v[62:63], v[62:63], v[8:9]
    v_pk_add_f32 v[64:65], v[64:65], v[8:9]
    v_pk_add_f32 v[66:67], v[66:67], v[8:9]
    v_pk_add_f32 v[68:69], v[68:69], v[8:9]
    v_pk_add_f32 v[70:71], v[70:71], v[8:9]
    v_pk_add_f32 v[72:73], v[72:73], v[8:9]
    v_pk_add_f32 v[74:75], v[74:75], v[8:9]
    v_pk_add_f32 v[76:77], v[76:77], v[8:9]
    v_pk_add_f32 v[78:79], v[78:79], v[8:9]
    v_pk_add_f32 v[80:81], v[80:81], v[8:9]
    v_pk_add_f32 v[82:83], v[82:83], v[8:9]
    v_pk_add_f32 v[84:85], v[84:85], v[8:9]
    v_pk_add_f32 v[86:87], v[86:87], v[8:9]
    v_pk_add_f32 v[88:89], v[88:89], v[8:9]
    v_pk_add_f32 v[90:91], v[90:91], v[8:9]
    v_pk_add_f32 v[92:93], v[92:93], v[8:9]
    v_pk_add_f32 v[94:95], v[94:95], v[8:9]
    v_pk_add_f32 v[96:97], v[96:97], v[8:9]
    v_pk_add_f32 v[98:99], v[98:99], v[8:9]
    v_pk_add_f32 v[100:101], v[100:101], v[8:9]
    v_pk_add_f32 v[102:103], v[102:103], v[8:9]
    v_pk_mul_f32 v[6:7], v[48:49], v[48:49]
    v_pk_mul_f32 v[8:9], v[50:51], v[50:51]
    v_pk_fma_f32 v[6:7], v[52:53], v[52:53], v[6:7]
    v_pk_fma_f32 v[8:9], v[54:55], v[54:55], v[8:9]
    v_pk_fma_f32 v[6:7], v[56:57], v[56:57], v[6:7]
    v_pk_fma_f32 v[8:9], v[58:59], v[58:59], v[8:9]
    v_pk_fma_f32 v[6:7], v[60:61], v[60:61], v[6:7]
    v_pk_fma_f32 v[8:9], v[62:63], v[62:63], v[8:9]
    v_pk_fma_f32 v[6:7], v[64:65], v[64:65], v[6:7]
    v_pk_fma_f32 v[8:9], v[66:67], v[66:67], v[8:9]
    v_pk_fma_f32 v[6:7], v[68:69], v[68:69], v[6:7]
    v_pk_fma_f32 v[8:9], v[70:71], v[70:71], v[8:9]
    v_pk_fma_f32 v[6:7], v[72:73], v[72:73], v[6:7]
    v_pk_fma_f32 v[8:9], v[74:75], v[74:75], v[8:9]
    v_pk_fma_f32 v[6:7], v[76:77], v[76:77], v[6:7]
    v_pk_fma_f32 v[8:9], v[78:79], v[78:79], v[8:9]
    v_pk_fma_f32 v[6:7], v[80:81], v[80:81], v[6:7]
    v_pk_fma_f32 v[8:9], v[82:83], v[82:83], v[8:9]
    v_pk_fma_f32 v[6:7], v[84:85], v[84:85], v[6:7]
    v_pk_fma_f32 v[8:9], v[86:87], v[86:87], v[8:9]
    v_pk_fma_f32 v[6:7], v[88:89], v[88:89], v[6:7]
    v_pk_fma_f32 v[8:9], v[90:91], v[90:91], v[8:9]
    v_pk_fma_f32 v[6:7], v[92:93], v[92:93], v[6:7]
    v_pk_fma_f32 v[8:9], v[94:95], v[94:95], v[8:9]
    v_pk_fma_f32 v[6:7], v[96:97], v[96:97], v[6:7]
    v_pk_fma_f32 v[8:9], v[98:99], v[98:99], v[8:9]
    v_pk_fma_f32 v[6:7], v[100:101], v[100:101], v[6:7]
    v_pk_fma_f32 v[8:9], v[102:103], v[102:103], v[8:9]
    v_pk_add_f32 v[6:7], v[6:7], v[8:9]
    v_add_f32 v4, v6, v7
    s_nop 1
    v_add_f32_dpp v4, v4, v4 quad_perm:[1,0,3,2] row_mask:0xf bank_mask:0xf
    s_nop 1
    v_add_f32_dpp v4, v4, v4 quad_perm:[2,3,0,1] row_mask:0xf bank_mask:0xf
    s_nop 1
    v_add_f32_dpp v4, v4, v4 row_half_mirror row_mask:0xf bank_mask:0xf
    v_mov_b32 v6, 0x3727c5ac
    v_fmac_f32 v6, 0x3b124925, v4
    v_rsq_f32 v6, v6
    s_nop 0
    v_mov_b32 v7, v6
    v_pk_mul_f32 v[48:49], v[48:49], v[6:7]
    v_cvt_pk_bf16_f32 v16, v48, v49
    v_pk_mul_f32 v[50:51], v[50:51], v[6:7]
    v_cvt_pk_bf16_f32 v17, v50, v51
    v_pk_mul_f32 v[52:53], v[52:53], v[6:7]
    v_cvt_pk_bf16_f32 v18, v52, v53
    v_pk_mul_f32 v[54:55], v[54:55], v[6:7]
    v_cvt_pk_bf16_f32 v19, v54, v55
    v_pk_mul_f32 v[56:57], v[56:57], v[6:7]
    v_cvt_pk_bf16_f32 v20, v56, v57
    v_pk_mul_f32 v[58:59], v[58:59], v[6:7]
    v_cvt_pk_bf16_f32 v21, v58, v59
    v_pk_mul_f32 v[60:61], v[60:61], v[6:7]
    v_cvt_pk_bf16_f32 v22, v60, v61
    v_pk_mul_f32 v[62:63], v[62:63], v[6:7]
    v_cvt_pk_bf16_f32 v23, v62, v63
    v_pk_mul_f32 v[64:65], v[64:65], v[6:7]
    v_cvt_pk_bf16_f32 v24, v64, v65
    v_pk_mul_f32 v[66:67], v[66:67], v[6:7]
    v_cvt_pk_bf16_f32 v25, v66, v67
    v_pk_mul_f32 v[68:69], v[68:69], v[6:7]
    v_cvt_pk_bf16_f32 v26, v68, v69
    v_pk_mul_f32 v[70:71], v[70:71], v[6:7]
    v_cvt_pk_bf16_f32 v27, v70, v71
    v_pk_mul_f32 v[72:73], v[72:73], v[6:7]
    v_cvt_pk_bf16_f32 v28, v72, v73
    v_pk_mul_f32 v[74:75], v[74:75], v[6:7]
    v_cvt_pk_bf16_f32 v29, v74, v75
    v_pk_mul_f32 v[76:77], v[76:77], v[6:7]
    v_cvt_pk_bf16_f32 v30, v76, v77
    v_pk_mul_f32 v[78:79], v[78:79], v[6:7]
    v_cvt_pk_bf16_f32 v31, v78, v79
    v_pk_mul_f32 v[80:81], v[80:81], v[6:7]
    v_cvt_pk_bf16_f32 v32, v80, v81
    v_pk_mul_f32 v[82:83], v[82:83], v[6:7]
    v_cvt_pk_bf16_f32 v33, v82, v83
    v_pk_mul_f32 v[84:85], v[84:85], v[6:7]
    v_cvt_pk_bf16_f32 v34, v84, v85
    v_pk_mul_f32 v[86:87], v[86:87], v[6:7]
    v_cvt_pk_bf16_f32 v35, v86, v87
    v_pk_mul_f32 v[88:89], v[88:89], v[6:7]
    v_cvt_pk_bf16_f32 v36, v88, v89
    v_pk_mul_f32 v[90:91], v[90:91], v[6:7]
    v_cvt_pk_bf16_f32 v37, v90, v91
    v_pk_mul_f32 v[92:93], v[92:93], v[6:7]
    v_cvt_pk_bf16_f32 v38, v92, v93
    v_pk_mul_f32 v[94:95], v[94:95], v[6:7]
    v_cvt_pk_bf16_f32 v39, v94, v95
    v_pk_mul_f32 v[96:97], v[96:97], v[6:7]
    v_cvt_pk_bf16_f32 v40, v96, v97
    v_pk_mul_f32 v[98:99], v[98:99], v[6:7]
    v_cvt_pk_bf16_f32 v41, v98, v99
    v_pk_mul_f32 v[100:101], v[100:101], v[6:7]
    v_cvt_pk_bf16_f32 v42, v100, v101
    v_pk_mul_f32 v[102:103], v[102:103], v[6:7]
    v_cvt_pk_bf16_f32 v43, v102, v103
    s_mul_i32 s42, s41, 29696
    s_add_u32 s42, s42, 19267584
    buffer_store_dwordx4 v[16:19], v3, s[4:7], s42 offen offset:0 sc1
    buffer_store_dwordx4 v[20:23], v3, s[4:7], s42 offen offset:128 sc1
    buffer_store_dwordx4 v[24:27], v3, s[4:7], s42 offen offset:256 sc1
    buffer_store_dwordx4 v[28:31], v3, s[4:7], s42 offen offset:384 sc1
    buffer_store_dwordx4 v[32:35], v3, s[4:7], s42 offen offset:512 sc1
    buffer_store_dwordx4 v[36:39], v3, s[4:7], s42 offen offset:640 sc1
    buffer_store_dwordx4 v[40:43], v3, s[4:7], s42 offen offset:768 sc1
    s_nop 1
M_end_204:
    s_waitcnt vmcnt(0)
    s_barrier
    s_cmp_lg_u32 s15, 0
    s_cbranch_scc1 L_ic_206
    v_mov_b32 v46, 32
    v_mov_b32 v47, 1
    s_mov_b64 exec, 1
    global_atomic_add v46, v47, s[36:37] sc1
    s_mov_b64 exec, -1
L_ic_206:
    s_cmp_ge_u32 s12, 3
    s_cselect_b32 s44, 1, 0
    s_mul_i32 s18, s44, 3
    s_sub_u32 s43, s12, s18
    s_load_dwordx2 s[8:9], s[34:35], 64
    s_waitcnt lgkmcnt(0)
    s_mov_b32 s10, 1204224
    s_mov_b32 s11, 0x00020000
    s_mul_i32 s46, s43, 896
    v_and_b32 v16, 63, v0
    v_lshlrev_b32 v21, 4, v16
    v_and_b32 v17, 15, v16
    v_lshrrev_b32 v18, 4, v16
    v_lshrrev_b32 v19, 2, v17
    v_lshl_add_u32 v19, v18, 3, v19
    v_mul_u32_u24 v19, 928, v19
    v_and_b32 v20, 3, v17
    s_mul_i32 s18, s15, 224
    v_add_u32 v19, s18, v19
    v_lshl_add_u32 v20, v20, 3, v19
    s_mov_b32 exec_hi, 0x00ffffff
    s_mul_i32 s22, s15, 21504
    s_add_u32 s22, s22, 0
    s_add_u32 s22, s22, s46
    s_mul_i32 s23, s15, 7424
    s_add_u32 s23, s23, 0
    s_mov_b32 m0, s23
    s_nop 0
    buffer_load_dwordx4 v21, s[8:11], s22 offen lds
    s_add_u32 s22, s22, 2688
    s_add_u32 s23, s23, 928
    s_mov_b32 m0, s23
    s_nop 0
    buffer_load_dwordx4 v21, s[8:11], s22 offen lds
    s_add_u32 s22, s22, 2688
    s_add_u32 s23, s23, 928
    s_mov_b32 m0, s23
    s_nop 0
    buffer_load_dwordx4 v21, s[8:11], s22 offen lds
    s_add_u32 s22, s22, 2688
    s_add_u32 s23, s23, 928
    s_mov_b32 m0, s23
    s_nop 0
    buffer_load_dwordx4 v21, s[8:11], s22 offen lds
    s_add_u32 s22, s22, 2688
    s_add_u32 s23, s23, 928
    s_mov_b32 m0, s23
    s_nop 0
    buffer_load_dwordx4 v21, s[8:11], s22 offen lds
    s_add_u32 s22, s22, 2688
    s_add_u32 s23, s23, 928
    s_mov_b32 m0, s23
    s_nop 0
    buffer_load_dwordx4 v21, s[8:11], s22 offen lds
    s_add_u32 s22, s22, 2688
    s_add_u32 s23, s23, 928
    s_mov_b32 m0, s23
    s_nop 0
    buffer_load_dwordx4 v21, s[8:11], s22 offen lds
    s_add_u32 s22, s22, 2688
    s_add_u32 s23, s23, 928
    s_mov_b32 m0, s23
    s_nop 0
    buffer_load_dwordx4 v21, s[8:11], s22 offen lds
    s_mul_i32 s22, s15, 21504
    s_add_u32 s22, s22, 86016
    s_add_u32 s22, s22, s46
    s_mul_i32 s23, s15, 7424
    s_add_u32 s23, s23, 29696
    s_mov_b32 m0, s23
    s_nop 0
    buffer_load_dwordx4 v21, s[8:11], s22 offen lds
    s_add_u32 s22, s22, 2688
    s_add_u32 s23, s23, 928
    s_mov_b32 m0, s23
    s_nop 0
    buffer_load_dwordx4 v21, s[8:11], s22 offen lds
    s_add_u32 s22, s22, 2688
    s_add_u32 s23, s23, 928
    s_mov_b32 m0, s23
    s_nop 0
    buffer_load_dwordx4 v21, s[8:11], s22 offen lds
    s_add_u32 s22, s22, 2688
    s_add_u32 s23, s23, 928
    s_mov_b32 m0, s23
    s_nop 0
    buffer_load_dwordx4 v21, s[8:11], s22 offen lds
    s_add_u32 s22, s22, 2688
    s_add_u32 s23, s23, 928
    s_mov_b32 m0, s23
    s_nop 0
    buffer_load_dwordx4 v21, s[8:11], s22 offen lds
    s_add_u32 s22, s22, 2688
    s_add_u32 s23, s23, 928
    s_mov_b32 m0, s23
    s_nop 0
    buffer_load_dwordx4 v21, s[8:11], s22 offen lds
    s_add_u32 s22, s22, 2688
    s_add_u32 s23, s23, 928
    s_mov_b32 m0, s23
    s_nop 0
    buffer_load_dwordx4 v21, s[8:11], s22 offen lds
    s_add_u32 s22, s22, 2688
    s_add_u32 s23, s23, 928
    s_mov_b32 m0, s23
    s_nop 0
    buffer_load_dwordx4 v21, s[8:11], s22 offen lds
    s_mul_i32 s22, s15, 21504
    s_add_u32 s22, s22, 172032
    s_add_u32 s22, s22, s46
    s_mul_i32 s23, s15, 7424
    s_add_u32 s23, s23, 59392
    s_mov_b32 m0, s23
    s_nop 0
    buffer_load_dwordx4 v21, s[8:11], s22 offen lds
    s_add_u32 s22, s22, 2688
    s_add_u32 s23, s23, 928
    s_mov_b32 m0, s23
    s_nop 0
    buffer_load_dwordx4 v21, s[8:11], s22 offen lds
    s_add_u32 s22, s22, 2688
    s_add_u32 s23, s23, 928
    s_mov_b32 m0, s23
    s_nop 0
    buffer_load_dwordx4 v21, s[8:11], s22 offen lds
    s_add_u32 s22, s22, 2688
    s_add_u32 s23, s23, 928
    s_mov_b32 m0, s23
    s_nop 0
    buffer_load_dwordx4 v21, s[8:11], s22 offen lds
    s_add_u32 s22, s22, 2688
    s_add_u32 s23, s23, 928
    s_mov_b32 m0, s23
    s_nop 0
    buffer_load_dwordx4 v21, s[8:11], s22 offen lds
    s_add_u32 s22, s22, 2688
    s_add_u32 s23, s23, 928
    s_mov_b32 m0, s23
    s_nop 0
    buffer_load_dwordx4 v21, s[8:11], s22 offen lds
    s_add_u32 s22, s22, 2688
    s_add_u32 s23, s23, 928
    s_mov_b32 m0, s23
    s_nop 0
    buffer_load_dwordx4 v21, s[8:11], s22 offen lds
    s_add_u32 s22, s22, 2688
    s_add_u32 s23, s23, 928
    s_mov_b32 m0, s23
    s_nop 0
    buffer_load_dwordx4 v21, s[8:11], s22 offen lds
    s_mul_i32 s22, s15, 21504
    s_add_u32 s22, s22, 258048
    s_add_u32 s22, s22, s46
    s_mul_i32 s23, s15, 7424
    s_add_u32 s23, s23, 89088
    s_mov_b32 m0, s23
    s_nop 0
    buffer_load_dwordx4 v21, s[8:11], s22 offen lds
    s_add_u32 s22, s22, 2688
    s_add_u32 s23, s23, 928
    s_mov_b32 m0, s23
    s_nop 0
    buffer_load_dwordx4 v21, s[8:11], s22 offen lds
    s_add_u32 s22, s22, 2688
    s_add_u32 s23, s23, 928
    s_mov_b32 m0, s23
    s_nop 0
    buffer_load_dwordx4 v21, s[8:11], s22 offen lds
    s_add_u32 s22, s22, 2688
    s_add_u32 s23, s23, 928
    s_mov_b32 m0, s23
    s_nop 0
    buffer_load_dwordx4 v21, s[8:11], s22 offen lds
    s_add_u32 s22, s22, 2688
    s_add_u32 s23, s23, 928
    s_mov_b32 m0, s23
    s_nop 0
    buffer_load_dwordx4 v21, s[8:11], s22 offen lds
    s_add_u32 s22, s22, 2688
    s_add_u32 s23, s23, 928
    s_mov_b32 m0, s23
    s_nop 0
    buffer_load_dwordx4 v21, s[8:11], s22 offen lds
    s_add_u32 s22, s22, 2688
    s_add_u32 s23, s23, 928
    s_mov_b32 m0, s23
    s_nop 0
    buffer_load_dwordx4 v21, s[8:11], s22 offen lds
    s_add_u32 s22, s22, 2688
    s_add_u32 s23, s23, 928
    s_mov_b32 m0, s23
    s_nop 0
    buffer_load_dwordx4 v21, s[8:11], s22 offen lds
    s_mul_i32 s22, s15, 21504
    s_add_u32 s22, s22, 344064
    s_add_u32 s22, s22, s46
    s_mul_i32 s23, s15, 7424
    s_add_u32 s23, s23, 118784
    s_mov_b32 m0, s23
    s_nop 0
    buffer_load_dwordx4 v21, s[8:11], s22 offen lds
    s_add_u32 s22, s22, 2688
    s_add_u32 s23, s23, 928
    s_mov_b32 m0, s23
    s_nop 0
    buffer_load_dwordx4 v21, s[8:11], s22 offen lds
    s_add_u32 s22, s22, 2688
    s_add_u32 s23, s23, 928
    s_mov_b32 m0, s23
    s_nop 0
    buffer_load_dwordx4 v21, s[8:11], s22 offen lds
    s_add_u32 s22, s22, 2688
    s_add_u32 s23, s23, 928
    s_mov_b32 m0, s23
    s_nop 0
    buffer_load_dwordx4 v21, s[8:11], s22 offen lds
    s_add_u32 s22, s22, 2688
    s_add_u32 s23, s23, 928
    s_mov_b32 m0, s23
    s_nop 0
    buffer_load_dwordx4 v21, s[8:11], s22 offen lds
    s_add_u32 s22, s22, 2688
    s_add_u32 s23, s23, 928
    s_mov_b32 m0, s23
    s_nop 0
    buffer_load_dwordx4 v21, s[8:11], s22 offen lds
    s_add_u32 s22, s22, 2688
    s_add_u32 s23, s23, 928
    s_mov_b32 m0, s23
    s_nop 0
    buffer_load_dwordx4 v21, s[8:11], s22 offen lds
    s_add_u32 s22, s22, 2688
    s_add_u32 s23, s23, 928
    s_mov_b32 m0, s23
    s_nop 0
    buffer_load_dwordx4 v21, s[8:11], s22 offen lds
    s_mov_b32 exec_hi, -1
    s_waitcnt vmcnt(0)
    s_barrier
    ds_read_b64_tr_b16 v[120:121], v20 offset:0
    ds_read_b64_tr_b16 v[122:123], v20 offset:3712
    ds_read_b64_tr_b16 v[176:177], v20 offset:32
    ds_read_b64_tr_b16 v[178:179], v20 offset:3744
    ds_read_b64_tr_b16 v[232:233], v20 offset:64
    ds_read_b64_tr_b16 v[234:235], v20 offset:3776
    ds_read_b64_tr_b16 a[32:33], v20 offset:96
    ds_read_b64_tr_b16 a[34:35], v20 offset:3808
    ds_read_b64_tr_b16 a[88:89], v20 offset:128
    ds_read_b64_tr_b16 a[90:91], v20 offset:3840
    ds_read_b64_tr_b16 a[144:145], v20 offset:160
    ds_read_b64_tr_b16 a[146:147], v20 offset:3872
    ds_read_b64_tr_b16 a[200:201], v20 offset:192
    ds_read_b64_tr_b16 a[202:203], v20 offset:3904
    s_waitcnt lgkmcnt(0)
    v_add_u32 v19, 29696, v19
    v_add_u32 v20, 29696, v20
    ds_read_b64_tr_b16 v[124:125], v20 offset:0
    ds_read_b64_tr_b16 v[126:127], v20 offset:3712
    ds_read_b64_tr_b16 v[180:181], v20 offset:32
    ds_read_b64_tr_b16 v[182:183], v20 offset:3744
    ds_read_b64_tr_b16 v[236:237], v20 offset:64
    ds_read_b64_tr_b16 v[238:239], v20 offset:3776
    ds_read_b64_tr_b16 a[36:37], v20 offset:96
    ds_read_b64_tr_b16 a[38:39], v20 offset:3808
    ds_read_b64_tr_b16 a[92:93], v20 offset:128
    ds_read_b64_tr_b16 a[94:95], v20 offset:3840
    ds_read_b64_tr_b16 a[148:149], v20 offset:160
    ds_read_b64_tr_b16 a[150:151], v20 offset:3872
    ds_read_b64_tr_b16 a[204:205], v20 offset:192
    ds_read_b64_tr_b16 a[206:207], v20 offset:3904
    s_waitcnt lgkmcnt(0)
    v_add_u32 v19, 29696, v19
    v_add_u32 v20, 29696, v20
    ds_read_b64_tr_b16 v[128:129], v20 offset:0
    ds_read_b64_tr_b16 v[130:131], v20 offset:3712
    ds_read_b64_tr_b16 v[184:185], v20 offset:32
    ds_read_b64_tr_b16 v[186:187], v20 offset:3744
    ds_read_b64_tr_b16 v[240:241], v20 offset:64
    ds_read_b64_tr_b16 v[242:243], v20 offset:3776
    ds_read_b64_tr_b16 a[40:41], v20 offset:96
    ds_read_b64_tr_b16 a[42:43], v20 offset:3808
    ds_read_b64_tr_b16 a[96:97], v20 offset:128
    ds_read_b64_tr_b16 a[98:99], v20 offset:3840
    ds_read_b64_tr_b16 a[152:153], v20 offset:160
    ds_read_b64_tr_b16 a[154:155], v20 offset:3872
    ds_read_b64_tr_b16 a[208:209], v20 offset:192
    ds_read_b64_tr_b16 a[210:211], v20 offset:3904
    s_waitcnt lgkmcnt(0)
    v_add_u32 v19, 29696, v19
    v_add_u32 v20, 29696, v20
    ds_read_b64_tr_b16 v[132:133], v20 offset:0
    ds_read_b64_tr_b16 v[134:135], v20 offset:3712
    ds_read_b64_tr_b16 v[188:189], v20 offset:32
    ds_read_b64_tr_b16 v[190:191], v20 offset:3744
    ds_read_b64_tr_b16 v[244:245], v20 offset:64
    ds_read_b64_tr_b16 v[246:247], v20 offset:3776
    ds_read_b64_tr_b16 a[44:45], v20 offset:96
    ds_read_b64_tr_b16 a[46:47], v20 offset:3808
    ds_read_b64_tr_b16 a[100:101], v20 offset:128
    ds_read_b64_tr_b16 a[102:103], v20 offset:3840
    ds_read_b64_tr_b16 a[156:157], v20 offset:160
    ds_read_b64_tr_b16 a[158:159], v20 offset:3872
    ds_read_b64_tr_b16 a[212:213], v20 offset:192
    ds_read_b64_tr_b16 a[214:215], v20 offset:3904
    s_waitcnt lgkmcnt(0)
    v_add_u32 v19, 29696, v19
    v_add_u32 v20, 29696, v20
    ds_read_b64_tr_b16 v[136:137], v20 offset:0
    ds_read_b64_tr_b16 v[138:139], v20 offset:3712
    ds_read_b64_tr_b16 v[192:193], v20 offset:32
    ds_read_b64_tr_b16 v[194:195], v20 offset:3744
    ds_read_b64_tr_b16 v[248:249], v20 offset:64
    ds_read_b64_tr_b16 v[250:251], v20 offset:3776
    ds_read_b64_tr_b16 a[48:49], v20 offset:96
    ds_read_b64_tr_b16 a[50:51], v20 offset:3808
    ds_read_b64_tr_b16 a[104:105], v20 offset:128
    ds_read_b64_tr_b16 a[106:107], v20 offset:3840
    ds_read_b64_tr_b16 a[160:161], v20 offset:160
    ds_read_b64_tr_b16 a[162:163], v20 offset:3872
    ds_read_b64_tr_b16 a[216:217], v20 offset:192
    ds_read_b64_tr_b16 a[218:219], v20 offset:3904
    s_waitcnt lgkmcnt(0)
    v_subrev_u32 v19, 118784, v19
    v_subrev_u32 v20, 118784, v20
    s_barrier
    s_mov_b32 exec_hi, 0x00ffffff
    s_mul_i32 s22, s15, 21504
    s_add_u32 s22, s22, 430080
    s_add_u32 s22, s22, s46
    s_mul_i32 s23, s15, 7424
    s_add_u32 s23, s23, 0
    s_mov_b32 m0, s23
    s_nop 0
    buffer_load_dwordx4 v21, s[8:11], s22 offen lds
    s_add_u32 s22, s22, 2688
    s_add_u32 s23, s23, 928
    s_mov_b32 m0, s23
    s_nop 0
    buffer_load_dwordx4 v21, s[8:11], s22 offen lds
    s_add_u32 s22, s22, 2688
    s_add_u32 s23, s23, 928
    s_mov_b32 m0, s23
    s_nop 0
    buffer_load_dwordx4 v21, s[8:11], s22 offen lds
    s_add_u32 s22, s22, 2688
    s_add_u32 s23, s23, 928
    s_mov_b32 m0, s23
    s_nop 0
    buffer_load_dwordx4 v21, s[8:11], s22 offen lds
    s_add_u32 s22, s22, 2688
    s_add_u32 s23, s23, 928
    s_mov_b32 m0, s23
    s_nop 0
    buffer_load_dwordx4 v21, s[8:11], s22 offen lds
    s_add_u32 s22, s22, 2688
    s_add_u32 s23, s23, 928
    s_mov_b32 m0, s23
    s_nop 0
    buffer_load_dwordx4 v21, s[8:11], s22 offen lds
    s_add_u32 s22, s22, 2688
    s_add_u32 s23, s23, 928
    s_mov_b32 m0, s23
    s_nop 0
    buffer_load_dwordx4 v21, s[8:11], s22 offen lds
    s_add_u32 s22, s22, 2688
    s_add_u32 s23, s23, 928
    s_mov_b32 m0, s23
    s_nop 0
    buffer_load_dwordx4 v21, s[8:11], s22 offen lds
    s_mul_i32 s22, s15, 21504
    s_add_u32 s22, s22, 516096
    s_add_u32 s22, s22, s46
    s_mul_i32 s23, s15, 7424
    s_add_u32 s23, s23, 29696
    s_mov_b32 m0, s23
    s_nop 0
    buffer_load_dwordx4 v21, s[8:11], s22 offen lds
    s_add_u32 s22, s22, 2688
    s_add_u32 s23, s23, 928
    s_mov_b32 m0, s23
    s_nop 0
    buffer_load_dwordx4 v21, s[8:11], s22 offen lds
    s_add_u32 s22, s22, 2688
    s_add_u32 s23, s23, 928
    s_mov_b32 m0, s23
    s_nop 0
    buffer_load_dwordx4 v21, s[8:11], s22 offen lds
    s_add_u32 s22, s22, 2688
    s_add_u32 s23, s23, 928
    s_mov_b32 m0, s23
    s_nop 0
    buffer_load_dwordx4 v21, s[8:11], s22 offen lds
    s_add_u32 s22, s22, 2688
    s_add_u32 s23, s23, 928
    s_mov_b32 m0, s23
    s_nop 0
    buffer_load_dwordx4 v21, s[8:11], s22 offen lds
    s_add_u32 s22, s22, 2688
    s_add_u32 s23, s23, 928
    s_mov_b32 m0, s23
    s_nop 0
    buffer_load_dwordx4 v21, s[8:11], s22 offen lds
    s_add_u32 s22, s22, 2688
    s_add_u32 s23, s23, 928
    s_mov_b32 m0, s23
    s_nop 0
    buffer_load_dwordx4 v21, s[8:11], s22 offen lds
    s_add_u32 s22, s22, 2688
    s_add_u32 s23, s23, 928
    s_mov_b32 m0, s23
    s_nop 0
    buffer_load_dwordx4 v21, s[8:11], s22 offen lds
    s_mul_i32 s22, s15, 21504
    s_add_u32 s22, s22, 602112
    s_add_u32 s22, s22, s46
    s_mul_i32 s23, s15, 7424
    s_add_u32 s23, s23, 59392
    s_mov_b32 m0, s23
    s_nop 0
    buffer_load_dwordx4 v21, s[8:11], s22 offen lds
    s_add_u32 s22, s22, 2688
    s_add_u32 s23, s23, 928
    s_mov_b32 m0, s23
    s_nop 0
    buffer_load_dwordx4 v21, s[8:11], s22 offen lds
    s_add_u32 s22, s22, 2688
    s_add_u32 s23, s23, 928
    s_mov_b32 m0, s23
    s_nop 0
    buffer_load_dwordx4 v21, s[8:11], s22 offen lds
    s_add_u32 s22, s22, 2688
    s_add_u32 s23, s23, 928
    s_mov_b32 m0, s23
    s_nop 0
    buffer_load_dwordx4 v21, s[8:11], s22 offen lds
    s_add_u32 s22, s22, 2688
    s_add_u32 s23, s23, 928
    s_mov_b32 m0, s23
    s_nop 0
    buffer_load_dwordx4 v21, s[8:11], s22 offen lds
    s_add_u32 s22, s22, 2688
    s_add_u32 s23, s23, 928
    s_mov_b32 m0, s23
    s_nop 0
    buffer_load_dwordx4 v21, s[8:11], s22 offen lds
    s_add_u32 s22, s22, 2688
    s_add_u32 s23, s23, 928
    s_mov_b32 m0, s23
    s_nop 0
    buffer_load_dwordx4 v21, s[8:11], s22 offen lds
    s_add_u32 s22, s22, 2688
    s_add_u32 s23, s23, 928
    s_mov_b32 m0, s23
    s_nop 0
    buffer_load_dwordx4 v21, s[8:11], s22 offen lds
    s_mul_i32 s22, s15, 21504
    s_add_u32 s22, s22, 688128
    s_add_u32 s22, s22, s46
    s_mul_i32 s23, s15, 7424
    s_add_u32 s23, s23, 89088
    s_mov_b32 m0, s23
    s_nop 0
    buffer_load_dwordx4 v21, s[8:11], s22 offen lds
    s_add_u32 s22, s22, 2688
    s_add_u32 s23, s23, 928
    s_mov_b32 m0, s23
    s_nop 0
    buffer_load_dwordx4 v21, s[8:11], s22 offen lds
    s_add_u32 s22, s22, 2688
    s_add_u32 s23, s23, 928
    s_mov_b32 m0, s23
    s_nop 0
    buffer_load_dwordx4 v21, s[8:11], s22 offen lds
    s_add_u32 s22, s22, 2688
    s_add_u32 s23, s23, 928
    s_mov_b32 m0, s23
    s_nop 0
    buffer_load_dwordx4 v21, s[8:11], s22 offen lds
    s_add_u32 s22, s22, 2688
    s_add_u32 s23, s23, 928
    s_mov_b32 m0, s23
    s_nop 0
    buffer_load_dwordx4 v21, s[8:11], s22 offen lds
    s_add_u32 s22, s22, 2688
    s_add_u32 s23, s23, 928
    s_mov_b32 m0, s23
    s_nop 0
    buffer_load_dwordx4 v21, s[8:11], s22 offen lds
    s_add_u32 s22, s22, 2688
    s_add_u32 s23, s23, 928
    s_mov_b32 m0, s23
    s_nop 0
    buffer_load_dwordx4 v21, s[8:11], s22 offen lds
    s_add_u32 s22, s22, 2688
    s_add_u32 s23, s23, 928
    s_mov_b32 m0, s23
    s_nop 0
    buffer_load_dwordx4 v21, s[8:11], s22 offen lds
    s_mul_i32 s22, s15, 21504
    s_add_u32 s22, s22, 774144
    s_add_u32 s22, s22, s46
    s_mul_i32 s23, s15, 7424
    s_add_u32 s23, s23, 118784
    s_mov_b32 m0, s23
    s_nop 0
    buffer_load_dwordx4 v21, s[8:11], s22 offen lds
    s_add_u32 s22, s22, 2688
    s_add_u32 s23, s23, 928
    s_mov_b32 m0, s23
    s_nop 0
    buffer_load_dwordx4 v21, s[8:11], s22 offen lds
    s_add_u32 s22, s22, 2688
    s_add_u32 s23, s23, 928
    s_mov_b32 m0, s23
    s_nop 0
    buffer_load_dwordx4 v21, s[8:11], s22 offen lds
    s_add_u32 s22, s22, 2688
    s_add_u32 s23, s23, 928
    s_mov_b32 m0, s23
    s_nop 0
    buffer_load_dwordx4 v21, s[8:11], s22 offen lds
    s_add_u32 s22, s22, 2688
    s_add_u32 s23, s23, 928
    s_mov_b32 m0, s23
    s_nop 0
    buffer_load_dwordx4 v21, s[8:11], s22 offen lds
    s_add_u32 s22, s22, 2688
    s_add_u32 s23, s23, 928
    s_mov_b32 m0, s23
    s_nop 0
    buffer_load_dwordx4 v21, s[8:11], s22 offen lds
    s_add_u32 s22, s22, 2688
    s_add_u32 s23, s23, 928
    s_mov_b32 m0, s23
    s_nop 0
    buffer_load_dwordx4 v21, s[8:11], s22 offen lds
    s_add_u32 s22, s22, 2688
    s_add_u32 s23, s23, 928
    s_mov_b32 m0, s23
    s_nop 0
    buffer_load_dwordx4 v21, s[8:11], s22 offen lds
    s_mov_b32 exec_hi, -1
    s_waitcnt vmcnt(0)
    s_barrier
    ds_read_b64_tr_b16 v[140:141], v20 offset:0
    ds_read_b64_tr_b16 v[142:143], v20 offset:3712
    ds_read_b64_tr_b16 v[196:197], v20 offset:32
    ds_read_b64_tr_b16 v[198:199], v20 offset:3744
    ds_read_b64_tr_b16 v[252:253], v20 offset:64
    ds_read_b64_tr_b16 v[254:255], v20 offset:3776
    ds_read_b64_tr_b16 a[52:53], v20 offset:96
    ds_read_b64_tr_b16 a[54:55], v20 offset:3808
    ds_read_b64_tr_b16 a[108:109], v20 offset:128
    ds_read_b64_tr_b16 a[110:111], v20 offset:3840
    ds_read_b64_tr_b16 a[164:165], v20 offset:160
    ds_read_b64_tr_b16 a[166:167], v20 offset:3872
    ds_read_b64_tr_b16 a[220:221], v20 offset:192
    ds_read_b64_tr_b16 a[222:223], v20 offset:3904
    s_waitcnt lgkmcnt(0)
    v_add_u32 v19, 29696, v19
    v_add_u32 v20, 29696, v20
    ds_read_b64_tr_b16 v[144:145], v20 offset:0
    ds_read_b64_tr_b16 v[146:147], v20 offset:3712
    ds_read_b64_tr_b16 v[200:201], v20 offset:32
    ds_read_b64_tr_b16 v[202:203], v20 offset:3744
    ds_read_b64_tr_b16 a[0:1], v20 offset:64
    ds_read_b64_tr_b16 a[2:3], v20 offset:3776
    ds_read_b64_tr_b16 a[56:57], v20 offset:96
    ds_read_b64_tr_b16 a[58:59], v20 offset:3808
    ds_read_b64_tr_b16 a[112:113], v20 offset:128
    ds_read_b64_tr_b16 a[114:115], v20 offset:3840
    ds_read_b64_tr_b16 a[168:169], v20 offset:160
    ds_read_b64_tr_b16 a[170:171], v20 offset:3872
    ds_read_b64_tr_b16 a[224:225], v20 offset:192
    ds_read_b64_tr_b16 a[226:227], v20 offset:3904
    s_waitcnt lgkmcnt(0)
    v_add_u32 v19, 29696, v19
    v_add_u32 v20, 29696, v20
    ds_read_b64_tr_b16 v[148:149], v20 offset:0
    ds_read_b64_tr_b16 v[150:151], v20 offset:3712
    ds_read_b64_tr_b16 v[204:205], v20 offset:32
    ds_read_b64_tr_b16 v[206:207], v20 offset:3744
    ds_read_b64_tr_b16 a[4:5], v20 offset:64
    ds_read_b64_tr_b16 a[6:7], v20 offset:3776
    ds_read_b64_tr_b16 a[60:61], v20 offset:96
    ds_read_b64_tr_b16 a[62:63], v20 offset:3808
    ds_read_b64_tr_b16 a[116:117], v20 offset:128
    ds_read_b64_tr_b16 a[118:119], v20 offset:3840
    ds_read_b64_tr_b16 a[172:173], v20 offset:160
    ds_read_b64_tr_b16 a[174:175], v20 offset:3872
    ds_read_b64_tr_b16 a[228:229], v20 offset:192
    ds_read_b64_tr_b16 a[230:231], v20 offset:3904
    s_waitcnt lgkmcnt(0)
    v_add_u32 v19, 29696, v19
    v_add_u32 v20, 29696, v20
    ds_read_b64_tr_b16 v[152:153], v20 offset:0
    ds_read_b64_tr_b16 v[154:155], v20 offset:3712
    ds_read_b64_tr_b16 v[208:209], v20 offset:32
    ds_read_b64_tr_b16 v[210:211], v20 offset:3744
    ds_read_b64_tr_b16 a[8:9], v20 offset:64
    ds_read_b64_tr_b16 a[10:11], v20 offset:3776
    ds_read_b64_tr_b16 a[64:65], v20 offset:96
    ds_read_b64_tr_b16 a[66:67], v20 offset:3808
    ds_read_b64_tr_b16 a[120:121], v20 offset:128
    ds_read_b64_tr_b16 a[122:123], v20 offset:3840
    ds_read_b64_tr_b16 a[176:177], v20 offset:160
    ds_read_b64_tr_b16 a[178:179], v20 offset:3872
    ds_read_b64_tr_b16 a[232:233], v20 offset:192
    ds_read_b64_tr_b16 a[234:235], v20 offset:3904
    s_waitcnt lgkmcnt(0)
    v_add_u32 v19, 29696, v19
    v_add_u32 v20, 29696, v20
    ds_read_b64_tr_b16 v[156:157], v20 offset:0
    ds_read_b64_tr_b16 v[158:159], v20 offset:3712
    ds_read_b64_tr_b16 v[212:213], v20 offset:32
    ds_read_b64_tr_b16 v[214:215], v20 offset:3744
    ds_read_b64_tr_b16 a[12:13], v20 offset:64
    ds_read_b64_tr_b16 a[14:15], v20 offset:3776
    ds_read_b64_tr_b16 a[68:69], v20 offset:96
    ds_read_b64_tr_b16 a[70:71], v20 offset:3808
    ds_read_b64_tr_b16 a[124:125], v20 offset:128
    ds_read_b64_tr_b16 a[126:127], v20 offset:3840
    ds_read_b64_tr_b16 a[180:181], v20 offset:160
    ds_read_b64_tr_b16 a[182:183], v20 offset:3872
    ds_read_b64_tr_b16 a[236:237], v20 offset:192
    ds_read_b64_tr_b16 a[238:239], v20 offset:3904
    s_waitcnt lgkmcnt(0)
    v_subrev_u32 v19, 118784, v19
    v_subrev_u32 v20, 118784, v20
    s_barrier
    s_mov_b32 exec_hi, 0x00ffffff
    s_mul_i32 s22, s15, 21504
    s_add_u32 s22, s22, 860160
    s_add_u32 s22, s22, s46
    s_mul_i32 s23, s15, 7424
    s_add_u32 s23, s23, 0
    s_mov_b32 m0, s23
    s_nop 0
    buffer_load_dwordx4 v21, s[8:11], s22 offen lds
    s_add_u32 s22, s22, 2688
    s_add_u32 s23, s23, 928
    s_mov_b32 m0, s23
    s_nop 0
    buffer_load_dwordx4 v21, s[8:11], s22 offen lds
    s_add_u32 s22, s22, 2688
    s_add_u32 s23, s23, 928
    s_mov_b32 m0, s23
    s_nop 0
    buffer_load_dwordx4 v21, s[8:11], s22 offen lds
    s_add_u32 s22, s22, 2688
    s_add_u32 s23, s23, 928
    s_mov_b32 m0, s23
    s_nop 0
    buffer_load_dwordx4 v21, s[8:11], s22 offen lds
    s_add_u32 s22, s22, 2688
    s_add_u32 s23, s23, 928
    s_mov_b32 m0, s23
    s_nop 0
    buffer_load_dwordx4 v21, s[8:11], s22 offen lds
    s_add_u32 s22, s22, 2688
    s_add_u32 s23, s23, 928
    s_mov_b32 m0, s23
    s_nop 0
    buffer_load_dwordx4 v21, s[8:11], s22 offen lds
    s_add_u32 s22, s22, 2688
    s_add_u32 s23, s23, 928
    s_mov_b32 m0, s23
    s_nop 0
    buffer_load_dwordx4 v21, s[8:11], s22 offen lds
    s_add_u32 s22, s22, 2688
    s_add_u32 s23, s23, 928
    s_mov_b32 m0, s23
    s_nop 0
    buffer_load_dwordx4 v21, s[8:11], s22 offen lds
    s_mul_i32 s22, s15, 21504
    s_add_u32 s22, s22, 946176
    s_add_u32 s22, s22, s46
    s_mul_i32 s23, s15, 7424
    s_add_u32 s23, s23, 29696
    s_mov_b32 m0, s23
    s_nop 0
    buffer_load_dwordx4 v21, s[8:11], s22 offen lds
    s_add_u32 s22, s22, 2688
    s_add_u32 s23, s23, 928
    s_mov_b32 m0, s23
    s_nop 0
    buffer_load_dwordx4 v21, s[8:11], s22 offen lds
    s_add_u32 s22, s22, 2688
    s_add_u32 s23, s23, 928
    s_mov_b32 m0, s23
    s_nop 0
    buffer_load_dwordx4 v21, s[8:11], s22 offen lds
    s_add_u32 s22, s22, 2688
    s_add_u32 s23, s23, 928
    s_mov_b32 m0, s23
    s_nop 0
    buffer_load_dwordx4 v21, s[8:11], s22 offen lds
    s_add_u32 s22, s22, 2688
    s_add_u32 s23, s23, 928
    s_mov_b32 m0, s23
    s_nop 0
    buffer_load_dwordx4 v21, s[8:11], s22 offen lds
    s_add_u32 s22, s22, 2688
    s_add_u32 s23, s23, 928
    s_mov_b32 m0, s23
    s_nop 0
    buffer_load_dwordx4 v21, s[8:11], s22 offen lds
    s_add_u32 s22, s22, 2688
    s_add_u32 s23, s23, 928
    s_mov_b32 m0, s23
    s_nop 0
    buffer_load_dwordx4 v21, s[8:11], s22 offen lds
    s_add_u32 s22, s22, 2688
    s_add_u32 s23, s23, 928
    s_mov_b32 m0, s23
    s_nop 0
    buffer_load_dwordx4 v21, s[8:11], s22 offen lds
    s_mul_i32 s22, s15, 21504
    s_add_u32 s22, s22, 1032192
    s_add_u32 s22, s22, s46
    s_mul_i32 s23, s15, 7424
    s_add_u32 s23, s23, 59392
    s_mov_b32 m0, s23
    s_nop 0
    buffer_load_dwordx4 v21, s[8:11], s22 offen lds
    s_add_u32 s22, s22, 2688
    s_add_u32 s23, s23, 928
    s_mov_b32 m0, s23
    s_nop 0
    buffer_load_dwordx4 v21, s[8:11], s22 offen lds
    s_add_u32 s22, s22, 2688
    s_add_u32 s23, s23, 928
    s_mov_b32 m0, s23
    s_nop 0
    buffer_load_dwordx4 v21, s[8:11], s22 offen lds
    s_add_u32 s22, s22, 2688
    s_add_u32 s23, s23, 928
    s_mov_b32 m0, s23
    s_nop 0
    buffer_load_dwordx4 v21, s[8:11], s22 offen lds
    s_add_u32 s22, s22, 2688
    s_add_u32 s23, s23, 928
    s_mov_b32 m0, s23
    s_nop 0
    buffer_load_dwordx4 v21, s[8:11], s22 offen lds
    s_add_u32 s22, s22, 2688
    s_add_u32 s23, s23, 928
    s_mov_b32 m0, s23
    s_nop 0
    buffer_load_dwordx4 v21, s[8:11], s22 offen lds
    s_add_u32 s22, s22, 2688
    s_add_u32 s23, s23, 928
    s_mov_b32 m0, s23
    s_nop 0
    buffer_load_dwordx4 v21, s[8:11], s22 offen lds
    s_add_u32 s22, s22, 2688
    s_add_u32 s23, s23, 928
    s_mov_b32 m0, s23
    s_nop 0
    buffer_load_dwordx4 v21, s[8:11], s22 offen lds
    s_mul_i32 s22, s15, 21504
    s_add_u32 s22, s22, 1118208
    s_add_u32 s22, s22, s46
    s_mul_i32 s23, s15, 7424
    s_add_u32 s23, s23, 89088
    s_mov_b32 m0, s23
    s_nop 0
    buffer_load_dwordx4 v21, s[8:11], s22 offen lds
    s_add_u32 s22, s22, 2688
    s_add_u32 s23, s23, 928
    s_mov_b32 m0, s23
    s_nop 0
    buffer_load_dwordx4 v21, s[8:11], s22 offen lds
    s_add_u32 s22, s22, 2688
    s_add_u32 s23, s23, 928
    s_mov_b32 m0, s23
    s_nop 0
    buffer_load_dwordx4 v21, s[8:11], s22 offen lds
    s_add_u32 s22, s22, 2688
    s_add_u32 s23, s23, 928
    s_mov_b32 m0, s23
    s_nop 0
    buffer_load_dwordx4 v21, s[8:11], s22 offen lds
    s_add_u32 s22, s22, 2688
    s_add_u32 s23, s23, 928
    s_mov_b32 m0, s23
    s_nop 0
    buffer_load_dwordx4 v21, s[8:11], s22 offen lds
    s_add_u32 s22, s22, 2688
    s_add_u32 s23, s23, 928
    s_mov_b32 m0, s23
    s_nop 0
    buffer_load_dwordx4 v21, s[8:11], s22 offen lds
    s_add_u32 s22, s22, 2688
    s_add_u32 s23, s23, 928
    s_mov_b32 m0, s23
    s_nop 0
    buffer_load_dwordx4 v21, s[8:11], s22 offen lds
    s_add_u32 s22, s22, 2688
    s_add_u32 s23, s23, 928
    s_mov_b32 m0, s23
    s_nop 0
    buffer_load_dwordx4 v21, s[8:11], s22 offen lds
    s_mov_b32 exec_hi, -1
    s_waitcnt vmcnt(0)
    s_barrier
    ds_read_b64_tr_b16 v[160:161], v20 offset:0
    ds_read_b64_tr_b16 v[162:163], v20 offset:3712
    ds_read_b64_tr_b16 v[216:217], v20 offset:32
    ds_read_b64_tr_b16 v[218:219], v20 offset:3744
    ds_read_b64_tr_b16 a[16:17], v20 offset:64
    ds_read_b64_tr_b16 a[18:19], v20 offset:3776
    ds_read_b64_tr_b16 a[72:73], v20 offset:96
    ds_read_b64_tr_b16 a[74:75], v20 offset:3808
    ds_read_b64_tr_b16 a[128:129], v20 offset:128
    ds_read_b64_tr_b16 a[130:131], v20 offset:3840
    ds_read_b64_tr_b16 a[184:185], v20 offset:160
    ds_read_b64_tr_b16 a[186:187], v20 offset:3872
    ds_read_b64_tr_b16 a[240:241], v20 offset:192
    ds_read_b64_tr_b16 a[242:243], v20 offset:3904
    s_waitcnt lgkmcnt(0)
    v_add_u32 v19, 29696, v19
    v_add_u32 v20, 29696, v20
    ds_read_b64_tr_b16 v[164:165], v20 offset:0
    ds_read_b64_tr_b16 v[166:167], v20 offset:3712
    ds_read_b64_tr_b16 v[220:221], v20 offset:32
    ds_read_b64_tr_b16 v[222:223], v20 offset:3744
    ds_read_b64_tr_b16 a[20:21], v20 offset:64
    ds_read_b64_tr_b16 a[22:23], v20 offset:3776
    ds_read_b64_tr_b16 a[76:77], v20 offset:96
    ds_read_b64_tr_b16 a[78:79], v20 offset:3808
    ds_read_b64_tr_b16 a[132:133], v20 offset:128
    ds_read_b64_tr_b16 a[134:135], v20 offset:3840
    ds_read_b64_tr_b16 a[188:189], v20 offset:160
    ds_read_b64_tr_b16 a[190:191], v20 offset:3872
    ds_read_b64_tr_b16 a[244:245], v20 offset:192
    ds_read_b64_tr_b16 a[246:247], v20 offset:3904
    s_waitcnt lgkmcnt(0)
    v_add_u32 v19, 29696, v19
    v_add_u32 v20, 29696, v20
    ds_read_b64_tr_b16 v[168:169], v20 offset:0
    ds_read_b64_tr_b16 v[170:171], v20 offset:3712
    ds_read_b64_tr_b16 v[224:225], v20 offset:32
    ds_read_b64_tr_b16 v[226:227], v20 offset:3744
    ds_read_b64_tr_b16 a[24:25], v20 offset:64
    ds_read_b64_tr_b16 a[26:27], v20 offset:3776
    ds_read_b64_tr_b16 a[80:81], v20 offset:96
    ds_read_b64_tr_b16 a[82:83], v20 offset:3808
    ds_read_b64_tr_b16 a[136:137], v20 offset:128
    ds_read_b64_tr_b16 a[138:139], v20 offset:3840
    ds_read_b64_tr_b16 a[192:193], v20 offset:160
    ds_read_b64_tr_b16 a[194:195], v20 offset:3872
    ds_read_b64_tr_b16 a[248:249], v20 offset:192
    ds_read_b64_tr_b16 a[250:251], v20 offset:3904
    s_waitcnt lgkmcnt(0)
    v_add_u32 v19, 29696, v19
    v_add_u32 v20, 29696, v20
    ds_read_b64_tr_b16 v[172:173], v20 offset:0
    ds_read_b64_tr_b16 v[174:175], v20 offset:3712
    ds_read_b64_tr_b16 v[228:229], v20 offset:32
    ds_read_b64_tr_b16 v[230:231], v20 offset:3744
    ds_read_b64_tr_b16 a[28:29], v20 offset:64
    ds_read_b64_tr_b16 a[30:31], v20 offset:3776
    ds_read_b64_tr_b16 a[84:85], v20 offset:96
    ds_read_b64_tr_b16 a[86:87], v20 offset:3808
    ds_read_b64_tr_b16 a[140:141], v20 offset:128
    ds_read_b64_tr_b16 a[142:143], v20 offset:3840
    ds_read_b64_tr_b16 a[196:197], v20 offset:160
    ds_read_b64_tr_b16 a[198:199], v20 offset:3872
    ds_read_b64_tr_b16 a[252:253], v20 offset:192
    ds_read_b64_tr_b16 a[254:255], v20 offset:3904
    s_waitcnt lgkmcnt(0)
    v_subrev_u32 v19, 89088, v19
    v_subrev_u32 v20, 89088, v20
    s_barrier
    v_mov_b32 v4, 0
    v_mov_b32 v15, 0
    v_lshrrev_b32 v16, 4, v0
    v_and_b32 v17, 15, v0
    v_cmp_gt_u32 s[48:49], 14, v17
    v_min_u32 v17, 13, v17
    v_mul_u32_u24 v5, 896, v16
    v_lshl_add_u32 v5, v17, 4, v5
    s_mul_i32 s18, s44, 14336
    v_add_u32 v5, s18, v5
    v_mul_u32_u24 v6, 928, v16
    v_lshl_add_u32 v6, v17, 4, v6
    v_and_b32 v19, 63, v0
    v_and_b32 v20, 15, v19
    v_lshrrev_b32 v21, 4, v19
    v_mul_u32_u24 v2, 928, v20
    v_lshl_add_u32 v2, v21, 4, v2
    v_add_u32 v2, 0, v2
    v_add_u32 v3, 14848, v2
    v_and_b32 v16, 63, v0
    v_and_b32 v17, 15, v16
    v_lshrrev_b32 v18, 4, v16
    s_cmp_eq_u32 s43, 2
    s_cbranch_scc1 L_QKV_v_207
    s_mul_i32 s18, s15, 112
    s_add_u32 s18, s18, 0
    v_lshlrev_b32 v19, 2, v18
    v_add_u32 v19, s18, v19
    s_mov_b32 s19, 2341
    v_mul_u32_u24 v20, s19, v19
    v_lshrrev_b32 v20, 16, v20
    v_mul_u32_u24 v21, 28, v20
    v_sub_u32 v21, v19, v21
    v_mul_u32_u24 v8, 1280, v20
    v_mul_u32_u24 v20, 80, v17
    v_add_u32 v8, v8, v20
    v_lshl_add_u32 v8, v21, 1, v8
    v_add_u32 v8, 29696, v8
    s_mul_i32 s18, s15, 112
    s_add_u32 s18, s18, 16
    v_lshlrev_b32 v19, 2, v18
    v_add_u32 v19, s18, v19
    s_mov_b32 s19, 2341
    v_mul_u32_u24 v20, s19, v19
    v_lshrrev_b32 v20, 16, v20
    v_mul_u32_u24 v21, 28, v20
    v_sub_u32 v21, v19, v21
    v_mul_u32_u24 v9, 1280, v20
    v_mul_u32_u24 v20, 80, v17
    v_add_u32 v9, v9, v20
    v_lshl_add_u32 v9, v21, 1, v9
    v_add_u32 v9, 29696, v9
    s_mul_i32 s18, s15, 112
    s_add_u32 s18, s18, 32
    v_lshlrev_b32 v19, 2, v18
    v_add_u32 v19, s18, v19
    s_mov_b32 s19, 2341
    v_mul_u32_u24 v20, s19, v19
    v_lshrrev_b32 v20, 16, v20
    v_mul_u32_u24 v21, 28, v20
    v_sub_u32 v21, v19, v21
    v_mul_u32_u24 v10, 1280, v20
    v_mul_u32_u24 v20, 80, v17
    v_add_u32 v10, v10, v20
    v_lshl_add_u32 v10, v21, 1, v10
    v_add_u32 v10, 29696, v10
    s_mul_i32 s18, s15, 112
    s_add_u32 s18, s18, 48
    v_lshlrev_b32 v19, 2, v18
    v_add_u32 v19, s18, v19
    s_mov_b32 s19, 2341
    v_mul_u32_u24 v20, s19, v19
    v_lshrrev_b32 v20, 16, v20
    v_mul_u32_u24 v21, 28, v20
    v_sub_u32 v21, v19, v21
    v_mul_u32_u24 v11, 1280, v20
    v_mul_u32_u24 v20, 80, v17
    v_add_u32 v11, v11, v20
    v_lshl_add_u32 v11, v21, 1, v11
    v_add_u32 v11, 29696, v11
    s_mul_i32 s18, s15, 112
    s_add_u32 s18, s18, 64
    v_lshlrev_b32 v19, 2, v18
    v_add_u32 v19, s18, v19
    s_mov_b32 s19, 2341
    v_mul_u32_u24 v20, s19, v19
    v_lshrrev_b32 v20, 16, v20
    v_mul_u32_u24 v21, 28, v20
    v_sub_u32 v21, v19, v21
    v_mul_u32_u24 v12, 1280, v20
    v_mul_u32_u24 v20, 80, v17
    v_add_u32 v12, v12, v20
    v_lshl_add_u32 v12, v21, 1, v12
    v_add_u32 v12, 29696, v12
    s_mul_i32 s18, s15, 112
    s_add_u32 s18, s18, 80
    v_lshlrev_b32 v19, 2, v18
    v_add_u32 v19, s18, v19
    s_mov_b32 s19, 2341
    v_mul_u32_u24 v20, s19, v19
    v_lshrrev_b32 v20, 16, v20
    v_mul_u32_u24 v21, 28, v20
    v_sub_u32 v21, v19, v21
    v_mul_u32_u24 v13, 1280, v20
    v_mul_u32_u24 v20, 80, v17
    v_add_u32 v13, v13, v20
    v_lshl_add_u32 v13, v21, 1, v13
    v_add_u32 v13, 29696, v13
    s_mul_i32 s18, s15, 112
    s_add_u32 s18, s18, 96
    v_lshlrev_b32 v19, 2, v18
    v_add_u32 v19, s18, v19
    s_mov_b32 s19, 2341
    v_mul_u32_u24 v20, s19, v19
    v_lshrrev_b32 v20, 16, v20
    v_mul_u32_u24 v21, 28, v20
    v_sub_u32 v21, v19, v21
    v_mul_u32_u24 v14, 1280, v20
    v_mul_u32_u24 v20, 80, v17
    v_add_u32 v14, v14, v20
    v_lshl_add_u32 v14, v21, 1, v14
    v_add_u32 v14, 29696, v14
    v_lshrrev_b32 v19, 4, v0
    v_mul_u32_u24 v7, 1280, v19
    v_and_b32 v19, 15, v0
    v_mul_u32_u24 v19, 80, v19
    v_add_u32 v7, v7, v19
    v_add_u32 v7, 29752, v7
    v_mov_b32 v22, 0
    v_mov_b32 v23, 0
    ds_write_b64 v7, v[22:23]
    v_lshrrev_b32 v19, 2, v16
    v_mul_u32_u24 v40, 80, v19
    v_and_b32 v19, 3, v16
    v_lshl_add_u32 v40, v19, 4, v40
    s_nop 0
    s_branch L_QKV_j_208
L_QKV_v_207:
    s_mul_i32 s18, s15, 112
    s_add_u32 s18, s18, 0
    v_add_u32 v19, s18, v17
    s_mov_b32 s19, 2341
    v_mul_u32_u24 v20, s19, v19
    v_lshrrev_b32 v20, 16, v20
    v_mul_u32_u24 v21, 28, v20
    v_sub_u32 v21, v19, v21
    v_mul_u32_u24 v8, 1280, v20
    v_lshrrev_b32 v20, 1, v18
    v_lshl_add_u32 v8, v20, 9, v8
    v_lshl_add_u32 v8, v21, 4, v8
    v_and_b32 v20, 1, v18
    v_lshl_add_u32 v8, v20, 3, v8
    v_add_u32 v8, 29696, v8
    s_mul_i32 s18, s15, 112
    s_add_u32 s18, s18, 16
    v_add_u32 v19, s18, v17
    s_mov_b32 s19, 2341
    v_mul_u32_u24 v20, s19, v19
    v_lshrrev_b32 v20, 16, v20
    v_mul_u32_u24 v21, 28, v20
    v_sub_u32 v21, v19, v21
    v_mul_u32_u24 v9, 1280, v20
    v_lshrrev_b32 v20, 1, v18
    v_lshl_add_u32 v9, v20, 9, v9
    v_lshl_add_u32 v9, v21, 4, v9
    v_and_b32 v20, 1, v18
    v_lshl_add_u32 v9, v20, 3, v9
    v_add_u32 v9, 29696, v9
    s_mul_i32 s18, s15, 112
    s_add_u32 s18, s18, 32
    v_add_u32 v19, s18, v17
    s_mov_b32 s19, 2341
    v_mul_u32_u24 v20, s19, v19
    v_lshrrev_b32 v20, 16, v20
    v_mul_u32_u24 v21, 28, v20
    v_sub_u32 v21, v19, v21
    v_mul_u32_u24 v10, 1280, v20
    v_lshrrev_b32 v20, 1, v18
    v_lshl_add_u32 v10, v20, 9, v10
    v_lshl_add_u32 v10, v21, 4, v10
    v_and_b32 v20, 1, v18
    v_lshl_add_u32 v10, v20, 3, v10
    v_add_u32 v10, 29696, v10
    s_mul_i32 s18, s15, 112
    s_add_u32 s18, s18, 48
    v_add_u32 v19, s18, v17
    s_mov_b32 s19, 2341
    v_mul_u32_u24 v20, s19, v19
    v_lshrrev_b32 v20, 16, v20
    v_mul_u32_u24 v21, 28, v20
    v_sub_u32 v21, v19, v21
    v_mul_u32_u24 v11, 1280, v20
    v_lshrrev_b32 v20, 1, v18
    v_lshl_add_u32 v11, v20, 9, v11
    v_lshl_add_u32 v11, v21, 4, v11
    v_and_b32 v20, 1, v18
    v_lshl_add_u32 v11, v20, 3, v11
    v_add_u32 v11, 29696, v11
    s_mul_i32 s18, s15, 112
    s_add_u32 s18, s18, 64
    v_add_u32 v19, s18, v17
    s_mov_b32 s19, 2341
    v_mul_u32_u24 v20, s19, v19
    v_lshrrev_b32 v20, 16, v20
    v_mul_u32_u24 v21, 28, v20
    v_sub_u32 v21, v19, v21
    v_mul_u32_u24 v12, 1280, v20
    v_lshrrev_b32 v20, 1, v18
    v_lshl_add_u32 v12, v20, 9, v12
    v_lshl_add_u32 v12, v21, 4, v12
    v_and_b32 v20, 1, v18
    v_lshl_add_u32 v12, v20, 3, v12
    v_add_u32 v12, 29696, v12
    s_mul_i32 s18, s15, 112
    s_add_u32 s18, s18, 80
    v_add_u32 v19, s18, v17
    s_mov_b32 s19, 2341
    v_mul_u32_u24 v20, s19, v19
    v_lshrrev_b32 v20, 16, v20
    v_mul_u32_u24 v21, 28, v20
    v_sub_u32 v21, v19, v21
    v_mul_u32_u24 v13, 1280, v20
    v_lshrrev_b32 v20, 1, v18
    v_lshl_add_u32 v13, v20, 9, v13
    v_lshl_add_u32 v13, v21, 4, v13
    v_and_b32 v20, 1, v18
    v_lshl_add_u32 v13, v20, 3, v13
    v_add_u32 v13, 29696, v13
    s_mul_i32 s18, s15, 112
    s_add_u32 s18, s18, 96
    v_add_u32 v19, s18, v17
    s_mov_b32 s19, 2341
    v_mul_u32_u24 v20, s19, v19
    v_lshrrev_b32 v20, 16, v20
    v_mul_u32_u24 v21, 28, v20
    v_sub_u32 v21, v19, v21
    v_mul_u32_u24 v14, 1280, v20
    v_lshrrev_b32 v20, 1, v18
    v_lshl_add_u32 v14, v20, 9, v14
    v_lshl_add_u32 v14, v21, 4, v14
    v_and_b32 v20, 1, v18
    v_lshl_add_u32 v14, v20, 3, v14
    v_add_u32 v14, 29696, v14
    v_bfe_u32 v19, v0, 3, 4
    v_mul_u32_u24 v7, 1280, v19
    v_bfe_u32 v19, v0, 2, 1
    v_lshl_add_u32 v7, v19, 9, v7
    v_and_b32 v19, 3, v0
    v_add_u32 v20, 28, v19
    v_lshl_add_u32 v7, v20, 4, v7
    v_add_u32 v7, 29696, v7
    v_mov_b32 v24, 0x3f803f80
    v_cmp_eq_u32 vcc, 0, v19
    s_nop 1
    v_cndmask_b32 v24, v4, v24, vcc
    v_mov_b32 v25, v24
    v_mov_b32 v26, v24
    v_mov_b32 v27, v24
    ds_write_b128 v7, v[24:27]
    v_lshlrev_b32 v40, 4, v16
    s_nop 1
L_QKV_j_208:
    s_mul_i32 s18, s15, 5120
    s_add_u32 s18, s18, 29696
    v_add_u32 v40, s18, v40
    v_lshlrev_b32 v41, 4, v16
    s_lshl_b32 s18, s15, 13
    v_add_u32 v41, s18, v41
    s_waitcnt lgkmcnt(0)
    s_mov_b32 s32, 400000
    v_mbcnt_lo_u32_b32 v45, -1, 0
    v_add_u32 v45, 8, v45
    v_lshlrev_b32 v45, 2, v45
    s_mov_b64 exec, 1
    s_nop 0
L_dw_210:
    global_load_dword v44, v45, s[36:37] sc1
    s_waitcnt vmcnt(0)
    v_cmp_gt_u32 vcc, 256, v44
    s_nop 3
    s_cbranch_vccz L_dwok_211
    s_sleep 1
    s_sub_u32 s32, s32, 1
    s_cmp_lg_u32 s32, 0
    s_cbranch_scc1 L_dw_210
    s_branch L_fail
L_dwok_211:
    s_mov_b64 exec, -1
L_iok_209:
    s_mov_b32 s45, 0
    s_cmp_eq_u32 s13, 0
    s_mov_b32 s50, 0x78f8000
    s_cselect_b32 s50, 0x78e8000, s50
    s_cmp_eq_u32 s13, 0
    s_mov_b32 s51, 0x1982000
    s_cselect_b32 s51, 0x17c2000, s51
    s_cmp_eq_u32 s13, 0
    s_mov_b32 s52, 0x78fa000
    s_cselect_b32 s52, 0x78ea000, s52
    s_cmp_eq_u32 s13, 0
    s_mov_b32 s53, 0x6ee4000
    s_cselect_b32 s53, 0x6ce4000, s53
    s_cmp_eq_u32 s13, 0
    s_mov_b32 s20, 0x72e4000
    s_cselect_b32 s20, 0x70e4000, s20
    s_cmp_eq_u32 s13, 0
    s_mov_b32 s21, 0x76e4000
    s_cselect_b32 s21, 0x74e4000, s21
    s_cmp_eq_u32 s43, 1
    s_cselect_b32 s53, s20, s53
    s_cmp_eq_u32 s43, 2
    s_cselect_b32 s53, s21, s53
    s_lshl_b32 s18, s44, 10
    s_add_u32 s53, s53, s18
    s_lshl_b32 s54, s12, 2
    s_add_u32 s54, s54, s15
    s_mov_b32 s16, s38
L_QKV_loop:
    s_cmp_eq_u32 s45, 1
    s_cbranch_scc1 L_Qrdy_212
    s_mov_b32 s32, 400000
    v_mbcnt_lo_u32_b32 v17, -1, 0
    v_lshlrev_b32 v17, 2, v17
    s_mov_b32 exec_lo, 0x7f
    s_mov_b32 exec_hi, 0
L_wf_213:
    buffer_load_dword v16, v17, s[4:7], s50 offen sc1
    s_waitcnt vmcnt(0)
    v_cmp_eq_u32 vcc, 0, v16
    s_nop 3
    s_cbranch_vccz L_wfok_214
    s_sleep 1
    s_sub_u32 s32, s32, 1
    s_cmp_lg_u32 s32, 0
    s_cbranch_scc1 L_wf_213
    s_branch L_fail
L_wfok_214:
    s_mov_b64 exec, -1
    s_mov_b32 s41, s51
    buffer_load_dwordx4 v[24:27], v5, s[4:7], s41 offen offset:0 sc1
    buffer_load_dwordx4 v[28:31], v5, s[4:7], s41 offen offset:224 sc1
    buffer_load_dwordx4 v[32:35], v5, s[4:7], s41 offen offset:448 sc1
    buffer_load_dwordx4 v[36:39], v5, s[4:7], s41 offen offset:672 sc1
L_Qrdy_212:
    s_add_u32 s40, s50, 128
    v_mbcnt_lo_u32_b32 v20, -1, 0
    v_lshlrev_b32 v20, 2, v20
    s_mov_b32 exec_lo, -1
    s_mov_b32 exec_hi, 0
    buffer_load_dword v15, v20, s[4:7], s40 offen sc1
    s_mov_b64 exec, -1
    v_lshlrev_b32 v16, 7, v0
    s_add_u32 s18, s51, 57344
    s_cmp_lg_u32 s14, 0
    s_cselect_b32 s27, 126898176, s18
    buffer_load_dword v17, v16, s[4:7], s27 offen sc1
    s_waitcnt vmcnt(2)
    v_lshlrev_b32 v64, 16, v24
    v_and_b32 v65, 0xffff0000, v24
    v_lshlrev_b32 v66, 16, v25
    v_and_b32 v67, 0xffff0000, v25
    v_lshlrev_b32 v68, 16, v26
    v_and_b32 v69, 0xffff0000, v26
    v_lshlrev_b32 v70, 16, v27
    v_and_b32 v71, 0xffff0000, v27
    v_lshlrev_b32 v72, 16, v28
    v_and_b32 v73, 0xffff0000, v28
    v_lshlrev_b32 v74, 16, v29
    v_and_b32 v75, 0xffff0000, v29
    v_lshlrev_b32 v76, 16, v30
    v_and_b32 v77, 0xffff0000, v30
    v_lshlrev_b32 v78, 16, v31
    v_and_b32 v79, 0xffff0000, v31
    v_lshlrev_b32 v80, 16, v32
    v_and_b32 v81, 0xffff0000, v32
    v_lshlrev_b32 v82, 16, v33
    v_and_b32 v83, 0xffff0000, v33
    v_lshlrev_b32 v84, 16, v34
    v_and_b32 v85, 0xffff0000, v34
    v_lshlrev_b32 v86, 16, v35
    v_and_b32 v87, 0xffff0000, v35
    v_lshlrev_b32 v88, 16, v36
    v_and_b32 v89, 0xffff0000, v36
    v_lshlrev_b32 v90, 16, v37
    v_and_b32 v91, 0xffff0000, v37
    v_lshlrev_b32 v92, 16, v38
    v_and_b32 v93, 0xffff0000, v38
    v_lshlrev_b32 v94, 16, v39
    v_and_b32 v95, 0xffff0000, v39
    v_pk_add_f32 v[18:19], v[64:65], v[66:67]
    v_pk_add_f32 v[20:21], v[68:69], v[70:71]
    v_pk_add_f32 v[18:19], v[18:19], v[72:73]
    v_pk_add_f32 v[20:21], v[20:21], v[74:75]
    v_pk_add_f32 v[18:19], v[18:19], v[76:77]
    v_pk_add_f32 v[20:21], v[20:21], v[78:79]
    v_pk_add_f32 v[18:19], v[18:19], v[80:81]
    v_pk_add_f32 v[20:21], v[20:21], v[82:83]
    v_pk_add_f32 v[18:19], v[18:19], v[84:85]
    v_pk_add_f32 v[20:21], v[20:21], v[86:87]
    v_pk_add_f32 v[18:19], v[18:19], v[88:89]
    v_pk_add_f32 v[20:21], v[20:21], v[90:91]
    v_pk_add_f32 v[18:19], v[18:19], v[92:93]
    v_pk_add_f32 v[20:21], v[20:21], v[94:95]
    v_pk_add_f32 v[18:19], v[18:19], v[20:21]
    v_add_f32 v16, v18, v19
    v_cndmask_b32 v16, 0, v16, s[48:49]
    s_nop 1
    v_add_f32_dpp v16, v16, v16 row_ror:1 row_mask:0xf bank_mask:0xf
    s_nop 1
    v_add_f32_dpp v16, v16, v16 row_ror:2 row_mask:0xf bank_mask:0xf
    s_nop 1
    v_add_f32_dpp v16, v16, v16 row_ror:4 row_mask:0xf bank_mask:0xf
    s_nop 1
    v_add_f32_dpp v16, v16, v16 row_ror:8 row_mask:0xf bank_mask:0xf
    v_mul_f32 v20, 0xbb124925, v16
    v_mov_b32 v21, v20
    v_pk_add_f32 v[64:65], v[64:65], v[20:21]
    v_pk_add_f32 v[66:67], v[66:67], v[20:21]
    v_pk_add_f32 v[68:69], v[68:69], v[20:21]
    v_pk_add_f32 v[70:71], v[70:71], v[20:21]
    v_pk_add_f32 v[72:73], v[72:73], v[20:21]
    v_pk_add_f32 v[74:75], v[74:75], v[20:21]
    v_pk_add_f32 v[76:77], v[76:77], v[20:21]
    v_pk_add_f32 v[78:79], v[78:79], v[20:21]
    v_pk_add_f32 v[80:81], v[80:81], v[20:21]
    v_pk_add_f32 v[82:83], v[82:83], v[20:21]
    v_pk_add_f32 v[84:85], v[84:85], v[20:21]
    v_pk_add_f32 v[86:87], v[86:87], v[20:21]
    v_pk_add_f32 v[88:89], v[88:89], v[20:21]
    v_pk_add_f32 v[90:91], v[90:91], v[20:21]
    v_pk_add_f32 v[92:93], v[92:93], v[20:21]
    v_pk_add_f32 v[94:95], v[94:95], v[20:21]
    v_pk_mul_f32 v[18:19], v[64:65], v[64:65]
    v_pk_mul_f32 v[20:21], v[66:67], v[66:67]
    v_pk_fma_f32 v[18:19], v[68:69], v[68:69], v[18:19]
    v_pk_fma_f32 v[20:21], v[70:71], v[70:71], v[20:21]
    v_pk_fma_f32 v[18:19], v[72:73], v[72:73], v[18:19]
    v_pk_fma_f32 v[20:21], v[74:75], v[74:75], v[20:21]
    v_pk_fma_f32 v[18:19], v[76:77], v[76:77], v[18:19]
    v_pk_fma_f32 v[20:21], v[78:79], v[78:79], v[20:21]
    v_pk_fma_f32 v[18:19], v[80:81], v[80:81], v[18:19]
    v_pk_fma_f32 v[20:21], v[82:83], v[82:83], v[20:21]
    v_pk_fma_f32 v[18:19], v[84:85], v[84:85], v[18:19]
    v_pk_fma_f32 v[20:21], v[86:87], v[86:87], v[20:21]
    v_pk_fma_f32 v[18:19], v[88:89], v[88:89], v[18:19]
    v_pk_fma_f32 v[20:21], v[90:91], v[90:91], v[20:21]
    v_pk_fma_f32 v[18:19], v[92:93], v[92:93], v[18:19]
    v_pk_fma_f32 v[20:21], v[94:95], v[94:95], v[20:21]
    v_pk_add_f32 v[18:19], v[18:19], v[20:21]
    v_add_f32 v16, v18, v19
    v_cndmask_b32 v16, 0, v16, s[48:49]
    s_nop 1
    v_add_f32_dpp v16, v16, v16 row_ror:1 row_mask:0xf bank_mask:0xf
    s_nop 1
    v_add_f32_dpp v16, v16, v16 row_ror:2 row_mask:0xf bank_mask:0xf
    s_nop 1
    v_add_f32_dpp v16, v16, v16 row_ror:4 row_mask:0xf bank_mask:0xf
    s_nop 1
    v_add_f32_dpp v16, v16, v16 row_ror:8 row_mask:0xf bank_mask:0xf
    v_mov_b32 v18, 0x3727c5ac
    v_fmac_f32 v18, 0x3b124925, v16
    v_rsq_f32 v18, v18
    s_nop 0
    v_mov_b32 v19, v18
    v_pk_mul_f32 v[64:65], v[64:65], v[18:19]
    v_cvt_pk_bf16_f32 v24, v64, v65
    v_pk_mul_f32 v[66:67], v[66:67], v[18:19]
    v_cvt_pk_bf16_f32 v25, v66, v67
    v_pk_mul_f32 v[68:69], v[68:69], v[18:19]
    v_cvt_pk_bf16_f32 v26, v68, v69
    v_pk_mul_f32 v[70:71], v[70:71], v[18:19]
    v_cvt_pk_bf16_f32 v27, v70, v71
    v_pk_mul_f32 v[72:73], v[72:73], v[18:19]
    v_cvt_pk_bf16_f32 v28, v72, v73
    v_pk_mul_f32 v[74:75], v[74:75], v[18:19]
    v_cvt_pk_bf16_f32 v29, v74, v75
    v_pk_mul_f32 v[76:77], v[76:77], v[18:19]
    v_cvt_pk_bf16_f32 v30, v76, v77
    v_pk_mul_f32 v[78:79], v[78:79], v[18:19]
    v_cvt_pk_bf16_f32 v31, v78, v79
    v_pk_mul_f32 v[80:81], v[80:81], v[18:19]
    v_cvt_pk_bf16_f32 v32, v80, v81
    v_pk_mul_f32 v[82:83], v[82:83], v[18:19]
    v_cvt_pk_bf16_f32 v33, v82, v83
    v_pk_mul_f32 v[84:85], v[84:85], v[18:19]
    v_cvt_pk_bf16_f32 v34, v84, v85
    v_pk_mul_f32 v[86:87], v[86:87], v[18:19]
    v_cvt_pk_bf16_f32 v35, v86, v87
    v_pk_mul_f32 v[88:89], v[88:89], v[18:19]
    v_cvt_pk_bf16_f32 v36, v88, v89
    v_pk_mul_f32 v[90:91], v[90:91], v[18:19]
    v_cvt_pk_bf16_f32 v37, v90, v91
    v_pk_mul_f32 v[92:93], v[92:93], v[18:19]
    v_cvt_pk_bf16_f32 v38, v92, v93
    v_pk_mul_f32 v[94:95], v[94:95], v[18:19]
    v_cvt_pk_bf16_f32 v39, v94, v95
    s_mov_b64 exec, s[48:49]
    ds_write_b128 v6, v[24:27] offset:0
    ds_write_b128 v6, v[28:31] offset:224
    ds_write_b128 v6, v[32:35] offset:448
    ds_write_b128 v6, v[36:39] offset:672
    s_mov_b64 exec, -1
    s_waitcnt lgkmcnt(0)
    s_barrier
    s_cmp_eq_u32 s43, 2
    s_cbranch_scc1 L_QKV_v2_216
    ds_read_b128 v[48:51], v2 offset:0
    ds_read_b128 v[56:59], v2 offset:64
    s_waitcnt lgkmcnt(1)
    v_mfma_f32_16x16x32_bf16 v[64:67], v[120:123], v[48:51], 0
    v_mfma_f32_16x16x32_bf16 v[72:75], v[176:179], v[48:51], 0
    v_mfma_f32_16x16x32_bf16 v[80:83], v[232:235], v[48:51], 0
    v_mfma_f32_16x16x32_bf16 v[88:91], a[32:35], v[48:51], 0
    v_mfma_f32_16x16x32_bf16 v[96:99], a[88:91], v[48:51], 0
    v_mfma_f32_16x16x32_bf16 v[104:107], a[144:147], v[48:51], 0
    v_mfma_f32_16x16x32_bf16 v[112:115], a[200:203], v[48:51], 0
    ds_read_b128 v[48:51], v2 offset:128
    s_waitcnt lgkmcnt(1)
    v_mfma_f32_16x16x32_bf16 v[64:67], v[124:127], v[56:59], v[64:67]
    v_mfma_f32_16x16x32_bf16 v[72:75], v[180:183], v[56:59], v[72:75]
    v_mfma_f32_16x16x32_bf16 v[80:83], v[236:239], v[56:59], v[80:83]
    v_mfma_f32_16x16x32_bf16 v[88:91], a[36:39], v[56:59], v[88:91]
    v_mfma_f32_16x16x32_bf16 v[96:99], a[92:95], v[56:59], v[96:99]
    v_mfma_f32_16x16x32_bf16 v[104:107], a[148:151], v[56:59], v[104:107]
    v_mfma_f32_16x16x32_bf16 v[112:115], a[204:207], v[56:59], v[112:115]
    ds_read_b128 v[56:59], v2 offset:192
    s_waitcnt lgkmcnt(1)
    v_mfma_f32_16x16x32_bf16 v[64:67], v[128:131], v[48:51], v[64:67]
    v_mfma_f32_16x16x32_bf16 v[72:75], v[184:187], v[48:51], v[72:75]
    v_mfma_f32_16x16x32_bf16 v[80:83], v[240:243], v[48:51], v[80:83]
    v_mfma_f32_16x16x32_bf16 v[88:91], a[40:43], v[48:51], v[88:91]
    v_mfma_f32_16x16x32_bf16 v[96:99], a[96:99], v[48:51], v[96:99]
    v_mfma_f32_16x16x32_bf16 v[104:107], a[152:155], v[48:51], v[104:107]
    v_mfma_f32_16x16x32_bf16 v[112:115], a[208:211], v[48:51], v[112:115]
    ds_read_b128 v[48:51], v2 offset:256
    s_waitcnt lgkmcnt(1)
    v_mfma_f32_16x16x32_bf16 v[64:67], v[132:135], v[56:59], v[64:67]
    v_mfma_f32_16x16x32_bf16 v[72:75], v[188:191], v[56:59], v[72:75]
    v_mfma_f32_16x16x32_bf16 v[80:83], v[244:247], v[56:59], v[80:83]
    v_mfma_f32_16x16x32_bf16 v[88:91], a[44:47], v[56:59], v[88:91]
    v_mfma_f32_16x16x32_bf16 v[96:99], a[100:103], v[56:59], v[96:99]
    v_mfma_f32_16x16x32_bf16 v[104:107], a[156:159], v[56:59], v[104:107]
    v_mfma_f32_16x16x32_bf16 v[112:115], a[212:215], v[56:59], v[112:115]
    ds_read_b128 v[56:59], v2 offset:320
    s_waitcnt lgkmcnt(1)
    v_mfma_f32_16x16x32_bf16 v[64:67], v[136:139], v[48:51], v[64:67]
    v_mfma_f32_16x16x32_bf16 v[72:75], v[192:195], v[48:51], v[72:75]
    v_mfma_f32_16x16x32_bf16 v[80:83], v[248:251], v[48:51], v[80:83]
    v_mfma_f32_16x16x32_bf16 v[88:91], a[48:51], v[48:51], v[88:91]
    v_mfma_f32_16x16x32_bf16 v[96:99], a[104:107], v[48:51], v[96:99]
    v_mfma_f32_16x16x32_bf16 v[104:107], a[160:163], v[48:51], v[104:107]
    v_mfma_f32_16x16x32_bf16 v[112:115], a[216:219], v[48:51], v[112:115]
    ds_read_b128 v[48:51], v2 offset:384
    s_waitcnt lgkmcnt(1)
    v_mfma_f32_16x16x32_bf16 v[64:67], v[140:143], v[56:59], v[64:67]
    v_mfma_f32_16x16x32_bf16 v[72:75], v[196:199], v[56:59], v[72:75]
    v_mfma_f32_16x16x32_bf16 v[80:83], v[252:255], v[56:59], v[80:83]
    v_mfma_f32_16x16x32_bf16 v[88:91], a[52:55], v[56:59], v[88:91]
    v_mfma_f32_16x16x32_bf16 v[96:99], a[108:111], v[56:59], v[96:99]
    v_mfma_f32_16x16x32_bf16 v[104:107], a[164:167], v[56:59], v[104:107]
    v_mfma_f32_16x16x32_bf16 v[112:115], a[220:223], v[56:59], v[112:115]
    ds_read_b128 v[56:59], v2 offset:448
    s_waitcnt lgkmcnt(1)
    v_mfma_f32_16x16x32_bf16 v[64:67], v[144:147], v[48:51], v[64:67]
    v_mfma_f32_16x16x32_bf16 v[72:75], v[200:203], v[48:51], v[72:75]
    v_mfma_f32_16x16x32_bf16 v[80:83], a[0:3], v[48:51], v[80:83]
    v_mfma_f32_16x16x32_bf16 v[88:91], a[56:59], v[48:51], v[88:91]
    v_mfma_f32_16x16x32_bf16 v[96:99], a[112:115], v[48:51], v[96:99]
    v_mfma_f32_16x16x32_bf16 v[104:107], a[168:171], v[48:51], v[104:107]
    v_mfma_f32_16x16x32_bf16 v[112:115], a[224:227], v[48:51], v[112:115]
    ds_read_b128 v[48:51], v2 offset:512
    s_waitcnt lgkmcnt(1)
    v_mfma_f32_16x16x32_bf16 v[64:67], v[148:151], v[56:59], v[64:67]
    v_mfma_f32_16x16x32_bf16 v[72:75], v[204:207], v[56:59], v[72:75]
    v_mfma_f32_16x16x32_bf16 v[80:83], a[4:7], v[56:59], v[80:83]
    v_mfma_f32_16x16x32_bf16 v[88:91], a[60:63], v[56:59], v[88:91]
    v_mfma_f32_16x16x32_bf16 v[96:99], a[116:119], v[56:59], v[96:99]
    v_mfma_f32_16x16x32_bf16 v[104:107], a[172:175], v[56:59], v[104:107]
    v_mfma_f32_16x16x32_bf16 v[112:115], a[228:231], v[56:59], v[112:115]
    ds_read_b128 v[56:59], v2 offset:576
    s_waitcnt lgkmcnt(1)
    v_mfma_f32_16x16x32_bf16 v[64:67], v[152:155], v[48:51], v[64:67]
    v_mfma_f32_16x16x32_bf16 v[72:75], v[208:211], v[48:51], v[72:75]
    v_mfma_f32_16x16x32_bf16 v[80:83], a[8:11], v[48:51], v[80:83]
    v_mfma_f32_16x16x32_bf16 v[88:91], a[64:67], v[48:51], v[88:91]
    v_mfma_f32_16x16x32_bf16 v[96:99], a[120:123], v[48:51], v[96:99]
    v_mfma_f32_16x16x32_bf16 v[104:107], a[176:179], v[48:51], v[104:107]
    v_mfma_f32_16x16x32_bf16 v[112:115], a[232:235], v[48:51], v[112:115]
    ds_read_b128 v[48:51], v2 offset:640
    s_waitcnt lgkmcnt(1)
    v_mfma_f32_16x16x32_bf16 v[64:67], v[156:159], v[56:59], v[64:67]
    v_mfma_f32_16x16x32_bf16 v[72:75], v[212:215], v[56:59], v[72:75]
    v_mfma_f32_16x16x32_bf16 v[80:83], a[12:15], v[56:59], v[80:83]
    v_mfma_f32_16x16x32_bf16 v[88:91], a[68:71], v[56:59], v[88:91]
    v_mfma_f32_16x16x32_bf16 v[96:99], a[124:127], v[56:59], v[96:99]
    v_mfma_f32_16x16x32_bf16 v[104:107], a[180:183], v[56:59], v[104:107]
    v_mfma_f32_16x16x32_bf16 v[112:115], a[236:239], v[56:59], v[112:115]
    ds_read_b128 v[56:59], v2 offset:704
    s_waitcnt lgkmcnt(1)
    v_mfma_f32_16x16x32_bf16 v[64:67], v[160:163], v[48:51], v[64:67]
    v_mfma_f32_16x16x32_bf16 v[72:75], v[216:219], v[48:51], v[72:75]
    v_mfma_f32_16x16x32_bf16 v[80:83], a[16:19], v[48:51], v[80:83]
    v_mfma_f32_16x16x32_bf16 v[88:91], a[72:75], v[48:51], v[88:91]
    v_mfma_f32_16x16x32_bf16 v[96:99], a[128:131], v[48:51], v[96:99]
    v_mfma_f32_16x16x32_bf16 v[104:107], a[184:187], v[48:51], v[104:107]
    v_mfma_f32_16x16x32_bf16 v[112:115], a[240:243], v[48:51], v[112:115]
    ds_read_b128 v[48:51], v2 offset:768
    s_waitcnt lgkmcnt(1)
    v_mfma_f32_16x16x32_bf16 v[64:67], v[164:167], v[56:59], v[64:67]
    v_mfma_f32_16x16x32_bf16 v[72:75], v[220:223], v[56:59], v[72:75]
    v_mfma_f32_16x16x32_bf16 v[80:83], a[20:23], v[56:59], v[80:83]
    v_mfma_f32_16x16x32_bf16 v[88:91], a[76:79], v[56:59], v[88:91]
    v_mfma_f32_16x16x32_bf16 v[96:99], a[132:135], v[56:59], v[96:99]
    v_mfma_f32_16x16x32_bf16 v[104:107], a[188:191], v[56:59], v[104:107]
    v_mfma_f32_16x16x32_bf16 v[112:115], a[244:247], v[56:59], v[112:115]
    ds_read_b128 v[56:59], v2 offset:832
    s_waitcnt lgkmcnt(1)
    v_mfma_f32_16x16x32_bf16 v[64:67], v[168:171], v[48:51], v[64:67]
    v_mfma_f32_16x16x32_bf16 v[72:75], v[224:227], v[48:51], v[72:75]
    v_mfma_f32_16x16x32_bf16 v[80:83], a[24:27], v[48:51], v[80:83]
    v_mfma_f32_16x16x32_bf16 v[88:91], a[80:83], v[48:51], v[88:91]
    v_mfma_f32_16x16x32_bf16 v[96:99], a[136:139], v[48:51], v[96:99]
    v_mfma_f32_16x16x32_bf16 v[104:107], a[192:195], v[48:51], v[104:107]
    v_mfma_f32_16x16x32_bf16 v[112:115], a[248:251], v[48:51], v[112:115]
    s_waitcnt lgkmcnt(0)
    v_mfma_f32_16x16x32_bf16 v[64:67], v[172:175], v[56:59], v[64:67]
    v_mfma_f32_16x16x32_bf16 v[72:75], v[228:231], v[56:59], v[72:75]
    v_mfma_f32_16x16x32_bf16 v[80:83], a[28:31], v[56:59], v[80:83]
    v_mfma_f32_16x16x32_bf16 v[88:91], a[84:87], v[56:59], v[88:91]
    v_mfma_f32_16x16x32_bf16 v[96:99], a[140:143], v[56:59], v[96:99]
    v_mfma_f32_16x16x32_bf16 v[104:107], a[196:199], v[56:59], v[104:107]
    v_mfma_f32_16x16x32_bf16 v[112:115], a[252:255], v[56:59], v[112:115]
    s_nop 1
    v_cvt_pk_bf16_f32 v64, v64, v65
    v_cvt_pk_bf16_f32 v65, v66, v67
    v_cvt_pk_bf16_f32 v72, v72, v73
    v_cvt_pk_bf16_f32 v73, v74, v75
    v_cvt_pk_bf16_f32 v80, v80, v81
    v_cvt_pk_bf16_f32 v81, v82, v83
    v_cvt_pk_bf16_f32 v88, v88, v89
    v_cvt_pk_bf16_f32 v89, v90, v91
    v_cvt_pk_bf16_f32 v96, v96, v97
    v_cvt_pk_bf16_f32 v97, v98, v99
    v_cvt_pk_bf16_f32 v104, v104, v105
    v_cvt_pk_bf16_f32 v105, v106, v107
    v_cvt_pk_bf16_f32 v112, v112, v113
    v_cvt_pk_bf16_f32 v113, v114, v115
    s_nop 0
    s_branch L_QKV_j2_217
L_QKV_v2_216:
    ds_read_b128 v[48:51], v2 offset:0
    ds_read_b128 v[56:59], v2 offset:64
    s_waitcnt lgkmcnt(1)
    v_mfma_f32_16x16x32_bf16 v[64:67], v[48:51], v[120:123], 0
    v_mfma_f32_16x16x32_bf16 v[72:75], v[48:51], v[176:179], 0
    v_mfma_f32_16x16x32_bf16 v[80:83], v[48:51], v[232:235], 0
    v_mfma_f32_16x16x32_bf16 v[88:91], v[48:51], a[32:35], 0
    v_mfma_f32_16x16x32_bf16 v[96:99], v[48:51], a[88:91], 0
    v_mfma_f32_16x16x32_bf16 v[104:107], v[48:51], a[144:147], 0
    v_mfma_f32_16x16x32_bf16 v[112:115], v[48:51], a[200:203], 0
    ds_read_b128 v[48:51], v2 offset:128
    s_waitcnt lgkmcnt(1)
    v_mfma_f32_16x16x32_bf16 v[64:67], v[56:59], v[124:127], v[64:67]
    v_mfma_f32_16x16x32_bf16 v[72:75], v[56:59], v[180:183], v[72:75]
    v_mfma_f32_16x16x32_bf16 v[80:83], v[56:59], v[236:239], v[80:83]
    v_mfma_f32_16x16x32_bf16 v[88:91], v[56:59], a[36:39], v[88:91]
    v_mfma_f32_16x16x32_bf16 v[96:99], v[56:59], a[92:95], v[96:99]
    v_mfma_f32_16x16x32_bf16 v[104:107], v[56:59], a[148:151], v[104:107]
    v_mfma_f32_16x16x32_bf16 v[112:115], v[56:59], a[204:207], v[112:115]
    ds_read_b128 v[56:59], v2 offset:192
    s_waitcnt lgkmcnt(1)
    v_mfma_f32_16x16x32_bf16 v[64:67], v[48:51], v[128:131], v[64:67]
    v_mfma_f32_16x16x32_bf16 v[72:75], v[48:51], v[184:187], v[72:75]
    v_mfma_f32_16x16x32_bf16 v[80:83], v[48:51], v[240:243], v[80:83]
    v_mfma_f32_16x16x32_bf16 v[88:91], v[48:51], a[40:43], v[88:91]
    v_mfma_f32_16x16x32_bf16 v[96:99], v[48:51], a[96:99], v[96:99]
    v_mfma_f32_16x16x32_bf16 v[104:107], v[48:51], a[152:155], v[104:107]
    v_mfma_f32_16x16x32_bf16 v[112:115], v[48:51], a[208:211], v[112:115]
    ds_read_b128 v[48:51], v2 offset:256
    s_waitcnt lgkmcnt(1)
    v_mfma_f32_16x16x32_bf16 v[64:67], v[56:59], v[132:135], v[64:67]
    v_mfma_f32_16x16x32_bf16 v[72:75], v[56:59], v[188:191], v[72:75]
    v_mfma_f32_16x16x32_bf16 v[80:83], v[56:59], v[244:247], v[80:83]
    v_mfma_f32_16x16x32_bf16 v[88:91], v[56:59], a[44:47], v[88:91]
    v_mfma_f32_16x16x32_bf16 v[96:99], v[56:59], a[100:103], v[96:99]
    v_mfma_f32_16x16x32_bf16 v[104:107], v[56:59], a[156:159], v[104:107]
    v_mfma_f32_16x16x32_bf16 v[112:115], v[56:59], a[212:215], v[112:115]
    ds_read_b128 v[56:59], v2 offset:320
    s_waitcnt lgkmcnt(1)
    v_mfma_f32_16x16x32_bf16 v[64:67], v[48:51], v[136:139], v[64:67]
    v_mfma_f32_16x16x32_bf16 v[72:75], v[48:51], v[192:195], v[72:75]
    v_mfma_f32_16x16x32_bf16 v[80:83], v[48:51], v[248:251], v[80:83]
    v_mfma_f32_16x16x32_bf16 v[88:91], v[48:51], a[48:51], v[88:91]
    v_mfma_f32_16x16x32_bf16 v[96:99], v[48:51], a[104:107], v[96:99]
    v_mfma_f32_16x16x32_bf16 v[104:107], v[48:51], a[160:163], v[104:107]
    v_mfma_f32_16x16x32_bf16 v[112:115], v[48:51], a[216:219], v[112:115]
    ds_read_b128 v[48:51], v2 offset:384
    s_waitcnt lgkmcnt(1)
    v_mfma_f32_16x16x32_bf16 v[64:67], v[56:59], v[140:143], v[64:67]
    v_mfma_f32_16x16x32_bf16 v[72:75], v[56:59], v[196:199], v[72:75]
    v_mfma_f32_16x16x32_bf16 v[80:83], v[56:59], v[252:255], v[80:83]
    v_mfma_f32_16x16x32_bf16 v[88:91], v[56:59], a[52:55], v[88:91]
    v_mfma_f32_16x16x32_bf16 v[96:99], v[56:59], a[108:111], v[96:99]
    v_mfma_f32_16x16x32_bf16 v[104:107], v[56:59], a[164:167], v[104:107]
    v_mfma_f32_16x16x32_bf16 v[112:115], v[56:59], a[220:223], v[112:115]
    ds_read_b128 v[56:59], v2 offset:448
    s_waitcnt lgkmcnt(1)
    v_mfma_f32_16x16x32_bf16 v[64:67], v[48:51], v[144:147], v[64:67]
    v_mfma_f32_16x16x32_bf16 v[72:75], v[48:51], v[200:203], v[72:75]
    v_mfma_f32_16x16x32_bf16 v[80:83], v[48:51], a[0:3], v[80:83]
    v_mfma_f32_16x16x32_bf16 v[88:91], v[48:51], a[56:59], v[88:91]
    v_mfma_f32_16x16x32_bf16 v[96:99], v[48:51], a[112:115], v[96:99]
    v_mfma_f32_16x16x32_bf16 v[104:107], v[48:51], a[168:171], v[104:107]
    v_mfma_f32_16x16x32_bf16 v[112:115], v[48:51], a[224:227], v[112:115]
    ds_read_b128 v[48:51], v2 offset:512
    s_waitcnt lgkmcnt(1)
    v_mfma_f32_16x16x32_bf16 v[64:67], v[56:59], v[148:151], v[64:67]
    v_mfma_f32_16x16x32_bf16 v[72:75], v[56:59], v[204:207], v[72:75]
    v_mfma_f32_16x16x32_bf16 v[80:83], v[56:59], a[4:7], v[80:83]
    v_mfma_f32_16x16x32_bf16 v[88:91], v[56:59], a[60:63], v[88:91]
    v_mfma_f32_16x16x32_bf16 v[96:99], v[56:59], a[116:119], v[96:99]
    v_mfma_f32_16x16x32_bf16 v[104:107], v[56:59], a[172:175], v[104:107]
    v_mfma_f32_16x16x32_bf16 v[112:115], v[56:59], a[228:231], v[112:115]
    ds_read_b128 v[56:59], v2 offset:576
    s_waitcnt lgkmcnt(1)
    v_mfma_f32_16x16x32_bf16 v[64:67], v[48:51], v[152:155], v[64:67]
    v_mfma_f32_16x16x32_bf16 v[72:75], v[48:51], v[208:211], v[72:75]
    v_mfma_f32_16x16x32_bf16 v[80:83], v[48:51], a[8:11], v[80:83]
    v_mfma_f32_16x16x32_bf16 v[88:91], v[48:51], a[64:67], v[88:91]
    v_mfma_f32_16x16x32_bf16 v[96:99], v[48:51], a[120:123], v[96:99]
    v_mfma_f32_16x16x32_bf16 v[104:107], v[48:51], a[176:179], v[104:107]
    v_mfma_f32_16x16x32_bf16 v[112:115], v[48:51], a[232:235], v[112:115]
    ds_read_b128 v[48:51], v2 offset:640
    s_waitcnt lgkmcnt(1)
    v_mfma_f32_16x16x32_bf16 v[64:67], v[56:59], v[156:159], v[64:67]
    v_mfma_f32_16x16x32_bf16 v[72:75], v[56:59], v[212:215], v[72:75]
    v_mfma_f32_16x16x32_bf16 v[80:83], v[56:59], a[12:15], v[80:83]
    v_mfma_f32_16x16x32_bf16 v[88:91], v[56:59], a[68:71], v[88:91]
    v_mfma_f32_16x16x32_bf16 v[96:99], v[56:59], a[124:127], v[96:99]
    v_mfma_f32_16x16x32_bf16 v[104:107], v[56:59], a[180:183], v[104:107]
    v_mfma_f32_16x16x32_bf16 v[112:115], v[56:59], a[236:239], v[112:115]
    ds_read_b128 v[56:59], v2 offset:704
    s_waitcnt lgkmcnt(1)
    v_mfma_f32_16x16x32_bf16 v[64:67], v[48:51], v[160:163], v[64:67]
    v_mfma_f32_16x16x32_bf16 v[72:75], v[48:51], v[216:219], v[72:75]
    v_mfma_f32_16x16x32_bf16 v[80:83], v[48:51], a[16:19], v[80:83]
    v_mfma_f32_16x16x32_bf16 v[88:91], v[48:51], a[72:75], v[88:91]
    v_mfma_f32_16x16x32_bf16 v[96:99], v[48:51], a[128:131], v[96:99]
    v_mfma_f32_16x16x32_bf16 v[104:107], v[48:51], a[184:187], v[104:107]
    v_mfma_f32_16x16x32_bf16 v[112:115], v[48:51], a[240:243], v[112:115]
    ds_read_b128 v[48:51], v2 offset:768
    s_waitcnt lgkmcnt(1)
    v_mfma_f32_16x16x32_bf16 v[64:67], v[56:59], v[164:167], v[64:67]
    v_mfma_f32_16x16x32_bf16 v[72:75], v[56:59], v[220:223], v[72:75]
    v_mfma_f32_16x16x32_bf16 v[80:83], v[56:59], a[20:23], v[80:83]
    v_mfma_f32_16x16x32_bf16 v[88:91], v[56:59], a[76:79], v[88:91]
    v_mfma_f32_16x16x32_bf16 v[96:99], v[56:59], a[132:135], v[96:99]
    v_mfma_f32_16x16x32_bf16 v[104:107], v[56:59], a[188:191], v[104:107]
    v_mfma_f32_16x16x32_bf16 v[112:115], v[56:59], a[244:247], v[112:115]
    ds_read_b128 v[56:59], v2 offset:832
    s_waitcnt lgkmcnt(1)
    v_mfma_f32_16x16x32_bf16 v[64:67], v[48:51], v[168:171], v[64:67]
    v_mfma_f32_16x16x32_bf16 v[72:75], v[48:51], v[224:227], v[72:75]
    v_mfma_f32_16x16x32_bf16 v[80:83], v[48:51], a[24:27], v[80:83]
    v_mfma_f32_16x16x32_bf16 v[88:91], v[48:51], a[80:83], v[88:91]
    v_mfma_f32_16x16x32_bf16 v[96:99], v[48:51], a[136:139], v[96:99]
    v_mfma_f32_16x16x32_bf16 v[104:107], v[48:51], a[192:195], v[104:107]
    v_mfma_f32_16x16x32_bf16 v[112:115], v[48:51], a[248:251], v[112:115]
    s_waitcnt lgkmcnt(0)
    v_mfma_f32_16x16x32_bf16 v[64:67], v[56:59], v[172:175], v[64:67]
    v_mfma_f32_16x16x32_bf16 v[72:75], v[56:59], v[228:231], v[72:75]
    v_mfma_f32_16x16x32_bf16 v[80:83], v[56:59], a[28:31], v[80:83]
    v_mfma_f32_16x16x32_bf16 v[88:91], v[56:59], a[84:87], v[88:91]
    v_mfma_f32_16x16x32_bf16 v[96:99], v[56:59], a[140:143], v[96:99]
    v_mfma_f32_16x16x32_bf16 v[104:107], v[56:59], a[196:199], v[104:107]
    v_mfma_f32_16x16x32_bf16 v[112:115], v[56:59], a[252:255], v[112:115]
    s_nop 1
    v_cvt_pk_bf16_f32 v64, v64, v65
    v_cvt_pk_bf16_f32 v65, v66, v67
    v_cvt_pk_bf16_f32 v72, v72, v73
    v_cvt_pk_bf16_f32 v73, v74, v75
    v_cvt_pk_bf16_f32 v80, v80, v81
    v_cvt_pk_bf16_f32 v81, v82, v83
    v_cvt_pk_bf16_f32 v88, v88, v89
    v_cvt_pk_bf16_f32 v89, v90, v91
    v_cvt_pk_bf16_f32 v96, v96, v97
    v_cvt_pk_bf16_f32 v97, v98, v99
    v_cvt_pk_bf16_f32 v104, v104, v105
    v_cvt_pk_bf16_f32 v105, v106, v107
    v_cvt_pk_bf16_f32 v112, v112, v113
    v_cvt_pk_bf16_f32 v113, v114, v115
    s_nop 1
L_QKV_j2_217:
    ds_write_b64 v8, v[64:65]
    ds_write_b64 v9, v[72:73]
    ds_write_b64 v10, v[80:81]
    ds_write_b64 v11, v[88:89]
    ds_write_b64 v12, v[96:97]
    ds_write_b64 v13, v[104:105]
    ds_write_b64 v14, v[112:113]
    s_waitcnt lgkmcnt(0)
    s_barrier
    ds_read_b128 v[48:51], v40 offset:0
    ds_read_b128 v[52:55], v40 offset:1280
    ds_read_b128 v[56:59], v40 offset:2560
    ds_read_b128 v[60:63], v40 offset:3840
    s_cmp_lg_u32 s14, 0
    s_cbranch_scc1 L_slow_218
    s_waitcnt lgkmcnt(3)
    buffer_store_dwordx4 v[48:51], v41, s[4:7], s53 offen offset:0
    s_waitcnt lgkmcnt(2)
    buffer_store_dwordx4 v[52:55], v41, s[4:7], s53 offen offset:2048
    s_add_u32 s20, s53, 4096
    s_waitcnt lgkmcnt(1)
    buffer_store_dwordx4 v[56:59], v41, s[4:7], s20 offen offset:0
    s_waitcnt lgkmcnt(0)
    buffer_store_dwordx4 v[60:63], v41, s[4:7], s20 offen offset:2048
    s_nop 0
    s_branch L_md_219
L_slow_218:
    s_waitcnt lgkmcnt(3)
    buffer_store_dwordx4 v[48:51], v41, s[4:7], s53 offen offset:0 sc1
    s_waitcnt lgkmcnt(2)
    buffer_store_dwordx4 v[52:55], v41, s[4:7], s53 offen offset:2048 sc1
    s_add_u32 s20, s53, 4096
    s_waitcnt lgkmcnt(1)
    buffer_store_dwordx4 v[56:59], v41, s[4:7], s20 offen offset:0 sc1
    s_waitcnt lgkmcnt(0)
    buffer_store_dwordx4 v[60:63], v41, s[4:7], s20 offen offset:2048 sc1
    s_nop 1
L_md_219:
    s_mov_b32 s45, 0
    s_cmp_ge_u32 s16, 63
    s_cbranch_scc1 L_Qnp_220
    s_waitcnt vmcnt(4)
    s_mov_b32 exec_lo, 0x7f
    s_mov_b32 exec_hi, 0
    v_cmp_eq_u32 vcc, 0, v15
    s_mov_b64 exec, -1
    s_nop 2
    s_cbranch_vccz L_Qpf_222
    s_branch L_Qnp_220
L_Qpf_222:
    s_add_u32 s41, s51, 28672
    buffer_load_dwordx4 v[24:27], v5, s[4:7], s41 offen offset:0 sc1
    buffer_load_dwordx4 v[28:31], v5, s[4:7], s41 offen offset:224 sc1
    buffer_load_dwordx4 v[32:35], v5, s[4:7], s41 offen offset:448 sc1
    buffer_load_dwordx4 v[36:39], v5, s[4:7], s41 offen offset:672 sc1
    s_mov_b32 s45, 1
    s_waitcnt vmcnt(4)
    s_branch L_Qsg_221
L_Qnp_220:
    s_waitcnt vmcnt(0)
L_Qsg_221:
    v_mov_b32 v16, 1
    s_lshl_b32 s18, s54, 2
    v_mov_b32 v17, s18
    s_mov_b64 exec, 1
    s_cmp_lg_u32 s14, 0
    s_cbranch_scc1 L_slow_223
    buffer_store_dword v16, v17, s[4:7], s52 offen
    s_branch L_md_224
L_slow_223:
    buffer_store_dword v16, v17, s[4:7], s52 offen sc1
L_md_224:
    s_mov_b64 exec, -1
    s_add_u32 s50, s50, 128
    s_add_u32 s51, s51, 28672
    s_add_u32 s52, s52, 128
    s_add_u32 s53, s53, 32768
    s_add_u32 s16, s16, 1
    s_cmp_lt_u32 s16, 64
    s_cbranch_scc1 L_QKV_loop
    s_branch L_role_done
L_nQKV:
    s_cmp_ge_u32 s19, 28
    s_cbranch_scc1 L_nATT
    s_sub_u32 s12, s19, 20
    s_mov_b32 s38, 0
    s_mov_b32 s40, s93
    s_cmp_ge_u32 s40, 160
    s_cbranch_scc1 M_end_225
    v_lshlrev_b32 v6, 4, v0
    v_mov_b32 v8, -1
    v_mov_b32 v12, 0
    v_mov_b32 v9, -1
    v_mov_b32 v13, 0
    v_mov_b32 v10, -1
    v_mov_b32 v14, 0
    v_mov_b32 v11, -1
    v_mov_b32 v15, 0
    s_lshl_b32 s42, s40, 12
    s_add_u32 s42, s42, 126763008
    s_mov_b32 s46, 126894080
    s_mov_b32 s44, s4
    s_mov_b32 s45, s5
    s_mov_b32 s47, 0x00020000
    buffer_store_dwordx4 v[12:15], v6, s[44:47], s42 offen sc1
    s_lshl_b32 s42, s40, 12
    s_add_u32 s42, s42, 32398336
    s_mov_b32 s46, 32849920
    s_mov_b32 s44, s4
    s_mov_b32 s45, s5
    s_mov_b32 s47, 0x00020000
    buffer_store_dwordx4 v[8:11], v6, s[44:47], s42 offen sc1
    s_lshl_b32 s42, s40, 12
    s_add_u32 s42, s42, 33315840
    s_mov_b32 s46, 33767424
    s_mov_b32 s44, s4
    s_mov_b32 s45, s5
    s_mov_b32 s47, 0x00020000
    buffer_store_dwordx4 v[8:11], v6, s[44:47], s42 offen sc1
    s_lshl_b32 s42, s40, 12
    s_add_u32 s42, s42, 34226176
    s_mov_b32 s46, 34881536
    s_mov_b32 s44, s4
    s_mov_b32 s45, s5
    s_mov_b32 s47, 0x00020000
    buffer_store_dwordx4 v[8:11], v6, s[44:47], s42 offen sc1
    s_lshl_b32 s42, s40, 12
    s_add_u32 s42, s42, 32857088
    s_mov_b32 s46, 33308672
    s_mov_b32 s44, s4
    s_mov_b32 s45, s5
    s_mov_b32 s47, 0x00020000
    buffer_store_dwordx4 v[8:11], v6, s[44:47], s42 offen sc1
    s_lshl_b32 s42, s40, 12
    s_add_u32 s42, s42, 33774592
    s_mov_b32 s46, 34226176
    s_mov_b32 s44, s4
    s_mov_b32 s45, s5
    s_mov_b32 s47, 0x00020000
    buffer_store_dwordx4 v[8:11], v6, s[44:47], s42 offen sc1
    s_lshl_b32 s42, s40, 12
    s_add_u32 s42, s42, 34881536
    s_mov_b32 s46, 35536896
    s_mov_b32 s44, s4
    s_mov_b32 s45, s5
    s_mov_b32 s47, 0x00020000
    buffer_store_dwordx4 v[8:11], v6, s[44:47], s42 offen sc1
    s_cmp_ge_u32 s40, 32
    s_cbranch_scc1 M_end_225
    s_load_dwordx2 s[8:9], s[34:35], 0
    s_waitcnt lgkmcnt(0)
    s_mov_b32 s10, 1835008
    s_mov_b32 s11, 0x00020000
    v_lshrrev_b32 v4, 3, v0
    v_and_b32 v5, 7, v0
    v_mul_u32_u24 v2, 896, v4
    v_lshl_add_u32 v2, v5, 4, v2
    v_mul_u32_u24 v3, 928, v4
    v_lshl_add_u32 v3, v5, 4, v3
    s_add_u32 s41, s40, 32
    s_mul_i32 s42, s41, 28672
    buffer_load_dwordx4 v[16:19], v2, s[8:11], s42 offen offset:0
    buffer_load_dwordx4 v[20:23], v2, s[8:11], s42 offen offset:128
    buffer_load_dwordx4 v[24:27], v2, s[8:11], s42 offen offset:256
    buffer_load_dwordx4 v[28:31], v2, s[8:11], s42 offen offset:384
    buffer_load_dwordx4 v[32:35], v2, s[8:11], s42 offen offset:512
    buffer_load_dwordx4 v[36:39], v2, s[8:11], s42 offen offset:640
    buffer_load_dwordx4 v[40:43], v2, s[8:11], s42 offen offset:768
    s_waitcnt vmcnt(0)
    v_lshlrev_b32 v48, 16, v16
    v_and_b32 v49, 0xffff0000, v16
    v_lshlrev_b32 v50, 16, v17
    v_and_b32 v51, 0xffff0000, v17
    v_lshlrev_b32 v52, 16, v18
    v_and_b32 v53, 0xffff0000, v18
    v_lshlrev_b32 v54, 16, v19
    v_and_b32 v55, 0xffff0000, v19
    v_lshlrev_b32 v56, 16, v20
    v_and_b32 v57, 0xffff0000, v20
    v_lshlrev_b32 v58, 16, v21
    v_and_b32 v59, 0xffff0000, v21
    v_lshlrev_b32 v60, 16, v22
    v_and_b32 v61, 0xffff0000, v22
    v_lshlrev_b32 v62, 16, v23
    v_and_b32 v63, 0xffff0000, v23
    v_lshlrev_b32 v64, 16, v24
    v_and_b32 v65, 0xffff0000, v24
    v_lshlrev_b32 v66, 16, v25
    v_and_b32 v67, 0xffff0000, v25
    v_lshlrev_b32 v68, 16, v26
    v_and_b32 v69, 0xffff0000, v26
    v_lshlrev_b32 v70, 16, v27
    v_and_b32 v71, 0xffff0000, v27
    v_lshlrev_b32 v72, 16, v28
    v_and_b32 v73, 0xffff0000, v28
    v_lshlrev_b32 v74, 16, v29
    v_and_b32 v75, 0xffff0000, v29
    v_lshlrev_b32 v76, 16, v30
    v_and_b32 v77, 0xffff0000, v30
    v_lshlrev_b32 v78, 16, v31
    v_and_b32 v79, 0xffff0000, v31
    v_lshlrev_b32 v80, 16, v32
    v_and_b32 v81, 0xffff0000, v32
    v_lshlrev_b32 v82, 16, v33
    v_and_b32 v83, 0xffff0000, v33
    v_lshlrev_b32 v84, 16, v34
    v_and_b32 v85, 0xffff0000, v34
    v_lshlrev_b32 v86, 16, v35
    v_and_b32 v87, 0xffff0000, v35
    v_lshlrev_b32 v88, 16, v36
    v_and_b32 v89, 0xffff0000, v36
    v_lshlrev_b32 v90, 16, v37
    v_and_b32 v91, 0xffff0000, v37
    v_lshlrev_b32 v92, 16, v38
    v_and_b32 v93, 0xffff0000, v38
    v_lshlrev_b32 v94, 16, v39
    v_and_b32 v95, 0xffff0000, v39
    v_lshlrev_b32 v96, 16, v40
    v_and_b32 v97, 0xffff0000, v40
    v_lshlrev_b32 v98, 16, v41
    v_and_b32 v99, 0xffff0000, v41
    v_lshlrev_b32 v100, 16, v42
    v_and_b32 v101, 0xffff0000, v42
    v_lshlrev_b32 v102, 16, v43
    v_and_b32 v103, 0xffff0000, v43
    v_pk_add_f32 v[6:7], v[48:49], v[50:51]
    v_pk_add_f32 v[8:9], v[52:53], v[54:55]
    v_pk_add_f32 v[6:7], v[6:7], v[56:57]
    v_pk_add_f32 v[8:9], v[8:9], v[58:59]
    v_pk_add_f32 v[6:7], v[6:7], v[60:61]
    v_pk_add_f32 v[8:9], v[8:9], v[62:63]
    v_pk_add_f32 v[6:7], v[6:7], v[64:65]
    v_pk_add_f32 v[8:9], v[8:9], v[66:67]
    v_pk_add_f32 v[6:7], v[6:7], v[68:69]
    v_pk_add_f32 v[8:9], v[8:9], v[70:71]
    v_pk_add_f32 v[6:7], v[6:7], v[72:73]
    v_pk_add_f32 v[8:9], v[8:9], v[74:75]
    v_pk_add_f32 v[6:7], v[6:7], v[76:77]
    v_pk_add_f32 v[8:9], v[8:9], v[78:79]
    v_pk_add_f32 v[6:7], v[6:7], v[80:81]
    v_pk_add_f32 v[8:9], v[8:9], v[82:83]
    v_pk_add_f32 v[6:7], v[6:7], v[84:85]
    v_pk_add_f32 v[8:9], v[8:9], v[86:87]
    v_pk_add_f32 v[6:7], v[6:7], v[88:89]
    v_pk_add_f32 v[8:9], v[8:9], v[90:91]
    v_pk_add_f32 v[6:7], v[6:7], v[92:93]
    v_pk_add_f32 v[8:9], v[8:9], v[94:95]
    v_pk_add_f32 v[6:7], v[6:7], v[96:97]
    v_pk_add_f32 v[8:9], v[8:9], v[98:99]
    v_pk_add_f32 v[6:7], v[6:7], v[100:101]
    v_pk_add_f32 v[8:9], v[8:9], v[102:103]
    v_pk_add_f32 v[6:7], v[6:7], v[8:9]
    v_add_f32 v4, v6, v7
    s_nop 1
    v_add_f32_dpp v4, v4, v4 quad_perm:[1,0,3,2] row_mask:0xf bank_mask:0xf
    s_nop 1
    v_add_f32_dpp v4, v4, v4 quad_perm:[2,3,0,1] row_mask:0xf bank_mask:0xf
    s_nop 1
    v_add_f32_dpp v4, v4, v4 row_half_mirror row_mask:0xf bank_mask:0xf
    v_mul_f32 v8, 0xbb124925, v4
    v_mov_b32 v9, v8
    v_pk_add_f32 v[48:49], v[48:49], v[8:9]
    v_pk_add_f32 v[50:51], v[50:51], v[8:9]
    v_pk_add_f32 v[52:53], v[52:53], v[8:9]
    v_pk_add_f32 v[54:55], v[54:55], v[8:9]
    v_pk_add_f32 v[56:57], v[56:57], v[8:9]
    v_pk_add_f32 v[58:59], v[58:59], v[8:9]
    v_pk_add_f32 v[60:61], v[60:61], v[8:9]
    v_pk_add_f32 v[62:63], v[62:63], v[8:9]
    v_pk_add_f32 v[64:65], v[64:65], v[8:9]
    v_pk_add_f32 v[66:67], v[66:67], v[8:9]
    v_pk_add_f32 v[68:69], v[68:69], v[8:9]
    v_pk_add_f32 v[70:71], v[70:71], v[8:9]
    v_pk_add_f32 v[72:73], v[72:73], v[8:9]
    v_pk_add_f32 v[74:75], v[74:75], v[8:9]
    v_pk_add_f32 v[76:77], v[76:77], v[8:9]
    v_pk_add_f32 v[78:79], v[78:79], v[8:9]
    v_pk_add_f32 v[80:81], v[80:81], v[8:9]
    v_pk_add_f32 v[82:83], v[82:83], v[8:9]
    v_pk_add_f32 v[84:85], v[84:85], v[8:9]
    v_pk_add_f32 v[86:87], v[86:87], v[8:9]
    v_pk_add_f32 v[88:89], v[88:89], v[8:9]
    v_pk_add_f32 v[90:91], v[90:91], v[8:9]
    v_pk_add_f32 v[92:93], v[92:93], v[8:9]
    v_pk_add_f32 v[94:95], v[94:95], v[8:9]
    v_pk_add_f32 v[96:97], v[96:97], v[8:9]
    v_pk_add_f32 v[98:99], v[98:99], v[8:9]
    v_pk_add_f32 v[100:101], v[100:101], v[8:9]
    v_pk_add_f32 v[102:103], v[102:103], v[8:9]
    v_pk_mul_f32 v[6:7], v[48:49], v[48:49]
    v_pk_mul_f32 v[8:9], v[50:51], v[50:51]
    v_pk_fma_f32 v[6:7], v[52:53], v[52:53], v[6:7]
    v_pk_fma_f32 v[8:9], v[54:55], v[54:55], v[8:9]
    v_pk_fma_f32 v[6:7], v[56:57], v[56:57], v[6:7]
    v_pk_fma_f32 v[8:9], v[58:59], v[58:59], v[8:9]
    v_pk_fma_f32 v[6:7], v[60:61], v[60:61], v[6:7]
    v_pk_fma_f32 v[8:9], v[62:63], v[62:63], v[8:9]
    v_pk_fma_f32 v[6:7], v[64:65], v[64:65], v[6:7]
    v_pk_fma_f32 v[8:9], v[66:67], v[66:67], v[8:9]
    v_pk_fma_f32 v[6:7], v[68:69], v[68:69], v[6:7]
    v_pk_fma_f32 v[8:9], v[70:71], v[70:71], v[8:9]
    v_pk_fma_f32 v[6:7], v[72:73], v[72:73], v[6:7]
    v_pk_fma_f32 v[8:9], v[74:75], v[74:75], v[8:9]
    v_pk_fma_f32 v[6:7], v[76:77], v[76:77], v[6:7]
    v_pk_fma_f32 v[8:9], v[78:79], v[78:79], v[8:9]
    v_pk_fma_f32 v[6:7], v[80:81], v[80:81], v[6:7]
    v_pk_fma_f32 v[8:9], v[82:83], v[82:83], v[8:9]
    v_pk_fma_f32 v[6:7], v[84:85], v[84:85], v[6:7]
    v_pk_fma_f32 v[8:9], v[86:87], v[86:87], v[8:9]
    v_pk_fma_f32 v[6:7], v[88:89], v[88:89], v[6:7]
    v_pk_fma_f32 v[8:9], v[90:91], v[90:91], v[8:9]
    v_pk_fma_f32 v[6:7], v[92:93], v[92:93], v[6:7]
    v_pk_fma_f32 v[8:9], v[94:95], v[94:95], v[8:9]
    v_pk_fma_f32 v[6:7], v[96:97], v[96:97], v[6:7]
    v_pk_fma_f32 v[8:9], v[98:99], v[98:99], v[8:9]
    v_pk_fma_f32 v[6:7], v[100:101], v[100:101], v[6:7]
    v_pk_fma_f32 v[8:9], v[102:103], v[102:103], v[8:9]
    v_pk_add_f32 v[6:7], v[6:7], v[8:9]
    v_add_f32 v4, v6, v7
    s_nop 1
    v_add_f32_dpp v4, v4, v4 quad_perm:[1,0,3,2] row_mask:0xf bank_mask:0xf
    s_nop 1
    v_add_f32_dpp v4, v4, v4 quad_perm:[2,3,0,1] row_mask:0xf bank_mask:0xf
    s_nop 1
    v_add_f32_dpp v4, v4, v4 row_half_mirror row_mask:0xf bank_mask:0xf
    v_mov_b32 v6, 0x3727c5ac
    v_fmac_f32 v6, 0x3b124925, v4
    v_rsq_f32 v6, v6
    s_nop 0
    v_mov_b32 v7, v6
    v_pk_mul_f32 v[48:49], v[48:49], v[6:7]
    v_cvt_pk_bf16_f32 v16, v48, v49
    v_pk_mul_f32 v[50:51], v[50:51], v[6:7]
    v_cvt_pk_bf16_f32 v17, v50, v51
    v_pk_mul_f32 v[52:53], v[52:53], v[6:7]
    v_cvt_pk_bf16_f32 v18, v52, v53
    v_pk_mul_f32 v[54:55], v[54:55], v[6:7]
    v_cvt_pk_bf16_f32 v19, v54, v55
    v_pk_mul_f32 v[56:57], v[56:57], v[6:7]
    v_cvt_pk_bf16_f32 v20, v56, v57
    v_pk_mul_f32 v[58:59], v[58:59], v[6:7]
    v_cvt_pk_bf16_f32 v21, v58, v59
    v_pk_mul_f32 v[60:61], v[60:61], v[6:7]
    v_cvt_pk_bf16_f32 v22, v60, v61
    v_pk_mul_f32 v[62:63], v[62:63], v[6:7]
    v_cvt_pk_bf16_f32 v23, v62, v63
    v_pk_mul_f32 v[64:65], v[64:65], v[6:7]
    v_cvt_pk_bf16_f32 v24, v64, v65
    v_pk_mul_f32 v[66:67], v[66:67], v[6:7]
    v_cvt_pk_bf16_f32 v25, v66, v67
    v_pk_mul_f32 v[68:69], v[68:69], v[6:7]
    v_cvt_pk_bf16_f32 v26, v68, v69
    v_pk_mul_f32 v[70:71], v[70:71], v[6:7]
    v_cvt_pk_bf16_f32 v27, v70, v71
    v_pk_mul_f32 v[72:73], v[72:73], v[6:7]
    v_cvt_pk_bf16_f32 v28, v72, v73
    v_pk_mul_f32 v[74:75], v[74:75], v[6:7]
    v_cvt_pk_bf16_f32 v29, v74, v75
    v_pk_mul_f32 v[76:77], v[76:77], v[6:7]
    v_cvt_pk_bf16_f32 v30, v76, v77
    v_pk_mul_f32 v[78:79], v[78:79], v[6:7]
    v_cvt_pk_bf16_f32 v31, v78, v79
    v_pk_mul_f32 v[80:81], v[80:81], v[6:7]
    v_cvt_pk_bf16_f32 v32, v80, v81
    v_pk_mul_f32 v[82:83], v[82:83], v[6:7]
    v_cvt_pk_bf16_f32 v33, v82, v83
    v_pk_mul_f32 v[84:85], v[84:85], v[6:7]
    v_cvt_pk_bf16_f32 v34, v84, v85
    v_pk_mul_f32 v[86:87], v[86:87], v[6:7]
    v_cvt_pk_bf16_f32 v35, v86, v87
    v_pk_mul_f32 v[88:89], v[88:89], v[6:7]
    v_cvt_pk_bf16_f32 v36, v88, v89
    v_pk_mul_f32 v[90:91], v[90:91], v[6:7]
    v_cvt_pk_bf16_f32 v37, v90, v91
    v_pk_mul_f32 v[92:93], v[92:93], v[6:7]
    v_cvt_pk_bf16_f32 v38, v92, v93
    v_pk_mul_f32 v[94:95], v[94:95], v[6:7]
    v_cvt_pk_bf16_f32 v39, v94, v95
    v_pk_mul_f32 v[96:97], v[96:97], v[6:7]
    v_cvt_pk_bf16_f32 v40, v96, v97
    v_pk_mul_f32 v[98:99], v[98:99], v[6:7]
    v_cvt_pk_bf16_f32 v41, v98, v99
    v_pk_mul_f32 v[100:101], v[100:101], v[6:7]
    v_cvt_pk_bf16_f32 v42, v100, v101
    v_pk_mul_f32 v[102:103], v[102:103], v[6:7]
    v_cvt_pk_bf16_f32 v43, v102, v103
    s_mul_i32 s42, s41, 29696
    s_add_u32 s42, s42, 19267584
    buffer_store_dwordx4 v[16:19], v3, s[4:7], s42 offen offset:0 sc1
    buffer_store_dwordx4 v[20:23], v3, s[4:7], s42 offen offset:128 sc1
    buffer_store_dwordx4 v[24:27], v3, s[4:7], s42 offen offset:256 sc1
    buffer_store_dwordx4 v[28:31], v3, s[4:7], s42 offen offset:384 sc1
    buffer_store_dwordx4 v[32:35], v3, s[4:7], s42 offen offset:512 sc1
    buffer_store_dwordx4 v[36:39], v3, s[4:7], s42 offen offset:640 sc1
    buffer_store_dwordx4 v[40:43], v3, s[4:7], s42 offen offset:768 sc1
    s_nop 1
M_end_225:
    s_waitcnt vmcnt(0)
    s_barrier
    s_cmp_lg_u32 s15, 0
    s_cbranch_scc1 L_ic_227
    v_mov_b32 v46, 32
    v_mov_b32 v47, 1
    s_mov_b64 exec, 1
    global_atomic_add v46, v47, s[36:37] sc1
    s_mov_b64 exec, -1
L_ic_227:
    v_and_b32 v8, 63, v0
    v_lshlrev_b32 v2, 4, v8
    v_and_b32 v9, 15, v8
    v_lshrrev_b32 v10, 4, v8
    v_mov_b32 v3, 0
    s_lshr_b32 s18, s15, 1
    s_lshl_b32 s19, s12, 1
    s_add_u32 s18, s18, s19
    s_lshl_b32 s43, s18, 11
    s_and_b32 s20, s15, 1
    s_lshl_b32 s64, s20, 4
    s_add_u32 s64, s64, s18
    s_mul_i32 s44, s15, 36864
    v_lshrrev_b32 v11, 2, v9
    v_lshlrev_b32 v11, 3, v11
    v_and_b32 v12, 3, v9
    v_add_u32 v11, v11, v12
    v_lshlrev_b32 v4, 6, v11
    v_lshl_add_u32 v4, v10, 4, v4
    v_lshlrev_b32 v5, 9, v10
    v_lshl_add_u32 v5, v9, 4, v5
    v_add_u32 v5, 2048, v5
    s_lshl_b32 s21, s20, 4
    v_add_u32 v11, s21, v9
    v_lshlrev_b32 v6, 6, v11
    v_lshl_add_u32 v6, v10, 4, v6
    v_add_u32 v6, s43, v6
    v_mul_u32_u24 v7, 928, v11
    v_lshl_add_u32 v7, v10, 3, v7
    s_mul_i32 s18, s18, 56
    v_add_u32 v7, s18, v7
    v_lshlrev_b32 v12, 3, v10
    v_add_u32 v13, 0, v12
    v_cmp_le_u32 s[48:49], v13, v11
    v_add_u32 v13, 1, v12
    v_cmp_le_u32 s[50:51], v13, v11
    v_add_u32 v13, 2, v12
    v_cmp_le_u32 s[52:53], v13, v11
    v_add_u32 v13, 3, v12
    v_cmp_le_u32 s[54:55], v13, v11
    v_add_u32 v13, 4, v12
    v_cmp_le_u32 s[56:57], v13, v11
    v_add_u32 v13, 5, v12
    v_cmp_le_u32 s[58:59], v13, v11
    v_add_u32 v13, 6, v12
    v_cmp_le_u32 s[60:61], v13, v11
    v_add_u32 v13, 7, v12
    v_cmp_le_u32 s[62:63], v13, v11
    s_mov_b32 s45, 0x3e8b97f6
    v_mov_b32 v12, 0
    v_mov_b32 v13, 0
    v_mov_b32 v14, 0
    v_mov_b32 v15, 0
    v_add_u32 v11, s44, v2
    ds_write_b128 v11, v[12:15] offset:0
    ds_write_b128 v11, v[12:15] offset:1024
    ds_write_b128 v11, v[12:15] offset:2048
    ds_write_b128 v11, v[12:15] offset:3072
    ds_write_b128 v11, v[12:15] offset:4096
    ds_write_b128 v11, v[12:15] offset:5120
    ds_write_b128 v11, v[12:15] offset:6144
    ds_write_b128 v11, v[12:15] offset:7168
    ds_write_b128 v11, v[12:15] offset:8192
    ds_write_b128 v11, v[12:15] offset:9216
    ds_write_b128 v11, v[12:15] offset:10240
    ds_write_b128 v11, v[12:15] offset:11264
    ds_write_b128 v11, v[12:15] offset:12288
    ds_write_b128 v11, v[12:15] offset:13312
    ds_write_b128 v11, v[12:15] offset:14336
    ds_write_b128 v11, v[12:15] offset:15360
    ds_write_b128 v11, v[12:15] offset:16384
    ds_write_b128 v11, v[12:15] offset:17408
    ds_write_b128 v11, v[12:15] offset:18432
    ds_write_b128 v11, v[12:15] offset:19456
    ds_write_b128 v11, v[12:15] offset:20480
    ds_write_b128 v11, v[12:15] offset:21504
    ds_write_b128 v11, v[12:15] offset:22528
    ds_write_b128 v11, v[12:15] offset:23552
    ds_write_b128 v11, v[12:15] offset:24576
    ds_write_b128 v11, v[12:15] offset:25600
    ds_write_b128 v11, v[12:15] offset:26624
    ds_write_b128 v11, v[12:15] offset:27648
    ds_write_b128 v11, v[12:15] offset:28672
    ds_write_b128 v11, v[12:15] offset:29696
    ds_write_b128 v11, v[12:15] offset:30720
    ds_write_b128 v11, v[12:15] offset:31744
    ds_write_b128 v11, v[12:15] offset:32768
    ds_write_b128 v11, v[12:15] offset:33792
    ds_write_b128 v11, v[12:15] offset:34816
    ds_write_b128 v11, v[12:15] offset:35840
    s_waitcnt lgkmcnt(0)
    s_mov_b32 s32, 400000
    v_mbcnt_lo_u32_b32 v45, -1, 0
    v_add_u32 v45, 8, v45
    v_lshlrev_b32 v45, 2, v45
    s_mov_b64 exec, 1
    s_nop 0
L_dw_229:
    global_load_dword v44, v45, s[36:37] sc1
    s_waitcnt vmcnt(0)
    v_cmp_gt_u32 vcc, 256, v44
    s_nop 3
    s_cbranch_vccz L_dwok_230
    s_sleep 1
    s_sub_u32 s32, s32, 1
    s_cmp_lg_u32 s32, 0
    s_cbranch_scc1 L_dw_229
    s_branch L_fail
L_dwok_230:
    s_mov_b64 exec, -1
L_iok_228:
    s_mov_b32 s16, 0
    s_add_u32 s80, s44, 4096
    s_add_u32 s81, s44, 8192
    s_add_u32 s82, s44, 12288
    s_add_u32 s83, s44, 16384
    s_add_u32 s84, s44, 20480
    s_add_u32 s85, s44, 24576
    s_add_u32 s86, s44, 28672
    s_add_u32 s87, s44, 32768
    s_add_u32 s88, s44, 0
    s_cmp_eq_u32 s13, 0
    s_mov_b32 s66, 0x72e4000
    s_cselect_b32 s66, 0x70e4000, s66
    s_add_u32 s66, s66, s43
    s_cmp_eq_u32 s13, 0
    s_mov_b32 s67, 0x76e4000
    s_cselect_b32 s67, 0x74e4000, s67
    s_add_u32 s67, s67, s43
    s_cmp_eq_u32 s13, 0
    s_mov_b32 s68, 0x6ee4000
    s_cselect_b32 s68, 0x6ce4000, s68
    s_cmp_eq_u32 s13, 0
    s_mov_b32 s69, 0x1d13000
    s_cselect_b32 s69, 0x1b42000, s69
    s_cmp_eq_u32 s13, 0
    s_mov_b32 s70, 0x78fa000
    s_cselect_b32 s70, 0x78ea000, s70
    s_cmp_eq_u32 s13, 0
    s_mov_b32 s71, 0x78fc000
    s_cselect_b32 s71, 0x78ec000, s71
L_ATT_loop:
    v_add_u32 v8, s80, v4
    ds_read_b128 v[136:139], v8
    ds_read_b128 v[140:143], v8 offset:256
    v_add_u32 v9, s81, v4
    ds_read_b128 v[144:147], v9
    ds_read_b128 v[148:151], v9 offset:256
    v_add_u32 v8, s82, v4
    ds_read_b128 v[152:155], v8
    ds_read_b128 v[156:159], v8 offset:256
    v_add_u32 v9, s83, v4
    ds_read_b128 v[160:163], v9
    ds_read_b128 v[164:167], v9 offset:256
    s_waitcnt lgkmcnt(0)
    v_add_u32 v8, s84, v4
    ds_read_b128 v[168:171], v8
    ds_read_b128 v[172:175], v8 offset:256
    v_add_u32 v9, s85, v4
    ds_read_b128 v[176:179], v9
    ds_read_b128 v[180:183], v9 offset:256
    v_add_u32 v8, s86, v4
    ds_read_b128 v[184:187], v8
    ds_read_b128 v[188:191], v8 offset:256
    v_add_u32 v9, s87, v4
    ds_read_b128 v[192:195], v9
    ds_read_b128 v[196:199], v9 offset:256
    s_waitcnt lgkmcnt(0)
    v_add_u32 v8, s80, v5
    ds_read_b128 a[0:3], v8
    ds_read_b128 a[4:7], v8 offset:256
    v_add_u32 v9, s81, v5
    ds_read_b128 a[8:11], v9
    ds_read_b128 a[12:15], v9 offset:256
    v_add_u32 v8, s82, v5
    ds_read_b128 a[16:19], v8
    ds_read_b128 a[20:23], v8 offset:256
    v_add_u32 v9, s83, v5
    ds_read_b128 a[24:27], v9
    ds_read_b128 a[28:31], v9 offset:256
    s_waitcnt lgkmcnt(0)
    v_add_u32 v8, s84, v5
    ds_read_b128 a[32:35], v8
    ds_read_b128 a[36:39], v8 offset:256
    v_add_u32 v9, s85, v5
    ds_read_b128 a[40:43], v9
    ds_read_b128 a[44:47], v9 offset:256
    v_add_u32 v8, s86, v5
    ds_read_b128 a[48:51], v8
    ds_read_b128 a[52:55], v8 offset:256
    v_add_u32 v9, s87, v5
    ds_read_b128 a[56:59], v9
    ds_read_b128 a[60:63], v9 offset:256
    s_mov_b32 s32, 400000
    v_mbcnt_lo_u32_b32 v11, -1, 0
    v_lshlrev_b32 v11, 2, v11
    s_mov_b32 exec_lo, 0xffffff
    s_mov_b32 exec_hi, 0
L_wf_231:
    buffer_load_dword v10, v11, s[4:7], s70 offen sc1
    s_waitcnt vmcnt(0)
    v_cmp_eq_u32 vcc, 0, v10
    s_nop 3
    s_cbranch_vccz L_wfok_232
    s_sleep 1
    s_sub_u32 s32, s32, 1
    s_cmp_lg_u32 s32, 0
    s_cbranch_scc1 L_wf_231
    s_branch L_fail
L_wfok_232:
    s_mov_b64 exec, -1
    s_mov_b32 m0, s88
    buffer_load_dwordx4 v[48:51], v6, s[4:7], s68 offen sc1
    buffer_load_dwordx4 v2, s[4:7], s66 offen sc1 lds
    buffer_load_dwordx4 v2, s[4:7], s66 offen offset:1024 sc1 lds
    s_add_u32 s47, s88, 2048
    s_mov_b32 m0, s47
    s_nop 0
    buffer_load_dwordx4 v2, s[4:7], s67 offen sc1 lds
    buffer_load_dwordx4 v2, s[4:7], s67 offen offset:1024 sc1 lds
    s_waitcnt vmcnt(4) lgkmcnt(0)
    v_mfma_f32_16x16x32_bf16 v[64:67], v[136:139], v[48:51], 0
    v_mfma_f32_16x16x32_bf16 v[68:71], v[140:143], v[48:51], 0
    v_mfma_f32_16x16x32_bf16 v[72:75], v[144:147], v[48:51], 0
    v_mfma_f32_16x16x32_bf16 v[76:79], v[148:151], v[48:51], 0
    v_mfma_f32_16x16x32_bf16 v[80:83], v[152:155], v[48:51], 0
    v_mfma_f32_16x16x32_bf16 v[84:87], v[156:159], v[48:51], 0
    v_mfma_f32_16x16x32_bf16 v[88:91], v[160:163], v[48:51], 0
    v_mfma_f32_16x16x32_bf16 v[92:95], v[164:167], v[48:51], 0
    v_mfma_f32_16x16x32_bf16 v[96:99], v[168:171], v[48:51], 0
    v_mfma_f32_16x16x32_bf16 v[100:103], v[172:175], v[48:51], 0
    v_mfma_f32_16x16x32_bf16 v[104:107], v[176:179], v[48:51], 0
    v_mfma_f32_16x16x32_bf16 v[108:111], v[180:183], v[48:51], 0
    v_mfma_f32_16x16x32_bf16 v[112:115], v[184:187], v[48:51], 0
    v_mfma_f32_16x16x32_bf16 v[116:119], v[188:191], v[48:51], 0
    v_mfma_f32_16x16x32_bf16 v[120:123], v[192:195], v[48:51], 0
    v_mfma_f32_16x16x32_bf16 v[124:127], v[196:199], v[48:51], 0
    s_waitcnt vmcnt(0)
    v_add_u32 v8, s88, v4
    v_add_u32 v9, s88, v5
    ds_read_b128 v[200:203], v8
    ds_read_b128 v[204:207], v8 offset:256
    ds_read_b128 a[64:67], v9
    ds_read_b128 a[68:71], v9 offset:256
    s_waitcnt lgkmcnt(2)
    v_mfma_f32_16x16x32_bf16 v[128:131], v[200:203], v[48:51], 0
    v_mfma_f32_16x16x32_bf16 v[132:135], v[204:207], v[48:51], 0
    v_mov_b32 v10, 0xff800000
    s_nop 5
    v_cndmask_b32 v128, v10, v128, s[48:49]
    v_cndmask_b32 v64, v64, v10, s[48:49]
    v_cndmask_b32 v129, v10, v129, s[50:51]
    v_cndmask_b32 v65, v65, v10, s[50:51]
    v_cndmask_b32 v130, v10, v130, s[52:53]
    v_cndmask_b32 v66, v66, v10, s[52:53]
    v_cndmask_b32 v131, v10, v131, s[54:55]
    v_cndmask_b32 v67, v67, v10, s[54:55]
    v_cndmask_b32 v132, v10, v132, s[56:57]
    v_cndmask_b32 v68, v68, v10, s[56:57]
    v_cndmask_b32 v133, v10, v133, s[58:59]
    v_cndmask_b32 v69, v69, v10, s[58:59]
    v_cndmask_b32 v134, v10, v134, s[60:61]
    v_cndmask_b32 v70, v70, v10, s[60:61]
    v_cndmask_b32 v135, v10, v135, s[62:63]
    v_cndmask_b32 v71, v71, v10, s[62:63]
    s_cmp_ge_u32 s16, 8
    s_cbranch_scc1 L_att_full_234
    s_add_u32 s18, s16, 0
    s_cmp_ge_u32 s18, 8
    s_cbranch_scc1 L_att_full_234
    v_mov_b32 v64, v10
    v_mov_b32 v65, v10
    v_mov_b32 v66, v10
    v_mov_b32 v67, v10
    v_mov_b32 v68, v10
    v_mov_b32 v69, v10
    v_mov_b32 v70, v10
    v_mov_b32 v71, v10
    s_add_u32 s18, s16, 1
    s_cmp_ge_u32 s18, 8
    s_cbranch_scc1 L_att_full_234
    v_mov_b32 v72, v10
    v_mov_b32 v73, v10
    v_mov_b32 v74, v10
    v_mov_b32 v75, v10
    v_mov_b32 v76, v10
    v_mov_b32 v77, v10
    v_mov_b32 v78, v10
    v_mov_b32 v79, v10
    s_add_u32 s18, s16, 2
    s_cmp_ge_u32 s18, 8
    s_cbranch_scc1 L_att_full_234
    v_mov_b32 v80, v10
    v_mov_b32 v81, v10
    v_mov_b32 v82, v10
    v_mov_b32 v83, v10
    v_mov_b32 v84, v10
    v_mov_b32 v85, v10
    v_mov_b32 v86, v10
    v_mov_b32 v87, v10
    s_add_u32 s18, s16, 3
    s_cmp_ge_u32 s18, 8
    s_cbranch_scc1 L_att_full_234
    v_mov_b32 v88, v10
    v_mov_b32 v89, v10
    v_mov_b32 v90, v10
    v_mov_b32 v91, v10
    v_mov_b32 v92, v10
    v_mov_b32 v93, v10
    v_mov_b32 v94, v10
    v_mov_b32 v95, v10
    s_add_u32 s18, s16, 4
    s_cmp_ge_u32 s18, 8
    s_cbranch_scc1 L_att_full_234
    v_mov_b32 v96, v10
    v_mov_b32 v97, v10
    v_mov_b32 v98, v10
    v_mov_b32 v99, v10
    v_mov_b32 v100, v10
    v_mov_b32 v101, v10
    v_mov_b32 v102, v10
    v_mov_b32 v103, v10
    s_add_u32 s18, s16, 5
    s_cmp_ge_u32 s18, 8
    s_cbranch_scc1 L_att_full_234
    v_mov_b32 v104, v10
    v_mov_b32 v105, v10
    v_mov_b32 v106, v10
    v_mov_b32 v107, v10
    v_mov_b32 v108, v10
    v_mov_b32 v109, v10
    v_mov_b32 v110, v10
    v_mov_b32 v111, v10
    s_add_u32 s18, s16, 6
    s_cmp_ge_u32 s18, 8
    s_cbranch_scc1 L_att_full_234
    v_mov_b32 v112, v10
    v_mov_b32 v113, v10
    v_mov_b32 v114, v10
    v_mov_b32 v115, v10
    v_mov_b32 v116, v10
    v_mov_b32 v117, v10
    v_mov_b32 v118, v10
    v_mov_b32 v119, v10
    s_add_u32 s18, s16, 7
    s_cmp_ge_u32 s18, 8
    s_cbranch_scc1 L_att_full_234
    v_mov_b32 v120, v10
    v_mov_b32 v121, v10
    v_mov_b32 v122, v10
    v_mov_b32 v123, v10
    v_mov_b32 v124, v10
    v_mov_b32 v125, v10
    v_mov_b32 v126, v10
    v_mov_b32 v127, v10
    s_nop 1
L_att_full_234:
    v_max3_f32 v8, v64, v65, v66
    v_max3_f32 v9, v67, v68, v69
    v_max3_f32 v8, v8, v70, v71
    v_max3_f32 v9, v9, v72, v73
    v_max3_f32 v8, v8, v74, v75
    v_max3_f32 v9, v9, v76, v77
    v_max3_f32 v8, v8, v78, v79
    v_max3_f32 v9, v9, v80, v81
    v_max3_f32 v8, v8, v82, v83
    v_max3_f32 v9, v9, v84, v85
    v_max3_f32 v8, v8, v86, v87
    v_max3_f32 v9, v9, v88, v89
    v_max3_f32 v8, v8, v90, v91
    v_max3_f32 v9, v9, v92, v93
    v_max3_f32 v8, v8, v94, v95
    v_max3_f32 v9, v9, v96, v97
    v_max3_f32 v8, v8, v98, v99
    v_max3_f32 v9, v9, v100, v101
    v_max3_f32 v8, v8, v102, v103
    v_max3_f32 v9, v9, v104, v105
    v_max3_f32 v8, v8, v106, v107
    v_max3_f32 v9, v9, v108, v109
    v_max3_f32 v8, v8, v110, v111
    v_max3_f32 v9, v9, v112, v113
    v_max3_f32 v8, v8, v114, v115
    v_max3_f32 v9, v9, v116, v117
    v_max3_f32 v8, v8, v118, v119
    v_max3_f32 v9, v9, v120, v121
    v_max3_f32 v8, v8, v122, v123
    v_max3_f32 v9, v9, v124, v125
    v_max3_f32 v8, v8, v126, v127
    v_max3_f32 v9, v9, v128, v129
    v_max3_f32 v8, v8, v130, v131
    v_max3_f32 v9, v9, v132, v133
    v_max3_f32 v8, v8, v134, v135
    v_max_f32 v8, v8, v9
    v_mov_b32 v9, v8
    s_nop 1
    v_permlane16_swap_b32 v9, v8
    v_max_f32 v8, v8, v9
    v_mov_b32 v9, v8
    s_nop 1
    v_permlane32_swap_b32 v9, v8
    v_max_f32 v8, v8, v9
    v_mul_f32 v14, s45, v8
    v_sub_f32 v14, 0, v14
    v_mov_b32 v15, v14
    v_mov_b32 v12, s45
    v_mov_b32 v13, s45
    s_waitcnt lgkmcnt(0)
    v_pk_fma_f32 v[64:65], v[64:65], v[12:13], v[14:15]
    v_pk_fma_f32 v[66:67], v[66:67], v[12:13], v[14:15]
    v_pk_fma_f32 v[68:69], v[68:69], v[12:13], v[14:15]
    v_pk_fma_f32 v[70:71], v[70:71], v[12:13], v[14:15]
    v_exp_f32 v64, v64
    v_exp_f32 v65, v65
    v_exp_f32 v66, v66
    v_exp_f32 v67, v67
    v_exp_f32 v68, v68
    v_exp_f32 v69, v69
    v_exp_f32 v70, v70
    v_exp_f32 v71, v71
    v_cvt_pk_bf16_f32 v208, v64, v65
    v_cvt_pk_bf16_f32 v209, v66, v67
    v_cvt_pk_bf16_f32 v210, v68, v69
    v_cvt_pk_bf16_f32 v211, v70, v71
    v_pk_fma_f32 v[72:73], v[72:73], v[12:13], v[14:15]
    v_pk_fma_f32 v[74:75], v[74:75], v[12:13], v[14:15]
    v_pk_fma_f32 v[76:77], v[76:77], v[12:13], v[14:15]
    v_pk_fma_f32 v[78:79], v[78:79], v[12:13], v[14:15]
    v_exp_f32 v72, v72
    v_exp_f32 v73, v73
    v_exp_f32 v74, v74
    v_exp_f32 v75, v75
    v_exp_f32 v76, v76
    v_exp_f32 v77, v77
    v_exp_f32 v78, v78
    v_exp_f32 v79, v79
    v_cvt_pk_bf16_f32 v212, v72, v73
    v_cvt_pk_bf16_f32 v213, v74, v75
    v_cvt_pk_bf16_f32 v214, v76, v77
    v_cvt_pk_bf16_f32 v215, v78, v79
    v_mfma_f32_16x16x32_bf16 v[244:247], a[0:3], v[208:211], 0
    v_mfma_f32_16x16x32_bf16 v[248:251], a[4:7], v[208:211], 0
    v_pk_fma_f32 v[80:81], v[80:81], v[12:13], v[14:15]
    v_pk_fma_f32 v[82:83], v[82:83], v[12:13], v[14:15]
    v_pk_fma_f32 v[84:85], v[84:85], v[12:13], v[14:15]
    v_pk_fma_f32 v[86:87], v[86:87], v[12:13], v[14:15]
    v_exp_f32 v80, v80
    v_exp_f32 v81, v81
    v_exp_f32 v82, v82
    v_exp_f32 v83, v83
    v_exp_f32 v84, v84
    v_exp_f32 v85, v85
    v_exp_f32 v86, v86
    v_exp_f32 v87, v87
    v_cvt_pk_bf16_f32 v216, v80, v81
    v_cvt_pk_bf16_f32 v217, v82, v83
    v_cvt_pk_bf16_f32 v218, v84, v85
    v_cvt_pk_bf16_f32 v219, v86, v87
    v_mfma_f32_16x16x32_bf16 v[244:247], a[8:11], v[212:215], v[244:247]
    v_mfma_f32_16x16x32_bf16 v[248:251], a[12:15], v[212:215], v[248:251]
    v_pk_fma_f32 v[88:89], v[88:89], v[12:13], v[14:15]
    v_pk_fma_f32 v[90:91], v[90:91], v[12:13], v[14:15]
    v_pk_fma_f32 v[92:93], v[92:93], v[12:13], v[14:15]
    v_pk_fma_f32 v[94:95], v[94:95], v[12:13], v[14:15]
    v_exp_f32 v88, v88
    v_exp_f32 v89, v89
    v_exp_f32 v90, v90
    v_exp_f32 v91, v91
    v_exp_f32 v92, v92
    v_exp_f32 v93, v93
    v_exp_f32 v94, v94
    v_exp_f32 v95, v95
    v_cvt_pk_bf16_f32 v220, v88, v89
    v_cvt_pk_bf16_f32 v221, v90, v91
    v_cvt_pk_bf16_f32 v222, v92, v93
    v_cvt_pk_bf16_f32 v223, v94, v95
    v_mfma_f32_16x16x32_bf16 v[244:247], a[16:19], v[216:219], v[244:247]
    v_mfma_f32_16x16x32_bf16 v[248:251], a[20:23], v[216:219], v[248:251]
    v_pk_fma_f32 v[96:97], v[96:97], v[12:13], v[14:15]
    v_pk_fma_f32 v[98:99], v[98:99], v[12:13], v[14:15]
    v_pk_fma_f32 v[100:101], v[100:101], v[12:13], v[14:15]
    v_pk_fma_f32 v[102:103], v[102:103], v[12:13], v[14:15]
    v_exp_f32 v96, v96
    v_exp_f32 v97, v97
    v_exp_f32 v98, v98
    v_exp_f32 v99, v99
    v_exp_f32 v100, v100
    v_exp_f32 v101, v101
    v_exp_f32 v102, v102
    v_exp_f32 v103, v103
    v_cvt_pk_bf16_f32 v224, v96, v97
    v_cvt_pk_bf16_f32 v225, v98, v99
    v_cvt_pk_bf16_f32 v226, v100, v101
    v_cvt_pk_bf16_f32 v227, v102, v103
    v_mfma_f32_16x16x32_bf16 v[244:247], a[24:27], v[220:223], v[244:247]
    v_mfma_f32_16x16x32_bf16 v[248:251], a[28:31], v[220:223], v[248:251]
    v_pk_fma_f32 v[104:105], v[104:105], v[12:13], v[14:15]
    v_pk_fma_f32 v[106:107], v[106:107], v[12:13], v[14:15]
    v_pk_fma_f32 v[108:109], v[108:109], v[12:13], v[14:15]
    v_pk_fma_f32 v[110:111], v[110:111], v[12:13], v[14:15]
    v_exp_f32 v104, v104
    v_exp_f32 v105, v105
    v_exp_f32 v106, v106
    v_exp_f32 v107, v107
    v_exp_f32 v108, v108
    v_exp_f32 v109, v109
    v_exp_f32 v110, v110
    v_exp_f32 v111, v111
    v_cvt_pk_bf16_f32 v228, v104, v105
    v_cvt_pk_bf16_f32 v229, v106, v107
    v_cvt_pk_bf16_f32 v230, v108, v109
    v_cvt_pk_bf16_f32 v231, v110, v111
    v_mfma_f32_16x16x32_bf16 v[244:247], a[32:35], v[224:227], v[244:247]
    v_mfma_f32_16x16x32_bf16 v[248:251], a[36:39], v[224:227], v[248:251]
    v_pk_fma_f32 v[112:113], v[112:113], v[12:13], v[14:15]
    v_pk_fma_f32 v[114:115], v[114:115], v[12:13], v[14:15]
    v_pk_fma_f32 v[116:117], v[116:117], v[12:13], v[14:15]
    v_pk_fma_f32 v[118:119], v[118:119], v[12:13], v[14:15]
    v_exp_f32 v112, v112
    v_exp_f32 v113, v113
    v_exp_f32 v114, v114
    v_exp_f32 v115, v115
    v_exp_f32 v116, v116
    v_exp_f32 v117, v117
    v_exp_f32 v118, v118
    v_exp_f32 v119, v119
    v_cvt_pk_bf16_f32 v232, v112, v113
    v_cvt_pk_bf16_f32 v233, v114, v115
    v_cvt_pk_bf16_f32 v234, v116, v117
    v_cvt_pk_bf16_f32 v235, v118, v119
    v_mfma_f32_16x16x32_bf16 v[244:247], a[40:43], v[228:231], v[244:247]
    v_mfma_f32_16x16x32_bf16 v[248:251], a[44:47], v[228:231], v[248:251]
    v_pk_fma_f32 v[120:121], v[120:121], v[12:13], v[14:15]
    v_pk_fma_f32 v[122:123], v[122:123], v[12:13], v[14:15]
    v_pk_fma_f32 v[124:125], v[124:125], v[12:13], v[14:15]
    v_pk_fma_f32 v[126:127], v[126:127], v[12:13], v[14:15]
    v_exp_f32 v120, v120
    v_exp_f32 v121, v121
    v_exp_f32 v122, v122
    v_exp_f32 v123, v123
    v_exp_f32 v124, v124
    v_exp_f32 v125, v125
    v_exp_f32 v126, v126
    v_exp_f32 v127, v127
    v_cvt_pk_bf16_f32 v236, v120, v121
    v_cvt_pk_bf16_f32 v237, v122, v123
    v_cvt_pk_bf16_f32 v238, v124, v125
    v_cvt_pk_bf16_f32 v239, v126, v127
    v_mfma_f32_16x16x32_bf16 v[244:247], a[48:51], v[232:235], v[244:247]
    v_mfma_f32_16x16x32_bf16 v[248:251], a[52:55], v[232:235], v[248:251]
    v_pk_fma_f32 v[128:129], v[128:129], v[12:13], v[14:15]
    v_pk_fma_f32 v[130:131], v[130:131], v[12:13], v[14:15]
    v_pk_fma_f32 v[132:133], v[132:133], v[12:13], v[14:15]
    v_pk_fma_f32 v[134:135], v[134:135], v[12:13], v[14:15]
    v_exp_f32 v128, v128
    v_exp_f32 v129, v129
    v_exp_f32 v130, v130
    v_exp_f32 v131, v131
    v_exp_f32 v132, v132
    v_exp_f32 v133, v133
    v_exp_f32 v134, v134
    v_exp_f32 v135, v135
    v_cvt_pk_bf16_f32 v240, v128, v129
    v_cvt_pk_bf16_f32 v241, v130, v131
    v_cvt_pk_bf16_f32 v242, v132, v133
    v_cvt_pk_bf16_f32 v243, v134, v135
    v_mfma_f32_16x16x32_bf16 v[244:247], a[56:59], v[236:239], v[244:247]
    v_mfma_f32_16x16x32_bf16 v[248:251], a[60:63], v[236:239], v[248:251]
    v_mfma_f32_16x16x32_bf16 v[244:247], a[64:67], v[240:243], v[244:247]
    v_mfma_f32_16x16x32_bf16 v[248:251], a[68:71], v[240:243], v[248:251]
    s_nop 7
    v_mov_b32 v8, v248
    v_mov_b32 v9, v8
    s_nop 1
    v_permlane32_swap_b32 v9, v8
    v_mov_b32 v9, v8
    s_nop 1
    v_permlane16_swap_b32 v9, v8
    v_rcp_f32 v8, v8
    s_nop 0
    v_mul_f32 v244, v244, v8
    v_mul_f32 v245, v245, v8
    v_mul_f32 v246, v246, v8
    v_mul_f32 v247, v247, v8
    v_mul_f32 v248, v248, v8
    v_mul_f32 v249, v249, v8
    v_mul_f32 v250, v250, v8
    v_mul_f32 v251, v251, v8
    v_cvt_pk_bf16_f32 v244, v244, v245
    v_cvt_pk_bf16_f32 v245, v246, v247
    v_cvt_pk_bf16_f32 v248, v248, v249
    v_cvt_pk_bf16_f32 v249, v250, v251
    s_cmp_lg_u32 s14, 0
    s_cbranch_scc1 L_slow_243
    buffer_store_dwordx2 v[244:245], v7, s[4:7], s69 offen
    s_mov_b32 exec_hi, 0x0000ffff
    buffer_store_dwordx2 v[248:249], v7, s[4:7], s69 offen offset:32
    s_mov_b32 exec_hi, -1
    s_branch L_md_244
L_slow_243:
    buffer_store_dwordx2 v[244:245], v7, s[4:7], s69 offen sc1
    s_mov_b32 exec_hi, 0x0000ffff
    buffer_store_dwordx2 v[248:249], v7, s[4:7], s69 offen offset:32 sc1
    s_mov_b32 exec_hi, -1
L_md_244:
    s_mov_b32 s47, s80
    s_mov_b32 s80, s81
    s_mov_b32 s81, s82
    s_mov_b32 s82, s83
    s_mov_b32 s83, s84
    s_mov_b32 s84, s85
    s_mov_b32 s85, s86
    s_mov_b32 s86, s87
    s_mov_b32 s87, s88
    s_mov_b32 s88, s47
    s_add_u32 s66, s66, 32768
    s_add_u32 s67, s67, 32768
    s_add_u32 s68, s68, 32768
    s_add_u32 s69, s69, 29696
    s_add_u32 s70, s70, 128
    s_waitcnt vmcnt(0)
    v_mov_b32 v8, 1
    s_lshl_b32 s18, s64, 2
    v_mov_b32 v9, s18
    s_mov_b64 exec, 1
    s_cmp_lg_u32 s14, 0
    s_cbranch_scc1 L_slow_245
    buffer_store_dword v8, v9, s[4:7], s71 offen
    s_branch L_md_246
L_slow_245:
    buffer_store_dword v8, v9, s[4:7], s71 offen sc1
L_md_246:
    s_mov_b64 exec, -1
    s_add_u32 s71, s71, 128
    s_add_u32 s16, s16, 1
    s_cmp_lt_u32 s16, 64
    s_cbranch_scc1 L_ATT_loop
    s_branch L_role_done
L_nATT:
    s_sub_u32 s19, s19, 28
    s_and_b32 s38, s19, 1
    s_lshr_b32 s12, s19, 1
    s_mov_b32 s40, s93
    s_cmp_ge_u32 s40, 160
    s_cbranch_scc1 M_end_247
    v_lshlrev_b32 v6, 4, v0
    v_mov_b32 v8, -1
    v_mov_b32 v12, 0
    v_mov_b32 v9, -1
    v_mov_b32 v13, 0
    v_mov_b32 v10, -1
    v_mov_b32 v14, 0
    v_mov_b32 v11, -1
    v_mov_b32 v15, 0
    s_lshl_b32 s42, s40, 12
    s_add_u32 s42, s42, 126763008
    s_mov_b32 s46, 126894080
    s_mov_b32 s44, s4
    s_mov_b32 s45, s5
    s_mov_b32 s47, 0x00020000
    buffer_store_dwordx4 v[12:15], v6, s[44:47], s42 offen sc1
    s_lshl_b32 s42, s40, 12
    s_add_u32 s42, s42, 32398336
    s_mov_b32 s46, 32849920
    s_mov_b32 s44, s4
    s_mov_b32 s45, s5
    s_mov_b32 s47, 0x00020000
    buffer_store_dwordx4 v[8:11], v6, s[44:47], s42 offen sc1
    s_lshl_b32 s42, s40, 12
    s_add_u32 s42, s42, 33315840
    s_mov_b32 s46, 33767424
    s_mov_b32 s44, s4
    s_mov_b32 s45, s5
    s_mov_b32 s47, 0x00020000
    buffer_store_dwordx4 v[8:11], v6, s[44:47], s42 offen sc1
    s_lshl_b32 s42, s40, 12
    s_add_u32 s42, s42, 34226176
    s_mov_b32 s46, 34881536
    s_mov_b32 s44, s4
    s_mov_b32 s45, s5
    s_mov_b32 s47, 0x00020000
    buffer_store_dwordx4 v[8:11], v6, s[44:47], s42 offen sc1
    s_lshl_b32 s42, s40, 12
    s_add_u32 s42, s42, 32857088
    s_mov_b32 s46, 33308672
    s_mov_b32 s44, s4
    s_mov_b32 s45, s5
    s_mov_b32 s47, 0x00020000
    buffer_store_dwordx4 v[8:11], v6, s[44:47], s42 offen sc1
    s_lshl_b32 s42, s40, 12
    s_add_u32 s42, s42, 33774592
    s_mov_b32 s46, 34226176
    s_mov_b32 s44, s4
    s_mov_b32 s45, s5
    s_mov_b32 s47, 0x00020000
    buffer_store_dwordx4 v[8:11], v6, s[44:47], s42 offen sc1
    s_lshl_b32 s42, s40, 12
    s_add_u32 s42, s42, 34881536
    s_mov_b32 s46, 35536896
    s_mov_b32 s44, s4
    s_mov_b32 s45, s5
    s_mov_b32 s47, 0x00020000
    buffer_store_dwordx4 v[8:11], v6, s[44:47], s42 offen sc1
    s_cmp_ge_u32 s40, 32
    s_cbranch_scc1 M_end_247
    s_load_dwordx2 s[8:9], s[34:35], 0
    s_waitcnt lgkmcnt(0)
    s_mov_b32 s10, 1835008
    s_mov_b32 s11, 0x00020000
    v_lshrrev_b32 v4, 3, v0
    v_and_b32 v5, 7, v0
    v_mul_u32_u24 v2, 896, v4
    v_lshl_add_u32 v2, v5, 4, v2
    v_mul_u32_u24 v3, 928, v4
    v_lshl_add_u32 v3, v5, 4, v3
    s_add_u32 s41, s40, 32
    s_mul_i32 s42, s41, 28672
    buffer_load_dwordx4 v[16:19], v2, s[8:11], s42 offen offset:0
    buffer_load_dwordx4 v[20:23], v2, s[8:11], s42 offen offset:128
    buffer_load_dwordx4 v[24:27], v2, s[8:11], s42 offen offset:256
    buffer_load_dwordx4 v[28:31], v2, s[8:11], s42 offen offset:384
    buffer_load_dwordx4 v[32:35], v2, s[8:11], s42 offen offset:512
    buffer_load_dwordx4 v[36:39], v2, s[8:11], s42 offen offset:640
    buffer_load_dwordx4 v[40:43], v2, s[8:11], s42 offen offset:768
    s_waitcnt vmcnt(0)
    v_lshlrev_b32 v48, 16, v16
    v_and_b32 v49, 0xffff0000, v16
    v_lshlrev_b32 v50, 16, v17
    v_and_b32 v51, 0xffff0000, v17
    v_lshlrev_b32 v52, 16, v18
    v_and_b32 v53, 0xffff0000, v18
    v_lshlrev_b32 v54, 16, v19
    v_and_b32 v55, 0xffff0000, v19
    v_lshlrev_b32 v56, 16, v20
    v_and_b32 v57, 0xffff0000, v20
    v_lshlrev_b32 v58, 16, v21
    v_and_b32 v59, 0xffff0000, v21
    v_lshlrev_b32 v60, 16, v22
    v_and_b32 v61, 0xffff0000, v22
    v_lshlrev_b32 v62, 16, v23
    v_and_b32 v63, 0xffff0000, v23
    v_lshlrev_b32 v64, 16, v24
    v_and_b32 v65, 0xffff0000, v24
    v_lshlrev_b32 v66, 16, v25
    v_and_b32 v67, 0xffff0000, v25
    v_lshlrev_b32 v68, 16, v26
    v_and_b32 v69, 0xffff0000, v26
    v_lshlrev_b32 v70, 16, v27
    v_and_b32 v71, 0xffff0000, v27
    v_lshlrev_b32 v72, 16, v28
    v_and_b32 v73, 0xffff0000, v28
    v_lshlrev_b32 v74, 16, v29
    v_and_b32 v75, 0xffff0000, v29
    v_lshlrev_b32 v76, 16, v30
    v_and_b32 v77, 0xffff0000, v30
    v_lshlrev_b32 v78, 16, v31
    v_and_b32 v79, 0xffff0000, v31
    v_lshlrev_b32 v80, 16, v32
    v_and_b32 v81, 0xffff0000, v32
    v_lshlrev_b32 v82, 16, v33
    v_and_b32 v83, 0xffff0000, v33
    v_lshlrev_b32 v84, 16, v34
    v_and_b32 v85, 0xffff0000, v34
    v_lshlrev_b32 v86, 16, v35
    v_and_b32 v87, 0xffff0000, v35
    v_lshlrev_b32 v88, 16, v36
    v_and_b32 v89, 0xffff0000, v36
    v_lshlrev_b32 v90, 16, v37
    v_and_b32 v91, 0xffff0000, v37
    v_lshlrev_b32 v92, 16, v38
    v_and_b32 v93, 0xffff0000, v38
    v_lshlrev_b32 v94, 16, v39
    v_and_b32 v95, 0xffff0000, v39
    v_lshlrev_b32 v96, 16, v40
    v_and_b32 v97, 0xffff0000, v40
    v_lshlrev_b32 v98, 16, v41
    v_and_b32 v99, 0xffff0000, v41
    v_lshlrev_b32 v100, 16, v42
    v_and_b32 v101, 0xffff0000, v42
    v_lshlrev_b32 v102, 16, v43
    v_and_b32 v103, 0xffff0000, v43
    v_pk_add_f32 v[6:7], v[48:49], v[50:51]
    v_pk_add_f32 v[8:9], v[52:53], v[54:55]
    v_pk_add_f32 v[6:7], v[6:7], v[56:57]
    v_pk_add_f32 v[8:9], v[8:9], v[58:59]
    v_pk_add_f32 v[6:7], v[6:7], v[60:61]
    v_pk_add_f32 v[8:9], v[8:9], v[62:63]
    v_pk_add_f32 v[6:7], v[6:7], v[64:65]
    v_pk_add_f32 v[8:9], v[8:9], v[66:67]
    v_pk_add_f32 v[6:7], v[6:7], v[68:69]
    v_pk_add_f32 v[8:9], v[8:9], v[70:71]
    v_pk_add_f32 v[6:7], v[6:7], v[72:73]
    v_pk_add_f32 v[8:9], v[8:9], v[74:75]
    v_pk_add_f32 v[6:7], v[6:7], v[76:77]
    v_pk_add_f32 v[8:9], v[8:9], v[78:79]
    v_pk_add_f32 v[6:7], v[6:7], v[80:81]
    v_pk_add_f32 v[8:9], v[8:9], v[82:83]
    v_pk_add_f32 v[6:7], v[6:7], v[84:85]
    v_pk_add_f32 v[8:9], v[8:9], v[86:87]
    v_pk_add_f32 v[6:7], v[6:7], v[88:89]
    v_pk_add_f32 v[8:9], v[8:9], v[90:91]
    v_pk_add_f32 v[6:7], v[6:7], v[92:93]
    v_pk_add_f32 v[8:9], v[8:9], v[94:95]
    v_pk_add_f32 v[6:7], v[6:7], v[96:97]
    v_pk_add_f32 v[8:9], v[8:9], v[98:99]
    v_pk_add_f32 v[6:7], v[6:7], v[100:101]
    v_pk_add_f32 v[8:9], v[8:9], v[102:103]
    v_pk_add_f32 v[6:7], v[6:7], v[8:9]
    v_add_f32 v4, v6, v7
    s_nop 1
    v_add_f32_dpp v4, v4, v4 quad_perm:[1,0,3,2] row_mask:0xf bank_mask:0xf
    s_nop 1
    v_add_f32_dpp v4, v4, v4 quad_perm:[2,3,0,1] row_mask:0xf bank_mask:0xf
    s_nop 1
    v_add_f32_dpp v4, v4, v4 row_half_mirror row_mask:0xf bank_mask:0xf
    v_mul_f32 v8, 0xbb124925, v4
    v_mov_b32 v9, v8
    v_pk_add_f32 v[48:49], v[48:49], v[8:9]
    v_pk_add_f32 v[50:51], v[50:51], v[8:9]
    v_pk_add_f32 v[52:53], v[52:53], v[8:9]
    v_pk_add_f32 v[54:55], v[54:55], v[8:9]
    v_pk_add_f32 v[56:57], v[56:57], v[8:9]
    v_pk_add_f32 v[58:59], v[58:59], v[8:9]
    v_pk_add_f32 v[60:61], v[60:61], v[8:9]
    v_pk_add_f32 v[62:63], v[62:63], v[8:9]
    v_pk_add_f32 v[64:65], v[64:65], v[8:9]
    v_pk_add_f32 v[66:67], v[66:67], v[8:9]
    v_pk_add_f32 v[68:69], v[68:69], v[8:9]
    v_pk_add_f32 v[70:71], v[70:71], v[8:9]
    v_pk_add_f32 v[72:73], v[72:73], v[8:9]
    v_pk_add_f32 v[74:75], v[74:75], v[8:9]
    v_pk_add_f32 v[76:77], v[76:77], v[8:9]
    v_pk_add_f32 v[78:79], v[78:79], v[8:9]
    v_pk_add_f32 v[80:81], v[80:81], v[8:9]
    v_pk_add_f32 v[82:83], v[82:83], v[8:9]
    v_pk_add_f32 v[84:85], v[84:85], v[8:9]
    v_pk_add_f32 v[86:87], v[86:87], v[8:9]
    v_pk_add_f32 v[88:89], v[88:89], v[8:9]
    v_pk_add_f32 v[90:91], v[90:91], v[8:9]
    v_pk_add_f32 v[92:93], v[92:93], v[8:9]
    v_pk_add_f32 v[94:95], v[94:95], v[8:9]
    v_pk_add_f32 v[96:97], v[96:97], v[8:9]
    v_pk_add_f32 v[98:99], v[98:99], v[8:9]
    v_pk_add_f32 v[100:101], v[100:101], v[8:9]
    v_pk_add_f32 v[102:103], v[102:103], v[8:9]
    v_pk_mul_f32 v[6:7], v[48:49], v[48:49]
    v_pk_mul_f32 v[8:9], v[50:51], v[50:51]
    v_pk_fma_f32 v[6:7], v[52:53], v[52:53], v[6:7]
    v_pk_fma_f32 v[8:9], v[54:55], v[54:55], v[8:9]
    v_pk_fma_f32 v[6:7], v[56:57], v[56:57], v[6:7]
    v_pk_fma_f32 v[8:9], v[58:59], v[58:59], v[8:9]
    v_pk_fma_f32 v[6:7], v[60:61], v[60:61], v[6:7]
    v_pk_fma_f32 v[8:9], v[62:63], v[62:63], v[8:9]
    v_pk_fma_f32 v[6:7], v[64:65], v[64:65], v[6:7]
    v_pk_fma_f32 v[8:9], v[66:67], v[66:67], v[8:9]
    v_pk_fma_f32 v[6:7], v[68:69], v[68:69], v[6:7]
    v_pk_fma_f32 v[8:9], v[70:71], v[70:71], v[8:9]
    v_pk_fma_f32 v[6:7], v[72:73], v[72:73], v[6:7]
    v_pk_fma_f32 v[8:9], v[74:75], v[74:75], v[8:9]
    v_pk_fma_f32 v[6:7], v[76:77], v[76:77], v[6:7]
    v_pk_fma_f32 v[8:9], v[78:79], v[78:79], v[8:9]
    v_pk_fma_f32 v[6:7], v[80:81], v[80:81], v[6:7]
    v_pk_fma_f32 v[8:9], v[82:83], v[82:83], v[8:9]
    v_pk_fma_f32 v[6:7], v[84:85], v[84:85], v[6:7]
    v_pk_fma_f32 v[8:9], v[86:87], v[86:87], v[8:9]
    v_pk_fma_f32 v[6:7], v[88:89], v[88:89], v[6:7]
    v_pk_fma_f32 v[8:9], v[90:91], v[90:91], v[8:9]
    v_pk_fma_f32 v[6:7], v[92:93], v[92:93], v[6:7]
    v_pk_fma_f32 v[8:9], v[94:95], v[94:95], v[8:9]
    v_pk_fma_f32 v[6:7], v[96:97], v[96:97], v[6:7]
    v_pk_fma_f32 v[8:9], v[98:99], v[98:99], v[8:9]
    v_pk_fma_f32 v[6:7], v[100:101], v[100:101], v[6:7]
    v_pk_fma_f32 v[8:9], v[102:103], v[102:103], v[8:9]
    v_pk_add_f32 v[6:7], v[6:7], v[8:9]
    v_add_f32 v4, v6, v7
    s_nop 1
    v_add_f32_dpp v4, v4, v4 quad_perm:[1,0,3,2] row_mask:0xf bank_mask:0xf
    s_nop 1
    v_add_f32_dpp v4, v4, v4 quad_perm:[2,3,0,1] row_mask:0xf bank_mask:0xf
    s_nop 1
    v_add_f32_dpp v4, v4, v4 row_half_mirror row_mask:0xf bank_mask:0xf
    v_mov_b32 v6, 0x3727c5ac
    v_fmac_f32 v6, 0x3b124925, v4
    v_rsq_f32 v6, v6
    s_nop 0
    v_mov_b32 v7, v6
    v_pk_mul_f32 v[48:49], v[48:49], v[6:7]
    v_cvt_pk_bf16_f32 v16, v48, v49
    v_pk_mul_f32 v[50:51], v[50:51], v[6:7]
    v_cvt_pk_bf16_f32 v17, v50, v51
    v_pk_mul_f32 v[52:53], v[52:53], v[6:7]
    v_cvt_pk_bf16_f32 v18, v52, v53
    v_pk_mul_f32 v[54:55], v[54:55], v[6:7]
    v_cvt_pk_bf16_f32 v19, v54, v55
    v_pk_mul_f32 v[56:57], v[56:57], v[6:7]
    v_cvt_pk_bf16_f32 v20, v56, v57
    v_pk_mul_f32 v[58:59], v[58:59], v[6:7]
    v_cvt_pk_bf16_f32 v21, v58, v59
    v_pk_mul_f32 v[60:61], v[60:61], v[6:7]
    v_cvt_pk_bf16_f32 v22, v60, v61
    v_pk_mul_f32 v[62:63], v[62:63], v[6:7]
    v_cvt_pk_bf16_f32 v23, v62, v63
    v_pk_mul_f32 v[64:65], v[64:65], v[6:7]
    v_cvt_pk_bf16_f32 v24, v64, v65
    v_pk_mul_f32 v[66:67], v[66:67], v[6:7]
    v_cvt_pk_bf16_f32 v25, v66, v67
    v_pk_mul_f32 v[68:69], v[68:69], v[6:7]
    v_cvt_pk_bf16_f32 v26, v68, v69
    v_pk_mul_f32 v[70:71], v[70:71], v[6:7]
    v_cvt_pk_bf16_f32 v27, v70, v71
    v_pk_mul_f32 v[72:73], v[72:73], v[6:7]
    v_cvt_pk_bf16_f32 v28, v72, v73
    v_pk_mul_f32 v[74:75], v[74:75], v[6:7]
    v_cvt_pk_bf16_f32 v29, v74, v75
    v_pk_mul_f32 v[76:77], v[76:77], v[6:7]
    v_cvt_pk_bf16_f32 v30, v76, v77
    v_pk_mul_f32 v[78:79], v[78:79], v[6:7]
    v_cvt_pk_bf16_f32 v31, v78, v79
    v_pk_mul_f32 v[80:81], v[80:81], v[6:7]
    v_cvt_pk_bf16_f32 v32, v80, v81
    v_pk_mul_f32 v[82:83], v[82:83], v[6:7]
    v_cvt_pk_bf16_f32 v33, v82, v83
    v_pk_mul_f32 v[84:85], v[84:85], v[6:7]
    v_cvt_pk_bf16_f32 v34, v84, v85
    v_pk_mul_f32 v[86:87], v[86:87], v[6:7]
    v_cvt_pk_bf16_f32 v35, v86, v87
    v_pk_mul_f32 v[88:89], v[88:89], v[6:7]
    v_cvt_pk_bf16_f32 v36, v88, v89
    v_pk_mul_f32 v[90:91], v[90:91], v[6:7]
    v_cvt_pk_bf16_f32 v37, v90, v91
    v_pk_mul_f32 v[92:93], v[92:93], v[6:7]
    v_cvt_pk_bf16_f32 v38, v92, v93
    v_pk_mul_f32 v[94:95], v[94:95], v[6:7]
    v_cvt_pk_bf16_f32 v39, v94, v95
    v_pk_mul_f32 v[96:97], v[96:97], v[6:7]
    v_cvt_pk_bf16_f32 v40, v96, v97
    v_pk_mul_f32 v[98:99], v[98:99], v[6:7]
    v_cvt_pk_bf16_f32 v41, v98, v99
    v_pk_mul_f32 v[100:101], v[100:101], v[6:7]
    v_cvt_pk_bf16_f32 v42, v100, v101
    v_pk_mul_f32 v[102:103], v[102:103], v[6:7]
    v_cvt_pk_bf16_f32 v43, v102, v103
    s_mul_i32 s42, s41, 29696
    s_add_u32 s42, s42, 19267584
    buffer_store_dwordx4 v[16:19], v3, s[4:7], s42 offen offset:0 sc1
    buffer_store_dwordx4 v[20:23], v3, s[4:7], s42 offen offset:128 sc1
    buffer_store_dwordx4 v[24:27], v3, s[4:7], s42 offen offset:256 sc1
    buffer_store_dwordx4 v[28:31], v3, s[4:7], s42 offen offset:384 sc1
    buffer_store_dwordx4 v[32:35], v3, s[4:7], s42 offen offset:512 sc1
    buffer_store_dwordx4 v[36:39], v3, s[4:7], s42 offen offset:640 sc1
    buffer_store_dwordx4 v[40:43], v3, s[4:7], s42 offen offset:768 sc1
    s_nop 1
M_end_247:
    s_waitcnt vmcnt(0)
    s_barrier
    s_cmp_lg_u32 s15, 0
    s_cbranch_scc1 L_ic_249
    v_mov_b32 v46, 32
    v_mov_b32 v47, 1
    s_mov_b64 exec, 1
    global_atomic_add v46, v47, s[36:37] sc1
    s_mov_b64 exec, -1
L_ic_249:
    s_load_dwordx2 s[8:9], s[34:35], 72
    s_waitcnt lgkmcnt(0)
    s_mov_b32 s10, 401408
    s_mov_b32 s11, 0x00020000
    s_mov_b32 s46, 0
    v_and_b32 v12, 63, v0
    v_lshlrev_b32 v17, 4, v12
    v_and_b32 v13, 15, v12
    v_lshrrev_b32 v14, 4, v12
    v_lshrrev_b32 v15, 2, v13
    v_lshl_add_u32 v15, v14, 3, v15
    v_mul_u32_u24 v15, 928, v15
    v_and_b32 v16, 3, v13
    s_mul_i32 s18, s15, 224
    v_add_u32 v15, s18, v15
    v_lshl_add_u32 v16, v16, 3, v15
    v_and_b32 v13, 3, v13
    v_lshl_add_u32 v15, v13, 4, v15
    s_mov_b32 exec_hi, 0x00ffffff
    s_mul_i32 s22, s15, 7168
    s_add_u32 s22, s22, 0
    s_add_u32 s22, s22, s46
    s_mul_i32 s23, s15, 7424
    s_add_u32 s23, s23, 0
    s_mov_b32 m0, s23
    s_nop 0
    buffer_load_dwordx4 v17, s[8:11], s22 offen lds
    s_add_u32 s22, s22, 896
    s_add_u32 s23, s23, 928
    s_mov_b32 m0, s23
    s_nop 0
    buffer_load_dwordx4 v17, s[8:11], s22 offen lds
    s_add_u32 s22, s22, 896
    s_add_u32 s23, s23, 928
    s_mov_b32 m0, s23
    s_nop 0
    buffer_load_dwordx4 v17, s[8:11], s22 offen lds
    s_add_u32 s22, s22, 896
    s_add_u32 s23, s23, 928
    s_mov_b32 m0, s23
    s_nop 0
    buffer_load_dwordx4 v17, s[8:11], s22 offen lds
    s_add_u32 s22, s22, 896
    s_add_u32 s23, s23, 928
    s_mov_b32 m0, s23
    s_nop 0
    buffer_load_dwordx4 v17, s[8:11], s22 offen lds
    s_add_u32 s22, s22, 896
    s_add_u32 s23, s23, 928
    s_mov_b32 m0, s23
    s_nop 0
    buffer_load_dwordx4 v17, s[8:11], s22 offen lds
    s_add_u32 s22, s22, 896
    s_add_u32 s23, s23, 928
    s_mov_b32 m0, s23
    s_nop 0
    buffer_load_dwordx4 v17, s[8:11], s22 offen lds
    s_add_u32 s22, s22, 896
    s_add_u32 s23, s23, 928
    s_mov_b32 m0, s23
    s_nop 0
    buffer_load_dwordx4 v17, s[8:11], s22 offen lds
    s_mul_i32 s22, s15, 7168
    s_add_u32 s22, s22, 28672
    s_add_u32 s22, s22, s46
    s_mul_i32 s23, s15, 7424
    s_add_u32 s23, s23, 29696
    s_mov_b32 m0, s23
    s_nop 0
    buffer_load_dwordx4 v17, s[8:11], s22 offen lds
    s_add_u32 s22, s22, 896
    s_add_u32 s23, s23, 928
    s_mov_b32 m0, s23
    s_nop 0
    buffer_load_dwordx4 v17, s[8:11], s22 offen lds
    s_add_u32 s22, s22, 896
    s_add_u32 s23, s23, 928
    s_mov_b32 m0, s23
    s_nop 0
    buffer_load_dwordx4 v17, s[8:11], s22 offen lds
    s_add_u32 s22, s22, 896
    s_add_u32 s23, s23, 928
    s_mov_b32 m0, s23
    s_nop 0
    buffer_load_dwordx4 v17, s[8:11], s22 offen lds
    s_add_u32 s22, s22, 896
    s_add_u32 s23, s23, 928
    s_mov_b32 m0, s23
    s_nop 0
    buffer_load_dwordx4 v17, s[8:11], s22 offen lds
    s_add_u32 s22, s22, 896
    s_add_u32 s23, s23, 928
    s_mov_b32 m0, s23
    s_nop 0
    buffer_load_dwordx4 v17, s[8:11], s22 offen lds
    s_add_u32 s22, s22, 896
    s_add_u32 s23, s23, 928
    s_mov_b32 m0, s23
    s_nop 0
    buffer_load_dwordx4 v17, s[8:11], s22 offen lds
    s_add_u32 s22, s22, 896
    s_add_u32 s23, s23, 928
    s_mov_b32 m0, s23
    s_nop 0
    buffer_load_dwordx4 v17, s[8:11], s22 offen lds
    s_mul_i32 s22, s15, 7168
    s_add_u32 s22, s22, 57344
    s_add_u32 s22, s22, s46
    s_mul_i32 s23, s15, 7424
    s_add_u32 s23, s23, 59392
    s_mov_b32 m0, s23
    s_nop 0
    buffer_load_dwordx4 v17, s[8:11], s22 offen lds
    s_add_u32 s22, s22, 896
    s_add_u32 s23, s23, 928
    s_mov_b32 m0, s23
    s_nop 0
    buffer_load_dwordx4 v17, s[8:11], s22 offen lds
    s_add_u32 s22, s22, 896
    s_add_u32 s23, s23, 928
    s_mov_b32 m0, s23
    s_nop 0
    buffer_load_dwordx4 v17, s[8:11], s22 offen lds
    s_add_u32 s22, s22, 896
    s_add_u32 s23, s23, 928
    s_mov_b32 m0, s23
    s_nop 0
    buffer_load_dwordx4 v17, s[8:11], s22 offen lds
    s_add_u32 s22, s22, 896
    s_add_u32 s23, s23, 928
    s_mov_b32 m0, s23
    s_nop 0
    buffer_load_dwordx4 v17, s[8:11], s22 offen lds
    s_add_u32 s22, s22, 896
    s_add_u32 s23, s23, 928
    s_mov_b32 m0, s23
    s_nop 0
    buffer_load_dwordx4 v17, s[8:11], s22 offen lds
    s_add_u32 s22, s22, 896
    s_add_u32 s23, s23, 928
    s_mov_b32 m0, s23
    s_nop 0
    buffer_load_dwordx4 v17, s[8:11], s22 offen lds
    s_add_u32 s22, s22, 896
    s_add_u32 s23, s23, 928
    s_mov_b32 m0, s23
    s_nop 0
    buffer_load_dwordx4 v17, s[8:11], s22 offen lds
    s_mul_i32 s22, s15, 7168
    s_add_u32 s22, s22, 86016
    s_add_u32 s22, s22, s46
    s_mul_i32 s23, s15, 7424
    s_add_u32 s23, s23, 89088
    s_mov_b32 m0, s23
    s_nop 0
    buffer_load_dwordx4 v17, s[8:11], s22 offen lds
    s_add_u32 s22, s22, 896
    s_add_u32 s23, s23, 928
    s_mov_b32 m0, s23
    s_nop 0
    buffer_load_dwordx4 v17, s[8:11], s22 offen lds
    s_add_u32 s22, s22, 896
    s_add_u32 s23, s23, 928
    s_mov_b32 m0, s23
    s_nop 0
    buffer_load_dwordx4 v17, s[8:11], s22 offen lds
    s_add_u32 s22, s22, 896
    s_add_u32 s23, s23, 928
    s_mov_b32 m0, s23
    s_nop 0
    buffer_load_dwordx4 v17, s[8:11], s22 offen lds
    s_add_u32 s22, s22, 896
    s_add_u32 s23, s23, 928
    s_mov_b32 m0, s23
    s_nop 0
    buffer_load_dwordx4 v17, s[8:11], s22 offen lds
    s_add_u32 s22, s22, 896
    s_add_u32 s23, s23, 928
    s_mov_b32 m0, s23
    s_nop 0
    buffer_load_dwordx4 v17, s[8:11], s22 offen lds
    s_add_u32 s22, s22, 896
    s_add_u32 s23, s23, 928
    s_mov_b32 m0, s23
    s_nop 0
    buffer_load_dwordx4 v17, s[8:11], s22 offen lds
    s_add_u32 s22, s22, 896
    s_add_u32 s23, s23, 928
    s_mov_b32 m0, s23
    s_nop 0
    buffer_load_dwordx4 v17, s[8:11], s22 offen lds
    s_mul_i32 s22, s15, 7168
    s_add_u32 s22, s22, 114688
    s_add_u32 s22, s22, s46
    s_mul_i32 s23, s15, 7424
    s_add_u32 s23, s23, 118784
    s_mov_b32 m0, s23
    s_nop 0
    buffer_load_dwordx4 v17, s[8:11], s22 offen lds
    s_add_u32 s22, s22, 896
    s_add_u32 s23, s23, 928
    s_mov_b32 m0, s23
    s_nop 0
    buffer_load_dwordx4 v17, s[8:11], s22 offen lds
    s_add_u32 s22, s22, 896
    s_add_u32 s23, s23, 928
    s_mov_b32 m0, s23
    s_nop 0
    buffer_load_dwordx4 v17, s[8:11], s22 offen lds
    s_add_u32 s22, s22, 896
    s_add_u32 s23, s23, 928
    s_mov_b32 m0, s23
    s_nop 0
    buffer_load_dwordx4 v17, s[8:11], s22 offen lds
    s_add_u32 s22, s22, 896
    s_add_u32 s23, s23, 928
    s_mov_b32 m0, s23
    s_nop 0
    buffer_load_dwordx4 v17, s[8:11], s22 offen lds
    s_add_u32 s22, s22, 896
    s_add_u32 s23, s23, 928
    s_mov_b32 m0, s23
    s_nop 0
    buffer_load_dwordx4 v17, s[8:11], s22 offen lds
    s_add_u32 s22, s22, 896
    s_add_u32 s23, s23, 928
    s_mov_b32 m0, s23
    s_nop 0
    buffer_load_dwordx4 v17, s[8:11], s22 offen lds
    s_add_u32 s22, s22, 896
    s_add_u32 s23, s23, 928
    s_mov_b32 m0, s23
    s_nop 0
    buffer_load_dwordx4 v17, s[8:11], s22 offen lds
    s_mov_b32 exec_hi, -1
    s_waitcnt vmcnt(0)
    s_barrier
    ds_read_b64_tr_b16 v[120:121], v15 offset:0
    ds_read_b64_tr_b16 v[122:123], v15 offset:3712
    ds_read_b64_tr_b16 v[176:177], v15 offset:8
    ds_read_b64_tr_b16 v[178:179], v15 offset:3720
    ds_read_b64_tr_b16 v[232:233], v15 offset:64
    ds_read_b64_tr_b16 v[234:235], v15 offset:3776
    ds_read_b64_tr_b16 a[32:33], v15 offset:72
    ds_read_b64_tr_b16 a[34:35], v15 offset:3784
    ds_read_b64_tr_b16 a[88:89], v15 offset:128
    ds_read_b64_tr_b16 a[90:91], v15 offset:3840
    ds_read_b64_tr_b16 a[144:145], v15 offset:136
    ds_read_b64_tr_b16 a[146:147], v15 offset:3848
    ds_read_b64_tr_b16 a[200:201], v16 offset:192
    ds_read_b64_tr_b16 a[202:203], v16 offset:3904
    s_waitcnt lgkmcnt(0)
    v_add_u32 v15, 29696, v15
    v_add_u32 v16, 29696, v16
    ds_read_b64_tr_b16 v[124:125], v15 offset:0
    ds_read_b64_tr_b16 v[126:127], v15 offset:3712
    ds_read_b64_tr_b16 v[180:181], v15 offset:8
    ds_read_b64_tr_b16 v[182:183], v15 offset:3720
    ds_read_b64_tr_b16 v[236:237], v15 offset:64
    ds_read_b64_tr_b16 v[238:239], v15 offset:3776
    ds_read_b64_tr_b16 a[36:37], v15 offset:72
    ds_read_b64_tr_b16 a[38:39], v15 offset:3784
    ds_read_b64_tr_b16 a[92:93], v15 offset:128
    ds_read_b64_tr_b16 a[94:95], v15 offset:3840
    ds_read_b64_tr_b16 a[148:149], v15 offset:136
    ds_read_b64_tr_b16 a[150:151], v15 offset:3848
    ds_read_b64_tr_b16 a[204:205], v16 offset:192
    ds_read_b64_tr_b16 a[206:207], v16 offset:3904
    s_waitcnt lgkmcnt(0)
    v_add_u32 v15, 29696, v15
    v_add_u32 v16, 29696, v16
    ds_read_b64_tr_b16 v[128:129], v15 offset:0
    ds_read_b64_tr_b16 v[130:131], v15 offset:3712
    ds_read_b64_tr_b16 v[184:185], v15 offset:8
    ds_read_b64_tr_b16 v[186:187], v15 offset:3720
    ds_read_b64_tr_b16 v[240:241], v15 offset:64
    ds_read_b64_tr_b16 v[242:243], v15 offset:3776
    ds_read_b64_tr_b16 a[40:41], v15 offset:72
    ds_read_b64_tr_b16 a[42:43], v15 offset:3784
    ds_read_b64_tr_b16 a[96:97], v15 offset:128
    ds_read_b64_tr_b16 a[98:99], v15 offset:3840
    ds_read_b64_tr_b16 a[152:153], v15 offset:136
    ds_read_b64_tr_b16 a[154:155], v15 offset:3848
    ds_read_b64_tr_b16 a[208:209], v16 offset:192
    ds_read_b64_tr_b16 a[210:211], v16 offset:3904
    s_waitcnt lgkmcnt(0)
    v_add_u32 v15, 29696, v15
    v_add_u32 v16, 29696, v16
    ds_read_b64_tr_b16 v[132:133], v15 offset:0
    ds_read_b64_tr_b16 v[134:135], v15 offset:3712
    ds_read_b64_tr_b16 v[188:189], v15 offset:8
    ds_read_b64_tr_b16 v[190:191], v15 offset:3720
    ds_read_b64_tr_b16 v[244:245], v15 offset:64
    ds_read_b64_tr_b16 v[246:247], v15 offset:3776
    ds_read_b64_tr_b16 a[44:45], v15 offset:72
    ds_read_b64_tr_b16 a[46:47], v15 offset:3784
    ds_read_b64_tr_b16 a[100:101], v15 offset:128
    ds_read_b64_tr_b16 a[102:103], v15 offset:3840
    ds_read_b64_tr_b16 a[156:157], v15 offset:136
    ds_read_b64_tr_b16 a[158:159], v15 offset:3848
    ds_read_b64_tr_b16 a[212:213], v16 offset:192
    ds_read_b64_tr_b16 a[214:215], v16 offset:3904
    s_waitcnt lgkmcnt(0)
    v_add_u32 v15, 29696, v15
    v_add_u32 v16, 29696, v16
    ds_read_b64_tr_b16 v[136:137], v15 offset:0
    ds_read_b64_tr_b16 v[138:139], v15 offset:3712
    ds_read_b64_tr_b16 v[192:193], v15 offset:8
    ds_read_b64_tr_b16 v[194:195], v15 offset:3720
    ds_read_b64_tr_b16 v[248:249], v15 offset:64
    ds_read_b64_tr_b16 v[250:251], v15 offset:3776
    ds_read_b64_tr_b16 a[48:49], v15 offset:72
    ds_read_b64_tr_b16 a[50:51], v15 offset:3784
    ds_read_b64_tr_b16 a[104:105], v15 offset:128
    ds_read_b64_tr_b16 a[106:107], v15 offset:3840
    ds_read_b64_tr_b16 a[160:161], v15 offset:136
    ds_read_b64_tr_b16 a[162:163], v15 offset:3848
    ds_read_b64_tr_b16 a[216:217], v16 offset:192
    ds_read_b64_tr_b16 a[218:219], v16 offset:3904
    s_waitcnt lgkmcnt(0)
    v_subrev_u32 v15, 118784, v15
    v_subrev_u32 v16, 118784, v16
    s_barrier
    s_mov_b32 exec_hi, 0x00ffffff
    s_mul_i32 s22, s15, 7168
    s_add_u32 s22, s22, 143360
    s_add_u32 s22, s22, s46
    s_mul_i32 s23, s15, 7424
    s_add_u32 s23, s23, 0
    s_mov_b32 m0, s23
    s_nop 0
    buffer_load_dwordx4 v17, s[8:11], s22 offen lds
    s_add_u32 s22, s22, 896
    s_add_u32 s23, s23, 928
    s_mov_b32 m0, s23
    s_nop 0
    buffer_load_dwordx4 v17, s[8:11], s22 offen lds
    s_add_u32 s22, s22, 896
    s_add_u32 s23, s23, 928
    s_mov_b32 m0, s23
    s_nop 0
    buffer_load_dwordx4 v17, s[8:11], s22 offen lds
    s_add_u32 s22, s22, 896
    s_add_u32 s23, s23, 928
    s_mov_b32 m0, s23
    s_nop 0
    buffer_load_dwordx4 v17, s[8:11], s22 offen lds
    s_add_u32 s22, s22, 896
    s_add_u32 s23, s23, 928
    s_mov_b32 m0, s23
    s_nop 0
    buffer_load_dwordx4 v17, s[8:11], s22 offen lds
    s_add_u32 s22, s22, 896
    s_add_u32 s23, s23, 928
    s_mov_b32 m0, s23
    s_nop 0
    buffer_load_dwordx4 v17, s[8:11], s22 offen lds
    s_add_u32 s22, s22, 896
    s_add_u32 s23, s23, 928
    s_mov_b32 m0, s23
    s_nop 0
    buffer_load_dwordx4 v17, s[8:11], s22 offen lds
    s_add_u32 s22, s22, 896
    s_add_u32 s23, s23, 928
    s_mov_b32 m0, s23
    s_nop 0
    buffer_load_dwordx4 v17, s[8:11], s22 offen lds
    s_mul_i32 s22, s15, 7168
    s_add_u32 s22, s22, 172032
    s_add_u32 s22, s22, s46
    s_mul_i32 s23, s15, 7424
    s_add_u32 s23, s23, 29696
    s_mov_b32 m0, s23
    s_nop 0
    buffer_load_dwordx4 v17, s[8:11], s22 offen lds
    s_add_u32 s22, s22, 896
    s_add_u32 s23, s23, 928
    s_mov_b32 m0, s23
    s_nop 0
    buffer_load_dwordx4 v17, s[8:11], s22 offen lds
    s_add_u32 s22, s22, 896
    s_add_u32 s23, s23, 928
    s_mov_b32 m0, s23
    s_nop 0
    buffer_load_dwordx4 v17, s[8:11], s22 offen lds
    s_add_u32 s22, s22, 896
    s_add_u32 s23, s23, 928
    s_mov_b32 m0, s23
    s_nop 0
    buffer_load_dwordx4 v17, s[8:11], s22 offen lds
    s_add_u32 s22, s22, 896
    s_add_u32 s23, s23, 928
    s_mov_b32 m0, s23
    s_nop 0
    buffer_load_dwordx4 v17, s[8:11], s22 offen lds
    s_add_u32 s22, s22, 896
    s_add_u32 s23, s23, 928
    s_mov_b32 m0, s23
    s_nop 0
    buffer_load_dwordx4 v17, s[8:11], s22 offen lds
    s_add_u32 s22, s22, 896
    s_add_u32 s23, s23, 928
    s_mov_b32 m0, s23
    s_nop 0
    buffer_load_dwordx4 v17, s[8:11], s22 offen lds
    s_add_u32 s22, s22, 896
    s_add_u32 s23, s23, 928
    s_mov_b32 m0, s23
    s_nop 0
    buffer_load_dwordx4 v17, s[8:11], s22 offen lds
    s_mul_i32 s22, s15, 7168
    s_add_u32 s22, s22, 200704
    s_add_u32 s22, s22, s46
    s_mul_i32 s23, s15, 7424
    s_add_u32 s23, s23, 59392
    s_mov_b32 m0, s23
    s_nop 0
    buffer_load_dwordx4 v17, s[8:11], s22 offen lds
    s_add_u32 s22, s22, 896
    s_add_u32 s23, s23, 928
    s_mov_b32 m0, s23
    s_nop 0
    buffer_load_dwordx4 v17, s[8:11], s22 offen lds
    s_add_u32 s22, s22, 896
    s_add_u32 s23, s23, 928
    s_mov_b32 m0, s23
    s_nop 0
    buffer_load_dwordx4 v17, s[8:11], s22 offen lds
    s_add_u32 s22, s22, 896
    s_add_u32 s23, s23, 928
    s_mov_b32 m0, s23
    s_nop 0
    buffer_load_dwordx4 v17, s[8:11], s22 offen lds
    s_add_u32 s22, s22, 896
    s_add_u32 s23, s23, 928
    s_mov_b32 m0, s23
    s_nop 0
    buffer_load_dwordx4 v17, s[8:11], s22 offen lds
    s_add_u32 s22, s22, 896
    s_add_u32 s23, s23, 928
    s_mov_b32 m0, s23
    s_nop 0
    buffer_load_dwordx4 v17, s[8:11], s22 offen lds
    s_add_u32 s22, s22, 896
    s_add_u32 s23, s23, 928
    s_mov_b32 m0, s23
    s_nop 0
    buffer_load_dwordx4 v17, s[8:11], s22 offen lds
    s_add_u32 s22, s22, 896
    s_add_u32 s23, s23, 928
    s_mov_b32 m0, s23
    s_nop 0
    buffer_load_dwordx4 v17, s[8:11], s22 offen lds
    s_mul_i32 s22, s15, 7168
    s_add_u32 s22, s22, 229376
    s_add_u32 s22, s22, s46
    s_mul_i32 s23, s15, 7424
    s_add_u32 s23, s23, 89088
    s_mov_b32 m0, s23
    s_nop 0
    buffer_load_dwordx4 v17, s[8:11], s22 offen lds
    s_add_u32 s22, s22, 896
    s_add_u32 s23, s23, 928
    s_mov_b32 m0, s23
    s_nop 0
    buffer_load_dwordx4 v17, s[8:11], s22 offen lds
    s_add_u32 s22, s22, 896
    s_add_u32 s23, s23, 928
    s_mov_b32 m0, s23
    s_nop 0
    buffer_load_dwordx4 v17, s[8:11], s22 offen lds
    s_add_u32 s22, s22, 896
    s_add_u32 s23, s23, 928
    s_mov_b32 m0, s23
    s_nop 0
    buffer_load_dwordx4 v17, s[8:11], s22 offen lds
    s_add_u32 s22, s22, 896
    s_add_u32 s23, s23, 928
    s_mov_b32 m0, s23
    s_nop 0
    buffer_load_dwordx4 v17, s[8:11], s22 offen lds
    s_add_u32 s22, s22, 896
    s_add_u32 s23, s23, 928
    s_mov_b32 m0, s23
    s_nop 0
    buffer_load_dwordx4 v17, s[8:11], s22 offen lds
    s_add_u32 s22, s22, 896
    s_add_u32 s23, s23, 928
    s_mov_b32 m0, s23
    s_nop 0
    buffer_load_dwordx4 v17, s[8:11], s22 offen lds
    s_add_u32 s22, s22, 896
    s_add_u32 s23, s23, 928
    s_mov_b32 m0, s23
    s_nop 0
    buffer_load_dwordx4 v17, s[8:11], s22 offen lds
    s_mul_i32 s22, s15, 7168
    s_add_u32 s22, s22, 258048
    s_add_u32 s22, s22, s46
    s_mul_i32 s23, s15, 7424
    s_add_u32 s23, s23, 118784
    s_mov_b32 m0, s23
    s_nop 0
    buffer_load_dwordx4 v17, s[8:11], s22 offen lds
    s_add_u32 s22, s22, 896
    s_add_u32 s23, s23, 928
    s_mov_b32 m0, s23
    s_nop 0
    buffer_load_dwordx4 v17, s[8:11], s22 offen lds
    s_add_u32 s22, s22, 896
    s_add_u32 s23, s23, 928
    s_mov_b32 m0, s23
    s_nop 0
    buffer_load_dwordx4 v17, s[8:11], s22 offen lds
    s_add_u32 s22, s22, 896
    s_add_u32 s23, s23, 928
    s_mov_b32 m0, s23
    s_nop 0
    buffer_load_dwordx4 v17, s[8:11], s22 offen lds
    s_add_u32 s22, s22, 896
    s_add_u32 s23, s23, 928
    s_mov_b32 m0, s23
    s_nop 0
    buffer_load_dwordx4 v17, s[8:11], s22 offen lds
    s_add_u32 s22, s22, 896
    s_add_u32 s23, s23, 928
    s_mov_b32 m0, s23
    s_nop 0
    buffer_load_dwordx4 v17, s[8:11], s22 offen lds
    s_add_u32 s22, s22, 896
    s_add_u32 s23, s23, 928
    s_mov_b32 m0, s23
    s_nop 0
    buffer_load_dwordx4 v17, s[8:11], s22 offen lds
    s_add_u32 s22, s22, 896
    s_add_u32 s23, s23, 928
    s_mov_b32 m0, s23
    s_nop 0
    buffer_load_dwordx4 v17, s[8:11], s22 offen lds
    s_mov_b32 exec_hi, -1
    s_waitcnt vmcnt(0)
    s_barrier
    ds_read_b64_tr_b16 v[140:141], v15 offset:0
    ds_read_b64_tr_b16 v[142:143], v15 offset:3712
    ds_read_b64_tr_b16 v[196:197], v15 offset:8
    ds_read_b64_tr_b16 v[198:199], v15 offset:3720
    ds_read_b64_tr_b16 v[252:253], v15 offset:64
    ds_read_b64_tr_b16 v[254:255], v15 offset:3776
    ds_read_b64_tr_b16 a[52:53], v15 offset:72
    ds_read_b64_tr_b16 a[54:55], v15 offset:3784
    ds_read_b64_tr_b16 a[108:109], v15 offset:128
    ds_read_b64_tr_b16 a[110:111], v15 offset:3840
    ds_read_b64_tr_b16 a[164:165], v15 offset:136
    ds_read_b64_tr_b16 a[166:167], v15 offset:3848
    ds_read_b64_tr_b16 a[220:221], v16 offset:192
    ds_read_b64_tr_b16 a[222:223], v16 offset:3904
    s_waitcnt lgkmcnt(0)
    v_add_u32 v15, 29696, v15
    v_add_u32 v16, 29696, v16
    ds_read_b64_tr_b16 v[144:145], v15 offset:0
    ds_read_b64_tr_b16 v[146:147], v15 offset:3712
    ds_read_b64_tr_b16 v[200:201], v15 offset:8
    ds_read_b64_tr_b16 v[202:203], v15 offset:3720
    ds_read_b64_tr_b16 a[0:1], v15 offset:64
    ds_read_b64_tr_b16 a[2:3], v15 offset:3776
    ds_read_b64_tr_b16 a[56:57], v15 offset:72
    ds_read_b64_tr_b16 a[58:59], v15 offset:3784
    ds_read_b64_tr_b16 a[112:113], v15 offset:128
    ds_read_b64_tr_b16 a[114:115], v15 offset:3840
    ds_read_b64_tr_b16 a[168:169], v15 offset:136
    ds_read_b64_tr_b16 a[170:171], v15 offset:3848
    ds_read_b64_tr_b16 a[224:225], v16 offset:192
    ds_read_b64_tr_b16 a[226:227], v16 offset:3904
    s_waitcnt lgkmcnt(0)
    v_add_u32 v15, 29696, v15
    v_add_u32 v16, 29696, v16
    ds_read_b64_tr_b16 v[148:149], v15 offset:0
    ds_read_b64_tr_b16 v[150:151], v15 offset:3712
    ds_read_b64_tr_b16 v[204:205], v15 offset:8
    ds_read_b64_tr_b16 v[206:207], v15 offset:3720
    ds_read_b64_tr_b16 a[4:5], v15 offset:64
    ds_read_b64_tr_b16 a[6:7], v15 offset:3776
    ds_read_b64_tr_b16 a[60:61], v15 offset:72
    ds_read_b64_tr_b16 a[62:63], v15 offset:3784
    ds_read_b64_tr_b16 a[116:117], v15 offset:128
    ds_read_b64_tr_b16 a[118:119], v15 offset:3840
    ds_read_b64_tr_b16 a[172:173], v15 offset:136
    ds_read_b64_tr_b16 a[174:175], v15 offset:3848
    ds_read_b64_tr_b16 a[228:229], v16 offset:192
    ds_read_b64_tr_b16 a[230:231], v16 offset:3904
    s_waitcnt lgkmcnt(0)
    v_add_u32 v15, 29696, v15
    v_add_u32 v16, 29696, v16
    ds_read_b64_tr_b16 v[152:153], v15 offset:0
    ds_read_b64_tr_b16 v[154:155], v15 offset:3712
    ds_read_b64_tr_b16 v[208:209], v15 offset:8
    ds_read_b64_tr_b16 v[210:211], v15 offset:3720
    ds_read_b64_tr_b16 a[8:9], v15 offset:64
    ds_read_b64_tr_b16 a[10:11], v15 offset:3776
    ds_read_b64_tr_b16 a[64:65], v15 offset:72
    ds_read_b64_tr_b16 a[66:67], v15 offset:3784
    ds_read_b64_tr_b16 a[120:121], v15 offset:128
    ds_read_b64_tr_b16 a[122:123], v15 offset:3840
    ds_read_b64_tr_b16 a[176:177], v15 offset:136
    ds_read_b64_tr_b16 a[178:179], v15 offset:3848
    ds_read_b64_tr_b16 a[232:233], v16 offset:192
    ds_read_b64_tr_b16 a[234:235], v16 offset:3904
    s_waitcnt lgkmcnt(0)
    v_add_u32 v15, 29696, v15
    v_add_u32 v16, 29696, v16
    ds_read_b64_tr_b16 v[156:157], v15 offset:0
    ds_read_b64_tr_b16 v[158:159], v15 offset:3712
    ds_read_b64_tr_b16 v[212:213], v15 offset:8
    ds_read_b64_tr_b16 v[214:215], v15 offset:3720
    ds_read_b64_tr_b16 a[12:13], v15 offset:64
    ds_read_b64_tr_b16 a[14:15], v15 offset:3776
    ds_read_b64_tr_b16 a[68:69], v15 offset:72
    ds_read_b64_tr_b16 a[70:71], v15 offset:3784
    ds_read_b64_tr_b16 a[124:125], v15 offset:128
    ds_read_b64_tr_b16 a[126:127], v15 offset:3840
    ds_read_b64_tr_b16 a[180:181], v15 offset:136
    ds_read_b64_tr_b16 a[182:183], v15 offset:3848
    ds_read_b64_tr_b16 a[236:237], v16 offset:192
    ds_read_b64_tr_b16 a[238:239], v16 offset:3904
    s_waitcnt lgkmcnt(0)
    v_subrev_u32 v15, 118784, v15
    v_subrev_u32 v16, 118784, v16
    s_barrier
    s_mov_b32 exec_hi, 0x00ffffff
    s_mul_i32 s22, s15, 7168
    s_add_u32 s22, s22, 286720
    s_add_u32 s22, s22, s46
    s_mul_i32 s23, s15, 7424
    s_add_u32 s23, s23, 0
    s_mov_b32 m0, s23
    s_nop 0
    buffer_load_dwordx4 v17, s[8:11], s22 offen lds
    s_add_u32 s22, s22, 896
    s_add_u32 s23, s23, 928
    s_mov_b32 m0, s23
    s_nop 0
    buffer_load_dwordx4 v17, s[8:11], s22 offen lds
    s_add_u32 s22, s22, 896
    s_add_u32 s23, s23, 928
    s_mov_b32 m0, s23
    s_nop 0
    buffer_load_dwordx4 v17, s[8:11], s22 offen lds
    s_add_u32 s22, s22, 896
    s_add_u32 s23, s23, 928
    s_mov_b32 m0, s23
    s_nop 0
    buffer_load_dwordx4 v17, s[8:11], s22 offen lds
    s_add_u32 s22, s22, 896
    s_add_u32 s23, s23, 928
    s_mov_b32 m0, s23
    s_nop 0
    buffer_load_dwordx4 v17, s[8:11], s22 offen lds
    s_add_u32 s22, s22, 896
    s_add_u32 s23, s23, 928
    s_mov_b32 m0, s23
    s_nop 0
    buffer_load_dwordx4 v17, s[8:11], s22 offen lds
    s_add_u32 s22, s22, 896
    s_add_u32 s23, s23, 928
    s_mov_b32 m0, s23
    s_nop 0
    buffer_load_dwordx4 v17, s[8:11], s22 offen lds
    s_add_u32 s22, s22, 896
    s_add_u32 s23, s23, 928
    s_mov_b32 m0, s23
    s_nop 0
    buffer_load_dwordx4 v17, s[8:11], s22 offen lds
    s_mul_i32 s22, s15, 7168
    s_add_u32 s22, s22, 315392
    s_add_u32 s22, s22, s46
    s_mul_i32 s23, s15, 7424
    s_add_u32 s23, s23, 29696
    s_mov_b32 m0, s23
    s_nop 0
    buffer_load_dwordx4 v17, s[8:11], s22 offen lds
    s_add_u32 s22, s22, 896
    s_add_u32 s23, s23, 928
    s_mov_b32 m0, s23
    s_nop 0
    buffer_load_dwordx4 v17, s[8:11], s22 offen lds
    s_add_u32 s22, s22, 896
    s_add_u32 s23, s23, 928
    s_mov_b32 m0, s23
    s_nop 0
    buffer_load_dwordx4 v17, s[8:11], s22 offen lds
    s_add_u32 s22, s22, 896
    s_add_u32 s23, s23, 928
    s_mov_b32 m0, s23
    s_nop 0
    buffer_load_dwordx4 v17, s[8:11], s22 offen lds
    s_add_u32 s22, s22, 896
    s_add_u32 s23, s23, 928
    s_mov_b32 m0, s23
    s_nop 0
    buffer_load_dwordx4 v17, s[8:11], s22 offen lds
    s_add_u32 s22, s22, 896
    s_add_u32 s23, s23, 928
    s_mov_b32 m0, s23
    s_nop 0
    buffer_load_dwordx4 v17, s[8:11], s22 offen lds
    s_add_u32 s22, s22, 896
    s_add_u32 s23, s23, 928
    s_mov_b32 m0, s23
    s_nop 0
    buffer_load_dwordx4 v17, s[8:11], s22 offen lds
    s_add_u32 s22, s22, 896
    s_add_u32 s23, s23, 928
    s_mov_b32 m0, s23
    s_nop 0
    buffer_load_dwordx4 v17, s[8:11], s22 offen lds
    s_mul_i32 s22, s15, 7168
    s_add_u32 s22, s22, 344064
    s_add_u32 s22, s22, s46
    s_mul_i32 s23, s15, 7424
    s_add_u32 s23, s23, 59392
    s_mov_b32 m0, s23
    s_nop 0
    buffer_load_dwordx4 v17, s[8:11], s22 offen lds
    s_add_u32 s22, s22, 896
    s_add_u32 s23, s23, 928
    s_mov_b32 m0, s23
    s_nop 0
    buffer_load_dwordx4 v17, s[8:11], s22 offen lds
    s_add_u32 s22, s22, 896
    s_add_u32 s23, s23, 928
    s_mov_b32 m0, s23
    s_nop 0
    buffer_load_dwordx4 v17, s[8:11], s22 offen lds
    s_add_u32 s22, s22, 896
    s_add_u32 s23, s23, 928
    s_mov_b32 m0, s23
    s_nop 0
    buffer_load_dwordx4 v17, s[8:11], s22 offen lds
    s_add_u32 s22, s22, 896
    s_add_u32 s23, s23, 928
    s_mov_b32 m0, s23
    s_nop 0
    buffer_load_dwordx4 v17, s[8:11], s22 offen lds
    s_add_u32 s22, s22, 896
    s_add_u32 s23, s23, 928
    s_mov_b32 m0, s23
    s_nop 0
    buffer_load_dwordx4 v17, s[8:11], s22 offen lds
    s_add_u32 s22, s22, 896
    s_add_u32 s23, s23, 928
    s_mov_b32 m0, s23
    s_nop 0
    buffer_load_dwordx4 v17, s[8:11], s22 offen lds
    s_add_u32 s22, s22, 896
    s_add_u32 s23, s23, 928
    s_mov_b32 m0, s23
    s_nop 0
    buffer_load_dwordx4 v17, s[8:11], s22 offen lds
    s_mul_i32 s22, s15, 7168
    s_add_u32 s22, s22, 372736
    s_add_u32 s22, s22, s46
    s_mul_i32 s23, s15, 7424
    s_add_u32 s23, s23, 89088
    s_mov_b32 m0, s23
    s_nop 0
    buffer_load_dwordx4 v17, s[8:11], s22 offen lds
    s_add_u32 s22, s22, 896
    s_add_u32 s23, s23, 928
    s_mov_b32 m0, s23
    s_nop 0
    buffer_load_dwordx4 v17, s[8:11], s22 offen lds
    s_add_u32 s22, s22, 896
    s_add_u32 s23, s23, 928
    s_mov_b32 m0, s23
    s_nop 0
    buffer_load_dwordx4 v17, s[8:11], s22 offen lds
    s_add_u32 s22, s22, 896
    s_add_u32 s23, s23, 928
    s_mov_b32 m0, s23
    s_nop 0
    buffer_load_dwordx4 v17, s[8:11], s22 offen lds
    s_add_u32 s22, s22, 896
    s_add_u32 s23, s23, 928
    s_mov_b32 m0, s23
    s_nop 0
    buffer_load_dwordx4 v17, s[8:11], s22 offen lds
    s_add_u32 s22, s22, 896
    s_add_u32 s23, s23, 928
    s_mov_b32 m0, s23
    s_nop 0
    buffer_load_dwordx4 v17, s[8:11], s22 offen lds
    s_add_u32 s22, s22, 896
    s_add_u32 s23, s23, 928
    s_mov_b32 m0, s23
    s_nop 0
    buffer_load_dwordx4 v17, s[8:11], s22 offen lds
    s_add_u32 s22, s22, 896
    s_add_u32 s23, s23, 928
    s_mov_b32 m0, s23
    s_nop 0
    buffer_load_dwordx4 v17, s[8:11], s22 offen lds
    s_mov_b32 exec_hi, -1
    s_waitcnt vmcnt(0)
    s_barrier
    ds_read_b64_tr_b16 v[160:161], v15 offset:0
    ds_read_b64_tr_b16 v[162:163], v15 offset:3712
    ds_read_b64_tr_b16 v[216:217], v15 offset:8
    ds_read_b64_tr_b16 v[218:219], v15 offset:3720
    ds_read_b64_tr_b16 a[16:17], v15 offset:64
    ds_read_b64_tr_b16 a[18:19], v15 offset:3776
    ds_read_b64_tr_b16 a[72:73], v15 offset:72
    ds_read_b64_tr_b16 a[74:75], v15 offset:3784
    ds_read_b64_tr_b16 a[128:129], v15 offset:128
    ds_read_b64_tr_b16 a[130:131], v15 offset:3840
    ds_read_b64_tr_b16 a[184:185], v15 offset:136
    ds_read_b64_tr_b16 a[186:187], v15 offset:3848
    ds_read_b64_tr_b16 a[240:241], v16 offset:192
    ds_read_b64_tr_b16 a[242:243], v16 offset:3904
    s_waitcnt lgkmcnt(0)
    v_add_u32 v15, 29696, v15
    v_add_u32 v16, 29696, v16
    ds_read_b64_tr_b16 v[164:165], v15 offset:0
    ds_read_b64_tr_b16 v[166:167], v15 offset:3712
    ds_read_b64_tr_b16 v[220:221], v15 offset:8
    ds_read_b64_tr_b16 v[222:223], v15 offset:3720
    ds_read_b64_tr_b16 a[20:21], v15 offset:64
    ds_read_b64_tr_b16 a[22:23], v15 offset:3776
    ds_read_b64_tr_b16 a[76:77], v15 offset:72
    ds_read_b64_tr_b16 a[78:79], v15 offset:3784
    ds_read_b64_tr_b16 a[132:133], v15 offset:128
    ds_read_b64_tr_b16 a[134:135], v15 offset:3840
    ds_read_b64_tr_b16 a[188:189], v15 offset:136
    ds_read_b64_tr_b16 a[190:191], v15 offset:3848
    ds_read_b64_tr_b16 a[244:245], v16 offset:192
    ds_read_b64_tr_b16 a[246:247], v16 offset:3904
    s_waitcnt lgkmcnt(0)
    v_add_u32 v15, 29696, v15
    v_add_u32 v16, 29696, v16
    ds_read_b64_tr_b16 v[168:169], v15 offset:0
    ds_read_b64_tr_b16 v[170:171], v15 offset:3712
    ds_read_b64_tr_b16 v[224:225], v15 offset:8
    ds_read_b64_tr_b16 v[226:227], v15 offset:3720
    ds_read_b64_tr_b16 a[24:25], v15 offset:64
    ds_read_b64_tr_b16 a[26:27], v15 offset:3776
    ds_read_b64_tr_b16 a[80:81], v15 offset:72
    ds_read_b64_tr_b16 a[82:83], v15 offset:3784
    ds_read_b64_tr_b16 a[136:137], v15 offset:128
    ds_read_b64_tr_b16 a[138:139], v15 offset:3840
    ds_read_b64_tr_b16 a[192:193], v15 offset:136
    ds_read_b64_tr_b16 a[194:195], v15 offset:3848
    ds_read_b64_tr_b16 a[248:249], v16 offset:192
    ds_read_b64_tr_b16 a[250:251], v16 offset:3904
    s_waitcnt lgkmcnt(0)
    v_add_u32 v15, 29696, v15
    v_add_u32 v16, 29696, v16
    ds_read_b64_tr_b16 v[172:173], v15 offset:0
    ds_read_b64_tr_b16 v[174:175], v15 offset:3712
    ds_read_b64_tr_b16 v[228:229], v15 offset:8
    ds_read_b64_tr_b16 v[230:231], v15 offset:3720
    ds_read_b64_tr_b16 a[28:29], v15 offset:64
    ds_read_b64_tr_b16 a[30:31], v15 offset:3776
    ds_read_b64_tr_b16 a[84:85], v15 offset:72
    ds_read_b64_tr_b16 a[86:87], v15 offset:3784
    ds_read_b64_tr_b16 a[140:141], v15 offset:128
    ds_read_b64_tr_b16 a[142:143], v15 offset:3840
    ds_read_b64_tr_b16 a[196:197], v15 offset:136
    ds_read_b64_tr_b16 a[198:199], v15 offset:3848
    ds_read_b64_tr_b16 a[252:253], v16 offset:192
    ds_read_b64_tr_b16 a[254:255], v16 offset:3904
    s_waitcnt lgkmcnt(0)
    v_subrev_u32 v15, 89088, v15
    v_subrev_u32 v16, 89088, v16
    s_barrier
    s_load_dwordx2 s[8:9], s[34:35], 80
    s_waitcnt lgkmcnt(0)
    s_mov_b32 s10, 1835008
    s_mov_b32 s11, 0x00020000
    v_and_b32 v12, 63, v0
    v_and_b32 v13, 15, v12
    v_lshrrev_b32 v14, 4, v12
    v_mul_u32_u24 v2, 928, v13
    v_lshl_add_u32 v2, v14, 4, v2
    v_add_u32 v2, 0, v2
    v_add_u32 v3, 14848, v2
    v_and_b32 v12, 63, v0
    v_lshlrev_b32 v4, 4, v12
    v_and_b32 v13, 15, v12
    v_lshrrev_b32 v14, 4, v12
    v_mov_b32 v5, 0
    v_mov_b32 v11, 0
    s_mul_i32 s18, s15, 224
    v_mul_u32_u24 v6, 896, v13
    v_add_u32 v6, s18, v6
    s_mul_i32 s19, s12, 14336
    v_add_u32 v6, s19, v6
    v_lshl_add_u32 v7, v14, 3, v6
    v_add_u32 v7, 192, v7
    v_lshl_add_u32 v6, v14, 4, v6
    v_mul_u32_u24 v9, 928, v13
    v_add_u32 v9, s18, v9
    s_mul_i32 s19, s12, 14848
    v_add_u32 v9, s19, v9
    v_lshl_add_u32 v10, v14, 3, v9
    v_add_u32 v10, 192, v10
    v_lshl_add_u32 v9, v14, 4, v9
    v_lshlrev_b32 v8, 5, v13
    v_add_u32 v8, 29696, v8
    v_mul_u32_u24 v9, 928, v13
    s_mul_i32 s18, s15, 224
    v_add_u32 v9, s18, v9
    v_lshl_add_u32 v10, v14, 3, v9
    v_add_u32 v10, 192, v10
    v_lshl_add_u32 v9, v14, 4, v9
    v_add_u32 v16, 0, v0
    v_min_u32 v16, 895, v16
    s_mov_b32 s19, 1171
    v_mul_u32_u24 v17, s19, v16
    v_lshrrev_b32 v17, 16, v17
    v_mul_u32_u24 v18, 56, v17
    v_sub_u32 v18, v16, v18
    v_mul_u32_u24 v68, 928, v17
    v_lshl_add_u32 v68, v18, 4, v68
    v_add_u32 v16, 256, v0
    v_min_u32 v16, 895, v16
    s_mov_b32 s19, 1171
    v_mul_u32_u24 v17, s19, v16
    v_lshrrev_b32 v17, 16, v17
    v_mul_u32_u24 v18, 56, v17
    v_sub_u32 v18, v16, v18
    v_mul_u32_u24 v69, 928, v17
    v_lshl_add_u32 v69, v18, 4, v69
    v_add_u32 v16, 512, v0
    v_min_u32 v16, 895, v16
    s_mov_b32 s19, 1171
    v_mul_u32_u24 v17, s19, v16
    v_lshrrev_b32 v17, 16, v17
    v_mul_u32_u24 v18, 56, v17
    v_sub_u32 v18, v16, v18
    v_mul_u32_u24 v70, 928, v17
    v_lshl_add_u32 v70, v18, 4, v70
    v_add_u32 v16, 768, v0
    v_min_u32 v16, 895, v16
    s_mov_b32 s19, 1171
    v_mul_u32_u24 v17, s19, v16
    v_lshrrev_b32 v17, 16, v17
    v_mul_u32_u24 v18, 56, v17
    v_sub_u32 v18, v16, v18
    v_mul_u32_u24 v71, 928, v17
    v_lshl_add_u32 v71, v18, 4, v71
    s_mov_b32 s32, 400000
    v_mbcnt_lo_u32_b32 v45, -1, 0
    v_add_u32 v45, 8, v45
    v_lshlrev_b32 v45, 2, v45
    s_mov_b64 exec, 1
    s_nop 0
L_dw_251:
    global_load_dword v44, v45, s[36:37] sc1
    s_waitcnt vmcnt(0)
    v_cmp_gt_u32 vcc, 256, v44
    s_nop 3
    s_cbranch_vccz L_dwok_252
    s_sleep 1
    s_sub_u32 s32, s32, 1
    s_cmp_lg_u32 s32, 0
    s_cbranch_scc1 L_dw_251
    s_branch L_fail
L_dwok_252:
    s_mov_b64 exec, -1
L_iok_250:
    s_mov_b32 s16, s38
    v_lshlrev_b32 v12, 7, v0
    v_min_u32 v12, 14848, v12
    s_cmp_eq_u32 s13, 0
    s_mov_b32 s43, 0x1d13000
    s_cselect_b32 s43, 0x1b42000, s43
    s_mul_i32 s18, s16, 29696
    s_add_u32 s43, s43, s18
    s_mul_i32 s18, s12, 14848
    s_add_u32 s43, s43, s18
    s_cmp_lg_u32 s14, 0
    s_cselect_b32 s27, 126898176, s43
    buffer_load_dword v13, v12, s[4:7], s27 offen sc1
    s_waitcnt vmcnt(0)
    s_mov_b32 s16, s38
L_WO_loop:
    s_mov_b32 exec_lo, 0xffff
    s_mov_b32 exec_hi, 0
    v_cmp_eq_u32 vcc, 0, v11
    s_mov_b64 exec, -1
    s_nop 2
    s_cbranch_vccz L_WOrdy_253
    s_cmp_eq_u32 s13, 0
    s_mov_b32 s40, 0x78fc000
    s_cselect_b32 s40, 0x78ec000, s40
    s_lshl_b32 s18, s16, 7
    s_add_u32 s40, s40, s18
    s_lshl_b32 s18, s12, 6
    s_add_u32 s40, s40, s18
    s_mov_b32 s32, 400000
    v_mbcnt_lo_u32_b32 v13, -1, 0
    v_lshlrev_b32 v13, 2, v13
    s_mov_b32 exec_lo, 0xffff
    s_mov_b32 exec_hi, 0
L_wf_254:
    buffer_load_dword v12, v13, s[4:7], s40 offen sc1
    s_waitcnt vmcnt(0)
    v_cmp_eq_u32 vcc, 0, v12
    s_nop 3
    s_cbranch_vccz L_wfok_255
    s_sleep 1
    s_sub_u32 s32, s32, 1
    s_cmp_lg_u32 s32, 0
    s_cbranch_scc1 L_wf_254
    s_branch L_fail
L_wfok_255:
    s_mov_b64 exec, -1
L_WOrdy_253:
    s_cmp_eq_u32 s13, 0
    s_mov_b32 s43, 0x1d13000
    s_cselect_b32 s43, 0x1b42000, s43
    s_mul_i32 s18, s16, 29696
    s_add_u32 s43, s43, s18
    s_mul_i32 s18, s12, 14848
    s_add_u32 s43, s43, s18
    s_lshl_b32 s18, s15, 12
    s_min_u32 s18, s18, 11264
    s_add_u32 s41, s43, s18
    s_mov_b32 m0, s18
    s_nop 0
    buffer_load_dwordx4 v4, s[4:7], s41 offen offset:0 sc1 lds
    buffer_load_dwordx4 v4, s[4:7], s41 offen offset:1024 sc1 lds
    buffer_load_dwordx4 v4, s[4:7], s41 offen offset:2048 sc1 lds
    s_cmp_eq_u32 s15, 3
    s_cselect_b32 exec_hi, 0, -1
    buffer_load_dwordx4 v4, s[4:7], s41 offen offset:3072 sc1 lds
    s_mov_b32 exec_hi, -1
    s_cmp_eq_u32 s13, 0
    s_mov_b32 s43, 0x1982000
    s_cselect_b32 s43, 0x17c2000, s43
    s_mul_i32 s18, s16, 28672
    s_add_u32 s43, s43, s18
    buffer_load_dwordx4 v[20:23], v6, s[4:7], s43 offen offset:0 sc1
    buffer_load_dwordx4 v[24:27], v6, s[4:7], s43 offen offset:64 sc1
    buffer_load_dwordx4 v[28:31], v6, s[4:7], s43 offen offset:128 sc1
    buffer_load_dwordx2 v[32:33], v7, s[4:7], s43 offen sc1
    v_lshlrev_b32 v12, 7, v0
    v_min_u32 v12, 14848, v12
    s_cmp_eq_u32 s13, 0
    s_mov_b32 s43, 0x1d13000
    s_cselect_b32 s43, 0x1b42000, s43
    s_mul_i32 s18, s16, 29696
    s_add_u32 s43, s43, s18
    s_mul_i32 s18, s12, 14848
    s_add_u32 s43, s43, s18
    s_add_u32 s43, s43, 59392
    s_cmp_lg_u32 s14, 0
    s_cselect_b32 s27, 126898176, s43
    buffer_load_dword v13, v12, s[4:7], s27 offen sc1
    s_waitcnt vmcnt(5)
    s_barrier
    ds_read_b128 v[48:51], v2 offset:0
    ds_read_b128 v[56:59], v2 offset:64
    s_waitcnt lgkmcnt(1)
    v_mfma_f32_16x16x32_bf16 v[64:67], v[120:123], v[48:51], 0
    v_mfma_f32_16x16x32_bf16 v[72:75], v[176:179], v[48:51], 0
    v_mfma_f32_16x16x32_bf16 v[80:83], v[232:235], v[48:51], 0
    v_mfma_f32_16x16x32_bf16 v[88:91], a[32:35], v[48:51], 0
    v_mfma_f32_16x16x32_bf16 v[96:99], a[88:91], v[48:51], 0
    v_mfma_f32_16x16x32_bf16 v[104:107], a[144:147], v[48:51], 0
    v_mfma_f32_16x16x32_bf16 v[112:115], a[200:203], v[48:51], 0
    ds_read_b128 v[48:51], v2 offset:128
    s_waitcnt lgkmcnt(1)
    v_mfma_f32_16x16x32_bf16 v[64:67], v[124:127], v[56:59], v[64:67]
    v_mfma_f32_16x16x32_bf16 v[72:75], v[180:183], v[56:59], v[72:75]
    v_mfma_f32_16x16x32_bf16 v[80:83], v[236:239], v[56:59], v[80:83]
    v_mfma_f32_16x16x32_bf16 v[88:91], a[36:39], v[56:59], v[88:91]
    v_mfma_f32_16x16x32_bf16 v[96:99], a[92:95], v[56:59], v[96:99]
    v_mfma_f32_16x16x32_bf16 v[104:107], a[148:151], v[56:59], v[104:107]
    v_mfma_f32_16x16x32_bf16 v[112:115], a[204:207], v[56:59], v[112:115]
    ds_read_b128 v[56:59], v2 offset:192
    s_waitcnt lgkmcnt(1)
    v_mfma_f32_16x16x32_bf16 v[64:67], v[128:131], v[48:51], v[64:67]
    v_mfma_f32_16x16x32_bf16 v[72:75], v[184:187], v[48:51], v[72:75]
    v_mfma_f32_16x16x32_bf16 v[80:83], v[240:243], v[48:51], v[80:83]
    v_mfma_f32_16x16x32_bf16 v[88:91], a[40:43], v[48:51], v[88:91]
    v_mfma_f32_16x16x32_bf16 v[96:99], a[96:99], v[48:51], v[96:99]
    v_mfma_f32_16x16x32_bf16 v[104:107], a[152:155], v[48:51], v[104:107]
    v_mfma_f32_16x16x32_bf16 v[112:115], a[208:211], v[48:51], v[112:115]
    ds_read_b128 v[48:51], v2 offset:256
    s_waitcnt lgkmcnt(1)
    v_mfma_f32_16x16x32_bf16 v[64:67], v[132:135], v[56:59], v[64:67]
    v_mfma_f32_16x16x32_bf16 v[72:75], v[188:191], v[56:59], v[72:75]
    v_mfma_f32_16x16x32_bf16 v[80:83], v[244:247], v[56:59], v[80:83]
    v_mfma_f32_16x16x32_bf16 v[88:91], a[44:47], v[56:59], v[88:91]
    v_mfma_f32_16x16x32_bf16 v[96:99], a[100:103], v[56:59], v[96:99]
    v_mfma_f32_16x16x32_bf16 v[104:107], a[156:159], v[56:59], v[104:107]
    v_mfma_f32_16x16x32_bf16 v[112:115], a[212:215], v[56:59], v[112:115]
    ds_read_b128 v[56:59], v2 offset:320
    s_waitcnt lgkmcnt(1)
    v_mfma_f32_16x16x32_bf16 v[64:67], v[136:139], v[48:51], v[64:67]
    v_mfma_f32_16x16x32_bf16 v[72:75], v[192:195], v[48:51], v[72:75]
    v_mfma_f32_16x16x32_bf16 v[80:83], v[248:251], v[48:51], v[80:83]
    v_mfma_f32_16x16x32_bf16 v[88:91], a[48:51], v[48:51], v[88:91]
    v_mfma_f32_16x16x32_bf16 v[96:99], a[104:107], v[48:51], v[96:99]
    v_mfma_f32_16x16x32_bf16 v[104:107], a[160:163], v[48:51], v[104:107]
    v_mfma_f32_16x16x32_bf16 v[112:115], a[216:219], v[48:51], v[112:115]
    ds_read_b128 v[48:51], v2 offset:384
    s_waitcnt lgkmcnt(1)
    v_mfma_f32_16x16x32_bf16 v[64:67], v[140:143], v[56:59], v[64:67]
    v_mfma_f32_16x16x32_bf16 v[72:75], v[196:199], v[56:59], v[72:75]
    v_mfma_f32_16x16x32_bf16 v[80:83], v[252:255], v[56:59], v[80:83]
    v_mfma_f32_16x16x32_bf16 v[88:91], a[52:55], v[56:59], v[88:91]
    v_mfma_f32_16x16x32_bf16 v[96:99], a[108:111], v[56:59], v[96:99]
    v_mfma_f32_16x16x32_bf16 v[104:107], a[164:167], v[56:59], v[104:107]
    v_mfma_f32_16x16x32_bf16 v[112:115], a[220:223], v[56:59], v[112:115]
    ds_read_b128 v[56:59], v2 offset:448
    s_waitcnt lgkmcnt(1)
    v_mfma_f32_16x16x32_bf16 v[64:67], v[144:147], v[48:51], v[64:67]
    v_mfma_f32_16x16x32_bf16 v[72:75], v[200:203], v[48:51], v[72:75]
    v_mfma_f32_16x16x32_bf16 v[80:83], a[0:3], v[48:51], v[80:83]
    v_mfma_f32_16x16x32_bf16 v[88:91], a[56:59], v[48:51], v[88:91]
    v_mfma_f32_16x16x32_bf16 v[96:99], a[112:115], v[48:51], v[96:99]
    v_mfma_f32_16x16x32_bf16 v[104:107], a[168:171], v[48:51], v[104:107]
    v_mfma_f32_16x16x32_bf16 v[112:115], a[224:227], v[48:51], v[112:115]
    ds_read_b128 v[48:51], v2 offset:512
    s_waitcnt lgkmcnt(1)
    v_mfma_f32_16x16x32_bf16 v[64:67], v[148:151], v[56:59], v[64:67]
    v_mfma_f32_16x16x32_bf16 v[72:75], v[204:207], v[56:59], v[72:75]
    v_mfma_f32_16x16x32_bf16 v[80:83], a[4:7], v[56:59], v[80:83]
    v_mfma_f32_16x16x32_bf16 v[88:91], a[60:63], v[56:59], v[88:91]
    v_mfma_f32_16x16x32_bf16 v[96:99], a[116:119], v[56:59], v[96:99]
    v_mfma_f32_16x16x32_bf16 v[104:107], a[172:175], v[56:59], v[104:107]
    v_mfma_f32_16x16x32_bf16 v[112:115], a[228:231], v[56:59], v[112:115]
    ds_read_b128 v[56:59], v2 offset:576
    s_waitcnt lgkmcnt(1)
    v_mfma_f32_16x16x32_bf16 v[64:67], v[152:155], v[48:51], v[64:67]
    v_mfma_f32_16x16x32_bf16 v[72:75], v[208:211], v[48:51], v[72:75]
    v_mfma_f32_16x16x32_bf16 v[80:83], a[8:11], v[48:51], v[80:83]
    v_mfma_f32_16x16x32_bf16 v[88:91], a[64:67], v[48:51], v[88:91]
    v_mfma_f32_16x16x32_bf16 v[96:99], a[120:123], v[48:51], v[96:99]
    v_mfma_f32_16x16x32_bf16 v[104:107], a[176:179], v[48:51], v[104:107]
    v_mfma_f32_16x16x32_bf16 v[112:115], a[232:235], v[48:51], v[112:115]
    ds_read_b128 v[48:51], v2 offset:640
    s_waitcnt lgkmcnt(1)
    v_mfma_f32_16x16x32_bf16 v[64:67], v[156:159], v[56:59], v[64:67]
    v_mfma_f32_16x16x32_bf16 v[72:75], v[212:215], v[56:59], v[72:75]
    v_mfma_f32_16x16x32_bf16 v[80:83], a[12:15], v[56:59], v[80:83]
    v_mfma_f32_16x16x32_bf16 v[88:91], a[68:71], v[56:59], v[88:91]
    v_mfma_f32_16x16x32_bf16 v[96:99], a[124:127], v[56:59], v[96:99]
    v_mfma_f32_16x16x32_bf16 v[104:107], a[180:183], v[56:59], v[104:107]
    v_mfma_f32_16x16x32_bf16 v[112:115], a[236:239], v[56:59], v[112:115]
    ds_read_b128 v[56:59], v2 offset:704
    s_waitcnt lgkmcnt(1)
    v_mfma_f32_16x16x32_bf16 v[64:67], v[160:163], v[48:51], v[64:67]
    v_mfma_f32_16x16x32_bf16 v[72:75], v[216:219], v[48:51], v[72:75]
    v_mfma_f32_16x16x32_bf16 v[80:83], a[16:19], v[48:51], v[80:83]
    v_mfma_f32_16x16x32_bf16 v[88:91], a[72:75], v[48:51], v[88:91]
    v_mfma_f32_16x16x32_bf16 v[96:99], a[128:131], v[48:51], v[96:99]
    v_mfma_f32_16x16x32_bf16 v[104:107], a[184:187], v[48:51], v[104:107]
    v_mfma_f32_16x16x32_bf16 v[112:115], a[240:243], v[48:51], v[112:115]
    ds_read_b128 v[48:51], v2 offset:768
    s_waitcnt lgkmcnt(1)
    v_mfma_f32_16x16x32_bf16 v[64:67], v[164:167], v[56:59], v[64:67]
    v_mfma_f32_16x16x32_bf16 v[72:75], v[220:223], v[56:59], v[72:75]
    v_mfma_f32_16x16x32_bf16 v[80:83], a[20:23], v[56:59], v[80:83]
    v_mfma_f32_16x16x32_bf16 v[88:91], a[76:79], v[56:59], v[88:91]
    v_mfma_f32_16x16x32_bf16 v[96:99], a[132:135], v[56:59], v[96:99]
    v_mfma_f32_16x16x32_bf16 v[104:107], a[188:191], v[56:59], v[104:107]
    v_mfma_f32_16x16x32_bf16 v[112:115], a[244:247], v[56:59], v[112:115]
    ds_read_b128 v[56:59], v2 offset:832
    s_waitcnt lgkmcnt(1)
    v_mfma_f32_16x16x32_bf16 v[64:67], v[168:171], v[48:51], v[64:67]
    v_mfma_f32_16x16x32_bf16 v[72:75], v[224:227], v[48:51], v[72:75]
    v_mfma_f32_16x16x32_bf16 v[80:83], a[24:27], v[48:51], v[80:83]
    v_mfma_f32_16x16x32_bf16 v[88:91], a[80:83], v[48:51], v[88:91]
    v_mfma_f32_16x16x32_bf16 v[96:99], a[136:139], v[48:51], v[96:99]
    v_mfma_f32_16x16x32_bf16 v[104:107], a[192:195], v[48:51], v[104:107]
    v_mfma_f32_16x16x32_bf16 v[112:115], a[248:251], v[48:51], v[112:115]
    s_waitcnt lgkmcnt(0)
    v_mfma_f32_16x16x32_bf16 v[64:67], v[172:175], v[56:59], v[64:67]
    v_mfma_f32_16x16x32_bf16 v[72:75], v[228:231], v[56:59], v[72:75]
    v_mfma_f32_16x16x32_bf16 v[80:83], a[28:31], v[56:59], v[80:83]
    v_mfma_f32_16x16x32_bf16 v[88:91], a[84:87], v[56:59], v[88:91]
    v_mfma_f32_16x16x32_bf16 v[96:99], a[140:143], v[56:59], v[96:99]
    v_mfma_f32_16x16x32_bf16 v[104:107], a[196:199], v[56:59], v[104:107]
    v_mfma_f32_16x16x32_bf16 v[112:115], a[252:255], v[56:59], v[112:115]
    s_waitcnt vmcnt(0)
    v_lshlrev_b32 v36, 16, v20
    v_and_b32 v37, 0xffff0000, v20
    v_pk_add_f32 v[64:65], v[64:65], v[36:37]
    v_cvt_pk_bf16_f32 v20, v64, v65
    v_lshlrev_b32 v38, 16, v21
    v_and_b32 v39, 0xffff0000, v21
    v_pk_add_f32 v[66:67], v[66:67], v[38:39]
    v_cvt_pk_bf16_f32 v21, v66, v67
    v_lshlrev_b32 v40, 16, v22
    v_and_b32 v41, 0xffff0000, v22
    v_pk_add_f32 v[72:73], v[72:73], v[40:41]
    v_cvt_pk_bf16_f32 v22, v72, v73
    v_lshlrev_b32 v42, 16, v23
    v_and_b32 v43, 0xffff0000, v23
    v_pk_add_f32 v[74:75], v[74:75], v[42:43]
    v_cvt_pk_bf16_f32 v23, v74, v75
    v_lshlrev_b32 v36, 16, v24
    v_and_b32 v37, 0xffff0000, v24
    v_pk_add_f32 v[80:81], v[80:81], v[36:37]
    v_cvt_pk_bf16_f32 v24, v80, v81
    v_lshlrev_b32 v38, 16, v25
    v_and_b32 v39, 0xffff0000, v25
    v_pk_add_f32 v[82:83], v[82:83], v[38:39]
    v_cvt_pk_bf16_f32 v25, v82, v83
    v_lshlrev_b32 v40, 16, v26
    v_and_b32 v41, 0xffff0000, v26
    v_pk_add_f32 v[88:89], v[88:89], v[40:41]
    v_cvt_pk_bf16_f32 v26, v88, v89
    v_lshlrev_b32 v42, 16, v27
    v_and_b32 v43, 0xffff0000, v27
    v_pk_add_f32 v[90:91], v[90:91], v[42:43]
    v_cvt_pk_bf16_f32 v27, v90, v91
    v_lshlrev_b32 v36, 16, v28
    v_and_b32 v37, 0xffff0000, v28
    v_pk_add_f32 v[96:97], v[96:97], v[36:37]
    v_cvt_pk_bf16_f32 v28, v96, v97
    v_lshlrev_b32 v38, 16, v29
    v_and_b32 v39, 0xffff0000, v29
    v_pk_add_f32 v[98:99], v[98:99], v[38:39]
    v_cvt_pk_bf16_f32 v29, v98, v99
    v_lshlrev_b32 v40, 16, v30
    v_and_b32 v41, 0xffff0000, v30
    v_pk_add_f32 v[104:105], v[104:105], v[40:41]
    v_cvt_pk_bf16_f32 v30, v104, v105
    v_lshlrev_b32 v42, 16, v31
    v_and_b32 v43, 0xffff0000, v31
    v_pk_add_f32 v[106:107], v[106:107], v[42:43]
    v_cvt_pk_bf16_f32 v31, v106, v107
    v_lshlrev_b32 v36, 16, v32
    v_and_b32 v37, 0xffff0000, v32
    v_pk_add_f32 v[112:113], v[112:113], v[36:37]
    v_cvt_pk_bf16_f32 v32, v112, v113
    v_lshlrev_b32 v38, 16, v33
    v_and_b32 v39, 0xffff0000, v33
    v_pk_add_f32 v[114:115], v[114:115], v[38:39]
    v_cvt_pk_bf16_f32 v33, v114, v115
    s_cmp_eq_u32 s13, 1
    s_cbranch_scc1 L_WO_l1_257
    s_mul_i32 s44, s16, 28672
    s_add_u32 s44, s44, 23076864
    s_mul_i32 s18, s12, 14336
    s_add_u32 s44, s44, s18
    ds_write_b128 v9, v[20:23] offset:32768
    ds_write_b128 v9, v[24:27] offset:32832
    ds_write_b128 v9, v[28:31] offset:32896
    ds_write_b64 v10, v[32:33] offset:32768
    v_pk_add_f32 v[36:37], v[64:65], v[66:67]
    v_pk_add_f32 v[38:39], v[72:73], v[74:75]
    v_pk_add_f32 v[36:37], v[36:37], v[80:81]
    v_pk_add_f32 v[38:39], v[38:39], v[82:83]
    v_pk_add_f32 v[36:37], v[36:37], v[88:89]
    v_pk_add_f32 v[38:39], v[38:39], v[90:91]
    v_pk_add_f32 v[36:37], v[36:37], v[96:97]
    v_pk_add_f32 v[38:39], v[38:39], v[98:99]
    v_pk_add_f32 v[36:37], v[36:37], v[104:105]
    v_pk_add_f32 v[38:39], v[38:39], v[106:107]
    v_pk_add_f32 v[36:37], v[36:37], v[112:113]
    v_pk_add_f32 v[38:39], v[38:39], v[114:115]
    v_pk_add_f32 v[36:37], v[36:37], v[38:39]
    v_add_f32 v12, v36, v37
    v_mov_b32 v13, v12
    s_nop 1
    v_permlane16_swap_b32 v13, v12
    v_add_f32 v12, v12, v13
    v_mov_b32 v13, v12
    s_nop 1
    v_permlane32_swap_b32 v13, v12
    v_add_f32 v12, v12, v13
    v_mul_f32 v12, 0xbc124925, v12
    v_mov_b32 v40, v12
    v_mov_b32 v41, v12
    v_pk_add_f32 v[64:65], v[64:65], v[40:41]
    v_pk_add_f32 v[66:67], v[66:67], v[40:41]
    v_pk_add_f32 v[72:73], v[72:73], v[40:41]
    v_pk_add_f32 v[74:75], v[74:75], v[40:41]
    v_pk_add_f32 v[80:81], v[80:81], v[40:41]
    v_pk_add_f32 v[82:83], v[82:83], v[40:41]
    v_pk_add_f32 v[88:89], v[88:89], v[40:41]
    v_pk_add_f32 v[90:91], v[90:91], v[40:41]
    v_pk_add_f32 v[96:97], v[96:97], v[40:41]
    v_pk_add_f32 v[98:99], v[98:99], v[40:41]
    v_pk_add_f32 v[104:105], v[104:105], v[40:41]
    v_pk_add_f32 v[106:107], v[106:107], v[40:41]
    v_pk_add_f32 v[112:113], v[112:113], v[40:41]
    v_pk_add_f32 v[114:115], v[114:115], v[40:41]
    v_pk_mul_f32 v[36:37], v[64:65], v[64:65]
    v_pk_mul_f32 v[38:39], v[66:67], v[66:67]
    v_pk_fma_f32 v[36:37], v[72:73], v[72:73], v[36:37]
    v_pk_fma_f32 v[38:39], v[74:75], v[74:75], v[38:39]
    v_pk_fma_f32 v[36:37], v[80:81], v[80:81], v[36:37]
    v_pk_fma_f32 v[38:39], v[82:83], v[82:83], v[38:39]
    v_pk_fma_f32 v[36:37], v[88:89], v[88:89], v[36:37]
    v_pk_fma_f32 v[38:39], v[90:91], v[90:91], v[38:39]
    v_pk_fma_f32 v[36:37], v[96:97], v[96:97], v[36:37]
    v_pk_fma_f32 v[38:39], v[98:99], v[98:99], v[38:39]
    v_pk_fma_f32 v[36:37], v[104:105], v[104:105], v[36:37]
    v_pk_fma_f32 v[38:39], v[106:107], v[106:107], v[38:39]
    v_pk_fma_f32 v[36:37], v[112:113], v[112:113], v[36:37]
    v_pk_fma_f32 v[38:39], v[114:115], v[114:115], v[38:39]
    v_pk_add_f32 v[36:37], v[36:37], v[38:39]
    v_add_f32 v13, v36, v37
    v_mov_b32 v14, v13
    s_nop 1
    v_permlane16_swap_b32 v14, v13
    v_add_f32 v13, v13, v14
    v_mov_b32 v14, v13
    s_nop 1
    v_permlane32_swap_b32 v14, v13
    v_add_f32 v13, v13, v14
    v_sub_f32 v12, 0, v12
    s_lshl_b32 s18, s15, 3
    v_add_u32 v16, s18, v8
    ds_write_b64 v16, v[12:13]
    s_waitcnt lgkmcnt(0)
    s_barrier
    ds_read_b128 v[48:51], v68 offset:32768
    ds_read_b128 v[52:55], v69 offset:32768
    ds_read_b128 v[56:59], v70 offset:32768
    ds_read_b128 v[60:63], v71 offset:32768
    v_lshlrev_b32 v16, 4, v0
    s_waitcnt lgkmcnt(3)
    s_mov_b32 s22, s44
    buffer_store_dwordx4 v[48:51], v16, s[4:7], s22 offen sc1
    s_waitcnt lgkmcnt(2)
    s_add_u32 s22, s22, 4096
    buffer_store_dwordx4 v[52:55], v16, s[4:7], s22 offen sc1
    s_waitcnt lgkmcnt(1)
    s_add_u32 s22, s22, 4096
    buffer_store_dwordx4 v[56:59], v16, s[4:7], s22 offen sc1
    s_waitcnt lgkmcnt(0)
    v_cmp_gt_u32 vcc, 128, v0
    s_and_saveexec_b64 s[20:21], vcc
    s_add_u32 s22, s22, 4096
    buffer_store_dwordx4 v[60:63], v16, s[4:7], s22 offen sc1
    s_mov_b64 exec, s[20:21]
    ds_read_b128 v[36:39], v8
    ds_read_b128 v[40:43], v8 offset:16
    s_waitcnt lgkmcnt(0)
    v_add_f32 v14, v36, v38
    v_add_f32 v15, v40, v42
    v_add_f32 v14, v14, v15
    v_mul_f32 v14, 0.25, v14
    v_add_f32 v15, v37, v39
    v_add_f32 v16, v41, v43
    v_add_f32 v15, v15, v16
    v_mov_b32 v17, 0
    v_sub_f32 v16, v36, v14
    v_fmac_f32 v17, v16, v16
    v_sub_f32 v16, v38, v14
    v_fmac_f32 v17, v16, v16
    v_sub_f32 v16, v40, v14
    v_fmac_f32 v17, v16, v16
    v_sub_f32 v16, v42, v14
    v_fmac_f32 v17, v16, v16
    v_fmac_f32 v15, 0x42e00000, v17
    v_mov_b32 v16, 0x3727c5ac
    v_fmac_f32 v16, 0x3b124925, v15
    v_rsq_f32 v16, v16
    v_sub_f32 v18, v12, v14
    v_mul_f32 v18, v18, v16
    v_mov_b32 v17, v16
    v_mov_b32 v19, v18
    v_pk_fma_f32 v[64:65], v[64:65], v[16:17], v[18:19]
    v_cvt_pk_bf16_f32 v20, v64, v65
    v_pk_fma_f32 v[66:67], v[66:67], v[16:17], v[18:19]
    v_cvt_pk_bf16_f32 v21, v66, v67
    v_pk_fma_f32 v[72:73], v[72:73], v[16:17], v[18:19]
    v_cvt_pk_bf16_f32 v22, v72, v73
    v_pk_fma_f32 v[74:75], v[74:75], v[16:17], v[18:19]
    v_cvt_pk_bf16_f32 v23, v74, v75
    v_pk_fma_f32 v[80:81], v[80:81], v[16:17], v[18:19]
    v_cvt_pk_bf16_f32 v24, v80, v81
    v_pk_fma_f32 v[82:83], v[82:83], v[16:17], v[18:19]
    v_cvt_pk_bf16_f32 v25, v82, v83
    v_pk_fma_f32 v[88:89], v[88:89], v[16:17], v[18:19]
    v_cvt_pk_bf16_f32 v26, v88, v89
    v_pk_fma_f32 v[90:91], v[90:91], v[16:17], v[18:19]
    v_cvt_pk_bf16_f32 v27, v90, v91
    v_pk_fma_f32 v[96:97], v[96:97], v[16:17], v[18:19]
    v_cvt_pk_bf16_f32 v28, v96, v97
    v_pk_fma_f32 v[98:99], v[98:99], v[16:17], v[18:19]
    v_cvt_pk_bf16_f32 v29, v98, v99
    v_pk_fma_f32 v[104:105], v[104:105], v[16:17], v[18:19]
    v_cvt_pk_bf16_f32 v30, v104, v105
    v_pk_fma_f32 v[106:107], v[106:107], v[16:17], v[18:19]
    v_cvt_pk_bf16_f32 v31, v106, v107
    v_pk_fma_f32 v[112:113], v[112:113], v[16:17], v[18:19]
    v_cvt_pk_bf16_f32 v32, v112, v113
    v_pk_fma_f32 v[114:115], v[114:115], v[16:17], v[18:19]
    v_cvt_pk_bf16_f32 v33, v114, v115
    s_mul_i32 s44, s16, 29696
    s_add_u32 s44, s44, 21172224
    s_mul_i32 s18, s12, 14848
    s_add_u32 s44, s44, s18
    ds_write_b128 v9, v[20:23] offset:49152
    ds_write_b128 v9, v[24:27] offset:49216
    ds_write_b128 v9, v[28:31] offset:49280
    ds_write_b64 v10, v[32:33] offset:49152
    s_waitcnt lgkmcnt(0)
    s_barrier
    v_lshlrev_b32 v16, 4, v0
    ds_read_b128 v[48:51], v16 offset:49152
    v_lshlrev_b32 v16, 4, v0
    ds_read_b128 v[52:55], v16 offset:53248
    v_lshlrev_b32 v16, 4, v0
    ds_read_b128 v[56:59], v16 offset:57344
    v_lshlrev_b32 v16, 4, v0
    ds_read_b128 v[60:63], v16 offset:61440
    v_lshlrev_b32 v16, 4, v0
    s_waitcnt lgkmcnt(3)
    s_mov_b32 s22, s44
    buffer_store_dwordx4 v[48:51], v16, s[4:7], s22 offen sc1
    s_waitcnt lgkmcnt(2)
    s_add_u32 s22, s22, 4096
    buffer_store_dwordx4 v[52:55], v16, s[4:7], s22 offen sc1
    s_waitcnt lgkmcnt(1)
    s_add_u32 s22, s22, 4096
    buffer_store_dwordx4 v[56:59], v16, s[4:7], s22 offen sc1
    s_waitcnt lgkmcnt(0)
    v_cmp_gt_u32 vcc, 160, v0
    s_and_saveexec_b64 s[20:21], vcc
    s_add_u32 s22, s22, 4096
    buffer_store_dwordx4 v[60:63], v16, s[4:7], s22 offen sc1
    s_mov_b64 exec, s[20:21]
    s_cmp_eq_u32 s13, 0
    s_mov_b32 s41, 0x78fc000
    s_cselect_b32 s41, 0x78ec000, s41
    s_lshl_b32 s18, s16, 7
    s_add_u32 s41, s41, s18
    s_lshl_b32 s18, s12, 6
    s_add_u32 s41, s41, s18
    s_add_u32 s41, s41, 256
    v_mbcnt_lo_u32_b32 v12, -1, 0
    v_lshlrev_b32 v12, 2, v12
    s_mov_b32 exec_lo, -1
    s_mov_b32 exec_hi, 0
    buffer_load_dword v11, v12, s[4:7], s41 offen sc1
    s_mov_b64 exec, -1
    s_lshl_b32 s40, s16, 7
    s_add_u32 s40, s40, 126869504
    s_waitcnt vmcnt(0)
    s_barrier
    s_cmp_lg_u32 s15, 0
    s_cbranch_scc1 L_sig_259
    v_mov_b32 v12, 1
    s_lshl_b32 s18, s12, 2
    v_mov_b32 v13, s18
    s_mov_b64 exec, 1
    buffer_store_dword v12, v13, s[4:7], s40 offen sc1
    s_mov_b64 exec, -1
L_sig_259:
    s_branch L_WO_j_258
L_WO_l1_257:
    s_mul_i32 s44, s16, 28672
    buffer_store_dwordx4 v[20:23], v6, s[8:11], s44 offen offset:0
    buffer_store_dwordx4 v[24:27], v6, s[8:11], s44 offen offset:64
    buffer_store_dwordx4 v[28:31], v6, s[8:11], s44 offen offset:128
    buffer_store_dwordx2 v[32:33], v7, s[8:11], s44 offen
    s_cmp_eq_u32 s13, 0
    s_mov_b32 s41, 0x78fc000
    s_cselect_b32 s41, 0x78ec000, s41
    s_lshl_b32 s18, s16, 7
    s_add_u32 s41, s41, s18
    s_lshl_b32 s18, s12, 6
    s_add_u32 s41, s41, s18
    s_add_u32 s41, s41, 256
    v_mbcnt_lo_u32_b32 v12, -1, 0
    v_lshlrev_b32 v12, 2, v12
    s_mov_b32 exec_lo, -1
    s_mov_b32 exec_hi, 0
    buffer_load_dword v11, v12, s[4:7], s41 offen sc1
    s_mov_b64 exec, -1
    s_waitcnt vmcnt(0)
    s_barrier
L_WO_j_258:
    s_add_u32 s16, s16, 2
    s_cmp_lt_u32 s16, 64
    s_cbranch_scc1 L_WO_loop
    s_branch L_role_done
L_fail:
    v_mov_b32 v2, 0x100
    v_mov_b32 v3, 1
    v_mov_b32 v5, 36
    s_mov_b64 exec, 1
    global_atomic_add v5, v3, s[36:37]
    s_mov_b64 exec, -1
L_role_done:
    s_waitcnt vmcnt(0)
L_end:
    s_endpgm
.section .rodata,"a"
.p2align 6
.amdhsa_kernel interleave_layers__memory_aug_recurrent_mem_tr__sliding_block__prompt_kernel
  .amdhsa_next_free_vgpr 512
  .amdhsa_next_free_sgpr 102
  .amdhsa_accum_offset 256
  .amdhsa_group_segment_fixed_size 0
  .amdhsa_kernarg_size 104
  .amdhsa_user_sgpr_count 2
  .amdhsa_user_sgpr_kernarg_segment_ptr 1
  .amdhsa_system_sgpr_workgroup_id_x 1
.end_amdhsa_kernel
```
